```python
import torch

def _softmax(x, axis=-1):
    return torch.softmax(x, dim=axis)

def _gelu(x):
    return torch.nn.functional.gelu(x, approximate='tanh')

def _silu(x):
    return torch.nn.functional.silu(x)

def _sigmoid(x):
    return torch.sigmoid(x)

def _layernorm(x, axis=-1, eps=1e-05):
    m = x.mean(dim=axis, keepdim=True)
    v = x.var(dim=axis, keepdim=True, unbiased=False)
    return (x - m) / torch.sqrt(v + eps)

def _scatter_add(tgt, idx, src, axis=0):
    return tgt.clone().index_add_(axis, idx, src)

def _segment_sum(src, seg, n):
    out = torch.zeros((n,) + src.shape[1:], dtype=src.dtype)
    return out.index_add_(0, seg, src)

def _pad(x, pw):
    flat = tuple((v for pair in reversed(pw) for v in pair))
    return torch.nn.functional.pad(x, flat)
kernel_name = 'interleave_layers__sliding_block__memory_aug_recurrent_mem_tr__prompt'

def setup_inputs():

    _w = lambda a: (lambda t: t.to(torch.bfloat16) if t.is_floating_point() else t)(torch.as_tensor(a))

    def _A_setup():
        B, S, D = (1, 2048, 512)
        return {'x': _w((lambda *s: torch.randn(*s, dtype=torch.bfloat16) * 0.05)(B, S, D)), 'wqkv': _w((lambda *s: torch.randn(*s, dtype=torch.bfloat16) * 0.05)(D, 3 * D)), 'wo': _w((lambda *s: torch.randn(*s, dtype=torch.bfloat16) * 0.05)(D, D))}
    _A_in = _A_setup()

    def _B_setup():
        B, S, Dm = (1, 2048, 512)
        H, Dh = (32, 128)
        M, seg = (8, 32)
        seg = min(seg, S)
        S = S // seg * seg
        return {'x': _w((lambda *s: torch.randn(*s, dtype=torch.bfloat16) * 0.05)(B, S, Dm)), 'mem0': _w((lambda *s: torch.randn(*s, dtype=torch.bfloat16) * 0.8)(B, M, Dm)), 'Wq': _w((lambda *s: torch.randn(*s, dtype=torch.bfloat16) * 1.6)(Dm, H, Dh) * Dm ** (-0.5)), 'Wk': _w((lambda *s: torch.randn(*s, dtype=torch.bfloat16) * 1.6)(Dm, H, Dh) * Dm ** (-0.5)), 'Wv': _w((lambda *s: torch.randn(*s, dtype=torch.bfloat16) * 0.8)(Dm, H, Dh) * Dm ** (-0.5)), 'Wo': _w((lambda *s: torch.randn(*s, dtype=torch.bfloat16) * 0.8)(H, Dh, Dm) * (H * Dh) ** (-0.5)), 'seg_len': seg}
    _B_in = _B_setup()
    return {'A_x': _A_in['x'], 'A_wqkv': _A_in['wqkv'], 'A_wo': _A_in['wo'], 'B_x': _B_in['x'], 'B_mem0': _B_in['mem0'], 'B_Wq': _B_in['Wq'], 'B_Wk': _B_in['Wk'], 'B_Wv': _B_in['Wv'], 'B_Wo': _B_in['Wo'], 'B_seg_len': _B_in['seg_len']}

def reference(A_x, A_wqkv, A_wo, B_x, B_mem0, B_Wq, B_Wk, B_Wv, B_Wo, B_seg_len):

    def _A_ref(x, wqkv, wo):
        B, S, D = x.shape
        H = 32
        Dh = D // H
        W = 256
        qkv = (lambda x, *d: x.permute(*d))((x @ wqkv).reshape(B, S, 3, H, Dh), 2, 0, 3, 1, 4)
        q, k, v = (qkv[0], qkv[1], qkv[2])
        scores = torch.einsum('bhqd,bhkd->bhqk', q, k) * Dh ** (-0.5)
        idx = torch.arange(S)
        mask = (idx[:, None] - idx[None, :] >= 0) & (idx[:, None] - idx[None, :] < W)
        scores = torch.where(mask[None, None], scores, -1000000000.0)
        p = _softmax(scores, axis=-1)
        o = torch.einsum('bhqk,bhkd->bhqd', p, v)
        return (lambda x, *d: x.permute(*d))(o, 0, 2, 1, 3).reshape(B, S, D) @ wo

    def _B_ref(x, mem0, Wq, Wk, Wv, Wo, seg_len):
        B, S, Dm = x.shape
        H, Dh = (Wq.shape[1], Wq.shape[2])
        M = mem0.shape[1]
        scale = Dh ** (-0.5)
        n_seg = S // seg_len
        L = M + seg_len
        idx = torch.arange(L)
        mask = (idx[:, None] < M) | (idx[:, None] >= idx[None, :])
        mem = mem0
        outs = []
        for s in range(n_seg):
            xs = x[:, s * seg_len:(s + 1) * seg_len, :].clone()
            h = torch.concatenate([mem, xs], axis=1)
            q = torch.einsum('btd,dhe->bhte', h, Wq)
            k = torch.einsum('btd,dhe->bhte', h, Wk)
            v = torch.einsum('btd,dhe->bhte', h, Wv)
            scores = torch.einsum('bhqe,bhke->bhqk', q, k) * scale
            scores = torch.where(mask[None, None], scores, -1000000000.0)
            p = _softmax(scores, axis=-1)
            o = torch.einsum('bhqk,bhke->bhqe', p, v)
            o = torch.einsum('bhte,hed->btd', o, Wo)
            mem = o[:, :M, :].clone()
            outs.append(o[:, M:, :])
        return torch.concatenate(outs, axis=1)
    x = A_x
    x = x + _A_ref(_layernorm(x, axis=-1), A_wqkv, A_wo)
    x = x + _B_ref(_layernorm(x, axis=-1), B_mem0, B_Wq, B_Wk, B_Wv, B_Wo, B_seg_len)
    x = x + _A_ref(_layernorm(x, axis=-1), A_wqkv, A_wo)
    x = x + _B_ref(_layernorm(x, axis=-1), B_mem0, B_Wq, B_Wk, B_Wv, B_Wo, B_seg_len)
    return x
```

```asm
; @launch grid=(256,1,1) block=(256,1,1) lds=163840
.amdgcn_target "amdgcn-amd-amdhsa--gfx950"
.text
.globl interleave_layers__sliding_block__memory_aug_recurrent_mem_tr__prompt_kernel
.p2align 8
.type interleave_layers__sliding_block__memory_aug_recurrent_mem_tr__prompt_kernel,@function
interleave_layers__sliding_block__memory_aug_recurrent_mem_tr__prompt_kernel:
    s_cmp_ge_u32 s2, 256
    s_cbranch_scc1 L_end
    s_load_dwordx2 s[8:9], s[0:1], 96
    s_load_dwordx2 s[12:13], s[0:1], 88
    s_getreg_b32 s3, hwreg(HW_REG_XCC_ID, 0, 4)
    v_lshrrev_b32 v1, 6, v0
    s_nop 0
    v_readfirstlane_b32 s6, v1
    v_and_b32 v0, 63, v0
    s_waitcnt lgkmcnt(0)
    s_mov_b32 s10, 0x10000000
    s_mov_b32 s11, 0x20000
    s_mov_b32 s14, 256
    s_mov_b32 s15, 0x20000
    s_mul_i32 s24, s2, 1280
    s_add_u32 s24, s24, 205520896
    v_lshlrev_b32 v2, 4, v0
    s_lshl_b32 s25, s6, 10
    v_add_u32 v2, s25, v2
    v_mov_b32 v4, 0
    v_mov_b32 v5, 0
    v_mov_b32 v6, 0
    v_mov_b32 v7, 0
    v_cmp_gt_u32 vcc, 1280, v2
    s_and_saveexec_b64 s[26:27], vcc
    s_cbranch_execz L_si0
    buffer_store_dwordx4 v[4:7], v2, s[8:11], s24 offen sc1
L_si0:
    s_mov_b64 exec, s[26:27]
    s_waitcnt vmcnt(0)
    s_barrier
    s_cmp_lg_u32 s6, 0
    s_cbranch_scc1 L_claimed
    v_mov_b32 v3, 1
    s_and_b32 s24, s3, 1
    s_lshl_b32 s24, s24, 7
    s_lshr_b32 s25, s3, 1
    s_lshl_b32 s25, s25, 2
    s_add_u32 s24, s24, s25
    v_mov_b32 v4, s24
    s_mov_b64 exec, 1
    buffer_atomic_add v3, v4, s[12:15], 0 offen sc0
    s_waitcnt vmcnt(0)
    v_mov_b32 v5, 0
    ds_write_b32 v5, v3
    s_waitcnt lgkmcnt(0)
    s_mov_b64 exec, -1
L_claimed:
    s_barrier
    v_mov_b32 v5, 0
    ds_read_b32 v3, v5
    s_waitcnt lgkmcnt(0)
    v_readfirstlane_b32 s5, v3
    s_barrier
    s_cmp_ge_u32 s5, 32
    s_cbranch_scc1 L_end
    s_cmp_lt_u32 s3, 2
    s_cbranch_scc1 L_CH
    s_cmp_lt_u32 s3, 4
    s_cbranch_scc1 L_P
    s_cmp_eq_u32 s3, 4
    s_cbranch_scc1 L_ATT
    s_cmp_eq_u32 s3, 5
    s_cbranch_scc1 L_O
    s_cmp_eq_u32 s3, 6
    s_cbranch_scc1 L_AH
    s_cmp_lt_u32 s5, 8
    s_cbranch_scc1 L_AWO
    s_branch L_F
L_fail:
    s_load_dwordx2 s[12:13], s[0:1], 88
    s_waitcnt lgkmcnt(0)
    s_mov_b32 s14, 256
    s_mov_b32 s15, 0x20000
    s_lshl_b32 s24, s3, 2
    s_add_u32 s24, s24, 32
    v_mov_b32 v4, s24
    s_add_u32 s25, s5, 1
    v_mov_b32 v3, s25
    s_mov_b64 exec, 1
    buffer_store_dword v3, v4, s[12:15], 0 offen
L_end:
    s_endpgm
L_F:
    s_sub_u32 s5, s5, 8
    s_lshr_b32 s7, s5, 2
    s_and_b32 s5, s5, 3
    s_mov_b32 s4, 0
    s_cmp_eq_u32 s7, 0
    s_cbranch_scc1 L_F0
    s_cmp_eq_u32 s7, 2
    s_cbranch_scc1 L_F2
    s_cmp_eq_u32 s7, 4
    s_cbranch_scc1 L_F3
    s_mov_b32 s4, 1
    s_cmp_eq_u32 s7, 5
    s_cbranch_scc1 L_F2
    s_lshr_b32 s4, s7, 1
LB_FT1:
    v_and_b32 v1, 7, v0
    v_bfe_u32 v2, v0, 3, 1
    v_lshrrev_b32 v3, 4, v0
    v_lshlrev_b32 v4, 4, v1
    v_lshl_add_u32 v4, v2, 9, v4
    v_lshl_add_u32 v4, v3, 10, v4
    s_lshl_b32 s12, s6, 13
    s_lshl_b32 s13, s5, 7
    s_add_u32 s12, s12, s13
    v_add_u32 v4, s12, v4
    s_lshl_b32 s13, s5, 3
    v_add_u32 v5, s13, v1
    v_lshlrev_b32 v5, 10, v5
    v_lshl_add_u32 v5, v3, 5, v5
    v_lshl_add_u32 v5, v2, 4, v5
    s_lshl_b32 s13, s6, 8
    v_add_u32 v5, s13, v5
    v_lshlrev_b32 v6, 3, v1
    s_lshl_b32 s13, s6, 6
    v_add_u32 v7, s13, v6
    s_mul_i32 s13, s4, 12582912
    s_add_u32 s20, s13, 167772160
    s_add_u32 s21, s13, 174063616
    s_add_u32 s22, s13, 176160768
    s_add_u32 s23, s13, 178257920
    s_lshl_b32 s13, s4, 14
    s_add_u32 s24, s13, 205725696
    s_lshl_b32 s13, s4, 13
    s_add_u32 s25, s13, 205766656
    s_lshl_b32 s13, s5, 4
    s_lshl_b32 s14, s6, 2
    s_add_u32 s13, s13, s14
    s_add_u32 s24, s24, s13
    s_mov_b32 s26, 0
    v_mov_b32 v8, 0x3f803f80
    s_mov_b32 s27, 0xffff0000
    s_mov_b32 s30, 0
    s_mov_b32 s31, 0
    s_load_dwordx2 s[92:93], s[0:1], 88
    s_waitcnt lgkmcnt(0)
    s_mov_b32 s94, 256
    s_mov_b32 s95, 0x20000
    s_mov_b32 s96, 0
FT1_1_iw:
    v_mbcnt_lo_u32_b32 v9, -1, 0
    v_mbcnt_hi_u32_b32 v9, -1, v9
    v_min_u32 v9, 7, v9
    v_and_b32 v10, 1, v9
    v_lshlrev_b32 v10, 7, v10
    v_lshrrev_b32 v9, 1, v9
    v_lshl_add_u32 v9, v9, 2, v10
    buffer_load_dword v9, v9, s[92:95], 0 offen sc1
    s_waitcnt vmcnt(0)
    v_cmp_gt_u32 vcc, 32, v9
    s_cmp_eq_u64 vcc, 0
    s_cselect_b32 s97, 256, 0
    s_cmp_ge_u32 s97, 256
    s_cbranch_scc1 FT1_1_iwd
    s_add_u32 s96, s96, 1
    s_cmp_gt_u32 s96, 300000
    s_cbranch_scc1 L_fail
    s_sleep 2
    s_branch FT1_1_iw
FT1_1_iwd:
    s_mov_b32 s96, 0
    v_mbcnt_lo_u32_b32 v250, -1, 0
    v_mbcnt_hi_u32_b32 v250, -1, v250
    v_min_u32 v250, 15, v250
    v_lshlrev_b32 v250, 2, v250
FT1_1w0_2_spin:
    buffer_load_dword v251, v250, s[8:11], s25 offen sc1
    s_waitcnt vmcnt(0)
    v_cmp_eq_u32 vcc, 0, v251
    s_cbranch_vccz FT1_1w0_2_ok
    s_add_u32 s96, s96, 1
    s_cmp_gt_u32 s96, 300000
    s_cbranch_scc1 L_fail
    s_sleep 1
    s_branch FT1_1w0_2_spin
FT1_1w0_2_ok:
    s_add_u32 s13, s21, 0
    buffer_load_dwordx4 v[24:27], v4, s[8:11], s13 offen sc1
    s_add_u32 s13, s21, 4096
    buffer_load_dwordx4 v[28:31], v4, s[8:11], s13 offen sc1
    s_add_u32 s13, s20, 0
    buffer_load_dwordx4 v[16:19], v4, s[8:11], s13 offen sc1
    s_add_u32 s13, s20, 4096
    buffer_load_dwordx4 v[20:23], v4, s[8:11], s13 offen sc1
    s_add_u32 s20, s20, 32768
    s_add_u32 s21, s21, 32768
    s_add_u32 s25, s25, 128
FT1_1_i0:
    v_mbcnt_lo_u32_b32 v10, -1, 0
    v_mbcnt_hi_u32_b32 v10, -1, v10
    v_min_u32 v10, 15, v10
    v_lshlrev_b32 v10, 2, v10
    buffer_load_dword v9, v10, s[8:11], s25 offen sc1
    s_cmp_eq_u32 s31, 0
    s_cbranch_scc1 FT1_1_i0_w1
    s_waitcnt vmcnt(5)
    s_branch FT1_1_i0_w2
FT1_1_i0_w1:
    s_waitcnt vmcnt(1)
FT1_1_i0_w2:
    v_lshlrev_b32 v112, 16, v24
    v_and_b32 v113, s27, v24
    v_lshlrev_b32 v12, 16, v16
    v_and_b32 v13, s27, v16
    v_pk_add_f32 v[112:113], v[112:113], v[12:13]
    v_cvt_pk_bf16_f32 v16, v112, v113
    v_lshlrev_b32 v114, 16, v25
    v_and_b32 v115, s27, v25
    v_lshlrev_b32 v12, 16, v17
    v_and_b32 v13, s27, v17
    v_pk_add_f32 v[114:115], v[114:115], v[12:13]
    v_cvt_pk_bf16_f32 v17, v114, v115
    v_lshlrev_b32 v116, 16, v26
    v_and_b32 v117, s27, v26
    v_lshlrev_b32 v12, 16, v18
    v_and_b32 v13, s27, v18
    v_pk_add_f32 v[116:117], v[116:117], v[12:13]
    v_cvt_pk_bf16_f32 v18, v116, v117
    v_lshlrev_b32 v118, 16, v27
    v_and_b32 v119, s27, v27
    v_lshlrev_b32 v12, 16, v19
    v_and_b32 v13, s27, v19
    v_pk_add_f32 v[118:119], v[118:119], v[12:13]
    v_cvt_pk_bf16_f32 v19, v118, v119
    v_lshlrev_b32 v120, 16, v28
    v_and_b32 v121, s27, v28
    v_lshlrev_b32 v12, 16, v20
    v_and_b32 v13, s27, v20
    v_pk_add_f32 v[120:121], v[120:121], v[12:13]
    v_cvt_pk_bf16_f32 v20, v120, v121
    v_lshlrev_b32 v122, 16, v29
    v_and_b32 v123, s27, v29
    v_lshlrev_b32 v12, 16, v21
    v_and_b32 v13, s27, v21
    v_pk_add_f32 v[122:123], v[122:123], v[12:13]
    v_cvt_pk_bf16_f32 v21, v122, v123
    v_lshlrev_b32 v124, 16, v30
    v_and_b32 v125, s27, v30
    v_lshlrev_b32 v12, 16, v22
    v_and_b32 v13, s27, v22
    v_pk_add_f32 v[124:125], v[124:125], v[12:13]
    v_cvt_pk_bf16_f32 v22, v124, v125
    v_lshlrev_b32 v126, 16, v31
    v_and_b32 v127, s27, v31
    v_lshlrev_b32 v12, 16, v23
    v_and_b32 v13, s27, v23
    v_pk_add_f32 v[126:127], v[126:127], v[12:13]
    v_cvt_pk_bf16_f32 v23, v126, v127
    s_waitcnt vmcnt(0)
    s_mov_b32 s31, 0
    s_cmp_ge_u32 s26, 63
    s_cbranch_scc1 FT1_1_i0_np
    v_cmp_eq_u32 vcc, 0, v9
    s_cbranch_vccnz FT1_1_i0_np
    s_mov_b32 s31, 1
    s_add_u32 s13, s21, 0
    buffer_load_dwordx4 v[72:75], v4, s[8:11], s13 offen sc1
    s_add_u32 s13, s21, 4096
    buffer_load_dwordx4 v[76:79], v4, s[8:11], s13 offen sc1
    s_add_u32 s13, s20, 0
    buffer_load_dwordx4 v[64:67], v4, s[8:11], s13 offen sc1
    s_add_u32 s13, s20, 4096
    buffer_load_dwordx4 v[68:71], v4, s[8:11], s13 offen sc1
    s_add_u32 s20, s20, 32768
    s_add_u32 s21, s21, 32768
    s_add_u32 s25, s25, 128
FT1_1_i0_np:
    s_add_u32 s13, s22, 4096
    buffer_store_dwordx4 v[16:19], v4, s[8:11], s22 offen sc1
    buffer_store_dwordx4 v[20:23], v4, s[8:11], s13 offen sc1
    v_mov_b32 v12, 0
    v_mov_b32 v13, 0
    v_mov_b32 v14, 0
    v_mov_b32 v15, 0
    v_dot2_f32_bf16 v12, v16, v8, v12
    v_dot2_f32_bf16 v13, v16, v16, v13
    v_dot2_f32_bf16 v14, v17, v8, v14
    v_dot2_f32_bf16 v15, v17, v17, v15
    v_dot2_f32_bf16 v12, v18, v8, v12
    v_dot2_f32_bf16 v13, v18, v18, v13
    v_dot2_f32_bf16 v14, v19, v8, v14
    v_dot2_f32_bf16 v15, v19, v19, v15
    v_dot2_f32_bf16 v12, v20, v8, v12
    v_dot2_f32_bf16 v13, v20, v20, v13
    v_dot2_f32_bf16 v14, v21, v8, v14
    v_dot2_f32_bf16 v15, v21, v21, v15
    v_dot2_f32_bf16 v12, v22, v8, v12
    v_dot2_f32_bf16 v13, v22, v22, v13
    v_dot2_f32_bf16 v14, v23, v8, v14
    v_dot2_f32_bf16 v15, v23, v23, v15
    s_nop 2
    v_pk_add_f32 v[12:13], v[12:13], v[14:15]
    s_nop 1
    v_add_f32_dpp v12, v12, v12 row_ror:8 row_mask:0xf bank_mask:0xf
    v_add_f32_dpp v13, v13, v13 row_ror:8 row_mask:0xf bank_mask:0xf
    v_mov_b32 v10, v12
    v_mov_b32 v11, v13
    s_nop 0
    v_permlane16_swap_b32 v12, v10
    v_permlane16_swap_b32 v13, v11
    v_pk_add_f32 v[12:13], v[12:13], v[10:11]
    v_mov_b32 v10, v12
    v_mov_b32 v11, v13
    s_nop 0
    v_permlane32_swap_b32 v12, v10
    v_permlane32_swap_b32 v13, v11
    v_pk_add_f32 v[12:13], v[12:13], v[10:11]
    s_mov_b64 exec, 0xff
    ds_write_b64 v7, v[12:13] offset:0
    s_mov_b64 exec, -1
    s_waitcnt lgkmcnt(0)
    s_barrier
    ds_read_b64 v[10:11], v6 offset:0
    ds_read_b64 v[12:13], v6 offset:64
    ds_read_b64 v[14:15], v6 offset:128
    ds_read_b64 v[112:113], v6 offset:192
    s_waitcnt lgkmcnt(0)
    v_pk_add_f32 v[10:11], v[10:11], v[12:13]
    v_pk_add_f32 v[14:15], v[14:15], v[112:113]
    v_pk_add_f32 v[10:11], v[10:11], v[14:15]
    v_mul_f32 v10, 0x3b000000, v10
    v_mul_f32 v11, 0x3b000000, v11
    v_fma_f32 v11, -v10, v10, v11
    v_max_f32 v11, 0, v11
    v_cvt_pk_bf16_f32 v14, v10, v11
    v_lshlrev_b32 v12, 16, v14
    v_and_b32 v11, s27, v14
    v_add_f32 v11, 0x3727c5ac, v11
    v_cvt_pk_bf16_f32 v11, v11, v11
    v_and_b32 v11, s27, v11
    v_sqrt_f32 v11, v11
    v_mov_b32 v13, v12
    v_cvt_pk_bf16_f32 v11, v11, v11
    v_and_b32 v11, s27, v11
    v_rcp_f32 v14, v11
    s_nop 0
    v_mov_b32 v15, v14
    v_lshlrev_b32 v112, 16, v16
    v_and_b32 v113, s27, v16
    v_pk_add_f32 v[112:113], v[112:113], v[12:13] neg_lo:[0,1] neg_hi:[0,1]
    v_cvt_pk_bf16_f32 v24, v112, v113
    v_lshlrev_b32 v112, 16, v24
    v_and_b32 v113, s27, v24
    v_pk_mul_f32 v[112:113], v[112:113], v[14:15]
    v_cvt_pk_bf16_f32 v24, v112, v113
    v_lshlrev_b32 v114, 16, v17
    v_and_b32 v115, s27, v17
    v_pk_add_f32 v[114:115], v[114:115], v[12:13] neg_lo:[0,1] neg_hi:[0,1]
    v_cvt_pk_bf16_f32 v25, v114, v115
    v_lshlrev_b32 v114, 16, v25
    v_and_b32 v115, s27, v25
    v_pk_mul_f32 v[114:115], v[114:115], v[14:15]
    v_cvt_pk_bf16_f32 v25, v114, v115
    v_lshlrev_b32 v116, 16, v18
    v_and_b32 v117, s27, v18
    v_pk_add_f32 v[116:117], v[116:117], v[12:13] neg_lo:[0,1] neg_hi:[0,1]
    v_cvt_pk_bf16_f32 v26, v116, v117
    v_lshlrev_b32 v116, 16, v26
    v_and_b32 v117, s27, v26
    v_pk_mul_f32 v[116:117], v[116:117], v[14:15]
    v_cvt_pk_bf16_f32 v26, v116, v117
    v_lshlrev_b32 v118, 16, v19
    v_and_b32 v119, s27, v19
    v_pk_add_f32 v[118:119], v[118:119], v[12:13] neg_lo:[0,1] neg_hi:[0,1]
    v_cvt_pk_bf16_f32 v27, v118, v119
    v_lshlrev_b32 v118, 16, v27
    v_and_b32 v119, s27, v27
    v_pk_mul_f32 v[118:119], v[118:119], v[14:15]
    v_cvt_pk_bf16_f32 v27, v118, v119
    v_lshlrev_b32 v120, 16, v20
    v_and_b32 v121, s27, v20
    v_pk_add_f32 v[120:121], v[120:121], v[12:13] neg_lo:[0,1] neg_hi:[0,1]
    v_cvt_pk_bf16_f32 v28, v120, v121
    v_lshlrev_b32 v120, 16, v28
    v_and_b32 v121, s27, v28
    v_pk_mul_f32 v[120:121], v[120:121], v[14:15]
    v_cvt_pk_bf16_f32 v28, v120, v121
    v_lshlrev_b32 v122, 16, v21
    v_and_b32 v123, s27, v21
    v_pk_add_f32 v[122:123], v[122:123], v[12:13] neg_lo:[0,1] neg_hi:[0,1]
    v_cvt_pk_bf16_f32 v29, v122, v123
    v_lshlrev_b32 v122, 16, v29
    v_and_b32 v123, s27, v29
    v_pk_mul_f32 v[122:123], v[122:123], v[14:15]
    v_cvt_pk_bf16_f32 v29, v122, v123
    v_lshlrev_b32 v124, 16, v22
    v_and_b32 v125, s27, v22
    v_pk_add_f32 v[124:125], v[124:125], v[12:13] neg_lo:[0,1] neg_hi:[0,1]
    v_cvt_pk_bf16_f32 v30, v124, v125
    v_lshlrev_b32 v124, 16, v30
    v_and_b32 v125, s27, v30
    v_pk_mul_f32 v[124:125], v[124:125], v[14:15]
    v_cvt_pk_bf16_f32 v30, v124, v125
    v_lshlrev_b32 v126, 16, v23
    v_and_b32 v127, s27, v23
    v_pk_add_f32 v[126:127], v[126:127], v[12:13] neg_lo:[0,1] neg_hi:[0,1]
    v_cvt_pk_bf16_f32 v31, v126, v127
    v_lshlrev_b32 v126, 16, v31
    v_and_b32 v127, s27, v31
    v_pk_mul_f32 v[126:127], v[126:127], v[14:15]
    v_cvt_pk_bf16_f32 v31, v126, v127
    s_add_u32 s13, s23, 4096
    buffer_store_dwordx4 v[24:27], v4, s[8:11], s23 offen sc1
    buffer_store_dwordx4 v[28:31], v4, s[8:11], s13 offen sc1
    s_add_u32 s22, s22, 32768
    s_add_u32 s23, s23, 32768
    s_waitcnt vmcnt(0)
    v_mov_b32 v251, 1
    v_mov_b32 v250, 0
    s_mov_b64 exec, 1
    buffer_store_dword v251, v250, s[8:11], s24 offen sc1
    s_mov_b64 exec, -1
    s_add_u32 s24, s24, 128
    s_add_u32 s26, s26, 1
    s_cmp_eq_u32 s31, 1
    s_cbranch_scc0 FT1_1_i0_slow
    s_mov_b32 s31, 0
    s_branch FT1_1_i1
FT1_1_i0_slow:
    s_cmp_ge_u32 s26, 64
    s_cbranch_scc1 FT1_1_done
    s_mov_b32 s96, 0
    v_mbcnt_lo_u32_b32 v250, -1, 0
    v_mbcnt_hi_u32_b32 v250, -1, v250
    v_min_u32 v250, 15, v250
    v_lshlrev_b32 v250, 2, v250
FT1_1_i0ws_3_spin:
    buffer_load_dword v251, v250, s[8:11], s25 offen sc1
    s_waitcnt vmcnt(0)
    v_cmp_eq_u32 vcc, 0, v251
    s_cbranch_vccz FT1_1_i0ws_3_ok
    s_add_u32 s96, s96, 1
    s_cmp_gt_u32 s96, 300000
    s_cbranch_scc1 L_fail
    s_sleep 1
    s_branch FT1_1_i0ws_3_spin
FT1_1_i0ws_3_ok:
    s_add_u32 s13, s21, 0
    buffer_load_dwordx4 v[72:75], v4, s[8:11], s13 offen sc1
    s_add_u32 s13, s21, 4096
    buffer_load_dwordx4 v[76:79], v4, s[8:11], s13 offen sc1
    s_add_u32 s13, s20, 0
    buffer_load_dwordx4 v[64:67], v4, s[8:11], s13 offen sc1
    s_add_u32 s13, s20, 4096
    buffer_load_dwordx4 v[68:71], v4, s[8:11], s13 offen sc1
    s_add_u32 s20, s20, 32768
    s_add_u32 s21, s21, 32768
    s_add_u32 s25, s25, 128
FT1_1_i1:
    v_mbcnt_lo_u32_b32 v10, -1, 0
    v_mbcnt_hi_u32_b32 v10, -1, v10
    v_min_u32 v10, 15, v10
    v_lshlrev_b32 v10, 2, v10
    buffer_load_dword v9, v10, s[8:11], s25 offen sc1
    s_cmp_eq_u32 s31, 0
    s_cbranch_scc1 FT1_1_i1_w1
    s_waitcnt vmcnt(5)
    s_branch FT1_1_i1_w2
FT1_1_i1_w1:
    s_waitcnt vmcnt(1)
FT1_1_i1_w2:
    v_lshlrev_b32 v112, 16, v72
    v_and_b32 v113, s27, v72
    v_lshlrev_b32 v12, 16, v64
    v_and_b32 v13, s27, v64
    v_pk_add_f32 v[112:113], v[112:113], v[12:13]
    v_cvt_pk_bf16_f32 v64, v112, v113
    v_lshlrev_b32 v114, 16, v73
    v_and_b32 v115, s27, v73
    v_lshlrev_b32 v12, 16, v65
    v_and_b32 v13, s27, v65
    v_pk_add_f32 v[114:115], v[114:115], v[12:13]
    v_cvt_pk_bf16_f32 v65, v114, v115
    v_lshlrev_b32 v116, 16, v74
    v_and_b32 v117, s27, v74
    v_lshlrev_b32 v12, 16, v66
    v_and_b32 v13, s27, v66
    v_pk_add_f32 v[116:117], v[116:117], v[12:13]
    v_cvt_pk_bf16_f32 v66, v116, v117
    v_lshlrev_b32 v118, 16, v75
    v_and_b32 v119, s27, v75
    v_lshlrev_b32 v12, 16, v67
    v_and_b32 v13, s27, v67
    v_pk_add_f32 v[118:119], v[118:119], v[12:13]
    v_cvt_pk_bf16_f32 v67, v118, v119
    v_lshlrev_b32 v120, 16, v76
    v_and_b32 v121, s27, v76
    v_lshlrev_b32 v12, 16, v68
    v_and_b32 v13, s27, v68
    v_pk_add_f32 v[120:121], v[120:121], v[12:13]
    v_cvt_pk_bf16_f32 v68, v120, v121
    v_lshlrev_b32 v122, 16, v77
    v_and_b32 v123, s27, v77
    v_lshlrev_b32 v12, 16, v69
    v_and_b32 v13, s27, v69
    v_pk_add_f32 v[122:123], v[122:123], v[12:13]
    v_cvt_pk_bf16_f32 v69, v122, v123
    v_lshlrev_b32 v124, 16, v78
    v_and_b32 v125, s27, v78
    v_lshlrev_b32 v12, 16, v70
    v_and_b32 v13, s27, v70
    v_pk_add_f32 v[124:125], v[124:125], v[12:13]
    v_cvt_pk_bf16_f32 v70, v124, v125
    v_lshlrev_b32 v126, 16, v79
    v_and_b32 v127, s27, v79
    v_lshlrev_b32 v12, 16, v71
    v_and_b32 v13, s27, v71
    v_pk_add_f32 v[126:127], v[126:127], v[12:13]
    v_cvt_pk_bf16_f32 v71, v126, v127
    s_waitcnt vmcnt(0)
    s_mov_b32 s31, 0
    s_cmp_ge_u32 s26, 63
    s_cbranch_scc1 FT1_1_i1_np
    v_cmp_eq_u32 vcc, 0, v9
    s_cbranch_vccnz FT1_1_i1_np
    s_mov_b32 s31, 1
    s_add_u32 s13, s21, 0
    buffer_load_dwordx4 v[24:27], v4, s[8:11], s13 offen sc1
    s_add_u32 s13, s21, 4096
    buffer_load_dwordx4 v[28:31], v4, s[8:11], s13 offen sc1
    s_add_u32 s13, s20, 0
    buffer_load_dwordx4 v[16:19], v4, s[8:11], s13 offen sc1
    s_add_u32 s13, s20, 4096
    buffer_load_dwordx4 v[20:23], v4, s[8:11], s13 offen sc1
    s_add_u32 s20, s20, 32768
    s_add_u32 s21, s21, 32768
    s_add_u32 s25, s25, 128
FT1_1_i1_np:
    s_add_u32 s13, s22, 4096
    buffer_store_dwordx4 v[64:67], v4, s[8:11], s22 offen sc1
    buffer_store_dwordx4 v[68:71], v4, s[8:11], s13 offen sc1
    v_mov_b32 v12, 0
    v_mov_b32 v13, 0
    v_mov_b32 v14, 0
    v_mov_b32 v15, 0
    v_dot2_f32_bf16 v12, v64, v8, v12
    v_dot2_f32_bf16 v13, v64, v64, v13
    v_dot2_f32_bf16 v14, v65, v8, v14
    v_dot2_f32_bf16 v15, v65, v65, v15
    v_dot2_f32_bf16 v12, v66, v8, v12
    v_dot2_f32_bf16 v13, v66, v66, v13
    v_dot2_f32_bf16 v14, v67, v8, v14
    v_dot2_f32_bf16 v15, v67, v67, v15
    v_dot2_f32_bf16 v12, v68, v8, v12
    v_dot2_f32_bf16 v13, v68, v68, v13
    v_dot2_f32_bf16 v14, v69, v8, v14
    v_dot2_f32_bf16 v15, v69, v69, v15
    v_dot2_f32_bf16 v12, v70, v8, v12
    v_dot2_f32_bf16 v13, v70, v70, v13
    v_dot2_f32_bf16 v14, v71, v8, v14
    v_dot2_f32_bf16 v15, v71, v71, v15
    s_nop 2
    v_pk_add_f32 v[12:13], v[12:13], v[14:15]
    s_nop 1
    v_add_f32_dpp v12, v12, v12 row_ror:8 row_mask:0xf bank_mask:0xf
    v_add_f32_dpp v13, v13, v13 row_ror:8 row_mask:0xf bank_mask:0xf
    v_mov_b32 v10, v12
    v_mov_b32 v11, v13
    s_nop 0
    v_permlane16_swap_b32 v12, v10
    v_permlane16_swap_b32 v13, v11
    v_pk_add_f32 v[12:13], v[12:13], v[10:11]
    v_mov_b32 v10, v12
    v_mov_b32 v11, v13
    s_nop 0
    v_permlane32_swap_b32 v12, v10
    v_permlane32_swap_b32 v13, v11
    v_pk_add_f32 v[12:13], v[12:13], v[10:11]
    s_mov_b64 exec, 0xff
    ds_write_b64 v7, v[12:13] offset:256
    s_mov_b64 exec, -1
    s_waitcnt lgkmcnt(0)
    s_barrier
    ds_read_b64 v[10:11], v6 offset:256
    ds_read_b64 v[12:13], v6 offset:320
    ds_read_b64 v[14:15], v6 offset:384
    ds_read_b64 v[112:113], v6 offset:448
    s_waitcnt lgkmcnt(0)
    v_pk_add_f32 v[10:11], v[10:11], v[12:13]
    v_pk_add_f32 v[14:15], v[14:15], v[112:113]
    v_pk_add_f32 v[10:11], v[10:11], v[14:15]
    v_mul_f32 v10, 0x3b000000, v10
    v_mul_f32 v11, 0x3b000000, v11
    v_fma_f32 v11, -v10, v10, v11
    v_max_f32 v11, 0, v11
    v_cvt_pk_bf16_f32 v14, v10, v11
    v_lshlrev_b32 v12, 16, v14
    v_and_b32 v11, s27, v14
    v_add_f32 v11, 0x3727c5ac, v11
    v_cvt_pk_bf16_f32 v11, v11, v11
    v_and_b32 v11, s27, v11
    v_sqrt_f32 v11, v11
    v_mov_b32 v13, v12
    v_cvt_pk_bf16_f32 v11, v11, v11
    v_and_b32 v11, s27, v11
    v_rcp_f32 v14, v11
    s_nop 0
    v_mov_b32 v15, v14
    v_lshlrev_b32 v112, 16, v64
    v_and_b32 v113, s27, v64
    v_pk_add_f32 v[112:113], v[112:113], v[12:13] neg_lo:[0,1] neg_hi:[0,1]
    v_cvt_pk_bf16_f32 v72, v112, v113
    v_lshlrev_b32 v112, 16, v72
    v_and_b32 v113, s27, v72
    v_pk_mul_f32 v[112:113], v[112:113], v[14:15]
    v_cvt_pk_bf16_f32 v72, v112, v113
    v_lshlrev_b32 v114, 16, v65
    v_and_b32 v115, s27, v65
    v_pk_add_f32 v[114:115], v[114:115], v[12:13] neg_lo:[0,1] neg_hi:[0,1]
    v_cvt_pk_bf16_f32 v73, v114, v115
    v_lshlrev_b32 v114, 16, v73
    v_and_b32 v115, s27, v73
    v_pk_mul_f32 v[114:115], v[114:115], v[14:15]
    v_cvt_pk_bf16_f32 v73, v114, v115
    v_lshlrev_b32 v116, 16, v66
    v_and_b32 v117, s27, v66
    v_pk_add_f32 v[116:117], v[116:117], v[12:13] neg_lo:[0,1] neg_hi:[0,1]
    v_cvt_pk_bf16_f32 v74, v116, v117
    v_lshlrev_b32 v116, 16, v74
    v_and_b32 v117, s27, v74
    v_pk_mul_f32 v[116:117], v[116:117], v[14:15]
    v_cvt_pk_bf16_f32 v74, v116, v117
    v_lshlrev_b32 v118, 16, v67
    v_and_b32 v119, s27, v67
    v_pk_add_f32 v[118:119], v[118:119], v[12:13] neg_lo:[0,1] neg_hi:[0,1]
    v_cvt_pk_bf16_f32 v75, v118, v119
    v_lshlrev_b32 v118, 16, v75
    v_and_b32 v119, s27, v75
    v_pk_mul_f32 v[118:119], v[118:119], v[14:15]
    v_cvt_pk_bf16_f32 v75, v118, v119
    v_lshlrev_b32 v120, 16, v68
    v_and_b32 v121, s27, v68
    v_pk_add_f32 v[120:121], v[120:121], v[12:13] neg_lo:[0,1] neg_hi:[0,1]
    v_cvt_pk_bf16_f32 v76, v120, v121
    v_lshlrev_b32 v120, 16, v76
    v_and_b32 v121, s27, v76
    v_pk_mul_f32 v[120:121], v[120:121], v[14:15]
    v_cvt_pk_bf16_f32 v76, v120, v121
    v_lshlrev_b32 v122, 16, v69
    v_and_b32 v123, s27, v69
    v_pk_add_f32 v[122:123], v[122:123], v[12:13] neg_lo:[0,1] neg_hi:[0,1]
    v_cvt_pk_bf16_f32 v77, v122, v123
    v_lshlrev_b32 v122, 16, v77
    v_and_b32 v123, s27, v77
    v_pk_mul_f32 v[122:123], v[122:123], v[14:15]
    v_cvt_pk_bf16_f32 v77, v122, v123
    v_lshlrev_b32 v124, 16, v70
    v_and_b32 v125, s27, v70
    v_pk_add_f32 v[124:125], v[124:125], v[12:13] neg_lo:[0,1] neg_hi:[0,1]
    v_cvt_pk_bf16_f32 v78, v124, v125
    v_lshlrev_b32 v124, 16, v78
    v_and_b32 v125, s27, v78
    v_pk_mul_f32 v[124:125], v[124:125], v[14:15]
    v_cvt_pk_bf16_f32 v78, v124, v125
    v_lshlrev_b32 v126, 16, v71
    v_and_b32 v127, s27, v71
    v_pk_add_f32 v[126:127], v[126:127], v[12:13] neg_lo:[0,1] neg_hi:[0,1]
    v_cvt_pk_bf16_f32 v79, v126, v127
    v_lshlrev_b32 v126, 16, v79
    v_and_b32 v127, s27, v79
    v_pk_mul_f32 v[126:127], v[126:127], v[14:15]
    v_cvt_pk_bf16_f32 v79, v126, v127
    s_add_u32 s13, s23, 4096
    buffer_store_dwordx4 v[72:75], v4, s[8:11], s23 offen sc1
    buffer_store_dwordx4 v[76:79], v4, s[8:11], s13 offen sc1
    s_add_u32 s22, s22, 32768
    s_add_u32 s23, s23, 32768
    s_waitcnt vmcnt(0)
    v_mov_b32 v251, 1
    v_mov_b32 v250, 0
    s_mov_b64 exec, 1
    buffer_store_dword v251, v250, s[8:11], s24 offen sc1
    s_mov_b64 exec, -1
    s_add_u32 s24, s24, 128
    s_add_u32 s26, s26, 1
    s_cmp_eq_u32 s31, 1
    s_cbranch_scc0 FT1_1_i1_slow
    s_mov_b32 s31, 0
    s_branch FT1_1_i0
FT1_1_i1_slow:
    s_cmp_ge_u32 s26, 64
    s_cbranch_scc1 FT1_1_done
    s_mov_b32 s96, 0
    v_mbcnt_lo_u32_b32 v250, -1, 0
    v_mbcnt_hi_u32_b32 v250, -1, v250
    v_min_u32 v250, 15, v250
    v_lshlrev_b32 v250, 2, v250
FT1_1_i1ws_4_spin:
    buffer_load_dword v251, v250, s[8:11], s25 offen sc1
    s_waitcnt vmcnt(0)
    v_cmp_eq_u32 vcc, 0, v251
    s_cbranch_vccz FT1_1_i1ws_4_ok
    s_add_u32 s96, s96, 1
    s_cmp_gt_u32 s96, 300000
    s_cbranch_scc1 L_fail
    s_sleep 1
    s_branch FT1_1_i1ws_4_spin
FT1_1_i1ws_4_ok:
    s_add_u32 s13, s21, 0
    buffer_load_dwordx4 v[24:27], v4, s[8:11], s13 offen sc1
    s_add_u32 s13, s21, 4096
    buffer_load_dwordx4 v[28:31], v4, s[8:11], s13 offen sc1
    s_add_u32 s13, s20, 0
    buffer_load_dwordx4 v[16:19], v4, s[8:11], s13 offen sc1
    s_add_u32 s13, s20, 4096
    buffer_load_dwordx4 v[20:23], v4, s[8:11], s13 offen sc1
    s_add_u32 s20, s20, 32768
    s_add_u32 s21, s21, 32768
    s_add_u32 s25, s25, 128
    s_branch FT1_1_i0
FT1_1_done:
LE_FT1:
    s_endpgm
L_F0:
LB_FT0:
    v_and_b32 v1, 7, v0
    v_bfe_u32 v2, v0, 3, 1
    v_lshrrev_b32 v3, 4, v0
    v_lshlrev_b32 v4, 4, v1
    v_lshl_add_u32 v4, v2, 9, v4
    v_lshl_add_u32 v4, v3, 10, v4
    s_lshl_b32 s12, s6, 13
    s_lshl_b32 s13, s5, 7
    s_add_u32 s12, s12, s13
    v_add_u32 v4, s12, v4
    s_lshl_b32 s13, s5, 3
    v_add_u32 v5, s13, v1
    v_lshlrev_b32 v5, 10, v5
    v_lshl_add_u32 v5, v3, 5, v5
    v_lshl_add_u32 v5, v2, 4, v5
    s_lshl_b32 s13, s6, 8
    v_add_u32 v5, s13, v5
    v_lshlrev_b32 v6, 3, v1
    s_lshl_b32 s13, s6, 6
    v_add_u32 v7, s13, v6
    s_load_dwordx2 s[16:17], s[0:1], 0
    s_waitcnt lgkmcnt(0)
    s_mov_b32 s18, 2097152
    s_mov_b32 s19, 0x20000
    s_mov_b32 s20, 0
    s_mov_b32 s22, 167772160
    s_mov_b32 s23, 169869312
    s_mov_b32 s24, 205717504
    s_lshl_b32 s13, s5, 4
    s_lshl_b32 s14, s6, 2
    s_add_u32 s13, s13, s14
    s_add_u32 s24, s24, s13
    s_mov_b32 s26, 0
    v_mov_b32 v8, 0x3f803f80
    s_mov_b32 s27, 0xffff0000
    s_mov_b32 s30, 0
    s_mov_b32 s31, 0
    s_mov_b32 s34, 0
    buffer_load_dwordx4 v[16:19], v5, s[16:19], s20 offen offset:0
    buffer_load_dwordx4 v[20:23], v5, s[16:19], s20 offen offset:128
    s_add_u32 s20, s20, 32768
FT0_5_i0:
    s_cmp_eq_u32 s31, 0
    s_cbranch_scc1 FT0_5_i0_w1
    s_waitcnt vmcnt(4)
    s_branch FT0_5_i0_w2
FT0_5_i0_w1:
    s_waitcnt vmcnt(0)
FT0_5_i0_w2:
    v_mov_b32 v12, v16
    s_nop 1
    v_mov_b32_dpp v16, v18 row_shr:8 row_mask:0xf bank_mask:0xc
    v_mov_b32_dpp v18, v12 row_shl:8 row_mask:0xf bank_mask:0x3
    v_mov_b32 v12, v17
    s_nop 1
    v_mov_b32_dpp v17, v19 row_shr:8 row_mask:0xf bank_mask:0xc
    v_mov_b32_dpp v19, v12 row_shl:8 row_mask:0xf bank_mask:0x3
    v_mov_b32 v12, v20
    s_nop 1
    v_mov_b32_dpp v20, v22 row_shr:8 row_mask:0xf bank_mask:0xc
    v_mov_b32_dpp v22, v12 row_shl:8 row_mask:0xf bank_mask:0x3
    v_mov_b32 v12, v21
    s_nop 1
    v_mov_b32_dpp v21, v23 row_shr:8 row_mask:0xf bank_mask:0xc
    v_mov_b32_dpp v23, v12 row_shl:8 row_mask:0xf bank_mask:0x3
    s_mov_b32 s31, 0
    s_cmp_ge_u32 s26, 63
    s_cbranch_scc1 FT0_5_i0_np
    s_mov_b32 s31, 1
    buffer_load_dwordx4 v[64:67], v5, s[16:19], s20 offen offset:0
    buffer_load_dwordx4 v[68:71], v5, s[16:19], s20 offen offset:128
    s_add_u32 s20, s20, 32768
FT0_5_i0_np:
    s_add_u32 s13, s22, 4096
    buffer_store_dwordx4 v[16:19], v4, s[8:11], s22 offen sc1
    buffer_store_dwordx4 v[20:23], v4, s[8:11], s13 offen sc1
    v_mov_b32 v12, 0
    v_mov_b32 v13, 0
    v_mov_b32 v14, 0
    v_mov_b32 v15, 0
    v_dot2_f32_bf16 v12, v16, v8, v12
    v_dot2_f32_bf16 v13, v16, v16, v13
    v_dot2_f32_bf16 v14, v17, v8, v14
    v_dot2_f32_bf16 v15, v17, v17, v15
    v_dot2_f32_bf16 v12, v18, v8, v12
    v_dot2_f32_bf16 v13, v18, v18, v13
    v_dot2_f32_bf16 v14, v19, v8, v14
    v_dot2_f32_bf16 v15, v19, v19, v15
    v_dot2_f32_bf16 v12, v20, v8, v12
    v_dot2_f32_bf16 v13, v20, v20, v13
    v_dot2_f32_bf16 v14, v21, v8, v14
    v_dot2_f32_bf16 v15, v21, v21, v15
    v_dot2_f32_bf16 v12, v22, v8, v12
    v_dot2_f32_bf16 v13, v22, v22, v13
    v_dot2_f32_bf16 v14, v23, v8, v14
    v_dot2_f32_bf16 v15, v23, v23, v15
    s_nop 2
    v_pk_add_f32 v[12:13], v[12:13], v[14:15]
    s_nop 1
    v_add_f32_dpp v12, v12, v12 row_ror:8 row_mask:0xf bank_mask:0xf
    v_add_f32_dpp v13, v13, v13 row_ror:8 row_mask:0xf bank_mask:0xf
    v_mov_b32 v10, v12
    v_mov_b32 v11, v13
    s_nop 0
    v_permlane16_swap_b32 v12, v10
    v_permlane16_swap_b32 v13, v11
    v_pk_add_f32 v[12:13], v[12:13], v[10:11]
    v_mov_b32 v10, v12
    v_mov_b32 v11, v13
    s_nop 0
    v_permlane32_swap_b32 v12, v10
    v_permlane32_swap_b32 v13, v11
    v_pk_add_f32 v[12:13], v[12:13], v[10:11]
    s_mov_b64 exec, 0xff
    ds_write_b64 v7, v[12:13] offset:0
    s_mov_b64 exec, -1
    s_waitcnt lgkmcnt(0)
    s_barrier
    ds_read_b64 v[10:11], v6 offset:0
    ds_read_b64 v[12:13], v6 offset:64
    ds_read_b64 v[14:15], v6 offset:128
    ds_read_b64 v[112:113], v6 offset:192
    s_waitcnt lgkmcnt(0)
    v_pk_add_f32 v[10:11], v[10:11], v[12:13]
    v_pk_add_f32 v[14:15], v[14:15], v[112:113]
    v_pk_add_f32 v[10:11], v[10:11], v[14:15]
    v_mul_f32 v10, 0x3b000000, v10
    v_mul_f32 v11, 0x3b000000, v11
    v_fma_f32 v11, -v10, v10, v11
    v_max_f32 v11, 0, v11
    v_cvt_pk_bf16_f32 v14, v10, v11
    v_lshlrev_b32 v12, 16, v14
    v_and_b32 v11, s27, v14
    v_add_f32 v11, 0x3727c5ac, v11
    v_cvt_pk_bf16_f32 v11, v11, v11
    v_and_b32 v11, s27, v11
    v_sqrt_f32 v11, v11
    v_mov_b32 v13, v12
    v_cvt_pk_bf16_f32 v11, v11, v11
    v_and_b32 v11, s27, v11
    v_rcp_f32 v14, v11
    s_nop 0
    v_mov_b32 v15, v14
    v_lshlrev_b32 v112, 16, v16
    v_and_b32 v113, s27, v16
    v_pk_add_f32 v[112:113], v[112:113], v[12:13] neg_lo:[0,1] neg_hi:[0,1]
    v_cvt_pk_bf16_f32 v24, v112, v113
    v_lshlrev_b32 v112, 16, v24
    v_and_b32 v113, s27, v24
    v_pk_mul_f32 v[112:113], v[112:113], v[14:15]
    v_cvt_pk_bf16_f32 v24, v112, v113
    v_lshlrev_b32 v114, 16, v17
    v_and_b32 v115, s27, v17
    v_pk_add_f32 v[114:115], v[114:115], v[12:13] neg_lo:[0,1] neg_hi:[0,1]
    v_cvt_pk_bf16_f32 v25, v114, v115
    v_lshlrev_b32 v114, 16, v25
    v_and_b32 v115, s27, v25
    v_pk_mul_f32 v[114:115], v[114:115], v[14:15]
    v_cvt_pk_bf16_f32 v25, v114, v115
    v_lshlrev_b32 v116, 16, v18
    v_and_b32 v117, s27, v18
    v_pk_add_f32 v[116:117], v[116:117], v[12:13] neg_lo:[0,1] neg_hi:[0,1]
    v_cvt_pk_bf16_f32 v26, v116, v117
    v_lshlrev_b32 v116, 16, v26
    v_and_b32 v117, s27, v26
    v_pk_mul_f32 v[116:117], v[116:117], v[14:15]
    v_cvt_pk_bf16_f32 v26, v116, v117
    v_lshlrev_b32 v118, 16, v19
    v_and_b32 v119, s27, v19
    v_pk_add_f32 v[118:119], v[118:119], v[12:13] neg_lo:[0,1] neg_hi:[0,1]
    v_cvt_pk_bf16_f32 v27, v118, v119
    v_lshlrev_b32 v118, 16, v27
    v_and_b32 v119, s27, v27
    v_pk_mul_f32 v[118:119], v[118:119], v[14:15]
    v_cvt_pk_bf16_f32 v27, v118, v119
    v_lshlrev_b32 v120, 16, v20
    v_and_b32 v121, s27, v20
    v_pk_add_f32 v[120:121], v[120:121], v[12:13] neg_lo:[0,1] neg_hi:[0,1]
    v_cvt_pk_bf16_f32 v28, v120, v121
    v_lshlrev_b32 v120, 16, v28
    v_and_b32 v121, s27, v28
    v_pk_mul_f32 v[120:121], v[120:121], v[14:15]
    v_cvt_pk_bf16_f32 v28, v120, v121
    v_lshlrev_b32 v122, 16, v21
    v_and_b32 v123, s27, v21
    v_pk_add_f32 v[122:123], v[122:123], v[12:13] neg_lo:[0,1] neg_hi:[0,1]
    v_cvt_pk_bf16_f32 v29, v122, v123
    v_lshlrev_b32 v122, 16, v29
    v_and_b32 v123, s27, v29
    v_pk_mul_f32 v[122:123], v[122:123], v[14:15]
    v_cvt_pk_bf16_f32 v29, v122, v123
    v_lshlrev_b32 v124, 16, v22
    v_and_b32 v125, s27, v22
    v_pk_add_f32 v[124:125], v[124:125], v[12:13] neg_lo:[0,1] neg_hi:[0,1]
    v_cvt_pk_bf16_f32 v30, v124, v125
    v_lshlrev_b32 v124, 16, v30
    v_and_b32 v125, s27, v30
    v_pk_mul_f32 v[124:125], v[124:125], v[14:15]
    v_cvt_pk_bf16_f32 v30, v124, v125
    v_lshlrev_b32 v126, 16, v23
    v_and_b32 v127, s27, v23
    v_pk_add_f32 v[126:127], v[126:127], v[12:13] neg_lo:[0,1] neg_hi:[0,1]
    v_cvt_pk_bf16_f32 v31, v126, v127
    v_lshlrev_b32 v126, 16, v31
    v_and_b32 v127, s27, v31
    v_pk_mul_f32 v[126:127], v[126:127], v[14:15]
    v_cvt_pk_bf16_f32 v31, v126, v127
    s_add_u32 s13, s23, 4096
    buffer_store_dwordx4 v[24:27], v4, s[8:11], s23 offen sc1
    buffer_store_dwordx4 v[28:31], v4, s[8:11], s13 offen sc1
    s_add_u32 s22, s22, 32768
    s_add_u32 s23, s23, 32768
    s_waitcnt vmcnt(0)
    s_cmp_eq_u32 s34, 1
    s_cbranch_scc1 FT0_5iw_6
    s_load_dwordx2 s[92:93], s[0:1], 88
    s_waitcnt lgkmcnt(0)
    s_mov_b32 s94, 256
    s_mov_b32 s95, 0x20000
    s_mov_b32 s96, 0
FT0_5iw_6x_iw:
    v_mbcnt_lo_u32_b32 v9, -1, 0
    v_mbcnt_hi_u32_b32 v9, -1, v9
    v_min_u32 v9, 7, v9
    v_and_b32 v10, 1, v9
    v_lshlrev_b32 v10, 7, v10
    v_lshrrev_b32 v9, 1, v9
    v_lshl_add_u32 v9, v9, 2, v10
    buffer_load_dword v9, v9, s[92:95], 0 offen sc1
    s_waitcnt vmcnt(0)
    v_cmp_gt_u32 vcc, 32, v9
    s_cmp_eq_u64 vcc, 0
    s_cselect_b32 s97, 256, 0
    s_cmp_ge_u32 s97, 256
    s_cbranch_scc1 FT0_5iw_6x_iwd
    s_add_u32 s96, s96, 1
    s_cmp_gt_u32 s96, 300000
    s_cbranch_scc1 L_fail
    s_sleep 2
    s_branch FT0_5iw_6x_iw
FT0_5iw_6x_iwd:
    s_mov_b32 s34, 1
FT0_5iw_6:
    v_mov_b32 v251, 1
    v_mov_b32 v250, 0
    s_mov_b64 exec, 1
    buffer_store_dword v251, v250, s[8:11], s24 offen sc1
    s_mov_b64 exec, -1
    s_add_u32 s24, s24, 128
    s_add_u32 s26, s26, 1
    s_cmp_eq_u32 s31, 1
    s_cbranch_scc0 FT0_5_i0_slow
    s_mov_b32 s31, 0
    s_branch FT0_5_i1
FT0_5_i0_slow:
    s_cmp_ge_u32 s26, 64
    s_cbranch_scc1 FT0_5_done
    buffer_load_dwordx4 v[64:67], v5, s[16:19], s20 offen offset:0
    buffer_load_dwordx4 v[68:71], v5, s[16:19], s20 offen offset:128
    s_add_u32 s20, s20, 32768
FT0_5_i1:
    s_cmp_eq_u32 s31, 0
    s_cbranch_scc1 FT0_5_i1_w1
    s_waitcnt vmcnt(4)
    s_branch FT0_5_i1_w2
FT0_5_i1_w1:
    s_waitcnt vmcnt(0)
FT0_5_i1_w2:
    v_mov_b32 v12, v64
    s_nop 1
    v_mov_b32_dpp v64, v66 row_shr:8 row_mask:0xf bank_mask:0xc
    v_mov_b32_dpp v66, v12 row_shl:8 row_mask:0xf bank_mask:0x3
    v_mov_b32 v12, v65
    s_nop 1
    v_mov_b32_dpp v65, v67 row_shr:8 row_mask:0xf bank_mask:0xc
    v_mov_b32_dpp v67, v12 row_shl:8 row_mask:0xf bank_mask:0x3
    v_mov_b32 v12, v68
    s_nop 1
    v_mov_b32_dpp v68, v70 row_shr:8 row_mask:0xf bank_mask:0xc
    v_mov_b32_dpp v70, v12 row_shl:8 row_mask:0xf bank_mask:0x3
    v_mov_b32 v12, v69
    s_nop 1
    v_mov_b32_dpp v69, v71 row_shr:8 row_mask:0xf bank_mask:0xc
    v_mov_b32_dpp v71, v12 row_shl:8 row_mask:0xf bank_mask:0x3
    s_mov_b32 s31, 0
    s_cmp_ge_u32 s26, 63
    s_cbranch_scc1 FT0_5_i1_np
    s_mov_b32 s31, 1
    buffer_load_dwordx4 v[16:19], v5, s[16:19], s20 offen offset:0
    buffer_load_dwordx4 v[20:23], v5, s[16:19], s20 offen offset:128
    s_add_u32 s20, s20, 32768
FT0_5_i1_np:
    s_add_u32 s13, s22, 4096
    buffer_store_dwordx4 v[64:67], v4, s[8:11], s22 offen sc1
    buffer_store_dwordx4 v[68:71], v4, s[8:11], s13 offen sc1
    v_mov_b32 v12, 0
    v_mov_b32 v13, 0
    v_mov_b32 v14, 0
    v_mov_b32 v15, 0
    v_dot2_f32_bf16 v12, v64, v8, v12
    v_dot2_f32_bf16 v13, v64, v64, v13
    v_dot2_f32_bf16 v14, v65, v8, v14
    v_dot2_f32_bf16 v15, v65, v65, v15
    v_dot2_f32_bf16 v12, v66, v8, v12
    v_dot2_f32_bf16 v13, v66, v66, v13
    v_dot2_f32_bf16 v14, v67, v8, v14
    v_dot2_f32_bf16 v15, v67, v67, v15
    v_dot2_f32_bf16 v12, v68, v8, v12
    v_dot2_f32_bf16 v13, v68, v68, v13
    v_dot2_f32_bf16 v14, v69, v8, v14
    v_dot2_f32_bf16 v15, v69, v69, v15
    v_dot2_f32_bf16 v12, v70, v8, v12
    v_dot2_f32_bf16 v13, v70, v70, v13
    v_dot2_f32_bf16 v14, v71, v8, v14
    v_dot2_f32_bf16 v15, v71, v71, v15
    s_nop 2
    v_pk_add_f32 v[12:13], v[12:13], v[14:15]
    s_nop 1
    v_add_f32_dpp v12, v12, v12 row_ror:8 row_mask:0xf bank_mask:0xf
    v_add_f32_dpp v13, v13, v13 row_ror:8 row_mask:0xf bank_mask:0xf
    v_mov_b32 v10, v12
    v_mov_b32 v11, v13
    s_nop 0
    v_permlane16_swap_b32 v12, v10
    v_permlane16_swap_b32 v13, v11
    v_pk_add_f32 v[12:13], v[12:13], v[10:11]
    v_mov_b32 v10, v12
    v_mov_b32 v11, v13
    s_nop 0
    v_permlane32_swap_b32 v12, v10
    v_permlane32_swap_b32 v13, v11
    v_pk_add_f32 v[12:13], v[12:13], v[10:11]
    s_mov_b64 exec, 0xff
    ds_write_b64 v7, v[12:13] offset:256
    s_mov_b64 exec, -1
    s_waitcnt lgkmcnt(0)
    s_barrier
    ds_read_b64 v[10:11], v6 offset:256
    ds_read_b64 v[12:13], v6 offset:320
    ds_read_b64 v[14:15], v6 offset:384
    ds_read_b64 v[112:113], v6 offset:448
    s_waitcnt lgkmcnt(0)
    v_pk_add_f32 v[10:11], v[10:11], v[12:13]
    v_pk_add_f32 v[14:15], v[14:15], v[112:113]
    v_pk_add_f32 v[10:11], v[10:11], v[14:15]
    v_mul_f32 v10, 0x3b000000, v10
    v_mul_f32 v11, 0x3b000000, v11
    v_fma_f32 v11, -v10, v10, v11
    v_max_f32 v11, 0, v11
    v_cvt_pk_bf16_f32 v14, v10, v11
    v_lshlrev_b32 v12, 16, v14
    v_and_b32 v11, s27, v14
    v_add_f32 v11, 0x3727c5ac, v11
    v_cvt_pk_bf16_f32 v11, v11, v11
    v_and_b32 v11, s27, v11
    v_sqrt_f32 v11, v11
    v_mov_b32 v13, v12
    v_cvt_pk_bf16_f32 v11, v11, v11
    v_and_b32 v11, s27, v11
    v_rcp_f32 v14, v11
    s_nop 0
    v_mov_b32 v15, v14
    v_lshlrev_b32 v112, 16, v64
    v_and_b32 v113, s27, v64
    v_pk_add_f32 v[112:113], v[112:113], v[12:13] neg_lo:[0,1] neg_hi:[0,1]
    v_cvt_pk_bf16_f32 v72, v112, v113
    v_lshlrev_b32 v112, 16, v72
    v_and_b32 v113, s27, v72
    v_pk_mul_f32 v[112:113], v[112:113], v[14:15]
    v_cvt_pk_bf16_f32 v72, v112, v113
    v_lshlrev_b32 v114, 16, v65
    v_and_b32 v115, s27, v65
    v_pk_add_f32 v[114:115], v[114:115], v[12:13] neg_lo:[0,1] neg_hi:[0,1]
    v_cvt_pk_bf16_f32 v73, v114, v115
    v_lshlrev_b32 v114, 16, v73
    v_and_b32 v115, s27, v73
    v_pk_mul_f32 v[114:115], v[114:115], v[14:15]
    v_cvt_pk_bf16_f32 v73, v114, v115
    v_lshlrev_b32 v116, 16, v66
    v_and_b32 v117, s27, v66
    v_pk_add_f32 v[116:117], v[116:117], v[12:13] neg_lo:[0,1] neg_hi:[0,1]
    v_cvt_pk_bf16_f32 v74, v116, v117
    v_lshlrev_b32 v116, 16, v74
    v_and_b32 v117, s27, v74
    v_pk_mul_f32 v[116:117], v[116:117], v[14:15]
    v_cvt_pk_bf16_f32 v74, v116, v117
    v_lshlrev_b32 v118, 16, v67
    v_and_b32 v119, s27, v67
    v_pk_add_f32 v[118:119], v[118:119], v[12:13] neg_lo:[0,1] neg_hi:[0,1]
    v_cvt_pk_bf16_f32 v75, v118, v119
    v_lshlrev_b32 v118, 16, v75
    v_and_b32 v119, s27, v75
    v_pk_mul_f32 v[118:119], v[118:119], v[14:15]
    v_cvt_pk_bf16_f32 v75, v118, v119
    v_lshlrev_b32 v120, 16, v68
    v_and_b32 v121, s27, v68
    v_pk_add_f32 v[120:121], v[120:121], v[12:13] neg_lo:[0,1] neg_hi:[0,1]
    v_cvt_pk_bf16_f32 v76, v120, v121
    v_lshlrev_b32 v120, 16, v76
    v_and_b32 v121, s27, v76
    v_pk_mul_f32 v[120:121], v[120:121], v[14:15]
    v_cvt_pk_bf16_f32 v76, v120, v121
    v_lshlrev_b32 v122, 16, v69
    v_and_b32 v123, s27, v69
    v_pk_add_f32 v[122:123], v[122:123], v[12:13] neg_lo:[0,1] neg_hi:[0,1]
    v_cvt_pk_bf16_f32 v77, v122, v123
    v_lshlrev_b32 v122, 16, v77
    v_and_b32 v123, s27, v77
    v_pk_mul_f32 v[122:123], v[122:123], v[14:15]
    v_cvt_pk_bf16_f32 v77, v122, v123
    v_lshlrev_b32 v124, 16, v70
    v_and_b32 v125, s27, v70
    v_pk_add_f32 v[124:125], v[124:125], v[12:13] neg_lo:[0,1] neg_hi:[0,1]
    v_cvt_pk_bf16_f32 v78, v124, v125
    v_lshlrev_b32 v124, 16, v78
    v_and_b32 v125, s27, v78
    v_pk_mul_f32 v[124:125], v[124:125], v[14:15]
    v_cvt_pk_bf16_f32 v78, v124, v125
    v_lshlrev_b32 v126, 16, v71
    v_and_b32 v127, s27, v71
    v_pk_add_f32 v[126:127], v[126:127], v[12:13] neg_lo:[0,1] neg_hi:[0,1]
    v_cvt_pk_bf16_f32 v79, v126, v127
    v_lshlrev_b32 v126, 16, v79
    v_and_b32 v127, s27, v79
    v_pk_mul_f32 v[126:127], v[126:127], v[14:15]
    v_cvt_pk_bf16_f32 v79, v126, v127
    s_add_u32 s13, s23, 4096
    buffer_store_dwordx4 v[72:75], v4, s[8:11], s23 offen sc1
    buffer_store_dwordx4 v[76:79], v4, s[8:11], s13 offen sc1
    s_add_u32 s22, s22, 32768
    s_add_u32 s23, s23, 32768
    s_waitcnt vmcnt(0)
    s_cmp_eq_u32 s34, 1
    s_cbranch_scc1 FT0_5iw_7
    s_load_dwordx2 s[92:93], s[0:1], 88
    s_waitcnt lgkmcnt(0)
    s_mov_b32 s94, 256
    s_mov_b32 s95, 0x20000
    s_mov_b32 s96, 0
FT0_5iw_7x_iw:
    v_mbcnt_lo_u32_b32 v9, -1, 0
    v_mbcnt_hi_u32_b32 v9, -1, v9
    v_min_u32 v9, 7, v9
    v_and_b32 v10, 1, v9
    v_lshlrev_b32 v10, 7, v10
    v_lshrrev_b32 v9, 1, v9
    v_lshl_add_u32 v9, v9, 2, v10
    buffer_load_dword v9, v9, s[92:95], 0 offen sc1
    s_waitcnt vmcnt(0)
    v_cmp_gt_u32 vcc, 32, v9
    s_cmp_eq_u64 vcc, 0
    s_cselect_b32 s97, 256, 0
    s_cmp_ge_u32 s97, 256
    s_cbranch_scc1 FT0_5iw_7x_iwd
    s_add_u32 s96, s96, 1
    s_cmp_gt_u32 s96, 300000
    s_cbranch_scc1 L_fail
    s_sleep 2
    s_branch FT0_5iw_7x_iw
FT0_5iw_7x_iwd:
    s_mov_b32 s34, 1
FT0_5iw_7:
    v_mov_b32 v251, 1
    v_mov_b32 v250, 0
    s_mov_b64 exec, 1
    buffer_store_dword v251, v250, s[8:11], s24 offen sc1
    s_mov_b64 exec, -1
    s_add_u32 s24, s24, 128
    s_add_u32 s26, s26, 1
    s_cmp_eq_u32 s31, 1
    s_cbranch_scc0 FT0_5_i1_slow
    s_mov_b32 s31, 0
    s_branch FT0_5_i0
FT0_5_i1_slow:
    s_cmp_ge_u32 s26, 64
    s_cbranch_scc1 FT0_5_done
    buffer_load_dwordx4 v[16:19], v5, s[16:19], s20 offen offset:0
    buffer_load_dwordx4 v[20:23], v5, s[16:19], s20 offen offset:128
    s_add_u32 s20, s20, 32768
    s_branch FT0_5_i0
FT0_5_done:
LE_FT0:
    s_endpgm
L_F2:
LB_FT2:
    v_and_b32 v1, 7, v0
    v_bfe_u32 v2, v0, 3, 1
    v_lshrrev_b32 v3, 4, v0
    v_lshlrev_b32 v4, 4, v1
    v_lshl_add_u32 v4, v2, 9, v4
    v_lshl_add_u32 v4, v3, 10, v4
    s_lshl_b32 s12, s6, 13
    s_lshl_b32 s13, s5, 7
    s_add_u32 s12, s12, s13
    v_add_u32 v4, s12, v4
    s_lshl_b32 s13, s5, 3
    v_add_u32 v5, s13, v1
    v_lshlrev_b32 v5, 10, v5
    v_lshl_add_u32 v5, v3, 5, v5
    v_lshl_add_u32 v5, v2, 4, v5
    s_lshl_b32 s13, s6, 8
    v_add_u32 v5, s13, v5
    v_lshlrev_b32 v6, 3, v1
    s_lshl_b32 s13, s6, 6
    v_add_u32 v7, s13, v6
    s_lshl_b32 s13, s4, 15
    s_add_u32 s20, s13, 176160768
    s_add_u32 s22, s13, 180355072
    s_add_u32 s23, s13, 182452224
    s_lshl_b32 s13, s4, 17
    s_add_u32 s21, s13, 150994944
    s_lshl_b32 s13, s4, 7
    s_add_u32 s24, s13, 205733888
    s_lshl_b32 s13, s4, 8
    s_add_u32 s25, s13, 205799424
    s_lshl_b32 s13, s5, 4
    s_lshl_b32 s14, s6, 2
    s_add_u32 s13, s13, s14
    s_add_u32 s24, s24, s13
    s_mov_b32 s26, 0
    v_mov_b32 v8, 0x3f803f80
    s_mov_b32 s27, 0xffff0000
    s_mov_b32 s30, 0
    s_mov_b32 s31, 0
    s_load_dwordx2 s[92:93], s[0:1], 88
    s_waitcnt lgkmcnt(0)
    s_mov_b32 s94, 256
    s_mov_b32 s95, 0x20000
    s_mov_b32 s96, 0
FT2_8_iw:
    v_mbcnt_lo_u32_b32 v9, -1, 0
    v_mbcnt_hi_u32_b32 v9, -1, v9
    v_min_u32 v9, 7, v9
    v_and_b32 v10, 1, v9
    v_lshlrev_b32 v10, 7, v10
    v_lshrrev_b32 v9, 1, v9
    v_lshl_add_u32 v9, v9, 2, v10
    buffer_load_dword v9, v9, s[92:95], 0 offen sc1
    s_waitcnt vmcnt(0)
    v_cmp_gt_u32 vcc, 32, v9
    s_cmp_eq_u64 vcc, 0
    s_cselect_b32 s97, 256, 0
    s_cmp_ge_u32 s97, 256
    s_cbranch_scc1 FT2_8_iwd
    s_add_u32 s96, s96, 1
    s_cmp_gt_u32 s96, 300000
    s_cbranch_scc1 L_fail
    s_sleep 2
    s_branch FT2_8_iw
FT2_8_iwd:
    s_mov_b32 s96, 0
    v_mbcnt_lo_u32_b32 v250, -1, 0
    v_mbcnt_hi_u32_b32 v250, -1, v250
    v_min_u32 v250, 63, v250
    v_lshlrev_b32 v250, 2, v250
FT2_8w0_9_spin:
    buffer_load_dword v251, v250, s[8:11], s25 offen sc1
    s_waitcnt vmcnt(0)
    v_cmp_eq_u32 vcc, 0, v251
    s_cbranch_vccz FT2_8w0_9_ok
    s_add_u32 s96, s96, 1
    s_cmp_gt_u32 s96, 300000
    s_cbranch_scc1 L_fail
    s_sleep 1
    s_branch FT2_8w0_9_spin
FT2_8w0_9_ok:
    s_add_u32 s13, s21, 0
    buffer_load_dwordx4 v[24:27], v4, s[8:11], s13 offen sc1
    s_add_u32 s13, s21, 4096
    buffer_load_dwordx4 v[28:31], v4, s[8:11], s13 offen sc1
    s_add_u32 s13, s21, 32768
    buffer_load_dwordx4 v[32:35], v4, s[8:11], s13 offen sc1
    s_add_u32 s13, s21, 36864
    buffer_load_dwordx4 v[36:39], v4, s[8:11], s13 offen sc1
    s_add_u32 s13, s21, 65536
    buffer_load_dwordx4 v[40:43], v4, s[8:11], s13 offen sc1
    s_add_u32 s13, s21, 69632
    buffer_load_dwordx4 v[44:47], v4, s[8:11], s13 offen sc1
    s_add_u32 s13, s21, 98304
    buffer_load_dwordx4 v[48:51], v4, s[8:11], s13 offen sc1
    s_add_u32 s13, s21, 102400
    buffer_load_dwordx4 v[52:55], v4, s[8:11], s13 offen sc1
    s_add_u32 s13, s20, 0
    buffer_load_dwordx4 v[16:19], v4, s[8:11], s13 offen sc1
    s_add_u32 s13, s20, 4096
    buffer_load_dwordx4 v[20:23], v4, s[8:11], s13 offen sc1
    s_add_u32 s20, s20, 65536
    s_add_u32 s21, s21, 262144
    s_add_u32 s25, s25, 512
FT2_8_i0:
    v_mbcnt_lo_u32_b32 v10, -1, 0
    v_mbcnt_hi_u32_b32 v10, -1, v10
    v_min_u32 v10, 63, v10
    v_lshlrev_b32 v10, 2, v10
    buffer_load_dword v9, v10, s[8:11], s25 offen sc1
    s_cmp_eq_u32 s31, 0
    s_cbranch_scc1 FT2_8_i0_w1
    s_waitcnt vmcnt(5)
    s_branch FT2_8_i0_w2
FT2_8_i0_w1:
    s_waitcnt vmcnt(1)
FT2_8_i0_w2:
    v_lshlrev_b32 v112, 16, v24
    v_and_b32 v113, s27, v24
    v_lshlrev_b32 v12, 16, v32
    v_and_b32 v13, s27, v32
    v_lshlrev_b32 v14, 16, v40
    v_and_b32 v15, s27, v40
    v_pk_add_f32 v[112:113], v[112:113], v[12:13]
    v_lshlrev_b32 v12, 16, v48
    v_and_b32 v13, s27, v48
    v_pk_add_f32 v[14:15], v[14:15], v[12:13]
    v_pk_add_f32 v[112:113], v[112:113], v[14:15]
    v_cvt_pk_bf16_f32 v24, v112, v113
    v_lshlrev_b32 v112, 16, v24
    v_and_b32 v113, s27, v24
    v_lshlrev_b32 v12, 16, v16
    v_and_b32 v13, s27, v16
    v_pk_add_f32 v[112:113], v[112:113], v[12:13]
    v_cvt_pk_bf16_f32 v16, v112, v113
    v_lshlrev_b32 v114, 16, v25
    v_and_b32 v115, s27, v25
    v_lshlrev_b32 v12, 16, v33
    v_and_b32 v13, s27, v33
    v_lshlrev_b32 v14, 16, v41
    v_and_b32 v15, s27, v41
    v_pk_add_f32 v[114:115], v[114:115], v[12:13]
    v_lshlrev_b32 v12, 16, v49
    v_and_b32 v13, s27, v49
    v_pk_add_f32 v[14:15], v[14:15], v[12:13]
    v_pk_add_f32 v[114:115], v[114:115], v[14:15]
    v_cvt_pk_bf16_f32 v25, v114, v115
    v_lshlrev_b32 v114, 16, v25
    v_and_b32 v115, s27, v25
    v_lshlrev_b32 v12, 16, v17
    v_and_b32 v13, s27, v17
    v_pk_add_f32 v[114:115], v[114:115], v[12:13]
    v_cvt_pk_bf16_f32 v17, v114, v115
    v_lshlrev_b32 v116, 16, v26
    v_and_b32 v117, s27, v26
    v_lshlrev_b32 v12, 16, v34
    v_and_b32 v13, s27, v34
    v_lshlrev_b32 v14, 16, v42
    v_and_b32 v15, s27, v42
    v_pk_add_f32 v[116:117], v[116:117], v[12:13]
    v_lshlrev_b32 v12, 16, v50
    v_and_b32 v13, s27, v50
    v_pk_add_f32 v[14:15], v[14:15], v[12:13]
    v_pk_add_f32 v[116:117], v[116:117], v[14:15]
    v_cvt_pk_bf16_f32 v26, v116, v117
    v_lshlrev_b32 v116, 16, v26
    v_and_b32 v117, s27, v26
    v_lshlrev_b32 v12, 16, v18
    v_and_b32 v13, s27, v18
    v_pk_add_f32 v[116:117], v[116:117], v[12:13]
    v_cvt_pk_bf16_f32 v18, v116, v117
    v_lshlrev_b32 v118, 16, v27
    v_and_b32 v119, s27, v27
    v_lshlrev_b32 v12, 16, v35
    v_and_b32 v13, s27, v35
    v_lshlrev_b32 v14, 16, v43
    v_and_b32 v15, s27, v43
    v_pk_add_f32 v[118:119], v[118:119], v[12:13]
    v_lshlrev_b32 v12, 16, v51
    v_and_b32 v13, s27, v51
    v_pk_add_f32 v[14:15], v[14:15], v[12:13]
    v_pk_add_f32 v[118:119], v[118:119], v[14:15]
    v_cvt_pk_bf16_f32 v27, v118, v119
    v_lshlrev_b32 v118, 16, v27
    v_and_b32 v119, s27, v27
    v_lshlrev_b32 v12, 16, v19
    v_and_b32 v13, s27, v19
    v_pk_add_f32 v[118:119], v[118:119], v[12:13]
    v_cvt_pk_bf16_f32 v19, v118, v119
    v_lshlrev_b32 v120, 16, v28
    v_and_b32 v121, s27, v28
    v_lshlrev_b32 v12, 16, v36
    v_and_b32 v13, s27, v36
    v_lshlrev_b32 v14, 16, v44
    v_and_b32 v15, s27, v44
    v_pk_add_f32 v[120:121], v[120:121], v[12:13]
    v_lshlrev_b32 v12, 16, v52
    v_and_b32 v13, s27, v52
    v_pk_add_f32 v[14:15], v[14:15], v[12:13]
    v_pk_add_f32 v[120:121], v[120:121], v[14:15]
    v_cvt_pk_bf16_f32 v28, v120, v121
    v_lshlrev_b32 v120, 16, v28
    v_and_b32 v121, s27, v28
    v_lshlrev_b32 v12, 16, v20
    v_and_b32 v13, s27, v20
    v_pk_add_f32 v[120:121], v[120:121], v[12:13]
    v_cvt_pk_bf16_f32 v20, v120, v121
    v_lshlrev_b32 v122, 16, v29
    v_and_b32 v123, s27, v29
    v_lshlrev_b32 v12, 16, v37
    v_and_b32 v13, s27, v37
    v_lshlrev_b32 v14, 16, v45
    v_and_b32 v15, s27, v45
    v_pk_add_f32 v[122:123], v[122:123], v[12:13]
    v_lshlrev_b32 v12, 16, v53
    v_and_b32 v13, s27, v53
    v_pk_add_f32 v[14:15], v[14:15], v[12:13]
    v_pk_add_f32 v[122:123], v[122:123], v[14:15]
    v_cvt_pk_bf16_f32 v29, v122, v123
    v_lshlrev_b32 v122, 16, v29
    v_and_b32 v123, s27, v29
    v_lshlrev_b32 v12, 16, v21
    v_and_b32 v13, s27, v21
    v_pk_add_f32 v[122:123], v[122:123], v[12:13]
    v_cvt_pk_bf16_f32 v21, v122, v123
    v_lshlrev_b32 v124, 16, v30
    v_and_b32 v125, s27, v30
    v_lshlrev_b32 v12, 16, v38
    v_and_b32 v13, s27, v38
    v_lshlrev_b32 v14, 16, v46
    v_and_b32 v15, s27, v46
    v_pk_add_f32 v[124:125], v[124:125], v[12:13]
    v_lshlrev_b32 v12, 16, v54
    v_and_b32 v13, s27, v54
    v_pk_add_f32 v[14:15], v[14:15], v[12:13]
    v_pk_add_f32 v[124:125], v[124:125], v[14:15]
    v_cvt_pk_bf16_f32 v30, v124, v125
    v_lshlrev_b32 v124, 16, v30
    v_and_b32 v125, s27, v30
    v_lshlrev_b32 v12, 16, v22
    v_and_b32 v13, s27, v22
    v_pk_add_f32 v[124:125], v[124:125], v[12:13]
    v_cvt_pk_bf16_f32 v22, v124, v125
    v_lshlrev_b32 v126, 16, v31
    v_and_b32 v127, s27, v31
    v_lshlrev_b32 v12, 16, v39
    v_and_b32 v13, s27, v39
    v_lshlrev_b32 v14, 16, v47
    v_and_b32 v15, s27, v47
    v_pk_add_f32 v[126:127], v[126:127], v[12:13]
    v_lshlrev_b32 v12, 16, v55
    v_and_b32 v13, s27, v55
    v_pk_add_f32 v[14:15], v[14:15], v[12:13]
    v_pk_add_f32 v[126:127], v[126:127], v[14:15]
    v_cvt_pk_bf16_f32 v31, v126, v127
    v_lshlrev_b32 v126, 16, v31
    v_and_b32 v127, s27, v31
    v_lshlrev_b32 v12, 16, v23
    v_and_b32 v13, s27, v23
    v_pk_add_f32 v[126:127], v[126:127], v[12:13]
    v_cvt_pk_bf16_f32 v23, v126, v127
    s_waitcnt vmcnt(0)
    s_mov_b32 s31, 0
    s_cmp_ge_u32 s26, 31
    s_cbranch_scc1 FT2_8_i0_np
    v_cmp_eq_u32 vcc, 0, v9
    s_cbranch_vccnz FT2_8_i0_np
    s_mov_b32 s31, 1
    s_add_u32 s13, s21, 0
    buffer_load_dwordx4 v[72:75], v4, s[8:11], s13 offen sc1
    s_add_u32 s13, s21, 4096
    buffer_load_dwordx4 v[76:79], v4, s[8:11], s13 offen sc1
    s_add_u32 s13, s21, 32768
    buffer_load_dwordx4 v[80:83], v4, s[8:11], s13 offen sc1
    s_add_u32 s13, s21, 36864
    buffer_load_dwordx4 v[84:87], v4, s[8:11], s13 offen sc1
    s_add_u32 s13, s21, 65536
    buffer_load_dwordx4 v[88:91], v4, s[8:11], s13 offen sc1
    s_add_u32 s13, s21, 69632
    buffer_load_dwordx4 v[92:95], v4, s[8:11], s13 offen sc1
    s_add_u32 s13, s21, 98304
    buffer_load_dwordx4 v[96:99], v4, s[8:11], s13 offen sc1
    s_add_u32 s13, s21, 102400
    buffer_load_dwordx4 v[100:103], v4, s[8:11], s13 offen sc1
    s_add_u32 s13, s20, 0
    buffer_load_dwordx4 v[64:67], v4, s[8:11], s13 offen sc1
    s_add_u32 s13, s20, 4096
    buffer_load_dwordx4 v[68:71], v4, s[8:11], s13 offen sc1
    s_add_u32 s20, s20, 65536
    s_add_u32 s21, s21, 262144
    s_add_u32 s25, s25, 512
FT2_8_i0_np:
    s_add_u32 s13, s22, 4096
    buffer_store_dwordx4 v[16:19], v4, s[8:11], s22 offen sc1
    buffer_store_dwordx4 v[20:23], v4, s[8:11], s13 offen sc1
    v_mov_b32 v12, 0
    v_mov_b32 v13, 0
    v_mov_b32 v14, 0
    v_mov_b32 v15, 0
    v_dot2_f32_bf16 v12, v16, v8, v12
    v_dot2_f32_bf16 v13, v16, v16, v13
    v_dot2_f32_bf16 v14, v17, v8, v14
    v_dot2_f32_bf16 v15, v17, v17, v15
    v_dot2_f32_bf16 v12, v18, v8, v12
    v_dot2_f32_bf16 v13, v18, v18, v13
    v_dot2_f32_bf16 v14, v19, v8, v14
    v_dot2_f32_bf16 v15, v19, v19, v15
    v_dot2_f32_bf16 v12, v20, v8, v12
    v_dot2_f32_bf16 v13, v20, v20, v13
    v_dot2_f32_bf16 v14, v21, v8, v14
    v_dot2_f32_bf16 v15, v21, v21, v15
    v_dot2_f32_bf16 v12, v22, v8, v12
    v_dot2_f32_bf16 v13, v22, v22, v13
    v_dot2_f32_bf16 v14, v23, v8, v14
    v_dot2_f32_bf16 v15, v23, v23, v15
    s_nop 2
    v_pk_add_f32 v[12:13], v[12:13], v[14:15]
    s_nop 1
    v_add_f32_dpp v12, v12, v12 row_ror:8 row_mask:0xf bank_mask:0xf
    v_add_f32_dpp v13, v13, v13 row_ror:8 row_mask:0xf bank_mask:0xf
    v_mov_b32 v10, v12
    v_mov_b32 v11, v13
    s_nop 0
    v_permlane16_swap_b32 v12, v10
    v_permlane16_swap_b32 v13, v11
    v_pk_add_f32 v[12:13], v[12:13], v[10:11]
    v_mov_b32 v10, v12
    v_mov_b32 v11, v13
    s_nop 0
    v_permlane32_swap_b32 v12, v10
    v_permlane32_swap_b32 v13, v11
    v_pk_add_f32 v[12:13], v[12:13], v[10:11]
    s_mov_b64 exec, 0xff
    ds_write_b64 v7, v[12:13] offset:0
    s_mov_b64 exec, -1
    s_waitcnt lgkmcnt(0)
    s_barrier
    ds_read_b64 v[10:11], v6 offset:0
    ds_read_b64 v[12:13], v6 offset:64
    ds_read_b64 v[14:15], v6 offset:128
    ds_read_b64 v[112:113], v6 offset:192
    s_waitcnt lgkmcnt(0)
    v_pk_add_f32 v[10:11], v[10:11], v[12:13]
    v_pk_add_f32 v[14:15], v[14:15], v[112:113]
    v_pk_add_f32 v[10:11], v[10:11], v[14:15]
    v_mul_f32 v10, 0x3b000000, v10
    v_mul_f32 v11, 0x3b000000, v11
    v_fma_f32 v11, -v10, v10, v11
    v_max_f32 v11, 0, v11
    v_cvt_pk_bf16_f32 v14, v10, v11
    v_lshlrev_b32 v12, 16, v14
    v_and_b32 v11, s27, v14
    v_add_f32 v11, 0x3727c5ac, v11
    v_cvt_pk_bf16_f32 v11, v11, v11
    v_and_b32 v11, s27, v11
    v_sqrt_f32 v11, v11
    v_mov_b32 v13, v12
    v_cvt_pk_bf16_f32 v11, v11, v11
    v_and_b32 v11, s27, v11
    v_rcp_f32 v14, v11
    s_nop 0
    v_mov_b32 v15, v14
    v_lshlrev_b32 v112, 16, v16
    v_and_b32 v113, s27, v16
    v_pk_add_f32 v[112:113], v[112:113], v[12:13] neg_lo:[0,1] neg_hi:[0,1]
    v_cvt_pk_bf16_f32 v24, v112, v113
    v_lshlrev_b32 v112, 16, v24
    v_and_b32 v113, s27, v24
    v_pk_mul_f32 v[112:113], v[112:113], v[14:15]
    v_cvt_pk_bf16_f32 v24, v112, v113
    v_lshlrev_b32 v114, 16, v17
    v_and_b32 v115, s27, v17
    v_pk_add_f32 v[114:115], v[114:115], v[12:13] neg_lo:[0,1] neg_hi:[0,1]
    v_cvt_pk_bf16_f32 v25, v114, v115
    v_lshlrev_b32 v114, 16, v25
    v_and_b32 v115, s27, v25
    v_pk_mul_f32 v[114:115], v[114:115], v[14:15]
    v_cvt_pk_bf16_f32 v25, v114, v115
    v_lshlrev_b32 v116, 16, v18
    v_and_b32 v117, s27, v18
    v_pk_add_f32 v[116:117], v[116:117], v[12:13] neg_lo:[0,1] neg_hi:[0,1]
    v_cvt_pk_bf16_f32 v26, v116, v117
    v_lshlrev_b32 v116, 16, v26
    v_and_b32 v117, s27, v26
    v_pk_mul_f32 v[116:117], v[116:117], v[14:15]
    v_cvt_pk_bf16_f32 v26, v116, v117
    v_lshlrev_b32 v118, 16, v19
    v_and_b32 v119, s27, v19
    v_pk_add_f32 v[118:119], v[118:119], v[12:13] neg_lo:[0,1] neg_hi:[0,1]
    v_cvt_pk_bf16_f32 v27, v118, v119
    v_lshlrev_b32 v118, 16, v27
    v_and_b32 v119, s27, v27
    v_pk_mul_f32 v[118:119], v[118:119], v[14:15]
    v_cvt_pk_bf16_f32 v27, v118, v119
    v_lshlrev_b32 v120, 16, v20
    v_and_b32 v121, s27, v20
    v_pk_add_f32 v[120:121], v[120:121], v[12:13] neg_lo:[0,1] neg_hi:[0,1]
    v_cvt_pk_bf16_f32 v28, v120, v121
    v_lshlrev_b32 v120, 16, v28
    v_and_b32 v121, s27, v28
    v_pk_mul_f32 v[120:121], v[120:121], v[14:15]
    v_cvt_pk_bf16_f32 v28, v120, v121
    v_lshlrev_b32 v122, 16, v21
    v_and_b32 v123, s27, v21
    v_pk_add_f32 v[122:123], v[122:123], v[12:13] neg_lo:[0,1] neg_hi:[0,1]
    v_cvt_pk_bf16_f32 v29, v122, v123
    v_lshlrev_b32 v122, 16, v29
    v_and_b32 v123, s27, v29
    v_pk_mul_f32 v[122:123], v[122:123], v[14:15]
    v_cvt_pk_bf16_f32 v29, v122, v123
    v_lshlrev_b32 v124, 16, v22
    v_and_b32 v125, s27, v22
    v_pk_add_f32 v[124:125], v[124:125], v[12:13] neg_lo:[0,1] neg_hi:[0,1]
    v_cvt_pk_bf16_f32 v30, v124, v125
    v_lshlrev_b32 v124, 16, v30
    v_and_b32 v125, s27, v30
    v_pk_mul_f32 v[124:125], v[124:125], v[14:15]
    v_cvt_pk_bf16_f32 v30, v124, v125
    v_lshlrev_b32 v126, 16, v23
    v_and_b32 v127, s27, v23
    v_pk_add_f32 v[126:127], v[126:127], v[12:13] neg_lo:[0,1] neg_hi:[0,1]
    v_cvt_pk_bf16_f32 v31, v126, v127
    v_lshlrev_b32 v126, 16, v31
    v_and_b32 v127, s27, v31
    v_pk_mul_f32 v[126:127], v[126:127], v[14:15]
    v_cvt_pk_bf16_f32 v31, v126, v127
    s_add_u32 s13, s23, 4096
    buffer_store_dwordx4 v[24:27], v4, s[8:11], s23 offen sc1
    buffer_store_dwordx4 v[28:31], v4, s[8:11], s13 offen sc1
    s_add_u32 s22, s22, 65536
    s_add_u32 s23, s23, 65536
    s_waitcnt vmcnt(0)
    v_mov_b32 v251, 1
    v_mov_b32 v250, 0
    s_mov_b64 exec, 1
    buffer_store_dword v251, v250, s[8:11], s24 offen sc1
    s_mov_b64 exec, -1
    s_add_u32 s24, s24, 256
    s_add_u32 s26, s26, 1
    s_cmp_eq_u32 s31, 1
    s_cbranch_scc0 FT2_8_i0_slow
    s_mov_b32 s31, 0
    s_branch FT2_8_i1
FT2_8_i0_slow:
    s_cmp_ge_u32 s26, 32
    s_cbranch_scc1 FT2_8_done
    s_mov_b32 s96, 0
    v_mbcnt_lo_u32_b32 v250, -1, 0
    v_mbcnt_hi_u32_b32 v250, -1, v250
    v_min_u32 v250, 63, v250
    v_lshlrev_b32 v250, 2, v250
FT2_8_i0ws_10_spin:
    buffer_load_dword v251, v250, s[8:11], s25 offen sc1
    s_waitcnt vmcnt(0)
    v_cmp_eq_u32 vcc, 0, v251
    s_cbranch_vccz FT2_8_i0ws_10_ok
    s_add_u32 s96, s96, 1
    s_cmp_gt_u32 s96, 300000
    s_cbranch_scc1 L_fail
    s_sleep 1
    s_branch FT2_8_i0ws_10_spin
FT2_8_i0ws_10_ok:
    s_add_u32 s13, s21, 0
    buffer_load_dwordx4 v[72:75], v4, s[8:11], s13 offen sc1
    s_add_u32 s13, s21, 4096
    buffer_load_dwordx4 v[76:79], v4, s[8:11], s13 offen sc1
    s_add_u32 s13, s21, 32768
    buffer_load_dwordx4 v[80:83], v4, s[8:11], s13 offen sc1
    s_add_u32 s13, s21, 36864
    buffer_load_dwordx4 v[84:87], v4, s[8:11], s13 offen sc1
    s_add_u32 s13, s21, 65536
    buffer_load_dwordx4 v[88:91], v4, s[8:11], s13 offen sc1
    s_add_u32 s13, s21, 69632
    buffer_load_dwordx4 v[92:95], v4, s[8:11], s13 offen sc1
    s_add_u32 s13, s21, 98304
    buffer_load_dwordx4 v[96:99], v4, s[8:11], s13 offen sc1
    s_add_u32 s13, s21, 102400
    buffer_load_dwordx4 v[100:103], v4, s[8:11], s13 offen sc1
    s_add_u32 s13, s20, 0
    buffer_load_dwordx4 v[64:67], v4, s[8:11], s13 offen sc1
    s_add_u32 s13, s20, 4096
    buffer_load_dwordx4 v[68:71], v4, s[8:11], s13 offen sc1
    s_add_u32 s20, s20, 65536
    s_add_u32 s21, s21, 262144
    s_add_u32 s25, s25, 512
FT2_8_i1:
    v_mbcnt_lo_u32_b32 v10, -1, 0
    v_mbcnt_hi_u32_b32 v10, -1, v10
    v_min_u32 v10, 63, v10
    v_lshlrev_b32 v10, 2, v10
    buffer_load_dword v9, v10, s[8:11], s25 offen sc1
    s_cmp_eq_u32 s31, 0
    s_cbranch_scc1 FT2_8_i1_w1
    s_waitcnt vmcnt(5)
    s_branch FT2_8_i1_w2
FT2_8_i1_w1:
    s_waitcnt vmcnt(1)
FT2_8_i1_w2:
    v_lshlrev_b32 v112, 16, v72
    v_and_b32 v113, s27, v72
    v_lshlrev_b32 v12, 16, v80
    v_and_b32 v13, s27, v80
    v_lshlrev_b32 v14, 16, v88
    v_and_b32 v15, s27, v88
    v_pk_add_f32 v[112:113], v[112:113], v[12:13]
    v_lshlrev_b32 v12, 16, v96
    v_and_b32 v13, s27, v96
    v_pk_add_f32 v[14:15], v[14:15], v[12:13]
    v_pk_add_f32 v[112:113], v[112:113], v[14:15]
    v_cvt_pk_bf16_f32 v72, v112, v113
    v_lshlrev_b32 v112, 16, v72
    v_and_b32 v113, s27, v72
    v_lshlrev_b32 v12, 16, v64
    v_and_b32 v13, s27, v64
    v_pk_add_f32 v[112:113], v[112:113], v[12:13]
    v_cvt_pk_bf16_f32 v64, v112, v113
    v_lshlrev_b32 v114, 16, v73
    v_and_b32 v115, s27, v73
    v_lshlrev_b32 v12, 16, v81
    v_and_b32 v13, s27, v81
    v_lshlrev_b32 v14, 16, v89
    v_and_b32 v15, s27, v89
    v_pk_add_f32 v[114:115], v[114:115], v[12:13]
    v_lshlrev_b32 v12, 16, v97
    v_and_b32 v13, s27, v97
    v_pk_add_f32 v[14:15], v[14:15], v[12:13]
    v_pk_add_f32 v[114:115], v[114:115], v[14:15]
    v_cvt_pk_bf16_f32 v73, v114, v115
    v_lshlrev_b32 v114, 16, v73
    v_and_b32 v115, s27, v73
    v_lshlrev_b32 v12, 16, v65
    v_and_b32 v13, s27, v65
    v_pk_add_f32 v[114:115], v[114:115], v[12:13]
    v_cvt_pk_bf16_f32 v65, v114, v115
    v_lshlrev_b32 v116, 16, v74
    v_and_b32 v117, s27, v74
    v_lshlrev_b32 v12, 16, v82
    v_and_b32 v13, s27, v82
    v_lshlrev_b32 v14, 16, v90
    v_and_b32 v15, s27, v90
    v_pk_add_f32 v[116:117], v[116:117], v[12:13]
    v_lshlrev_b32 v12, 16, v98
    v_and_b32 v13, s27, v98
    v_pk_add_f32 v[14:15], v[14:15], v[12:13]
    v_pk_add_f32 v[116:117], v[116:117], v[14:15]
    v_cvt_pk_bf16_f32 v74, v116, v117
    v_lshlrev_b32 v116, 16, v74
    v_and_b32 v117, s27, v74
    v_lshlrev_b32 v12, 16, v66
    v_and_b32 v13, s27, v66
    v_pk_add_f32 v[116:117], v[116:117], v[12:13]
    v_cvt_pk_bf16_f32 v66, v116, v117
    v_lshlrev_b32 v118, 16, v75
    v_and_b32 v119, s27, v75
    v_lshlrev_b32 v12, 16, v83
    v_and_b32 v13, s27, v83
    v_lshlrev_b32 v14, 16, v91
    v_and_b32 v15, s27, v91
    v_pk_add_f32 v[118:119], v[118:119], v[12:13]
    v_lshlrev_b32 v12, 16, v99
    v_and_b32 v13, s27, v99
    v_pk_add_f32 v[14:15], v[14:15], v[12:13]
    v_pk_add_f32 v[118:119], v[118:119], v[14:15]
    v_cvt_pk_bf16_f32 v75, v118, v119
    v_lshlrev_b32 v118, 16, v75
    v_and_b32 v119, s27, v75
    v_lshlrev_b32 v12, 16, v67
    v_and_b32 v13, s27, v67
    v_pk_add_f32 v[118:119], v[118:119], v[12:13]
    v_cvt_pk_bf16_f32 v67, v118, v119
    v_lshlrev_b32 v120, 16, v76
    v_and_b32 v121, s27, v76
    v_lshlrev_b32 v12, 16, v84
    v_and_b32 v13, s27, v84
    v_lshlrev_b32 v14, 16, v92
    v_and_b32 v15, s27, v92
    v_pk_add_f32 v[120:121], v[120:121], v[12:13]
    v_lshlrev_b32 v12, 16, v100
    v_and_b32 v13, s27, v100
    v_pk_add_f32 v[14:15], v[14:15], v[12:13]
    v_pk_add_f32 v[120:121], v[120:121], v[14:15]
    v_cvt_pk_bf16_f32 v76, v120, v121
    v_lshlrev_b32 v120, 16, v76
    v_and_b32 v121, s27, v76
    v_lshlrev_b32 v12, 16, v68
    v_and_b32 v13, s27, v68
    v_pk_add_f32 v[120:121], v[120:121], v[12:13]
    v_cvt_pk_bf16_f32 v68, v120, v121
    v_lshlrev_b32 v122, 16, v77
    v_and_b32 v123, s27, v77
    v_lshlrev_b32 v12, 16, v85
    v_and_b32 v13, s27, v85
    v_lshlrev_b32 v14, 16, v93
    v_and_b32 v15, s27, v93
    v_pk_add_f32 v[122:123], v[122:123], v[12:13]
    v_lshlrev_b32 v12, 16, v101
    v_and_b32 v13, s27, v101
    v_pk_add_f32 v[14:15], v[14:15], v[12:13]
    v_pk_add_f32 v[122:123], v[122:123], v[14:15]
    v_cvt_pk_bf16_f32 v77, v122, v123
    v_lshlrev_b32 v122, 16, v77
    v_and_b32 v123, s27, v77
    v_lshlrev_b32 v12, 16, v69
    v_and_b32 v13, s27, v69
    v_pk_add_f32 v[122:123], v[122:123], v[12:13]
    v_cvt_pk_bf16_f32 v69, v122, v123
    v_lshlrev_b32 v124, 16, v78
    v_and_b32 v125, s27, v78
    v_lshlrev_b32 v12, 16, v86
    v_and_b32 v13, s27, v86
    v_lshlrev_b32 v14, 16, v94
    v_and_b32 v15, s27, v94
    v_pk_add_f32 v[124:125], v[124:125], v[12:13]
    v_lshlrev_b32 v12, 16, v102
    v_and_b32 v13, s27, v102
    v_pk_add_f32 v[14:15], v[14:15], v[12:13]
    v_pk_add_f32 v[124:125], v[124:125], v[14:15]
    v_cvt_pk_bf16_f32 v78, v124, v125
    v_lshlrev_b32 v124, 16, v78
    v_and_b32 v125, s27, v78
    v_lshlrev_b32 v12, 16, v70
    v_and_b32 v13, s27, v70
    v_pk_add_f32 v[124:125], v[124:125], v[12:13]
    v_cvt_pk_bf16_f32 v70, v124, v125
    v_lshlrev_b32 v126, 16, v79
    v_and_b32 v127, s27, v79
    v_lshlrev_b32 v12, 16, v87
    v_and_b32 v13, s27, v87
    v_lshlrev_b32 v14, 16, v95
    v_and_b32 v15, s27, v95
    v_pk_add_f32 v[126:127], v[126:127], v[12:13]
    v_lshlrev_b32 v12, 16, v103
    v_and_b32 v13, s27, v103
    v_pk_add_f32 v[14:15], v[14:15], v[12:13]
    v_pk_add_f32 v[126:127], v[126:127], v[14:15]
    v_cvt_pk_bf16_f32 v79, v126, v127
    v_lshlrev_b32 v126, 16, v79
    v_and_b32 v127, s27, v79
    v_lshlrev_b32 v12, 16, v71
    v_and_b32 v13, s27, v71
    v_pk_add_f32 v[126:127], v[126:127], v[12:13]
    v_cvt_pk_bf16_f32 v71, v126, v127
    s_waitcnt vmcnt(0)
    s_mov_b32 s31, 0
    s_cmp_ge_u32 s26, 31
    s_cbranch_scc1 FT2_8_i1_np
    v_cmp_eq_u32 vcc, 0, v9
    s_cbranch_vccnz FT2_8_i1_np
    s_mov_b32 s31, 1
    s_add_u32 s13, s21, 0
    buffer_load_dwordx4 v[24:27], v4, s[8:11], s13 offen sc1
    s_add_u32 s13, s21, 4096
    buffer_load_dwordx4 v[28:31], v4, s[8:11], s13 offen sc1
    s_add_u32 s13, s21, 32768
    buffer_load_dwordx4 v[32:35], v4, s[8:11], s13 offen sc1
    s_add_u32 s13, s21, 36864
    buffer_load_dwordx4 v[36:39], v4, s[8:11], s13 offen sc1
    s_add_u32 s13, s21, 65536
    buffer_load_dwordx4 v[40:43], v4, s[8:11], s13 offen sc1
    s_add_u32 s13, s21, 69632
    buffer_load_dwordx4 v[44:47], v4, s[8:11], s13 offen sc1
    s_add_u32 s13, s21, 98304
    buffer_load_dwordx4 v[48:51], v4, s[8:11], s13 offen sc1
    s_add_u32 s13, s21, 102400
    buffer_load_dwordx4 v[52:55], v4, s[8:11], s13 offen sc1
    s_add_u32 s13, s20, 0
    buffer_load_dwordx4 v[16:19], v4, s[8:11], s13 offen sc1
    s_add_u32 s13, s20, 4096
    buffer_load_dwordx4 v[20:23], v4, s[8:11], s13 offen sc1
    s_add_u32 s20, s20, 65536
    s_add_u32 s21, s21, 262144
    s_add_u32 s25, s25, 512
FT2_8_i1_np:
    s_add_u32 s13, s22, 4096
    buffer_store_dwordx4 v[64:67], v4, s[8:11], s22 offen sc1
    buffer_store_dwordx4 v[68:71], v4, s[8:11], s13 offen sc1
    v_mov_b32 v12, 0
    v_mov_b32 v13, 0
    v_mov_b32 v14, 0
    v_mov_b32 v15, 0
    v_dot2_f32_bf16 v12, v64, v8, v12
    v_dot2_f32_bf16 v13, v64, v64, v13
    v_dot2_f32_bf16 v14, v65, v8, v14
    v_dot2_f32_bf16 v15, v65, v65, v15
    v_dot2_f32_bf16 v12, v66, v8, v12
    v_dot2_f32_bf16 v13, v66, v66, v13
    v_dot2_f32_bf16 v14, v67, v8, v14
    v_dot2_f32_bf16 v15, v67, v67, v15
    v_dot2_f32_bf16 v12, v68, v8, v12
    v_dot2_f32_bf16 v13, v68, v68, v13
    v_dot2_f32_bf16 v14, v69, v8, v14
    v_dot2_f32_bf16 v15, v69, v69, v15
    v_dot2_f32_bf16 v12, v70, v8, v12
    v_dot2_f32_bf16 v13, v70, v70, v13
    v_dot2_f32_bf16 v14, v71, v8, v14
    v_dot2_f32_bf16 v15, v71, v71, v15
    s_nop 2
    v_pk_add_f32 v[12:13], v[12:13], v[14:15]
    s_nop 1
    v_add_f32_dpp v12, v12, v12 row_ror:8 row_mask:0xf bank_mask:0xf
    v_add_f32_dpp v13, v13, v13 row_ror:8 row_mask:0xf bank_mask:0xf
    v_mov_b32 v10, v12
    v_mov_b32 v11, v13
    s_nop 0
    v_permlane16_swap_b32 v12, v10
    v_permlane16_swap_b32 v13, v11
    v_pk_add_f32 v[12:13], v[12:13], v[10:11]
    v_mov_b32 v10, v12
    v_mov_b32 v11, v13
    s_nop 0
    v_permlane32_swap_b32 v12, v10
    v_permlane32_swap_b32 v13, v11
    v_pk_add_f32 v[12:13], v[12:13], v[10:11]
    s_mov_b64 exec, 0xff
    ds_write_b64 v7, v[12:13] offset:256
    s_mov_b64 exec, -1
    s_waitcnt lgkmcnt(0)
    s_barrier
    ds_read_b64 v[10:11], v6 offset:256
    ds_read_b64 v[12:13], v6 offset:320
    ds_read_b64 v[14:15], v6 offset:384
    ds_read_b64 v[112:113], v6 offset:448
    s_waitcnt lgkmcnt(0)
    v_pk_add_f32 v[10:11], v[10:11], v[12:13]
    v_pk_add_f32 v[14:15], v[14:15], v[112:113]
    v_pk_add_f32 v[10:11], v[10:11], v[14:15]
    v_mul_f32 v10, 0x3b000000, v10
    v_mul_f32 v11, 0x3b000000, v11
    v_fma_f32 v11, -v10, v10, v11
    v_max_f32 v11, 0, v11
    v_cvt_pk_bf16_f32 v14, v10, v11
    v_lshlrev_b32 v12, 16, v14
    v_and_b32 v11, s27, v14
    v_add_f32 v11, 0x3727c5ac, v11
    v_cvt_pk_bf16_f32 v11, v11, v11
    v_and_b32 v11, s27, v11
    v_sqrt_f32 v11, v11
    v_mov_b32 v13, v12
    v_cvt_pk_bf16_f32 v11, v11, v11
    v_and_b32 v11, s27, v11
    v_rcp_f32 v14, v11
    s_nop 0
    v_mov_b32 v15, v14
    v_lshlrev_b32 v112, 16, v64
    v_and_b32 v113, s27, v64
    v_pk_add_f32 v[112:113], v[112:113], v[12:13] neg_lo:[0,1] neg_hi:[0,1]
    v_cvt_pk_bf16_f32 v72, v112, v113
    v_lshlrev_b32 v112, 16, v72
    v_and_b32 v113, s27, v72
    v_pk_mul_f32 v[112:113], v[112:113], v[14:15]
    v_cvt_pk_bf16_f32 v72, v112, v113
    v_lshlrev_b32 v114, 16, v65
    v_and_b32 v115, s27, v65
    v_pk_add_f32 v[114:115], v[114:115], v[12:13] neg_lo:[0,1] neg_hi:[0,1]
    v_cvt_pk_bf16_f32 v73, v114, v115
    v_lshlrev_b32 v114, 16, v73
    v_and_b32 v115, s27, v73
    v_pk_mul_f32 v[114:115], v[114:115], v[14:15]
    v_cvt_pk_bf16_f32 v73, v114, v115
    v_lshlrev_b32 v116, 16, v66
    v_and_b32 v117, s27, v66
    v_pk_add_f32 v[116:117], v[116:117], v[12:13] neg_lo:[0,1] neg_hi:[0,1]
    v_cvt_pk_bf16_f32 v74, v116, v117
    v_lshlrev_b32 v116, 16, v74
    v_and_b32 v117, s27, v74
    v_pk_mul_f32 v[116:117], v[116:117], v[14:15]
    v_cvt_pk_bf16_f32 v74, v116, v117
    v_lshlrev_b32 v118, 16, v67
    v_and_b32 v119, s27, v67
    v_pk_add_f32 v[118:119], v[118:119], v[12:13] neg_lo:[0,1] neg_hi:[0,1]
    v_cvt_pk_bf16_f32 v75, v118, v119
    v_lshlrev_b32 v118, 16, v75
    v_and_b32 v119, s27, v75
    v_pk_mul_f32 v[118:119], v[118:119], v[14:15]
    v_cvt_pk_bf16_f32 v75, v118, v119
    v_lshlrev_b32 v120, 16, v68
    v_and_b32 v121, s27, v68
    v_pk_add_f32 v[120:121], v[120:121], v[12:13] neg_lo:[0,1] neg_hi:[0,1]
    v_cvt_pk_bf16_f32 v76, v120, v121
    v_lshlrev_b32 v120, 16, v76
    v_and_b32 v121, s27, v76
    v_pk_mul_f32 v[120:121], v[120:121], v[14:15]
    v_cvt_pk_bf16_f32 v76, v120, v121
    v_lshlrev_b32 v122, 16, v69
    v_and_b32 v123, s27, v69
    v_pk_add_f32 v[122:123], v[122:123], v[12:13] neg_lo:[0,1] neg_hi:[0,1]
    v_cvt_pk_bf16_f32 v77, v122, v123
    v_lshlrev_b32 v122, 16, v77
    v_and_b32 v123, s27, v77
    v_pk_mul_f32 v[122:123], v[122:123], v[14:15]
    v_cvt_pk_bf16_f32 v77, v122, v123
    v_lshlrev_b32 v124, 16, v70
    v_and_b32 v125, s27, v70
    v_pk_add_f32 v[124:125], v[124:125], v[12:13] neg_lo:[0,1] neg_hi:[0,1]
    v_cvt_pk_bf16_f32 v78, v124, v125
    v_lshlrev_b32 v124, 16, v78
    v_and_b32 v125, s27, v78
    v_pk_mul_f32 v[124:125], v[124:125], v[14:15]
    v_cvt_pk_bf16_f32 v78, v124, v125
    v_lshlrev_b32 v126, 16, v71
    v_and_b32 v127, s27, v71
    v_pk_add_f32 v[126:127], v[126:127], v[12:13] neg_lo:[0,1] neg_hi:[0,1]
    v_cvt_pk_bf16_f32 v79, v126, v127
    v_lshlrev_b32 v126, 16, v79
    v_and_b32 v127, s27, v79
    v_pk_mul_f32 v[126:127], v[126:127], v[14:15]
    v_cvt_pk_bf16_f32 v79, v126, v127
    s_add_u32 s13, s23, 4096
    buffer_store_dwordx4 v[72:75], v4, s[8:11], s23 offen sc1
    buffer_store_dwordx4 v[76:79], v4, s[8:11], s13 offen sc1
    s_add_u32 s22, s22, 65536
    s_add_u32 s23, s23, 65536
    s_waitcnt vmcnt(0)
    v_mov_b32 v251, 1
    v_mov_b32 v250, 0
    s_mov_b64 exec, 1
    buffer_store_dword v251, v250, s[8:11], s24 offen sc1
    s_mov_b64 exec, -1
    s_add_u32 s24, s24, 256
    s_add_u32 s26, s26, 1
    s_cmp_eq_u32 s31, 1
    s_cbranch_scc0 FT2_8_i1_slow
    s_mov_b32 s31, 0
    s_branch FT2_8_i0
FT2_8_i1_slow:
    s_cmp_ge_u32 s26, 32
    s_cbranch_scc1 FT2_8_done
    s_mov_b32 s96, 0
    v_mbcnt_lo_u32_b32 v250, -1, 0
    v_mbcnt_hi_u32_b32 v250, -1, v250
    v_min_u32 v250, 63, v250
    v_lshlrev_b32 v250, 2, v250
FT2_8_i1ws_11_spin:
    buffer_load_dword v251, v250, s[8:11], s25 offen sc1
    s_waitcnt vmcnt(0)
    v_cmp_eq_u32 vcc, 0, v251
    s_cbranch_vccz FT2_8_i1ws_11_ok
    s_add_u32 s96, s96, 1
    s_cmp_gt_u32 s96, 300000
    s_cbranch_scc1 L_fail
    s_sleep 1
    s_branch FT2_8_i1ws_11_spin
FT2_8_i1ws_11_ok:
    s_add_u32 s13, s21, 0
    buffer_load_dwordx4 v[24:27], v4, s[8:11], s13 offen sc1
    s_add_u32 s13, s21, 4096
    buffer_load_dwordx4 v[28:31], v4, s[8:11], s13 offen sc1
    s_add_u32 s13, s21, 32768
    buffer_load_dwordx4 v[32:35], v4, s[8:11], s13 offen sc1
    s_add_u32 s13, s21, 36864
    buffer_load_dwordx4 v[36:39], v4, s[8:11], s13 offen sc1
    s_add_u32 s13, s21, 65536
    buffer_load_dwordx4 v[40:43], v4, s[8:11], s13 offen sc1
    s_add_u32 s13, s21, 69632
    buffer_load_dwordx4 v[44:47], v4, s[8:11], s13 offen sc1
    s_add_u32 s13, s21, 98304
    buffer_load_dwordx4 v[48:51], v4, s[8:11], s13 offen sc1
    s_add_u32 s13, s21, 102400
    buffer_load_dwordx4 v[52:55], v4, s[8:11], s13 offen sc1
    s_add_u32 s13, s20, 0
    buffer_load_dwordx4 v[16:19], v4, s[8:11], s13 offen sc1
    s_add_u32 s13, s20, 4096
    buffer_load_dwordx4 v[20:23], v4, s[8:11], s13 offen sc1
    s_add_u32 s20, s20, 65536
    s_add_u32 s21, s21, 262144
    s_add_u32 s25, s25, 512
    s_branch FT2_8_i0
FT2_8_done:
LE_FT2:
    s_endpgm
L_F3:
LB_FT3:
    v_and_b32 v1, 7, v0
    v_bfe_u32 v2, v0, 3, 1
    v_lshrrev_b32 v3, 4, v0
    v_lshlrev_b32 v4, 4, v1
    v_lshl_add_u32 v4, v2, 9, v4
    v_lshl_add_u32 v4, v3, 10, v4
    s_lshl_b32 s12, s6, 13
    s_lshl_b32 s13, s5, 7
    s_add_u32 s12, s12, s13
    v_add_u32 v4, s12, v4
    s_lshl_b32 s13, s5, 3
    v_add_u32 v5, s13, v1
    v_lshlrev_b32 v5, 10, v5
    v_lshl_add_u32 v5, v3, 5, v5
    v_lshl_add_u32 v5, v2, 4, v5
    s_lshl_b32 s13, s6, 8
    v_add_u32 v5, s13, v5
    v_lshlrev_b32 v6, 3, v1
    s_lshl_b32 s13, s6, 6
    v_add_u32 v7, s13, v6
    s_load_dwordx2 s[16:17], s[0:1], 80
    s_waitcnt lgkmcnt(0)
    s_mov_b32 s18, 2097152
    s_mov_b32 s19, 0x20000
    s_mov_b32 s20, 188743680
    s_mov_b32 s21, 159383552
    s_mov_b32 s22, 0
    s_mov_b32 s25, 205815808
    s_lshl_b32 s13, s5, 4
    s_lshl_b32 s14, s6, 2
    s_add_u32 s13, s13, s14
    s_mov_b32 s26, 0
    v_mov_b32 v8, 0x3f803f80
    s_mov_b32 s27, 0xffff0000
    s_mov_b32 s30, 0
    s_mov_b32 s31, 0
    s_load_dwordx2 s[92:93], s[0:1], 88
    s_waitcnt lgkmcnt(0)
    s_mov_b32 s94, 256
    s_mov_b32 s95, 0x20000
    s_mov_b32 s96, 0
FT3_12_iw:
    v_mbcnt_lo_u32_b32 v9, -1, 0
    v_mbcnt_hi_u32_b32 v9, -1, v9
    v_min_u32 v9, 7, v9
    v_and_b32 v10, 1, v9
    v_lshlrev_b32 v10, 7, v10
    v_lshrrev_b32 v9, 1, v9
    v_lshl_add_u32 v9, v9, 2, v10
    buffer_load_dword v9, v9, s[92:95], 0 offen sc1
    s_waitcnt vmcnt(0)
    v_cmp_gt_u32 vcc, 32, v9
    s_cmp_eq_u64 vcc, 0
    s_cselect_b32 s97, 256, 0
    s_cmp_ge_u32 s97, 256
    s_cbranch_scc1 FT3_12_iwd
    s_add_u32 s96, s96, 1
    s_cmp_gt_u32 s96, 300000
    s_cbranch_scc1 L_fail
    s_sleep 2
    s_branch FT3_12_iw
FT3_12_iwd:
    s_mov_b32 s96, 0
    v_mbcnt_lo_u32_b32 v250, -1, 0
    v_mbcnt_hi_u32_b32 v250, -1, v250
    v_min_u32 v250, 63, v250
    v_lshlrev_b32 v250, 2, v250
FT3_12w0_13_spin:
    buffer_load_dword v251, v250, s[8:11], s25 offen sc1
    s_waitcnt vmcnt(0)
    v_cmp_eq_u32 vcc, 0, v251
    s_cbranch_vccz FT3_12w0_13_ok
    s_add_u32 s96, s96, 1
    s_cmp_gt_u32 s96, 300000
    s_cbranch_scc1 L_fail
    s_sleep 1
    s_branch FT3_12w0_13_spin
FT3_12w0_13_ok:
    s_add_u32 s13, s21, 0
    buffer_load_dwordx4 v[24:27], v4, s[8:11], s13 offen sc1
    s_add_u32 s13, s21, 4096
    buffer_load_dwordx4 v[28:31], v4, s[8:11], s13 offen sc1
    s_add_u32 s13, s21, 32768
    buffer_load_dwordx4 v[32:35], v4, s[8:11], s13 offen sc1
    s_add_u32 s13, s21, 36864
    buffer_load_dwordx4 v[36:39], v4, s[8:11], s13 offen sc1
    s_add_u32 s13, s21, 65536
    buffer_load_dwordx4 v[40:43], v4, s[8:11], s13 offen sc1
    s_add_u32 s13, s21, 69632
    buffer_load_dwordx4 v[44:47], v4, s[8:11], s13 offen sc1
    s_add_u32 s13, s21, 98304
    buffer_load_dwordx4 v[48:51], v4, s[8:11], s13 offen sc1
    s_add_u32 s13, s21, 102400
    buffer_load_dwordx4 v[52:55], v4, s[8:11], s13 offen sc1
    s_add_u32 s13, s20, 0
    buffer_load_dwordx4 v[16:19], v4, s[8:11], s13 offen sc1
    s_add_u32 s13, s20, 4096
    buffer_load_dwordx4 v[20:23], v4, s[8:11], s13 offen sc1
    s_add_u32 s20, s20, 32768
    s_add_u32 s21, s21, 131072
    s_add_u32 s25, s25, 256
FT3_12_i0:
    v_mbcnt_lo_u32_b32 v10, -1, 0
    v_mbcnt_hi_u32_b32 v10, -1, v10
    v_min_u32 v10, 63, v10
    v_lshlrev_b32 v10, 2, v10
    buffer_load_dword v9, v10, s[8:11], s25 offen sc1
    s_cmp_eq_u32 s31, 0
    s_cbranch_scc1 FT3_12_i0_w1
    s_waitcnt vmcnt(3)
    s_branch FT3_12_i0_w2
FT3_12_i0_w1:
    s_waitcnt vmcnt(1)
FT3_12_i0_w2:
    v_lshlrev_b32 v112, 16, v24
    v_and_b32 v113, s27, v24
    v_lshlrev_b32 v12, 16, v32
    v_and_b32 v13, s27, v32
    v_lshlrev_b32 v14, 16, v40
    v_and_b32 v15, s27, v40
    v_pk_add_f32 v[112:113], v[112:113], v[12:13]
    v_lshlrev_b32 v12, 16, v48
    v_and_b32 v13, s27, v48
    v_pk_add_f32 v[14:15], v[14:15], v[12:13]
    v_pk_add_f32 v[112:113], v[112:113], v[14:15]
    v_cvt_pk_bf16_f32 v24, v112, v113
    v_lshlrev_b32 v112, 16, v24
    v_and_b32 v113, s27, v24
    v_lshlrev_b32 v12, 16, v16
    v_and_b32 v13, s27, v16
    v_pk_add_f32 v[112:113], v[112:113], v[12:13]
    v_cvt_pk_bf16_f32 v16, v112, v113
    v_lshlrev_b32 v114, 16, v25
    v_and_b32 v115, s27, v25
    v_lshlrev_b32 v12, 16, v33
    v_and_b32 v13, s27, v33
    v_lshlrev_b32 v14, 16, v41
    v_and_b32 v15, s27, v41
    v_pk_add_f32 v[114:115], v[114:115], v[12:13]
    v_lshlrev_b32 v12, 16, v49
    v_and_b32 v13, s27, v49
    v_pk_add_f32 v[14:15], v[14:15], v[12:13]
    v_pk_add_f32 v[114:115], v[114:115], v[14:15]
    v_cvt_pk_bf16_f32 v25, v114, v115
    v_lshlrev_b32 v114, 16, v25
    v_and_b32 v115, s27, v25
    v_lshlrev_b32 v12, 16, v17
    v_and_b32 v13, s27, v17
    v_pk_add_f32 v[114:115], v[114:115], v[12:13]
    v_cvt_pk_bf16_f32 v17, v114, v115
    v_lshlrev_b32 v116, 16, v26
    v_and_b32 v117, s27, v26
    v_lshlrev_b32 v12, 16, v34
    v_and_b32 v13, s27, v34
    v_lshlrev_b32 v14, 16, v42
    v_and_b32 v15, s27, v42
    v_pk_add_f32 v[116:117], v[116:117], v[12:13]
    v_lshlrev_b32 v12, 16, v50
    v_and_b32 v13, s27, v50
    v_pk_add_f32 v[14:15], v[14:15], v[12:13]
    v_pk_add_f32 v[116:117], v[116:117], v[14:15]
    v_cvt_pk_bf16_f32 v26, v116, v117
    v_lshlrev_b32 v116, 16, v26
    v_and_b32 v117, s27, v26
    v_lshlrev_b32 v12, 16, v18
    v_and_b32 v13, s27, v18
    v_pk_add_f32 v[116:117], v[116:117], v[12:13]
    v_cvt_pk_bf16_f32 v18, v116, v117
    v_lshlrev_b32 v118, 16, v27
    v_and_b32 v119, s27, v27
    v_lshlrev_b32 v12, 16, v35
    v_and_b32 v13, s27, v35
    v_lshlrev_b32 v14, 16, v43
    v_and_b32 v15, s27, v43
    v_pk_add_f32 v[118:119], v[118:119], v[12:13]
    v_lshlrev_b32 v12, 16, v51
    v_and_b32 v13, s27, v51
    v_pk_add_f32 v[14:15], v[14:15], v[12:13]
    v_pk_add_f32 v[118:119], v[118:119], v[14:15]
    v_cvt_pk_bf16_f32 v27, v118, v119
    v_lshlrev_b32 v118, 16, v27
    v_and_b32 v119, s27, v27
    v_lshlrev_b32 v12, 16, v19
    v_and_b32 v13, s27, v19
    v_pk_add_f32 v[118:119], v[118:119], v[12:13]
    v_cvt_pk_bf16_f32 v19, v118, v119
    v_lshlrev_b32 v120, 16, v28
    v_and_b32 v121, s27, v28
    v_lshlrev_b32 v12, 16, v36
    v_and_b32 v13, s27, v36
    v_lshlrev_b32 v14, 16, v44
    v_and_b32 v15, s27, v44
    v_pk_add_f32 v[120:121], v[120:121], v[12:13]
    v_lshlrev_b32 v12, 16, v52
    v_and_b32 v13, s27, v52
    v_pk_add_f32 v[14:15], v[14:15], v[12:13]
    v_pk_add_f32 v[120:121], v[120:121], v[14:15]
    v_cvt_pk_bf16_f32 v28, v120, v121
    v_lshlrev_b32 v120, 16, v28
    v_and_b32 v121, s27, v28
    v_lshlrev_b32 v12, 16, v20
    v_and_b32 v13, s27, v20
    v_pk_add_f32 v[120:121], v[120:121], v[12:13]
    v_cvt_pk_bf16_f32 v20, v120, v121
    v_lshlrev_b32 v122, 16, v29
    v_and_b32 v123, s27, v29
    v_lshlrev_b32 v12, 16, v37
    v_and_b32 v13, s27, v37
    v_lshlrev_b32 v14, 16, v45
    v_and_b32 v15, s27, v45
    v_pk_add_f32 v[122:123], v[122:123], v[12:13]
    v_lshlrev_b32 v12, 16, v53
    v_and_b32 v13, s27, v53
    v_pk_add_f32 v[14:15], v[14:15], v[12:13]
    v_pk_add_f32 v[122:123], v[122:123], v[14:15]
    v_cvt_pk_bf16_f32 v29, v122, v123
    v_lshlrev_b32 v122, 16, v29
    v_and_b32 v123, s27, v29
    v_lshlrev_b32 v12, 16, v21
    v_and_b32 v13, s27, v21
    v_pk_add_f32 v[122:123], v[122:123], v[12:13]
    v_cvt_pk_bf16_f32 v21, v122, v123
    v_lshlrev_b32 v124, 16, v30
    v_and_b32 v125, s27, v30
    v_lshlrev_b32 v12, 16, v38
    v_and_b32 v13, s27, v38
    v_lshlrev_b32 v14, 16, v46
    v_and_b32 v15, s27, v46
    v_pk_add_f32 v[124:125], v[124:125], v[12:13]
    v_lshlrev_b32 v12, 16, v54
    v_and_b32 v13, s27, v54
    v_pk_add_f32 v[14:15], v[14:15], v[12:13]
    v_pk_add_f32 v[124:125], v[124:125], v[14:15]
    v_cvt_pk_bf16_f32 v30, v124, v125
    v_lshlrev_b32 v124, 16, v30
    v_and_b32 v125, s27, v30
    v_lshlrev_b32 v12, 16, v22
    v_and_b32 v13, s27, v22
    v_pk_add_f32 v[124:125], v[124:125], v[12:13]
    v_cvt_pk_bf16_f32 v22, v124, v125
    v_lshlrev_b32 v126, 16, v31
    v_and_b32 v127, s27, v31
    v_lshlrev_b32 v12, 16, v39
    v_and_b32 v13, s27, v39
    v_lshlrev_b32 v14, 16, v47
    v_and_b32 v15, s27, v47
    v_pk_add_f32 v[126:127], v[126:127], v[12:13]
    v_lshlrev_b32 v12, 16, v55
    v_and_b32 v13, s27, v55
    v_pk_add_f32 v[14:15], v[14:15], v[12:13]
    v_pk_add_f32 v[126:127], v[126:127], v[14:15]
    v_cvt_pk_bf16_f32 v31, v126, v127
    v_lshlrev_b32 v126, 16, v31
    v_and_b32 v127, s27, v31
    v_lshlrev_b32 v12, 16, v23
    v_and_b32 v13, s27, v23
    v_pk_add_f32 v[126:127], v[126:127], v[12:13]
    v_cvt_pk_bf16_f32 v23, v126, v127
    v_mov_b32 v12, v16
    s_nop 1
    v_mov_b32_dpp v16, v18 row_shr:8 row_mask:0xf bank_mask:0xc
    v_mov_b32_dpp v18, v12 row_shl:8 row_mask:0xf bank_mask:0x3
    v_mov_b32 v12, v17
    s_nop 1
    v_mov_b32_dpp v17, v19 row_shr:8 row_mask:0xf bank_mask:0xc
    v_mov_b32_dpp v19, v12 row_shl:8 row_mask:0xf bank_mask:0x3
    v_mov_b32 v12, v20
    s_nop 1
    v_mov_b32_dpp v20, v22 row_shr:8 row_mask:0xf bank_mask:0xc
    v_mov_b32_dpp v22, v12 row_shl:8 row_mask:0xf bank_mask:0x3
    v_mov_b32 v12, v21
    s_nop 1
    v_mov_b32_dpp v21, v23 row_shr:8 row_mask:0xf bank_mask:0xc
    v_mov_b32_dpp v23, v12 row_shl:8 row_mask:0xf bank_mask:0x3
    buffer_store_dwordx4 v[16:19], v5, s[16:19], s22 offen offset:0
    buffer_store_dwordx4 v[20:23], v5, s[16:19], s22 offen offset:128
    s_add_u32 s22, s22, 32768
    s_waitcnt vmcnt(2)
    s_mov_b32 s31, 0
    s_cmp_ge_u32 s26, 63
    s_cbranch_scc1 FT3_12_i0_np
    v_cmp_eq_u32 vcc, 0, v9
    s_cbranch_vccnz FT3_12_i0_np
    s_mov_b32 s31, 1
    s_add_u32 s13, s21, 0
    buffer_load_dwordx4 v[72:75], v4, s[8:11], s13 offen sc1
    s_add_u32 s13, s21, 4096
    buffer_load_dwordx4 v[76:79], v4, s[8:11], s13 offen sc1
    s_add_u32 s13, s21, 32768
    buffer_load_dwordx4 v[80:83], v4, s[8:11], s13 offen sc1
    s_add_u32 s13, s21, 36864
    buffer_load_dwordx4 v[84:87], v4, s[8:11], s13 offen sc1
    s_add_u32 s13, s21, 65536
    buffer_load_dwordx4 v[88:91], v4, s[8:11], s13 offen sc1
    s_add_u32 s13, s21, 69632
    buffer_load_dwordx4 v[92:95], v4, s[8:11], s13 offen sc1
    s_add_u32 s13, s21, 98304
    buffer_load_dwordx4 v[96:99], v4, s[8:11], s13 offen sc1
    s_add_u32 s13, s21, 102400
    buffer_load_dwordx4 v[100:103], v4, s[8:11], s13 offen sc1
    s_add_u32 s13, s20, 0
    buffer_load_dwordx4 v[64:67], v4, s[8:11], s13 offen sc1
    s_add_u32 s13, s20, 4096
    buffer_load_dwordx4 v[68:71], v4, s[8:11], s13 offen sc1
    s_add_u32 s20, s20, 32768
    s_add_u32 s21, s21, 131072
    s_add_u32 s25, s25, 256
FT3_12_i0_np:
    s_add_u32 s26, s26, 1
    s_cmp_eq_u32 s31, 1
    s_cbranch_scc0 FT3_12_i0_slow
    s_mov_b32 s31, 0
    s_branch FT3_12_i1
FT3_12_i0_slow:
    s_cmp_ge_u32 s26, 64
    s_cbranch_scc1 FT3_12_done
    s_mov_b32 s96, 0
    v_mbcnt_lo_u32_b32 v250, -1, 0
    v_mbcnt_hi_u32_b32 v250, -1, v250
    v_min_u32 v250, 63, v250
    v_lshlrev_b32 v250, 2, v250
FT3_12_i0ws_14_spin:
    buffer_load_dword v251, v250, s[8:11], s25 offen sc1
    s_waitcnt vmcnt(0)
    v_cmp_eq_u32 vcc, 0, v251
    s_cbranch_vccz FT3_12_i0ws_14_ok
    s_add_u32 s96, s96, 1
    s_cmp_gt_u32 s96, 300000
    s_cbranch_scc1 L_fail
    s_sleep 1
    s_branch FT3_12_i0ws_14_spin
FT3_12_i0ws_14_ok:
    s_add_u32 s13, s21, 0
    buffer_load_dwordx4 v[72:75], v4, s[8:11], s13 offen sc1
    s_add_u32 s13, s21, 4096
    buffer_load_dwordx4 v[76:79], v4, s[8:11], s13 offen sc1
    s_add_u32 s13, s21, 32768
    buffer_load_dwordx4 v[80:83], v4, s[8:11], s13 offen sc1
    s_add_u32 s13, s21, 36864
    buffer_load_dwordx4 v[84:87], v4, s[8:11], s13 offen sc1
    s_add_u32 s13, s21, 65536
    buffer_load_dwordx4 v[88:91], v4, s[8:11], s13 offen sc1
    s_add_u32 s13, s21, 69632
    buffer_load_dwordx4 v[92:95], v4, s[8:11], s13 offen sc1
    s_add_u32 s13, s21, 98304
    buffer_load_dwordx4 v[96:99], v4, s[8:11], s13 offen sc1
    s_add_u32 s13, s21, 102400
    buffer_load_dwordx4 v[100:103], v4, s[8:11], s13 offen sc1
    s_add_u32 s13, s20, 0
    buffer_load_dwordx4 v[64:67], v4, s[8:11], s13 offen sc1
    s_add_u32 s13, s20, 4096
    buffer_load_dwordx4 v[68:71], v4, s[8:11], s13 offen sc1
    s_add_u32 s20, s20, 32768
    s_add_u32 s21, s21, 131072
    s_add_u32 s25, s25, 256
FT3_12_i1:
    v_mbcnt_lo_u32_b32 v10, -1, 0
    v_mbcnt_hi_u32_b32 v10, -1, v10
    v_min_u32 v10, 63, v10
    v_lshlrev_b32 v10, 2, v10
    buffer_load_dword v9, v10, s[8:11], s25 offen sc1
    s_cmp_eq_u32 s31, 0
    s_cbranch_scc1 FT3_12_i1_w1
    s_waitcnt vmcnt(3)
    s_branch FT3_12_i1_w2
FT3_12_i1_w1:
    s_waitcnt vmcnt(1)
FT3_12_i1_w2:
    v_lshlrev_b32 v112, 16, v72
    v_and_b32 v113, s27, v72
    v_lshlrev_b32 v12, 16, v80
    v_and_b32 v13, s27, v80
    v_lshlrev_b32 v14, 16, v88
    v_and_b32 v15, s27, v88
    v_pk_add_f32 v[112:113], v[112:113], v[12:13]
    v_lshlrev_b32 v12, 16, v96
    v_and_b32 v13, s27, v96
    v_pk_add_f32 v[14:15], v[14:15], v[12:13]
    v_pk_add_f32 v[112:113], v[112:113], v[14:15]
    v_cvt_pk_bf16_f32 v72, v112, v113
    v_lshlrev_b32 v112, 16, v72
    v_and_b32 v113, s27, v72
    v_lshlrev_b32 v12, 16, v64
    v_and_b32 v13, s27, v64
    v_pk_add_f32 v[112:113], v[112:113], v[12:13]
    v_cvt_pk_bf16_f32 v64, v112, v113
    v_lshlrev_b32 v114, 16, v73
    v_and_b32 v115, s27, v73
    v_lshlrev_b32 v12, 16, v81
    v_and_b32 v13, s27, v81
    v_lshlrev_b32 v14, 16, v89
    v_and_b32 v15, s27, v89
    v_pk_add_f32 v[114:115], v[114:115], v[12:13]
    v_lshlrev_b32 v12, 16, v97
    v_and_b32 v13, s27, v97
    v_pk_add_f32 v[14:15], v[14:15], v[12:13]
    v_pk_add_f32 v[114:115], v[114:115], v[14:15]
    v_cvt_pk_bf16_f32 v73, v114, v115
    v_lshlrev_b32 v114, 16, v73
    v_and_b32 v115, s27, v73
    v_lshlrev_b32 v12, 16, v65
    v_and_b32 v13, s27, v65
    v_pk_add_f32 v[114:115], v[114:115], v[12:13]
    v_cvt_pk_bf16_f32 v65, v114, v115
    v_lshlrev_b32 v116, 16, v74
    v_and_b32 v117, s27, v74
    v_lshlrev_b32 v12, 16, v82
    v_and_b32 v13, s27, v82
    v_lshlrev_b32 v14, 16, v90
    v_and_b32 v15, s27, v90
    v_pk_add_f32 v[116:117], v[116:117], v[12:13]
    v_lshlrev_b32 v12, 16, v98
    v_and_b32 v13, s27, v98
    v_pk_add_f32 v[14:15], v[14:15], v[12:13]
    v_pk_add_f32 v[116:117], v[116:117], v[14:15]
    v_cvt_pk_bf16_f32 v74, v116, v117
    v_lshlrev_b32 v116, 16, v74
    v_and_b32 v117, s27, v74
    v_lshlrev_b32 v12, 16, v66
    v_and_b32 v13, s27, v66
    v_pk_add_f32 v[116:117], v[116:117], v[12:13]
    v_cvt_pk_bf16_f32 v66, v116, v117
    v_lshlrev_b32 v118, 16, v75
    v_and_b32 v119, s27, v75
    v_lshlrev_b32 v12, 16, v83
    v_and_b32 v13, s27, v83
    v_lshlrev_b32 v14, 16, v91
    v_and_b32 v15, s27, v91
    v_pk_add_f32 v[118:119], v[118:119], v[12:13]
    v_lshlrev_b32 v12, 16, v99
    v_and_b32 v13, s27, v99
    v_pk_add_f32 v[14:15], v[14:15], v[12:13]
    v_pk_add_f32 v[118:119], v[118:119], v[14:15]
    v_cvt_pk_bf16_f32 v75, v118, v119
    v_lshlrev_b32 v118, 16, v75
    v_and_b32 v119, s27, v75
    v_lshlrev_b32 v12, 16, v67
    v_and_b32 v13, s27, v67
    v_pk_add_f32 v[118:119], v[118:119], v[12:13]
    v_cvt_pk_bf16_f32 v67, v118, v119
    v_lshlrev_b32 v120, 16, v76
    v_and_b32 v121, s27, v76
    v_lshlrev_b32 v12, 16, v84
    v_and_b32 v13, s27, v84
    v_lshlrev_b32 v14, 16, v92
    v_and_b32 v15, s27, v92
    v_pk_add_f32 v[120:121], v[120:121], v[12:13]
    v_lshlrev_b32 v12, 16, v100
    v_and_b32 v13, s27, v100
    v_pk_add_f32 v[14:15], v[14:15], v[12:13]
    v_pk_add_f32 v[120:121], v[120:121], v[14:15]
    v_cvt_pk_bf16_f32 v76, v120, v121
    v_lshlrev_b32 v120, 16, v76
    v_and_b32 v121, s27, v76
    v_lshlrev_b32 v12, 16, v68
    v_and_b32 v13, s27, v68
    v_pk_add_f32 v[120:121], v[120:121], v[12:13]
    v_cvt_pk_bf16_f32 v68, v120, v121
    v_lshlrev_b32 v122, 16, v77
    v_and_b32 v123, s27, v77
    v_lshlrev_b32 v12, 16, v85
    v_and_b32 v13, s27, v85
    v_lshlrev_b32 v14, 16, v93
    v_and_b32 v15, s27, v93
    v_pk_add_f32 v[122:123], v[122:123], v[12:13]
    v_lshlrev_b32 v12, 16, v101
    v_and_b32 v13, s27, v101
    v_pk_add_f32 v[14:15], v[14:15], v[12:13]
    v_pk_add_f32 v[122:123], v[122:123], v[14:15]
    v_cvt_pk_bf16_f32 v77, v122, v123
    v_lshlrev_b32 v122, 16, v77
    v_and_b32 v123, s27, v77
    v_lshlrev_b32 v12, 16, v69
    v_and_b32 v13, s27, v69
    v_pk_add_f32 v[122:123], v[122:123], v[12:13]
    v_cvt_pk_bf16_f32 v69, v122, v123
    v_lshlrev_b32 v124, 16, v78
    v_and_b32 v125, s27, v78
    v_lshlrev_b32 v12, 16, v86
    v_and_b32 v13, s27, v86
    v_lshlrev_b32 v14, 16, v94
    v_and_b32 v15, s27, v94
    v_pk_add_f32 v[124:125], v[124:125], v[12:13]
    v_lshlrev_b32 v12, 16, v102
    v_and_b32 v13, s27, v102
    v_pk_add_f32 v[14:15], v[14:15], v[12:13]
    v_pk_add_f32 v[124:125], v[124:125], v[14:15]
    v_cvt_pk_bf16_f32 v78, v124, v125
    v_lshlrev_b32 v124, 16, v78
    v_and_b32 v125, s27, v78
    v_lshlrev_b32 v12, 16, v70
    v_and_b32 v13, s27, v70
    v_pk_add_f32 v[124:125], v[124:125], v[12:13]
    v_cvt_pk_bf16_f32 v70, v124, v125
    v_lshlrev_b32 v126, 16, v79
    v_and_b32 v127, s27, v79
    v_lshlrev_b32 v12, 16, v87
    v_and_b32 v13, s27, v87
    v_lshlrev_b32 v14, 16, v95
    v_and_b32 v15, s27, v95
    v_pk_add_f32 v[126:127], v[126:127], v[12:13]
    v_lshlrev_b32 v12, 16, v103
    v_and_b32 v13, s27, v103
    v_pk_add_f32 v[14:15], v[14:15], v[12:13]
    v_pk_add_f32 v[126:127], v[126:127], v[14:15]
    v_cvt_pk_bf16_f32 v79, v126, v127
    v_lshlrev_b32 v126, 16, v79
    v_and_b32 v127, s27, v79
    v_lshlrev_b32 v12, 16, v71
    v_and_b32 v13, s27, v71
    v_pk_add_f32 v[126:127], v[126:127], v[12:13]
    v_cvt_pk_bf16_f32 v71, v126, v127
    v_mov_b32 v12, v64
    s_nop 1
    v_mov_b32_dpp v64, v66 row_shr:8 row_mask:0xf bank_mask:0xc
    v_mov_b32_dpp v66, v12 row_shl:8 row_mask:0xf bank_mask:0x3
    v_mov_b32 v12, v65
    s_nop 1
    v_mov_b32_dpp v65, v67 row_shr:8 row_mask:0xf bank_mask:0xc
    v_mov_b32_dpp v67, v12 row_shl:8 row_mask:0xf bank_mask:0x3
    v_mov_b32 v12, v68
    s_nop 1
    v_mov_b32_dpp v68, v70 row_shr:8 row_mask:0xf bank_mask:0xc
    v_mov_b32_dpp v70, v12 row_shl:8 row_mask:0xf bank_mask:0x3
    v_mov_b32 v12, v69
    s_nop 1
    v_mov_b32_dpp v69, v71 row_shr:8 row_mask:0xf bank_mask:0xc
    v_mov_b32_dpp v71, v12 row_shl:8 row_mask:0xf bank_mask:0x3
    buffer_store_dwordx4 v[64:67], v5, s[16:19], s22 offen offset:0
    buffer_store_dwordx4 v[68:71], v5, s[16:19], s22 offen offset:128
    s_add_u32 s22, s22, 32768
    s_waitcnt vmcnt(2)
    s_mov_b32 s31, 0
    s_cmp_ge_u32 s26, 63
    s_cbranch_scc1 FT3_12_i1_np
    v_cmp_eq_u32 vcc, 0, v9
    s_cbranch_vccnz FT3_12_i1_np
    s_mov_b32 s31, 1
    s_add_u32 s13, s21, 0
    buffer_load_dwordx4 v[24:27], v4, s[8:11], s13 offen sc1
    s_add_u32 s13, s21, 4096
    buffer_load_dwordx4 v[28:31], v4, s[8:11], s13 offen sc1
    s_add_u32 s13, s21, 32768
    buffer_load_dwordx4 v[32:35], v4, s[8:11], s13 offen sc1
    s_add_u32 s13, s21, 36864
    buffer_load_dwordx4 v[36:39], v4, s[8:11], s13 offen sc1
    s_add_u32 s13, s21, 65536
    buffer_load_dwordx4 v[40:43], v4, s[8:11], s13 offen sc1
    s_add_u32 s13, s21, 69632
    buffer_load_dwordx4 v[44:47], v4, s[8:11], s13 offen sc1
    s_add_u32 s13, s21, 98304
    buffer_load_dwordx4 v[48:51], v4, s[8:11], s13 offen sc1
    s_add_u32 s13, s21, 102400
    buffer_load_dwordx4 v[52:55], v4, s[8:11], s13 offen sc1
    s_add_u32 s13, s20, 0
    buffer_load_dwordx4 v[16:19], v4, s[8:11], s13 offen sc1
    s_add_u32 s13, s20, 4096
    buffer_load_dwordx4 v[20:23], v4, s[8:11], s13 offen sc1
    s_add_u32 s20, s20, 32768
    s_add_u32 s21, s21, 131072
    s_add_u32 s25, s25, 256
FT3_12_i1_np:
    s_add_u32 s26, s26, 1
    s_cmp_eq_u32 s31, 1
    s_cbranch_scc0 FT3_12_i1_slow
    s_mov_b32 s31, 0
    s_branch FT3_12_i0
FT3_12_i1_slow:
    s_cmp_ge_u32 s26, 64
    s_cbranch_scc1 FT3_12_done
    s_mov_b32 s96, 0
    v_mbcnt_lo_u32_b32 v250, -1, 0
    v_mbcnt_hi_u32_b32 v250, -1, v250
    v_min_u32 v250, 63, v250
    v_lshlrev_b32 v250, 2, v250
FT3_12_i1ws_15_spin:
    buffer_load_dword v251, v250, s[8:11], s25 offen sc1
    s_waitcnt vmcnt(0)
    v_cmp_eq_u32 vcc, 0, v251
    s_cbranch_vccz FT3_12_i1ws_15_ok
    s_add_u32 s96, s96, 1
    s_cmp_gt_u32 s96, 300000
    s_cbranch_scc1 L_fail
    s_sleep 1
    s_branch FT3_12_i1ws_15_spin
FT3_12_i1ws_15_ok:
    s_add_u32 s13, s21, 0
    buffer_load_dwordx4 v[24:27], v4, s[8:11], s13 offen sc1
    s_add_u32 s13, s21, 4096
    buffer_load_dwordx4 v[28:31], v4, s[8:11], s13 offen sc1
    s_add_u32 s13, s21, 32768
    buffer_load_dwordx4 v[32:35], v4, s[8:11], s13 offen sc1
    s_add_u32 s13, s21, 36864
    buffer_load_dwordx4 v[36:39], v4, s[8:11], s13 offen sc1
    s_add_u32 s13, s21, 65536
    buffer_load_dwordx4 v[40:43], v4, s[8:11], s13 offen sc1
    s_add_u32 s13, s21, 69632
    buffer_load_dwordx4 v[44:47], v4, s[8:11], s13 offen sc1
    s_add_u32 s13, s21, 98304
    buffer_load_dwordx4 v[48:51], v4, s[8:11], s13 offen sc1
    s_add_u32 s13, s21, 102400
    buffer_load_dwordx4 v[52:55], v4, s[8:11], s13 offen sc1
    s_add_u32 s13, s20, 0
    buffer_load_dwordx4 v[16:19], v4, s[8:11], s13 offen sc1
    s_add_u32 s13, s20, 4096
    buffer_load_dwordx4 v[20:23], v4, s[8:11], s13 offen sc1
    s_add_u32 s20, s20, 32768
    s_add_u32 s21, s21, 131072
    s_add_u32 s25, s25, 256
    s_branch FT3_12_i0
FT3_12_done:
    s_waitcnt vmcnt(0)
LE_FT3:
    s_endpgm
L_AWO:
    s_lshr_b32 s4, s5, 2
    s_and_b32 s5, s5, 3
LB_AWO:
    s_load_dwordx2 s[12:13], s[0:1], 16
    s_waitcnt lgkmcnt(0)
    s_mov_b32 s14, 524288
    s_mov_b32 s15, 0x20000
    v_lshrrev_b32 v61, 4, v0
    v_and_b32 v60, 15, v0
    v_lshlrev_b32 v62, 2, v61
    v_xor_b32 v62, v60, v62
    v_lshlrev_b32 v62, 4, v62
    v_lshl_add_u32 v62, v61, 10, v62
    s_lshl_b32 s32, s5, 8
    v_add_u32 v40, s32, v62
    s_lshl_b32 s32, s6, 2
    v_lshrrev_b32 v60, 4, v0
    v_and_b32 v61, 1, v60
    v_lshrrev_b32 v60, 1, v60
    v_bfe_u32 v62, v0, 2, 2
    v_and_b32 v63, 3, v0
    v_lshl_add_u32 v60, v60, 2, v62
    v_lshrrev_b32 v64, 1, v63
    v_lshl_add_u32 v64, v61, 1, v64
    v_add_u32 v64, s32, v64
    v_lshlrev_b32 v65, 2, v62
    v_xor_b32 v64, v64, v65
    v_lshlrev_b32 v64, 4, v64
    v_and_b32 v63, 1, v63
    v_lshl_add_u32 v64, v63, 3, v64
    v_mul_u32_u24 v60, 256, v60
    v_add_u32 v44, v60, v64
    v_add_u32 v44, 0, v44
    v_add_u32 v45, 0x10000, v44
    s_lshl_b32 s33, s6, 17
    s_lshl_b32 s34, s6, 15
    s_add_u32 m0, s34, 0
    s_add_u32 s35, s33, 0
    buffer_load_dwordx4 v40, s[12:15], s35 offen lds
    s_add_u32 m0, s34, 1024
    s_add_u32 s35, s33, 4096
    buffer_load_dwordx4 v40, s[12:15], s35 offen lds
    s_add_u32 m0, s34, 2048
    s_add_u32 s35, s33, 8192
    buffer_load_dwordx4 v40, s[12:15], s35 offen lds
    s_add_u32 m0, s34, 3072
    s_add_u32 s35, s33, 12288
    buffer_load_dwordx4 v40, s[12:15], s35 offen lds
    s_add_u32 m0, s34, 4096
    s_add_u32 s35, s33, 16384
    buffer_load_dwordx4 v40, s[12:15], s35 offen lds
    s_add_u32 m0, s34, 5120
    s_add_u32 s35, s33, 20480
    buffer_load_dwordx4 v40, s[12:15], s35 offen lds
    s_add_u32 m0, s34, 6144
    s_add_u32 s35, s33, 24576
    buffer_load_dwordx4 v40, s[12:15], s35 offen lds
    s_add_u32 m0, s34, 7168
    s_add_u32 s35, s33, 28672
    buffer_load_dwordx4 v40, s[12:15], s35 offen lds
    s_add_u32 m0, s34, 8192
    s_add_u32 s35, s33, 32768
    buffer_load_dwordx4 v40, s[12:15], s35 offen lds
    s_add_u32 m0, s34, 9216
    s_add_u32 s35, s33, 36864
    buffer_load_dwordx4 v40, s[12:15], s35 offen lds
    s_add_u32 m0, s34, 10240
    s_add_u32 s35, s33, 40960
    buffer_load_dwordx4 v40, s[12:15], s35 offen lds
    s_add_u32 m0, s34, 11264
    s_add_u32 s35, s33, 45056
    buffer_load_dwordx4 v40, s[12:15], s35 offen lds
    s_add_u32 m0, s34, 12288
    s_add_u32 s35, s33, 49152
    buffer_load_dwordx4 v40, s[12:15], s35 offen lds
    s_add_u32 m0, s34, 13312
    s_add_u32 s35, s33, 53248
    buffer_load_dwordx4 v40, s[12:15], s35 offen lds
    s_add_u32 m0, s34, 14336
    s_add_u32 s35, s33, 57344
    buffer_load_dwordx4 v40, s[12:15], s35 offen lds
    s_add_u32 m0, s34, 15360
    s_add_u32 s35, s33, 61440
    buffer_load_dwordx4 v40, s[12:15], s35 offen lds
    s_add_u32 m0, s34, 16384
    s_add_u32 s35, s33, 65536
    buffer_load_dwordx4 v40, s[12:15], s35 offen lds
    s_add_u32 m0, s34, 17408
    s_add_u32 s35, s33, 69632
    buffer_load_dwordx4 v40, s[12:15], s35 offen lds
    s_add_u32 m0, s34, 18432
    s_add_u32 s35, s33, 73728
    buffer_load_dwordx4 v40, s[12:15], s35 offen lds
    s_add_u32 m0, s34, 19456
    s_add_u32 s35, s33, 77824
    buffer_load_dwordx4 v40, s[12:15], s35 offen lds
    s_add_u32 m0, s34, 20480
    s_add_u32 s35, s33, 81920
    buffer_load_dwordx4 v40, s[12:15], s35 offen lds
    s_add_u32 m0, s34, 21504
    s_add_u32 s35, s33, 86016
    buffer_load_dwordx4 v40, s[12:15], s35 offen lds
    s_add_u32 m0, s34, 22528
    s_add_u32 s35, s33, 90112
    buffer_load_dwordx4 v40, s[12:15], s35 offen lds
    s_add_u32 m0, s34, 23552
    s_add_u32 s35, s33, 94208
    buffer_load_dwordx4 v40, s[12:15], s35 offen lds
    s_add_u32 m0, s34, 24576
    s_add_u32 s35, s33, 98304
    buffer_load_dwordx4 v40, s[12:15], s35 offen lds
    s_add_u32 m0, s34, 25600
    s_add_u32 s35, s33, 102400
    buffer_load_dwordx4 v40, s[12:15], s35 offen lds
    s_add_u32 m0, s34, 26624
    s_add_u32 s35, s33, 106496
    buffer_load_dwordx4 v40, s[12:15], s35 offen lds
    s_add_u32 m0, s34, 27648
    s_add_u32 s35, s33, 110592
    buffer_load_dwordx4 v40, s[12:15], s35 offen lds
    s_add_u32 m0, s34, 28672
    s_add_u32 s35, s33, 114688
    buffer_load_dwordx4 v40, s[12:15], s35 offen lds
    s_add_u32 m0, s34, 29696
    s_add_u32 s35, s33, 118784
    buffer_load_dwordx4 v40, s[12:15], s35 offen lds
    s_add_u32 m0, s34, 30720
    s_add_u32 s35, s33, 122880
    buffer_load_dwordx4 v40, s[12:15], s35 offen lds
    s_add_u32 m0, s34, 31744
    s_add_u32 s35, s33, 126976
    buffer_load_dwordx4 v40, s[12:15], s35 offen lds
    s_waitcnt vmcnt(0)
    s_barrier
    ds_read_b64_tr_b16 a[0:1], v44 offset:0
    ds_read_b64_tr_b16 a[2:3], v44 offset:2048
    ds_read_b64_tr_b16 a[4:5], v44 offset:4096
    ds_read_b64_tr_b16 a[6:7], v44 offset:6144
    ds_read_b64_tr_b16 a[8:9], v44 offset:8192
    ds_read_b64_tr_b16 a[10:11], v44 offset:10240
    ds_read_b64_tr_b16 a[12:13], v44 offset:12288
    ds_read_b64_tr_b16 a[14:15], v44 offset:14336
    s_waitcnt lgkmcnt(4)
    ds_read_b64_tr_b16 a[16:17], v44 offset:16384
    ds_read_b64_tr_b16 a[18:19], v44 offset:18432
    ds_read_b64_tr_b16 a[20:21], v44 offset:20480
    ds_read_b64_tr_b16 a[22:23], v44 offset:22528
    ds_read_b64_tr_b16 a[24:25], v44 offset:24576
    ds_read_b64_tr_b16 a[26:27], v44 offset:26624
    ds_read_b64_tr_b16 a[28:29], v44 offset:28672
    ds_read_b64_tr_b16 a[30:31], v44 offset:30720
    s_waitcnt lgkmcnt(4)
    ds_read_b64_tr_b16 a[32:33], v44 offset:32768
    ds_read_b64_tr_b16 a[34:35], v44 offset:34816
    ds_read_b64_tr_b16 a[36:37], v44 offset:36864
    ds_read_b64_tr_b16 a[38:39], v44 offset:38912
    ds_read_b64_tr_b16 a[40:41], v44 offset:40960
    ds_read_b64_tr_b16 a[42:43], v44 offset:43008
    ds_read_b64_tr_b16 a[44:45], v44 offset:45056
    ds_read_b64_tr_b16 a[46:47], v44 offset:47104
    s_waitcnt lgkmcnt(4)
    ds_read_b64_tr_b16 a[48:49], v44 offset:49152
    ds_read_b64_tr_b16 a[50:51], v44 offset:51200
    ds_read_b64_tr_b16 a[52:53], v44 offset:53248
    ds_read_b64_tr_b16 a[54:55], v44 offset:55296
    ds_read_b64_tr_b16 a[56:57], v44 offset:57344
    ds_read_b64_tr_b16 a[58:59], v44 offset:59392
    ds_read_b64_tr_b16 a[60:61], v44 offset:61440
    ds_read_b64_tr_b16 a[62:63], v44 offset:63488
    s_waitcnt lgkmcnt(4)
    ds_read_b64_tr_b16 a[64:65], v45 offset:0
    ds_read_b64_tr_b16 a[66:67], v45 offset:2048
    ds_read_b64_tr_b16 a[68:69], v45 offset:4096
    ds_read_b64_tr_b16 a[70:71], v45 offset:6144
    ds_read_b64_tr_b16 a[72:73], v45 offset:8192
    ds_read_b64_tr_b16 a[74:75], v45 offset:10240
    ds_read_b64_tr_b16 a[76:77], v45 offset:12288
    ds_read_b64_tr_b16 a[78:79], v45 offset:14336
    s_waitcnt lgkmcnt(4)
    ds_read_b64_tr_b16 a[80:81], v45 offset:16384
    ds_read_b64_tr_b16 a[82:83], v45 offset:18432
    ds_read_b64_tr_b16 a[84:85], v45 offset:20480
    ds_read_b64_tr_b16 a[86:87], v45 offset:22528
    ds_read_b64_tr_b16 a[88:89], v45 offset:24576
    ds_read_b64_tr_b16 a[90:91], v45 offset:26624
    ds_read_b64_tr_b16 a[92:93], v45 offset:28672
    ds_read_b64_tr_b16 a[94:95], v45 offset:30720
    s_waitcnt lgkmcnt(4)
    ds_read_b64_tr_b16 a[96:97], v45 offset:32768
    ds_read_b64_tr_b16 a[98:99], v45 offset:34816
    ds_read_b64_tr_b16 a[100:101], v45 offset:36864
    ds_read_b64_tr_b16 a[102:103], v45 offset:38912
    ds_read_b64_tr_b16 a[104:105], v45 offset:40960
    ds_read_b64_tr_b16 a[106:107], v45 offset:43008
    ds_read_b64_tr_b16 a[108:109], v45 offset:45056
    ds_read_b64_tr_b16 a[110:111], v45 offset:47104
    s_waitcnt lgkmcnt(4)
    ds_read_b64_tr_b16 a[112:113], v45 offset:49152
    ds_read_b64_tr_b16 a[114:115], v45 offset:51200
    ds_read_b64_tr_b16 a[116:117], v45 offset:53248
    ds_read_b64_tr_b16 a[118:119], v45 offset:55296
    ds_read_b64_tr_b16 a[120:121], v45 offset:57344
    ds_read_b64_tr_b16 a[122:123], v45 offset:59392
    ds_read_b64_tr_b16 a[124:125], v45 offset:61440
    ds_read_b64_tr_b16 a[126:127], v45 offset:63488
    s_waitcnt lgkmcnt(4)
    s_waitcnt lgkmcnt(0)
    s_barrier
    v_lshlrev_b32 v1, 4, v0
    s_lshl_b32 s32, s6, 13
    v_add_u32 v2, s32, v1
    s_lshl_b32 s32, s5, 13
    s_lshl_b32 s33, s6, 11
    s_add_u32 s32, s32, s33
    v_add_u32 v3, s32, v1
    s_mul_i32 s32, s4, 12582912
    s_add_u32 s43, s32, 171966464
    s_add_u32 s44, s32, 174063616
    s_lshl_b32 s32, s4, 13
    s_add_u32 s45, s32, 205750272
    s_lshl_b32 s33, s5, 4
    s_lshl_b32 s34, s6, 2
    s_add_u32 s33, s33, s34
    s_add_u32 s46, s32, 205766656
    s_add_u32 s46, s46, s33
    s_mov_b32 s40, 0
    s_mov_b32 s42, 0
    s_load_dwordx2 s[92:93], s[0:1], 88
    s_waitcnt lgkmcnt(0)
    s_mov_b32 s94, 256
    s_mov_b32 s95, 0x20000
    s_mov_b32 s96, 0
AWO_16_iw:
    v_mbcnt_lo_u32_b32 v9, -1, 0
    v_mbcnt_hi_u32_b32 v9, -1, v9
    v_min_u32 v9, 7, v9
    v_and_b32 v10, 1, v9
    v_lshlrev_b32 v10, 7, v10
    v_lshrrev_b32 v9, 1, v9
    v_lshl_add_u32 v9, v9, 2, v10
    buffer_load_dword v9, v9, s[92:95], 0 offen sc1
    s_waitcnt vmcnt(0)
    v_cmp_gt_u32 vcc, 32, v9
    s_cmp_eq_u64 vcc, 0
    s_cselect_b32 s97, 256, 0
    s_cmp_ge_u32 s97, 256
    s_cbranch_scc1 AWO_16_iwd
    s_add_u32 s96, s96, 1
    s_cmp_gt_u32 s96, 300000
    s_cbranch_scc1 L_fail
    s_sleep 2
    s_branch AWO_16_iw
AWO_16_iwd:
    s_mov_b32 s96, 0
    v_mbcnt_lo_u32_b32 v250, -1, 0
    v_mbcnt_hi_u32_b32 v250, -1, v250
    v_min_u32 v250, 31, v250
    v_lshlrev_b32 v250, 2, v250
AWO_16w0_17_spin:
    buffer_load_dword v251, v250, s[8:11], s45 offen sc1
    s_waitcnt vmcnt(0)
    v_cmp_eq_u32 vcc, 0, v251
    s_cbranch_vccz AWO_16w0_17_ok
    s_add_u32 s96, s96, 1
    s_cmp_gt_u32 s96, 300000
    s_cbranch_scc1 L_fail
    s_sleep 1
    s_branch AWO_16w0_17_spin
AWO_16w0_17_ok:
    s_lshl_b32 s53, s6, 13
    s_add_u32 s53, s53, s42
    s_add_u32 m0, s53, 0
    s_add_u32 s33, s43, 0
    buffer_load_dwordx4 v2, s[8:11], s33 offen offset:0 sc1 lds
    buffer_load_dwordx4 v2, s[8:11], s33 offen offset:1024 sc1 lds
    buffer_load_dwordx4 v2, s[8:11], s33 offen offset:2048 sc1 lds
    buffer_load_dwordx4 v2, s[8:11], s33 offen offset:3072 sc1 lds
    s_add_u32 m0, s53, 4096
    s_add_u32 s33, s43, 4096
    buffer_load_dwordx4 v2, s[8:11], s33 offen offset:0 sc1 lds
    buffer_load_dwordx4 v2, s[8:11], s33 offen offset:1024 sc1 lds
    buffer_load_dwordx4 v2, s[8:11], s33 offen offset:2048 sc1 lds
    buffer_load_dwordx4 v2, s[8:11], s33 offen offset:3072 sc1 lds
    s_add_u32 s43, s43, 32768
    s_add_u32 s45, s45, 128
    s_waitcnt vmcnt(0)
    s_barrier
AWO_16_unit:
    v_add_u32 v5, s42, v1
    s_xor_b32 s50, s42, 32768
    v_mbcnt_lo_u32_b32 v10, -1, 0
    v_mbcnt_hi_u32_b32 v10, -1, v10
    v_min_u32 v10, 31, v10
    v_lshlrev_b32 v10, 2, v10
    buffer_load_dword v9, v10, s[8:11], s45 offen sc1
    ds_read_b128 v[64:67], v5 offset:0
    ds_read_b128 v[68:71], v5 offset:1024
    ds_read_b128 v[72:75], v5 offset:2048
    ds_read_b128 v[76:79], v5 offset:3072
    ds_read_b128 v[80:83], v5 offset:4096
    ds_read_b128 v[84:87], v5 offset:5120
    s_waitcnt lgkmcnt(5)
    v_mfma_f32_32x32x16_bf16 v[32:47], a[0:3], v[64:67], 0
    ds_read_b128 v[88:91], v5 offset:6144
    s_waitcnt lgkmcnt(5)
    v_mfma_f32_32x32x16_bf16 v[32:47], a[4:7], v[68:71], v[32:47]
    ds_read_b128 v[92:95], v5 offset:7168
    s_waitcnt lgkmcnt(5)
    v_mfma_f32_32x32x16_bf16 v[32:47], a[8:11], v[72:75], v[32:47]
    ds_read_b128 v[64:67], v5 offset:8192
    s_waitcnt lgkmcnt(5)
    v_mfma_f32_32x32x16_bf16 v[32:47], a[12:15], v[76:79], v[32:47]
    ds_read_b128 v[68:71], v5 offset:9216
    s_waitcnt lgkmcnt(5)
    v_mfma_f32_32x32x16_bf16 v[32:47], a[16:19], v[80:83], v[32:47]
    ds_read_b128 v[72:75], v5 offset:10240
    s_waitcnt lgkmcnt(5)
    v_mfma_f32_32x32x16_bf16 v[32:47], a[20:23], v[84:87], v[32:47]
    ds_read_b128 v[76:79], v5 offset:11264
    s_waitcnt lgkmcnt(5)
    v_mfma_f32_32x32x16_bf16 v[32:47], a[24:27], v[88:91], v[32:47]
    ds_read_b128 v[80:83], v5 offset:12288
    s_waitcnt lgkmcnt(5)
    v_mfma_f32_32x32x16_bf16 v[32:47], a[28:31], v[92:95], v[32:47]
    ds_read_b128 v[84:87], v5 offset:13312
    s_waitcnt lgkmcnt(5)
    v_mfma_f32_32x32x16_bf16 v[32:47], a[32:35], v[64:67], v[32:47]
    ds_read_b128 v[88:91], v5 offset:14336
    s_waitcnt lgkmcnt(5)
    v_mfma_f32_32x32x16_bf16 v[32:47], a[36:39], v[68:71], v[32:47]
    ds_read_b128 v[92:95], v5 offset:15360
    s_waitcnt lgkmcnt(5)
    v_mfma_f32_32x32x16_bf16 v[32:47], a[40:43], v[72:75], v[32:47]
    ds_read_b128 v[64:67], v5 offset:16384
    s_waitcnt lgkmcnt(5)
    v_mfma_f32_32x32x16_bf16 v[32:47], a[44:47], v[76:79], v[32:47]
    ds_read_b128 v[68:71], v5 offset:17408
    s_waitcnt lgkmcnt(5)
    v_mfma_f32_32x32x16_bf16 v[32:47], a[48:51], v[80:83], v[32:47]
    ds_read_b128 v[72:75], v5 offset:18432
    s_waitcnt lgkmcnt(5)
    v_mfma_f32_32x32x16_bf16 v[32:47], a[52:55], v[84:87], v[32:47]
    ds_read_b128 v[76:79], v5 offset:19456
    s_waitcnt lgkmcnt(5)
    v_mfma_f32_32x32x16_bf16 v[32:47], a[56:59], v[88:91], v[32:47]
    ds_read_b128 v[80:83], v5 offset:20480
    s_waitcnt lgkmcnt(5)
    v_mfma_f32_32x32x16_bf16 v[32:47], a[60:63], v[92:95], v[32:47]
    ds_read_b128 v[84:87], v5 offset:21504
    s_waitcnt lgkmcnt(5)
    v_mfma_f32_32x32x16_bf16 v[32:47], a[64:67], v[64:67], v[32:47]
    ds_read_b128 v[88:91], v5 offset:22528
    s_waitcnt lgkmcnt(5)
    v_mfma_f32_32x32x16_bf16 v[32:47], a[68:71], v[68:71], v[32:47]
    ds_read_b128 v[92:95], v5 offset:23552
    s_waitcnt lgkmcnt(5)
    v_mfma_f32_32x32x16_bf16 v[32:47], a[72:75], v[72:75], v[32:47]
    ds_read_b128 v[64:67], v5 offset:24576
    s_waitcnt lgkmcnt(5)
    v_mfma_f32_32x32x16_bf16 v[32:47], a[76:79], v[76:79], v[32:47]
    ds_read_b128 v[68:71], v5 offset:25600
    s_waitcnt lgkmcnt(5)
    v_mfma_f32_32x32x16_bf16 v[32:47], a[80:83], v[80:83], v[32:47]
    ds_read_b128 v[72:75], v5 offset:26624
    s_waitcnt vmcnt(0)
    s_mov_b32 s48, 0
    s_cmp_ge_u32 s40, 63
    s_cselect_b32 s49, 1, 0
    v_cmp_eq_u32 vcc, 0, v9
    s_cmp_eq_u64 vcc, 0
    s_cselect_b32 s48, 1, 0
    s_cmp_eq_u32 s49, 1
    s_cselect_b32 s48, 0, s48
    s_cmp_eq_u32 s48, 0
    s_cbranch_scc1 AWO_16v_18_n
    s_waitcnt lgkmcnt(5)
    v_mfma_f32_32x32x16_bf16 v[32:47], a[84:87], v[84:87], v[32:47]
    ds_read_b128 v[76:79], v5 offset:27648
    s_lshl_b32 s53, s6, 13
    s_add_u32 s53, s53, s50
    s_add_u32 m0, s53, 0
    s_add_u32 s33, s43, 0
    buffer_load_dwordx4 v2, s[8:11], s33 offen offset:0 sc1 lds
    s_waitcnt lgkmcnt(5)
    v_mfma_f32_32x32x16_bf16 v[32:47], a[88:91], v[88:91], v[32:47]
    ds_read_b128 v[80:83], v5 offset:28672
    buffer_load_dwordx4 v2, s[8:11], s33 offen offset:1024 sc1 lds
    s_waitcnt lgkmcnt(5)
    v_mfma_f32_32x32x16_bf16 v[32:47], a[92:95], v[92:95], v[32:47]
    ds_read_b128 v[84:87], v5 offset:29696
    buffer_load_dwordx4 v2, s[8:11], s33 offen offset:2048 sc1 lds
    s_waitcnt lgkmcnt(5)
    v_mfma_f32_32x32x16_bf16 v[32:47], a[96:99], v[64:67], v[32:47]
    ds_read_b128 v[88:91], v5 offset:30720
    buffer_load_dwordx4 v2, s[8:11], s33 offen offset:3072 sc1 lds
    s_waitcnt lgkmcnt(5)
    v_mfma_f32_32x32x16_bf16 v[32:47], a[100:103], v[68:71], v[32:47]
    ds_read_b128 v[92:95], v5 offset:31744
    s_add_u32 m0, s53, 4096
    s_add_u32 s33, s43, 4096
    buffer_load_dwordx4 v2, s[8:11], s33 offen offset:0 sc1 lds
    s_waitcnt lgkmcnt(5)
    v_mfma_f32_32x32x16_bf16 v[32:47], a[104:107], v[72:75], v[32:47]
    buffer_load_dwordx4 v2, s[8:11], s33 offen offset:1024 sc1 lds
    s_waitcnt lgkmcnt(4)
    v_mfma_f32_32x32x16_bf16 v[32:47], a[108:111], v[76:79], v[32:47]
    buffer_load_dwordx4 v2, s[8:11], s33 offen offset:2048 sc1 lds
    s_waitcnt lgkmcnt(3)
    v_mfma_f32_32x32x16_bf16 v[32:47], a[112:115], v[80:83], v[32:47]
    buffer_load_dwordx4 v2, s[8:11], s33 offen offset:3072 sc1 lds
    s_branch AWO_16v_18_e
AWO_16v_18_n:
    s_waitcnt lgkmcnt(5)
    v_mfma_f32_32x32x16_bf16 v[32:47], a[84:87], v[84:87], v[32:47]
    ds_read_b128 v[76:79], v5 offset:27648
    s_waitcnt lgkmcnt(5)
    v_mfma_f32_32x32x16_bf16 v[32:47], a[88:91], v[88:91], v[32:47]
    ds_read_b128 v[80:83], v5 offset:28672
    s_waitcnt lgkmcnt(5)
    v_mfma_f32_32x32x16_bf16 v[32:47], a[92:95], v[92:95], v[32:47]
    ds_read_b128 v[84:87], v5 offset:29696
    s_waitcnt lgkmcnt(5)
    v_mfma_f32_32x32x16_bf16 v[32:47], a[96:99], v[64:67], v[32:47]
    ds_read_b128 v[88:91], v5 offset:30720
    s_waitcnt lgkmcnt(5)
    v_mfma_f32_32x32x16_bf16 v[32:47], a[100:103], v[68:71], v[32:47]
    ds_read_b128 v[92:95], v5 offset:31744
    s_waitcnt lgkmcnt(5)
    v_mfma_f32_32x32x16_bf16 v[32:47], a[104:107], v[72:75], v[32:47]
    s_waitcnt lgkmcnt(4)
    v_mfma_f32_32x32x16_bf16 v[32:47], a[108:111], v[76:79], v[32:47]
    s_waitcnt lgkmcnt(3)
    v_mfma_f32_32x32x16_bf16 v[32:47], a[112:115], v[80:83], v[32:47]
AWO_16v_18_e:
    s_waitcnt lgkmcnt(2)
    v_mfma_f32_32x32x16_bf16 v[32:47], a[116:119], v[84:87], v[32:47]
    s_waitcnt lgkmcnt(1)
    v_mfma_f32_32x32x16_bf16 v[32:47], a[120:123], v[88:91], v[32:47]
    s_waitcnt lgkmcnt(0)
    v_mfma_f32_32x32x16_bf16 v[32:47], a[124:127], v[92:95], v[32:47]
    s_nop 11
    v_cvt_pk_bf16_f32 v96, v32, v33
    v_cvt_pk_bf16_f32 v97, v34, v35
    v_cvt_pk_bf16_f32 v98, v36, v37
    v_cvt_pk_bf16_f32 v99, v38, v39
    v_cvt_pk_bf16_f32 v100, v40, v41
    v_cvt_pk_bf16_f32 v101, v42, v43
    v_cvt_pk_bf16_f32 v102, v44, v45
    v_cvt_pk_bf16_f32 v103, v46, v47
    buffer_store_dwordx4 v[96:99], v3, s[8:11], s44 offen offset:0
    buffer_store_dwordx4 v[100:103], v3, s[8:11], s44 offen offset:1024
    s_add_u32 s44, s44, 32768
    s_add_u32 s40, s40, 1
    s_waitcnt vmcnt(0)
    v_mov_b32 v12, 1
    v_mov_b32 v11, 0
    s_mov_b64 exec, 1
    buffer_store_dword v12, v11, s[8:11], s46 offen
    s_mov_b64 exec, -1
    s_add_u32 s46, s46, 128
    s_mov_b32 s42, s50
    s_cmp_eq_u32 s48, 0
    s_cbranch_scc1 AWO_16_slow
    s_add_u32 s43, s43, 32768
    s_add_u32 s45, s45, 128
    s_barrier
    s_branch AWO_16_unit
AWO_16_slow:
    s_cmp_ge_u32 s40, 64
    s_cbranch_scc1 AWO_16_done
    s_mov_b32 s96, 0
    v_mbcnt_lo_u32_b32 v250, -1, 0
    v_mbcnt_hi_u32_b32 v250, -1, v250
    v_min_u32 v250, 31, v250
    v_lshlrev_b32 v250, 2, v250
AWO_16ws_19_spin:
    buffer_load_dword v251, v250, s[8:11], s45 offen sc1
    s_waitcnt vmcnt(0)
    v_cmp_eq_u32 vcc, 0, v251
    s_cbranch_vccz AWO_16ws_19_ok
    s_add_u32 s96, s96, 1
    s_cmp_gt_u32 s96, 300000
    s_cbranch_scc1 L_fail
    s_sleep 1
    s_branch AWO_16ws_19_spin
AWO_16ws_19_ok:
    s_lshl_b32 s53, s6, 13
    s_add_u32 s53, s53, s42
    s_add_u32 m0, s53, 0
    s_add_u32 s33, s43, 0
    buffer_load_dwordx4 v2, s[8:11], s33 offen offset:0 sc1 lds
    buffer_load_dwordx4 v2, s[8:11], s33 offen offset:1024 sc1 lds
    buffer_load_dwordx4 v2, s[8:11], s33 offen offset:2048 sc1 lds
    buffer_load_dwordx4 v2, s[8:11], s33 offen offset:3072 sc1 lds
    s_add_u32 m0, s53, 4096
    s_add_u32 s33, s43, 4096
    buffer_load_dwordx4 v2, s[8:11], s33 offen offset:0 sc1 lds
    buffer_load_dwordx4 v2, s[8:11], s33 offen offset:1024 sc1 lds
    buffer_load_dwordx4 v2, s[8:11], s33 offen offset:2048 sc1 lds
    buffer_load_dwordx4 v2, s[8:11], s33 offen offset:3072 sc1 lds
    s_add_u32 s43, s43, 32768
    s_add_u32 s45, s45, 128
    s_waitcnt vmcnt(0)
    s_barrier
    s_branch AWO_16_unit
AWO_16_done:
LE_AWO:
    s_endpgm
L_ATT:
LB_ATT:
    s_load_dwordx2 s[12:13], s[0:1], 40
    s_waitcnt lgkmcnt(0)
    s_mov_b32 s14, 4194304
    s_mov_b32 s15, 0x20000
    v_lshrrev_b32 v61, 4, v0
    v_and_b32 v60, 15, v0
    v_lshlrev_b32 v62, 2, v61
    v_xor_b32 v62, v60, v62
    v_lshlrev_b32 v62, 4, v62
    v_lshl_add_u32 v62, v61, 13, v62
    s_lshl_b32 s32, s5, 8
    v_add_u32 v40, s32, v62
    s_lshl_b32 s32, s6, 2
    v_lshrrev_b32 v60, 4, v0
    v_and_b32 v61, 1, v60
    v_lshrrev_b32 v60, 1, v60
    v_bfe_u32 v62, v0, 2, 2
    v_and_b32 v63, 3, v0
    v_lshl_add_u32 v60, v60, 2, v62
    v_lshrrev_b32 v64, 1, v63
    v_lshl_add_u32 v64, v61, 1, v64
    v_add_u32 v64, s32, v64
    v_lshlrev_b32 v65, 2, v62
    v_xor_b32 v64, v64, v65
    v_lshlrev_b32 v64, 4, v64
    v_and_b32 v63, 1, v63
    v_lshl_add_u32 v64, v63, 3, v64
    v_mul_u32_u24 v60, 256, v60
    v_add_u32 v44, v60, v64
    v_add_u32 v44, 131072, v44
    v_lshlrev_b32 v46, 4, v0
    s_lshl_b32 s32, s6, 15
    v_add_u32 v46, s32, v46
    s_lshl_b32 s33, s6, 18
    s_add_u32 s33, s33, 0
    s_lshl_b32 s34, s6, 13
    s_add_u32 s34, s34, 131072
    s_add_u32 m0, s34, 0
    s_add_u32 s35, s33, 0
    buffer_load_dwordx4 v40, s[12:15], s35 offen lds
    s_add_u32 m0, s34, 1024
    s_add_u32 s35, s33, 32768
    buffer_load_dwordx4 v40, s[12:15], s35 offen lds
    s_add_u32 m0, s34, 2048
    s_add_u32 s35, s33, 65536
    buffer_load_dwordx4 v40, s[12:15], s35 offen lds
    s_add_u32 m0, s34, 3072
    s_add_u32 s35, s33, 98304
    buffer_load_dwordx4 v40, s[12:15], s35 offen lds
    s_add_u32 m0, s34, 4096
    s_add_u32 s35, s33, 131072
    buffer_load_dwordx4 v40, s[12:15], s35 offen lds
    s_add_u32 m0, s34, 5120
    s_add_u32 s35, s33, 163840
    buffer_load_dwordx4 v40, s[12:15], s35 offen lds
    s_add_u32 m0, s34, 6144
    s_add_u32 s35, s33, 196608
    buffer_load_dwordx4 v40, s[12:15], s35 offen lds
    s_add_u32 m0, s34, 7168
    s_add_u32 s35, s33, 229376
    buffer_load_dwordx4 v40, s[12:15], s35 offen lds
    s_waitcnt vmcnt(0)
    s_barrier
    ds_read_b64_tr_b16 v[64:65], v44 offset:0
    ds_read_b64_tr_b16 v[66:67], v44 offset:2048
    ds_read_b64_tr_b16 v[68:69], v44 offset:4096
    ds_read_b64_tr_b16 v[70:71], v44 offset:6144
    ds_read_b64_tr_b16 v[72:73], v44 offset:8192
    ds_read_b64_tr_b16 v[74:75], v44 offset:10240
    ds_read_b64_tr_b16 v[76:77], v44 offset:12288
    ds_read_b64_tr_b16 v[78:79], v44 offset:14336
    ds_read_b64_tr_b16 v[80:81], v44 offset:16384
    ds_read_b64_tr_b16 v[82:83], v44 offset:18432
    ds_read_b64_tr_b16 v[84:85], v44 offset:20480
    ds_read_b64_tr_b16 v[86:87], v44 offset:22528
    ds_read_b64_tr_b16 v[88:89], v44 offset:24576
    ds_read_b64_tr_b16 v[90:91], v44 offset:26624
    ds_read_b64_tr_b16 v[92:93], v44 offset:28672
    ds_read_b64_tr_b16 v[94:95], v44 offset:30720
    s_waitcnt lgkmcnt(0)
    ds_write_b128 v46, v[64:67] offset:0
    ds_write_b128 v46, v[68:71] offset:1024
    ds_write_b128 v46, v[72:75] offset:2048
    ds_write_b128 v46, v[76:79] offset:3072
    ds_write_b128 v46, v[80:83] offset:4096
    ds_write_b128 v46, v[84:87] offset:5120
    ds_write_b128 v46, v[88:91] offset:6144
    ds_write_b128 v46, v[92:95] offset:7168
    s_waitcnt lgkmcnt(0)
    s_barrier
    s_lshl_b32 s33, s6, 18
    s_add_u32 s33, s33, 1048576
    s_lshl_b32 s34, s6, 13
    s_add_u32 s34, s34, 131072
    s_add_u32 m0, s34, 0
    s_add_u32 s35, s33, 0
    buffer_load_dwordx4 v40, s[12:15], s35 offen lds
    s_add_u32 m0, s34, 1024
    s_add_u32 s35, s33, 32768
    buffer_load_dwordx4 v40, s[12:15], s35 offen lds
    s_add_u32 m0, s34, 2048
    s_add_u32 s35, s33, 65536
    buffer_load_dwordx4 v40, s[12:15], s35 offen lds
    s_add_u32 m0, s34, 3072
    s_add_u32 s35, s33, 98304
    buffer_load_dwordx4 v40, s[12:15], s35 offen lds
    s_add_u32 m0, s34, 4096
    s_add_u32 s35, s33, 131072
    buffer_load_dwordx4 v40, s[12:15], s35 offen lds
    s_add_u32 m0, s34, 5120
    s_add_u32 s35, s33, 163840
    buffer_load_dwordx4 v40, s[12:15], s35 offen lds
    s_add_u32 m0, s34, 6144
    s_add_u32 s35, s33, 196608
    buffer_load_dwordx4 v40, s[12:15], s35 offen lds
    s_add_u32 m0, s34, 7168
    s_add_u32 s35, s33, 229376
    buffer_load_dwordx4 v40, s[12:15], s35 offen lds
    s_waitcnt vmcnt(0)
    s_barrier
    ds_read_b64_tr_b16 v[64:65], v44 offset:0
    ds_read_b64_tr_b16 v[66:67], v44 offset:2048
    ds_read_b64_tr_b16 v[68:69], v44 offset:4096
    ds_read_b64_tr_b16 v[70:71], v44 offset:6144
    ds_read_b64_tr_b16 v[72:73], v44 offset:8192
    ds_read_b64_tr_b16 v[74:75], v44 offset:10240
    ds_read_b64_tr_b16 v[76:77], v44 offset:12288
    ds_read_b64_tr_b16 v[78:79], v44 offset:14336
    ds_read_b64_tr_b16 v[80:81], v44 offset:16384
    ds_read_b64_tr_b16 v[82:83], v44 offset:18432
    ds_read_b64_tr_b16 v[84:85], v44 offset:20480
    ds_read_b64_tr_b16 v[86:87], v44 offset:22528
    ds_read_b64_tr_b16 v[88:89], v44 offset:24576
    ds_read_b64_tr_b16 v[90:91], v44 offset:26624
    ds_read_b64_tr_b16 v[92:93], v44 offset:28672
    ds_read_b64_tr_b16 v[94:95], v44 offset:30720
    s_waitcnt lgkmcnt(0)
    ds_write_b128 v46, v[64:67] offset:8192
    ds_write_b128 v46, v[68:71] offset:9216
    ds_write_b128 v46, v[72:75] offset:10240
    ds_write_b128 v46, v[76:79] offset:11264
    ds_write_b128 v46, v[80:83] offset:12288
    ds_write_b128 v46, v[84:87] offset:13312
    ds_write_b128 v46, v[88:91] offset:14336
    ds_write_b128 v46, v[92:95] offset:15360
    s_waitcnt lgkmcnt(0)
    s_barrier
    s_lshl_b32 s33, s6, 18
    s_add_u32 s33, s33, 2097152
    s_lshl_b32 s34, s6, 13
    s_add_u32 s34, s34, 131072
    s_add_u32 m0, s34, 0
    s_add_u32 s35, s33, 0
    buffer_load_dwordx4 v40, s[12:15], s35 offen lds
    s_add_u32 m0, s34, 1024
    s_add_u32 s35, s33, 32768
    buffer_load_dwordx4 v40, s[12:15], s35 offen lds
    s_add_u32 m0, s34, 2048
    s_add_u32 s35, s33, 65536
    buffer_load_dwordx4 v40, s[12:15], s35 offen lds
    s_add_u32 m0, s34, 3072
    s_add_u32 s35, s33, 98304
    buffer_load_dwordx4 v40, s[12:15], s35 offen lds
    s_add_u32 m0, s34, 4096
    s_add_u32 s35, s33, 131072
    buffer_load_dwordx4 v40, s[12:15], s35 offen lds
    s_add_u32 m0, s34, 5120
    s_add_u32 s35, s33, 163840
    buffer_load_dwordx4 v40, s[12:15], s35 offen lds
    s_add_u32 m0, s34, 6144
    s_add_u32 s35, s33, 196608
    buffer_load_dwordx4 v40, s[12:15], s35 offen lds
    s_add_u32 m0, s34, 7168
    s_add_u32 s35, s33, 229376
    buffer_load_dwordx4 v40, s[12:15], s35 offen lds
    s_waitcnt vmcnt(0)
    s_barrier
    ds_read_b64_tr_b16 v[64:65], v44 offset:0
    ds_read_b64_tr_b16 v[66:67], v44 offset:2048
    ds_read_b64_tr_b16 v[68:69], v44 offset:4096
    ds_read_b64_tr_b16 v[70:71], v44 offset:6144
    ds_read_b64_tr_b16 v[72:73], v44 offset:8192
    ds_read_b64_tr_b16 v[74:75], v44 offset:10240
    ds_read_b64_tr_b16 v[76:77], v44 offset:12288
    ds_read_b64_tr_b16 v[78:79], v44 offset:14336
    ds_read_b64_tr_b16 v[80:81], v44 offset:16384
    ds_read_b64_tr_b16 v[82:83], v44 offset:18432
    ds_read_b64_tr_b16 v[84:85], v44 offset:20480
    ds_read_b64_tr_b16 v[86:87], v44 offset:22528
    ds_read_b64_tr_b16 v[88:89], v44 offset:24576
    ds_read_b64_tr_b16 v[90:91], v44 offset:26624
    ds_read_b64_tr_b16 v[92:93], v44 offset:28672
    ds_read_b64_tr_b16 v[94:95], v44 offset:30720
    s_waitcnt lgkmcnt(0)
    ds_write_b128 v46, v[64:67] offset:16384
    ds_write_b128 v46, v[68:71] offset:17408
    ds_write_b128 v46, v[72:75] offset:18432
    ds_write_b128 v46, v[76:79] offset:19456
    ds_write_b128 v46, v[80:83] offset:20480
    ds_write_b128 v46, v[84:87] offset:21504
    ds_write_b128 v46, v[88:91] offset:22528
    ds_write_b128 v46, v[92:95] offset:23552
    s_waitcnt lgkmcnt(0)
    s_barrier
    s_lshl_b32 s33, s6, 18
    s_add_u32 s33, s33, 3145728
    s_lshl_b32 s34, s6, 13
    s_add_u32 s34, s34, 131072
    s_add_u32 m0, s34, 0
    s_add_u32 s35, s33, 0
    buffer_load_dwordx4 v40, s[12:15], s35 offen lds
    s_add_u32 m0, s34, 1024
    s_add_u32 s35, s33, 32768
    buffer_load_dwordx4 v40, s[12:15], s35 offen lds
    s_add_u32 m0, s34, 2048
    s_add_u32 s35, s33, 65536
    buffer_load_dwordx4 v40, s[12:15], s35 offen lds
    s_add_u32 m0, s34, 3072
    s_add_u32 s35, s33, 98304
    buffer_load_dwordx4 v40, s[12:15], s35 offen lds
    s_add_u32 m0, s34, 4096
    s_add_u32 s35, s33, 131072
    buffer_load_dwordx4 v40, s[12:15], s35 offen lds
    s_add_u32 m0, s34, 5120
    s_add_u32 s35, s33, 163840
    buffer_load_dwordx4 v40, s[12:15], s35 offen lds
    s_add_u32 m0, s34, 6144
    s_add_u32 s35, s33, 196608
    buffer_load_dwordx4 v40, s[12:15], s35 offen lds
    s_add_u32 m0, s34, 7168
    s_add_u32 s35, s33, 229376
    buffer_load_dwordx4 v40, s[12:15], s35 offen lds
    s_waitcnt vmcnt(0)
    s_barrier
    ds_read_b64_tr_b16 v[64:65], v44 offset:0
    ds_read_b64_tr_b16 v[66:67], v44 offset:2048
    ds_read_b64_tr_b16 v[68:69], v44 offset:4096
    ds_read_b64_tr_b16 v[70:71], v44 offset:6144
    ds_read_b64_tr_b16 v[72:73], v44 offset:8192
    ds_read_b64_tr_b16 v[74:75], v44 offset:10240
    ds_read_b64_tr_b16 v[76:77], v44 offset:12288
    ds_read_b64_tr_b16 v[78:79], v44 offset:14336
    ds_read_b64_tr_b16 v[80:81], v44 offset:16384
    ds_read_b64_tr_b16 v[82:83], v44 offset:18432
    ds_read_b64_tr_b16 v[84:85], v44 offset:20480
    ds_read_b64_tr_b16 v[86:87], v44 offset:22528
    ds_read_b64_tr_b16 v[88:89], v44 offset:24576
    ds_read_b64_tr_b16 v[90:91], v44 offset:26624
    ds_read_b64_tr_b16 v[92:93], v44 offset:28672
    ds_read_b64_tr_b16 v[94:95], v44 offset:30720
    s_waitcnt lgkmcnt(0)
    ds_write_b128 v46, v[64:67] offset:24576
    ds_write_b128 v46, v[68:71] offset:25600
    ds_write_b128 v46, v[72:75] offset:26624
    ds_write_b128 v46, v[76:79] offset:27648
    ds_write_b128 v46, v[80:83] offset:28672
    ds_write_b128 v46, v[84:87] offset:29696
    ds_write_b128 v46, v[88:91] offset:30720
    ds_write_b128 v46, v[92:95] offset:31744
    s_waitcnt lgkmcnt(0)
    s_barrier
    s_lshr_b32 s40, s6, 1
    s_and_b32 s41, s6, 1
    s_lshl_b32 s32, s40, 6
    s_add_u32 s32, s32, s41
    s_lshl_b32 s32, s32, 5
    s_add_u32 s32, s32, s5
    s_mul_i32 s43, s32, 24576
    s_lshl_b32 s44, s32, 12
    s_add_u32 s44, s44, 100663296
    s_lshl_b32 s45, s32, 4
    s_add_u32 s45, s45, 205651968
    s_lshl_b32 s49, s32, 5
    s_add_u32 s49, s49, 205520896
    s_lshl_b32 s33, s40, 6
    s_add_u32 s33, s33, s41
    s_mul_i32 s34, s40, 12582912
    s_lshl_b32 s35, s41, 15
    s_add_u32 s50, s34, s35
    s_add_u32 s50, s50, 178257920
    s_lshl_b32 s34, s40, 14
    s_lshl_b32 s35, s41, 7
    s_add_u32 s51, s34, s35
    s_add_u32 s51, s51, 205725696
    s_lshl_b32 s46, s32, 2
    s_add_u32 s46, s46, 205783040
    s_lshl_b32 s33, s40, 6
    s_add_u32 s33, s33, s41
    s_lshl_b32 s33, s33, 18
    s_lshl_b32 s34, s5, 13
    s_add_u32 s47, s33, s34
    s_add_u32 s47, s47, 117440512
    s_lshl_b32 s42, s6, 12
    s_add_u32 s42, s42, 131072
    v_lshlrev_b32 v1, 4, v0
    v_lshrrev_b32 v60, 5, v0
    v_and_b32 v61, 7, v0
    v_lshlrev_b32 v2, 4, v61
    v_lshl_add_u32 v2, v60, 7, v2
    v_add_u32 v2, s42, v2
    v_and_b32 v61, 31, v0
    v_lshlrev_b32 v3, 4, v61
    v_lshl_add_u32 v3, v60, 3, v3
    v_add_u32 v3, s42, v3
    v_mov_b32 v7, 0xff7fffff
    v_mov_b32 v12, 0x3f803f80
    v_mov_b32 v13, 0x3f803f80
    v_mov_b32 v14, 0x3f803f80
    v_mov_b32 v15, 0x3f803f80
    s_mov_b32 s48, 0x3e0293ee
    v_mov_b32 v4, v1
    v_add_u32 v5, 0x10000, v1
    v_and_b32 v60, 31, v0
    v_lshrrev_b32 v61, 5, v0
    v_lshlrev_b32 v61, 2, v61
    v_sub_u32 v60, v60, v61
    v_cmp_le_i32 s[64:65], 0, v60
    v_cmp_le_i32 s[66:67], 1, v60
    v_cmp_le_i32 s[68:69], 2, v60
    v_cmp_le_i32 s[70:71], 3, v60
    v_cmp_le_i32 s[72:73], 8, v60
    v_cmp_le_i32 s[74:75], 9, v60
    v_cmp_le_i32 s[76:77], 10, v60
    v_cmp_le_i32 s[78:79], 11, v60
    v_cmp_le_i32 s[80:81], 16, v60
    v_cmp_le_i32 s[82:83], 17, v60
    v_cmp_le_i32 s[84:85], 18, v60
    v_cmp_le_i32 s[86:87], 19, v60
    v_cmp_le_i32 s[88:89], 24, v60
    v_cmp_le_i32 s[90:91], 25, v60
    v_cmp_le_i32 s[92:93], 26, v60
    v_cmp_le_i32 s[94:95], 27, v60
    s_load_dwordx2 s[16:17], s[0:1], 88
    s_waitcnt lgkmcnt(0)
    s_mov_b32 s18, 256
    s_mov_b32 s19, 0x20000
    s_mov_b32 s20, 0
ATT_20_iw:
    v_mbcnt_lo_u32_b32 v9, -1, 0
    v_mbcnt_hi_u32_b32 v9, -1, v9
    v_min_u32 v9, 7, v9
    v_and_b32 v10, 1, v9
    v_lshlrev_b32 v10, 7, v10
    v_lshrrev_b32 v9, 1, v9
    v_lshl_add_u32 v9, v9, 2, v10
    buffer_load_dword v9, v9, s[16:19], 0 offen sc1
    s_waitcnt vmcnt(0)
    v_cmp_gt_u32 vcc, 32, v9
    s_cmp_eq_u64 vcc, 0
    s_cselect_b32 s21, 256, 0
    s_cmp_ge_u32 s21, 256
    s_cbranch_scc1 ATT_20_iwd
    s_add_u32 s20, s20, 1
    s_cmp_gt_u32 s20, 300000
    s_cbranch_scc1 L_fail
    s_sleep 2
    s_branch ATT_20_iw
ATT_20_iwd:
    s_mov_b32 s52, 0
    s_mov_b32 s96, 0
    v_mbcnt_lo_u32_b32 v250, -1, 0
    v_mbcnt_hi_u32_b32 v250, -1, v250
    v_min_u32 v250, 15, v250
    v_lshlrev_b32 v250, 2, v250
ATT_20wx0_21_spin:
    buffer_load_dword v251, v250, s[8:11], s51 offen sc1
    s_waitcnt vmcnt(0)
    v_cmp_eq_u32 vcc, 0, v251
    s_cbranch_vccz ATT_20wx0_21_ok
    s_add_u32 s96, s96, 1
    s_cmp_gt_u32 s96, 300000
    s_cbranch_scc1 L_fail
    s_sleep 1
    s_branch ATT_20wx0_21_spin
ATT_20wx0_21_ok:
    s_add_u32 s32, s50, 0
    buffer_load_dwordx4 a[96:99], v1, s[8:11], s32 offen offset:0 sc1
    buffer_load_dwordx4 a[100:103], v1, s[8:11], s32 offen offset:1024 sc1
    buffer_load_dwordx4 a[104:107], v1, s[8:11], s32 offen offset:2048 sc1
    buffer_load_dwordx4 a[108:111], v1, s[8:11], s32 offen offset:3072 sc1
    s_add_u32 s32, s50, 4096
    buffer_load_dwordx4 a[112:115], v1, s[8:11], s32 offen offset:0 sc1
    buffer_load_dwordx4 a[116:119], v1, s[8:11], s32 offen offset:1024 sc1
    buffer_load_dwordx4 a[120:123], v1, s[8:11], s32 offen offset:2048 sc1
    buffer_load_dwordx4 a[124:127], v1, s[8:11], s32 offen offset:3072 sc1
    s_add_u32 s32, s50, 8192
    buffer_load_dwordx4 a[128:131], v1, s[8:11], s32 offen offset:0 sc1
    buffer_load_dwordx4 a[132:135], v1, s[8:11], s32 offen offset:1024 sc1
    buffer_load_dwordx4 a[136:139], v1, s[8:11], s32 offen offset:2048 sc1
    buffer_load_dwordx4 a[140:143], v1, s[8:11], s32 offen offset:3072 sc1
    s_add_u32 s32, s50, 12288
    buffer_load_dwordx4 a[144:147], v1, s[8:11], s32 offen offset:0 sc1
    buffer_load_dwordx4 a[148:151], v1, s[8:11], s32 offen offset:1024 sc1
    buffer_load_dwordx4 a[152:155], v1, s[8:11], s32 offen offset:2048 sc1
    buffer_load_dwordx4 a[156:159], v1, s[8:11], s32 offen offset:3072 sc1
    s_add_u32 s32, s50, 16384
    buffer_load_dwordx4 a[160:163], v1, s[8:11], s32 offen offset:0 sc1
    buffer_load_dwordx4 a[164:167], v1, s[8:11], s32 offen offset:1024 sc1
    buffer_load_dwordx4 a[168:171], v1, s[8:11], s32 offen offset:2048 sc1
    buffer_load_dwordx4 a[172:175], v1, s[8:11], s32 offen offset:3072 sc1
    s_add_u32 s32, s50, 20480
    buffer_load_dwordx4 a[176:179], v1, s[8:11], s32 offen offset:0 sc1
    buffer_load_dwordx4 a[180:183], v1, s[8:11], s32 offen offset:1024 sc1
    buffer_load_dwordx4 a[184:187], v1, s[8:11], s32 offen offset:2048 sc1
    buffer_load_dwordx4 a[188:191], v1, s[8:11], s32 offen offset:3072 sc1
    s_add_u32 s32, s50, 24576
    buffer_load_dwordx4 a[192:195], v1, s[8:11], s32 offen offset:0 sc1
    buffer_load_dwordx4 a[196:199], v1, s[8:11], s32 offen offset:1024 sc1
    buffer_load_dwordx4 a[200:203], v1, s[8:11], s32 offen offset:2048 sc1
    buffer_load_dwordx4 a[204:207], v1, s[8:11], s32 offen offset:3072 sc1
    s_add_u32 s32, s50, 28672
    buffer_load_dwordx4 a[208:211], v1, s[8:11], s32 offen offset:0 sc1
    buffer_load_dwordx4 a[212:215], v1, s[8:11], s32 offen offset:1024 sc1
    buffer_load_dwordx4 a[216:219], v1, s[8:11], s32 offen offset:2048 sc1
    buffer_load_dwordx4 a[220:223], v1, s[8:11], s32 offen offset:3072 sc1
    s_add_u32 s50, s50, 131072
    s_add_u32 s51, s51, 512
ATT_20_H:
    ds_read_b128 v[64:67], v4 offset:0
    ds_read_b128 v[68:71], v4 offset:1024
    ds_read_b128 v[72:75], v4 offset:2048
    ds_read_b128 v[76:79], v4 offset:3072
    ds_read_b128 v[80:83], v4 offset:4096
    ds_read_b128 v[84:87], v4 offset:5120
    s_cmp_eq_u32 s52, 0
    s_cbranch_scc1 ATT_20x_22_0
    s_waitcnt vmcnt(39)
    s_branch ATT_20x_22_1
ATT_20x_22_0:
    s_waitcnt vmcnt(31)
ATT_20x_22_1:
    s_waitcnt lgkmcnt(5)
    v_mfma_f32_32x32x16_bf16 v[96:111], v[64:67], a[96:99], 0
    ds_read_b128 v[88:91], v4 offset:6144
    s_cmp_eq_u32 s52, 0
    s_cbranch_scc1 ATT_20x_23_0
    s_waitcnt vmcnt(38)
    s_branch ATT_20x_23_1
ATT_20x_23_0:
    s_waitcnt vmcnt(30)
ATT_20x_23_1:
    s_waitcnt lgkmcnt(5)
    v_mfma_f32_32x32x16_bf16 v[96:111], v[68:71], a[100:103], v[96:111]
    ds_read_b128 v[92:95], v4 offset:7168
    s_cmp_eq_u32 s52, 0
    s_cbranch_scc1 ATT_20x_24_0
    s_waitcnt vmcnt(37)
    s_branch ATT_20x_24_1
ATT_20x_24_0:
    s_waitcnt vmcnt(29)
ATT_20x_24_1:
    s_waitcnt lgkmcnt(5)
    v_mfma_f32_32x32x16_bf16 v[96:111], v[72:75], a[104:107], v[96:111]
    ds_read_b128 v[64:67], v4 offset:8192
    s_cmp_eq_u32 s52, 0
    s_cbranch_scc1 ATT_20x_25_0
    s_waitcnt vmcnt(36)
    s_branch ATT_20x_25_1
ATT_20x_25_0:
    s_waitcnt vmcnt(28)
ATT_20x_25_1:
    s_waitcnt lgkmcnt(5)
    v_mfma_f32_32x32x16_bf16 v[96:111], v[76:79], a[108:111], v[96:111]
    ds_read_b128 v[68:71], v4 offset:9216
    s_cmp_eq_u32 s52, 0
    s_cbranch_scc1 ATT_20x_26_0
    s_waitcnt vmcnt(35)
    s_branch ATT_20x_26_1
ATT_20x_26_0:
    s_waitcnt vmcnt(27)
ATT_20x_26_1:
    s_waitcnt lgkmcnt(5)
    v_mfma_f32_32x32x16_bf16 v[96:111], v[80:83], a[112:115], v[96:111]
    ds_read_b128 v[72:75], v4 offset:10240
    s_cmp_eq_u32 s52, 0
    s_cbranch_scc1 ATT_20x_27_0
    s_waitcnt vmcnt(34)
    s_branch ATT_20x_27_1
ATT_20x_27_0:
    s_waitcnt vmcnt(26)
ATT_20x_27_1:
    s_waitcnt lgkmcnt(5)
    v_mfma_f32_32x32x16_bf16 v[96:111], v[84:87], a[116:119], v[96:111]
    ds_read_b128 v[76:79], v4 offset:11264
    s_cmp_eq_u32 s52, 0
    s_cbranch_scc1 ATT_20x_28_0
    s_waitcnt vmcnt(33)
    s_branch ATT_20x_28_1
ATT_20x_28_0:
    s_waitcnt vmcnt(25)
ATT_20x_28_1:
    s_waitcnt lgkmcnt(5)
    v_mfma_f32_32x32x16_bf16 v[96:111], v[88:91], a[120:123], v[96:111]
    ds_read_b128 v[80:83], v4 offset:12288
    s_cmp_eq_u32 s52, 0
    s_cbranch_scc1 ATT_20x_29_0
    s_waitcnt vmcnt(32)
    s_branch ATT_20x_29_1
ATT_20x_29_0:
    s_waitcnt vmcnt(24)
ATT_20x_29_1:
    s_waitcnt lgkmcnt(5)
    v_mfma_f32_32x32x16_bf16 v[96:111], v[92:95], a[124:127], v[96:111]
    ds_read_b128 v[84:87], v4 offset:13312
    s_waitcnt vmcnt(23) lgkmcnt(5)
    v_mfma_f32_32x32x16_bf16 v[96:111], v[64:67], a[128:131], v[96:111]
    ds_read_b128 v[88:91], v4 offset:14336
    s_waitcnt vmcnt(22) lgkmcnt(5)
    v_mfma_f32_32x32x16_bf16 v[96:111], v[68:71], a[132:135], v[96:111]
    ds_read_b128 v[92:95], v4 offset:15360
    s_waitcnt vmcnt(21) lgkmcnt(5)
    v_mfma_f32_32x32x16_bf16 v[96:111], v[72:75], a[136:139], v[96:111]
    ds_read_b128 v[64:67], v4 offset:16384
    s_waitcnt vmcnt(20) lgkmcnt(5)
    v_mfma_f32_32x32x16_bf16 v[96:111], v[76:79], a[140:143], v[96:111]
    ds_read_b128 v[68:71], v4 offset:17408
    s_waitcnt vmcnt(19) lgkmcnt(5)
    v_mfma_f32_32x32x16_bf16 v[96:111], v[80:83], a[144:147], v[96:111]
    ds_read_b128 v[72:75], v4 offset:18432
    s_waitcnt vmcnt(18) lgkmcnt(5)
    v_mfma_f32_32x32x16_bf16 v[96:111], v[84:87], a[148:151], v[96:111]
    ds_read_b128 v[76:79], v4 offset:19456
    s_waitcnt vmcnt(17) lgkmcnt(5)
    v_mfma_f32_32x32x16_bf16 v[96:111], v[88:91], a[152:155], v[96:111]
    ds_read_b128 v[80:83], v4 offset:20480
    s_waitcnt vmcnt(16) lgkmcnt(5)
    v_mfma_f32_32x32x16_bf16 v[96:111], v[92:95], a[156:159], v[96:111]
    ds_read_b128 v[84:87], v4 offset:21504
    s_waitcnt vmcnt(15) lgkmcnt(5)
    v_mfma_f32_32x32x16_bf16 v[96:111], v[64:67], a[160:163], v[96:111]
    ds_read_b128 v[88:91], v4 offset:22528
    s_waitcnt vmcnt(14) lgkmcnt(5)
    v_mfma_f32_32x32x16_bf16 v[96:111], v[68:71], a[164:167], v[96:111]
    ds_read_b128 v[92:95], v4 offset:23552
    s_waitcnt vmcnt(13) lgkmcnt(5)
    v_mfma_f32_32x32x16_bf16 v[96:111], v[72:75], a[168:171], v[96:111]
    ds_read_b128 v[64:67], v4 offset:24576
    s_waitcnt vmcnt(12) lgkmcnt(5)
    v_mfma_f32_32x32x16_bf16 v[96:111], v[76:79], a[172:175], v[96:111]
    ds_read_b128 v[68:71], v4 offset:25600
    s_waitcnt vmcnt(11) lgkmcnt(5)
    v_mfma_f32_32x32x16_bf16 v[96:111], v[80:83], a[176:179], v[96:111]
    ds_read_b128 v[72:75], v4 offset:26624
    s_waitcnt vmcnt(10) lgkmcnt(5)
    v_mfma_f32_32x32x16_bf16 v[96:111], v[84:87], a[180:183], v[96:111]
    ds_read_b128 v[76:79], v4 offset:27648
    s_waitcnt vmcnt(9) lgkmcnt(5)
    v_mfma_f32_32x32x16_bf16 v[96:111], v[88:91], a[184:187], v[96:111]
    ds_read_b128 v[80:83], v4 offset:28672
    s_waitcnt vmcnt(8) lgkmcnt(5)
    v_mfma_f32_32x32x16_bf16 v[96:111], v[92:95], a[188:191], v[96:111]
    ds_read_b128 v[84:87], v4 offset:29696
    s_waitcnt vmcnt(7) lgkmcnt(5)
    v_mfma_f32_32x32x16_bf16 v[96:111], v[64:67], a[192:195], v[96:111]
    ds_read_b128 v[88:91], v4 offset:30720
    s_waitcnt vmcnt(6) lgkmcnt(5)
    v_mfma_f32_32x32x16_bf16 v[96:111], v[68:71], a[196:199], v[96:111]
    ds_read_b128 v[92:95], v4 offset:31744
    s_waitcnt vmcnt(5) lgkmcnt(5)
    v_mfma_f32_32x32x16_bf16 v[96:111], v[72:75], a[200:203], v[96:111]
    ds_read_b128 v[64:67], v4 offset:32768
    s_waitcnt vmcnt(4) lgkmcnt(5)
    v_mfma_f32_32x32x16_bf16 v[96:111], v[76:79], a[204:207], v[96:111]
    ds_read_b128 v[68:71], v4 offset:33792
    s_waitcnt vmcnt(3) lgkmcnt(5)
    v_mfma_f32_32x32x16_bf16 v[96:111], v[80:83], a[208:211], v[96:111]
    ds_read_b128 v[72:75], v4 offset:34816
    s_waitcnt vmcnt(2) lgkmcnt(5)
    v_mfma_f32_32x32x16_bf16 v[96:111], v[84:87], a[212:215], v[96:111]
    ds_read_b128 v[76:79], v4 offset:35840
    s_waitcnt vmcnt(1) lgkmcnt(5)
    v_mfma_f32_32x32x16_bf16 v[96:111], v[88:91], a[216:219], v[96:111]
    ds_read_b128 v[80:83], v4 offset:36864
    s_waitcnt vmcnt(0) lgkmcnt(5)
    v_mfma_f32_32x32x16_bf16 v[96:111], v[92:95], a[220:223], v[96:111]
    ds_read_b128 v[84:87], v4 offset:37888
    s_cmp_eq_u32 s52, 0
    s_cbranch_scc1 ATT_20_nf
    v_mov_b32 v11, 1
    v_mov_b32 v10, 0
    s_mov_b64 exec, 1
    buffer_store_dword v11, v10, s[8:11], s46 offen sc1
    s_mov_b64 exec, -1
    s_add_u32 s46, s46, 256
    s_mov_b32 s52, 0
ATT_20_nf:
    v_mbcnt_lo_u32_b32 v10, -1, 0
    v_mbcnt_hi_u32_b32 v10, -1, v10
    v_min_u32 v10, 3, v10
    v_lshlrev_b32 v10, 2, v10
    buffer_load_dword v30, v10, s[8:11], s49 offen sc1
    s_waitcnt lgkmcnt(5)
    v_mfma_f32_32x32x16_bf16 v[112:127], v[64:67], a[96:99], 0
    ds_read_b128 v[88:91], v4 offset:38912
    s_waitcnt lgkmcnt(5)
    v_mfma_f32_32x32x16_bf16 v[112:127], v[68:71], a[100:103], v[112:127]
    ds_read_b128 v[92:95], v4 offset:39936
    s_waitcnt lgkmcnt(5)
    v_mfma_f32_32x32x16_bf16 v[112:127], v[72:75], a[104:107], v[112:127]
    ds_read_b128 v[64:67], v4 offset:40960
    s_waitcnt lgkmcnt(5)
    v_mfma_f32_32x32x16_bf16 v[112:127], v[76:79], a[108:111], v[112:127]
    ds_read_b128 v[68:71], v4 offset:41984
    s_waitcnt lgkmcnt(5)
    v_mfma_f32_32x32x16_bf16 v[112:127], v[80:83], a[112:115], v[112:127]
    ds_read_b128 v[72:75], v4 offset:43008
    s_waitcnt lgkmcnt(5)
    v_mfma_f32_32x32x16_bf16 v[112:127], v[84:87], a[116:119], v[112:127]
    ds_read_b128 v[76:79], v4 offset:44032
    s_waitcnt lgkmcnt(5)
    v_mfma_f32_32x32x16_bf16 v[112:127], v[88:91], a[120:123], v[112:127]
    ds_read_b128 v[80:83], v4 offset:45056
    s_waitcnt lgkmcnt(5)
    v_mfma_f32_32x32x16_bf16 v[112:127], v[92:95], a[124:127], v[112:127]
    ds_read_b128 v[84:87], v4 offset:46080
    s_waitcnt lgkmcnt(5)
    v_mfma_f32_32x32x16_bf16 v[112:127], v[64:67], a[128:131], v[112:127]
    ds_read_b128 v[88:91], v4 offset:47104
    v_cvt_pk_bf16_f32 v128, v96, v97
    s_waitcnt lgkmcnt(5)
    v_mfma_f32_32x32x16_bf16 v[112:127], v[68:71], a[132:135], v[112:127]
    ds_read_b128 v[92:95], v4 offset:48128
    v_cvt_pk_bf16_f32 v129, v98, v99
    s_waitcnt lgkmcnt(5)
    v_mfma_f32_32x32x16_bf16 v[112:127], v[72:75], a[136:139], v[112:127]
    ds_read_b128 v[64:67], v4 offset:49152
    v_cvt_pk_bf16_f32 v130, v100, v101
    s_waitcnt lgkmcnt(5)
    v_mfma_f32_32x32x16_bf16 v[112:127], v[76:79], a[140:143], v[112:127]
    ds_read_b128 v[68:71], v4 offset:50176
    v_cvt_pk_bf16_f32 v131, v102, v103
    s_waitcnt lgkmcnt(5)
    v_mfma_f32_32x32x16_bf16 v[112:127], v[80:83], a[144:147], v[112:127]
    ds_read_b128 v[72:75], v4 offset:51200
    v_cvt_pk_bf16_f32 v132, v104, v105
    s_waitcnt lgkmcnt(5)
    v_mfma_f32_32x32x16_bf16 v[112:127], v[84:87], a[148:151], v[112:127]
    ds_read_b128 v[76:79], v4 offset:52224
    v_cvt_pk_bf16_f32 v133, v106, v107
    s_waitcnt lgkmcnt(5)
    v_mfma_f32_32x32x16_bf16 v[112:127], v[88:91], a[152:155], v[112:127]
    ds_read_b128 v[80:83], v4 offset:53248
    v_cvt_pk_bf16_f32 v134, v108, v109
    s_waitcnt lgkmcnt(5)
    v_mfma_f32_32x32x16_bf16 v[112:127], v[92:95], a[156:159], v[112:127]
    ds_read_b128 v[84:87], v4 offset:54272
    v_cvt_pk_bf16_f32 v135, v110, v111
    s_waitcnt lgkmcnt(5)
    v_mfma_f32_32x32x16_bf16 v[112:127], v[64:67], a[160:163], v[112:127]
    ds_read_b128 v[88:91], v4 offset:55296
    s_waitcnt lgkmcnt(5)
    v_mfma_f32_32x32x16_bf16 v[112:127], v[68:71], a[164:167], v[112:127]
    ds_read_b128 v[92:95], v4 offset:56320
    s_waitcnt lgkmcnt(5)
    v_mfma_f32_32x32x16_bf16 v[112:127], v[72:75], a[168:171], v[112:127]
    ds_read_b128 v[64:67], v4 offset:57344
    s_waitcnt lgkmcnt(5)
    v_mfma_f32_32x32x16_bf16 v[112:127], v[76:79], a[172:175], v[112:127]
    ds_read_b128 v[68:71], v4 offset:58368
    s_waitcnt lgkmcnt(5)
    v_mfma_f32_32x32x16_bf16 v[112:127], v[80:83], a[176:179], v[112:127]
    ds_read_b128 v[72:75], v4 offset:59392
    s_waitcnt lgkmcnt(5)
    v_mfma_f32_32x32x16_bf16 v[112:127], v[84:87], a[180:183], v[112:127]
    ds_read_b128 v[76:79], v4 offset:60416
    s_waitcnt lgkmcnt(5)
    v_mfma_f32_32x32x16_bf16 v[112:127], v[88:91], a[184:187], v[112:127]
    ds_read_b128 v[80:83], v4 offset:61440
    s_waitcnt lgkmcnt(5)
    v_mfma_f32_32x32x16_bf16 v[112:127], v[92:95], a[188:191], v[112:127]
    ds_read_b128 v[84:87], v4 offset:62464
    s_waitcnt lgkmcnt(5)
    v_mfma_f32_32x32x16_bf16 v[112:127], v[64:67], a[192:195], v[112:127]
    ds_read_b128 v[88:91], v4 offset:63488
    s_waitcnt lgkmcnt(5)
    v_mfma_f32_32x32x16_bf16 v[112:127], v[68:71], a[196:199], v[112:127]
    ds_read_b128 v[92:95], v4 offset:64512
    s_waitcnt lgkmcnt(5)
    v_mfma_f32_32x32x16_bf16 v[112:127], v[72:75], a[200:203], v[112:127]
    ds_read_b128 v[64:67], v5 offset:0
    s_waitcnt lgkmcnt(5)
    v_mfma_f32_32x32x16_bf16 v[112:127], v[76:79], a[204:207], v[112:127]
    ds_read_b128 v[68:71], v5 offset:1024
    s_waitcnt lgkmcnt(5)
    v_mfma_f32_32x32x16_bf16 v[112:127], v[80:83], a[208:211], v[112:127]
    ds_read_b128 v[72:75], v5 offset:2048
    s_waitcnt lgkmcnt(5)
    v_mfma_f32_32x32x16_bf16 v[112:127], v[84:87], a[212:215], v[112:127]
    ds_read_b128 v[76:79], v5 offset:3072
    s_waitcnt vmcnt(0)
    v_cmp_eq_u32 vcc, 0, v30
    s_cbranch_vccz ATT_20_pok
    s_mov_b32 s96, 0
    v_mbcnt_lo_u32_b32 v250, -1, 0
    v_mbcnt_hi_u32_b32 v250, -1, v250
    v_min_u32 v250, 3, v250
    v_lshlrev_b32 v250, 2, v250
ATT_20wp_30_spin:
    buffer_load_dword v251, v250, s[8:11], s49 offen sc1
    s_waitcnt vmcnt(0)
    v_cmp_eq_u32 vcc, 0, v251
    s_cbranch_vccz ATT_20wp_30_ok
    s_add_u32 s96, s96, 1
    s_cmp_gt_u32 s96, 300000
    s_cbranch_scc1 L_fail
    s_sleep 1
    s_branch ATT_20wp_30_spin
ATT_20wp_30_ok:
ATT_20_pok:
    s_waitcnt lgkmcnt(5)
    v_mfma_f32_32x32x16_bf16 v[112:127], v[88:91], a[216:219], v[112:127]
    ds_read_b128 v[80:83], v5 offset:4096
    s_waitcnt lgkmcnt(5)
    v_mfma_f32_32x32x16_bf16 v[112:127], v[92:95], a[220:223], v[112:127]
    ds_read_b128 v[84:87], v5 offset:5120
    s_waitcnt lgkmcnt(5)
    v_mfma_f32_32x32x16_bf16 v[96:111], v[64:67], a[96:99], 0
    ds_read_b128 v[88:91], v5 offset:6144
    s_waitcnt lgkmcnt(5)
    v_mfma_f32_32x32x16_bf16 v[96:111], v[68:71], a[100:103], v[96:111]
    ds_read_b128 v[92:95], v5 offset:7168
    s_add_u32 s32, s43, 8192
    buffer_load_dwordx4 a[32:35], v1, s[8:11], s32 offen offset:0 sc1
    s_waitcnt lgkmcnt(5)
    v_mfma_f32_32x32x16_bf16 v[96:111], v[72:75], a[104:107], v[96:111]
    ds_read_b128 v[64:67], v5 offset:8192
    s_waitcnt lgkmcnt(5)
    v_mfma_f32_32x32x16_bf16 v[96:111], v[76:79], a[108:111], v[96:111]
    ds_read_b128 v[68:71], v5 offset:9216
    buffer_load_dwordx4 a[36:39], v1, s[8:11], s32 offen offset:1024 sc1
    s_waitcnt lgkmcnt(5)
    v_mfma_f32_32x32x16_bf16 v[96:111], v[80:83], a[112:115], v[96:111]
    ds_read_b128 v[72:75], v5 offset:10240
    s_waitcnt lgkmcnt(5)
    v_mfma_f32_32x32x16_bf16 v[96:111], v[84:87], a[116:119], v[96:111]
    ds_read_b128 v[76:79], v5 offset:11264
    buffer_load_dwordx4 a[40:43], v1, s[8:11], s32 offen offset:2048 sc1
    s_waitcnt lgkmcnt(5)
    v_mfma_f32_32x32x16_bf16 v[96:111], v[88:91], a[120:123], v[96:111]
    ds_read_b128 v[80:83], v5 offset:12288
    s_waitcnt lgkmcnt(5)
    v_mfma_f32_32x32x16_bf16 v[96:111], v[92:95], a[124:127], v[96:111]
    ds_read_b128 v[84:87], v5 offset:13312
    buffer_load_dwordx4 a[44:47], v1, s[8:11], s32 offen offset:3072 sc1
    s_waitcnt lgkmcnt(5)
    v_mfma_f32_32x32x16_bf16 v[96:111], v[64:67], a[128:131], v[96:111]
    ds_read_b128 v[88:91], v5 offset:14336
    v_cvt_pk_bf16_f32 v136, v112, v113
    s_waitcnt lgkmcnt(5)
    v_mfma_f32_32x32x16_bf16 v[96:111], v[68:71], a[132:135], v[96:111]
    ds_read_b128 v[92:95], v5 offset:15360
    v_cvt_pk_bf16_f32 v137, v114, v115
    s_add_u32 s32, s43, 12288
    buffer_load_dwordx4 a[48:51], v1, s[8:11], s32 offen offset:0 sc1
    s_waitcnt lgkmcnt(5)
    v_mfma_f32_32x32x16_bf16 v[96:111], v[72:75], a[136:139], v[96:111]
    ds_read_b128 v[64:67], v5 offset:16384
    v_cvt_pk_bf16_f32 v138, v116, v117
    s_waitcnt lgkmcnt(5)
    v_mfma_f32_32x32x16_bf16 v[96:111], v[76:79], a[140:143], v[96:111]
    ds_read_b128 v[68:71], v5 offset:17408
    v_cvt_pk_bf16_f32 v139, v118, v119
    buffer_load_dwordx4 a[52:55], v1, s[8:11], s32 offen offset:1024 sc1
    s_waitcnt lgkmcnt(5)
    v_mfma_f32_32x32x16_bf16 v[96:111], v[80:83], a[144:147], v[96:111]
    ds_read_b128 v[72:75], v5 offset:18432
    v_cvt_pk_bf16_f32 v140, v120, v121
    s_waitcnt lgkmcnt(5)
    v_mfma_f32_32x32x16_bf16 v[96:111], v[84:87], a[148:151], v[96:111]
    ds_read_b128 v[76:79], v5 offset:19456
    v_cvt_pk_bf16_f32 v141, v122, v123
    buffer_load_dwordx4 a[56:59], v1, s[8:11], s32 offen offset:2048 sc1
    s_waitcnt lgkmcnt(5)
    v_mfma_f32_32x32x16_bf16 v[96:111], v[88:91], a[152:155], v[96:111]
    ds_read_b128 v[80:83], v5 offset:20480
    v_cvt_pk_bf16_f32 v142, v124, v125
    s_waitcnt lgkmcnt(5)
    v_mfma_f32_32x32x16_bf16 v[96:111], v[92:95], a[156:159], v[96:111]
    ds_read_b128 v[84:87], v5 offset:21504
    v_cvt_pk_bf16_f32 v143, v126, v127
    buffer_load_dwordx4 a[60:63], v1, s[8:11], s32 offen offset:3072 sc1
    s_waitcnt lgkmcnt(5)
    v_mfma_f32_32x32x16_bf16 v[96:111], v[64:67], a[160:163], v[96:111]
    ds_read_b128 v[88:91], v5 offset:22528
    s_waitcnt lgkmcnt(5)
    v_mfma_f32_32x32x16_bf16 v[96:111], v[68:71], a[164:167], v[96:111]
    ds_read_b128 v[92:95], v5 offset:23552
    s_add_u32 s32, s43, 16384
    buffer_load_dwordx4 a[64:67], v1, s[8:11], s32 offen offset:0 sc1
    s_waitcnt lgkmcnt(5)
    v_mfma_f32_32x32x16_bf16 v[96:111], v[72:75], a[168:171], v[96:111]
    ds_read_b128 v[64:67], v5 offset:24576
    s_waitcnt lgkmcnt(5)
    v_mfma_f32_32x32x16_bf16 v[96:111], v[76:79], a[172:175], v[96:111]
    ds_read_b128 v[68:71], v5 offset:25600
    buffer_load_dwordx4 a[68:71], v1, s[8:11], s32 offen offset:1024 sc1
    s_waitcnt lgkmcnt(5)
    v_mfma_f32_32x32x16_bf16 v[96:111], v[80:83], a[176:179], v[96:111]
    ds_read_b128 v[72:75], v5 offset:26624
    s_waitcnt lgkmcnt(5)
    v_mfma_f32_32x32x16_bf16 v[96:111], v[84:87], a[180:183], v[96:111]
    ds_read_b128 v[76:79], v5 offset:27648
    buffer_load_dwordx4 a[72:75], v1, s[8:11], s32 offen offset:2048 sc1
    s_waitcnt lgkmcnt(5)
    v_mfma_f32_32x32x16_bf16 v[96:111], v[88:91], a[184:187], v[96:111]
    ds_read_b128 v[80:83], v5 offset:28672
    s_waitcnt lgkmcnt(5)
    v_mfma_f32_32x32x16_bf16 v[96:111], v[92:95], a[188:191], v[96:111]
    ds_read_b128 v[84:87], v5 offset:29696
    buffer_load_dwordx4 a[76:79], v1, s[8:11], s32 offen offset:3072 sc1
    s_waitcnt lgkmcnt(5)
    v_mfma_f32_32x32x16_bf16 v[96:111], v[64:67], a[192:195], v[96:111]
    ds_read_b128 v[88:91], v5 offset:30720
    s_waitcnt lgkmcnt(5)
    v_mfma_f32_32x32x16_bf16 v[96:111], v[68:71], a[196:199], v[96:111]
    ds_read_b128 v[92:95], v5 offset:31744
    s_add_u32 s32, s43, 20480
    buffer_load_dwordx4 a[80:83], v1, s[8:11], s32 offen offset:0 sc1
    s_waitcnt lgkmcnt(5)
    v_mfma_f32_32x32x16_bf16 v[96:111], v[72:75], a[200:203], v[96:111]
    ds_read_b128 v[64:67], v5 offset:32768
    s_waitcnt lgkmcnt(5)
    v_mfma_f32_32x32x16_bf16 v[96:111], v[76:79], a[204:207], v[96:111]
    ds_read_b128 v[68:71], v5 offset:33792
    buffer_load_dwordx4 a[84:87], v1, s[8:11], s32 offen offset:1024 sc1
    s_waitcnt lgkmcnt(5)
    v_mfma_f32_32x32x16_bf16 v[96:111], v[80:83], a[208:211], v[96:111]
    ds_read_b128 v[72:75], v5 offset:34816
    s_waitcnt lgkmcnt(5)
    v_mfma_f32_32x32x16_bf16 v[96:111], v[84:87], a[212:215], v[96:111]
    ds_read_b128 v[76:79], v5 offset:35840
    buffer_load_dwordx4 a[88:91], v1, s[8:11], s32 offen offset:2048 sc1
    s_waitcnt lgkmcnt(5)
    v_mfma_f32_32x32x16_bf16 v[96:111], v[88:91], a[216:219], v[96:111]
    ds_read_b128 v[80:83], v5 offset:36864
    s_waitcnt lgkmcnt(5)
    v_mfma_f32_32x32x16_bf16 v[96:111], v[92:95], a[220:223], v[96:111]
    ds_read_b128 v[84:87], v5 offset:37888
    buffer_load_dwordx4 a[92:95], v1, s[8:11], s32 offen offset:3072 sc1
    s_waitcnt lgkmcnt(5)
    v_mfma_f32_32x32x16_bf16 v[112:127], v[64:67], a[96:99], 0
    ds_read_b128 v[88:91], v5 offset:38912
    s_waitcnt lgkmcnt(5)
    v_mfma_f32_32x32x16_bf16 v[112:127], v[68:71], a[100:103], v[112:127]
    ds_read_b128 v[92:95], v5 offset:39936
    s_waitcnt lgkmcnt(5)
    v_mfma_f32_32x32x16_bf16 v[112:127], v[72:75], a[104:107], v[112:127]
    ds_read_b128 v[64:67], v5 offset:40960
    s_waitcnt lgkmcnt(5)
    v_mfma_f32_32x32x16_bf16 v[112:127], v[76:79], a[108:111], v[112:127]
    ds_read_b128 v[68:71], v5 offset:41984
    s_waitcnt lgkmcnt(5)
    v_mfma_f32_32x32x16_bf16 v[112:127], v[80:83], a[112:115], v[112:127]
    ds_read_b128 v[72:75], v5 offset:43008
    v_mbcnt_lo_u32_b32 v10, -1, 0
    v_mbcnt_hi_u32_b32 v10, -1, v10
    v_min_u32 v10, 3, v10
    v_lshlrev_b32 v10, 2, v10
    buffer_load_dword v30, v10, s[8:11], s45 offen sc1
    s_waitcnt lgkmcnt(5)
    v_mfma_f32_32x32x16_bf16 v[112:127], v[84:87], a[116:119], v[112:127]
    ds_read_b128 v[76:79], v5 offset:44032
    s_waitcnt lgkmcnt(5)
    v_mfma_f32_32x32x16_bf16 v[112:127], v[88:91], a[120:123], v[112:127]
    ds_read_b128 v[80:83], v5 offset:45056
    s_waitcnt lgkmcnt(5)
    v_mfma_f32_32x32x16_bf16 v[112:127], v[92:95], a[124:127], v[112:127]
    ds_read_b128 v[84:87], v5 offset:46080
    s_waitcnt lgkmcnt(5)
    v_mfma_f32_32x32x16_bf16 v[112:127], v[64:67], a[128:131], v[112:127]
    ds_read_b128 v[88:91], v5 offset:47104
    v_cvt_pk_bf16_f32 v144, v96, v97
    s_waitcnt lgkmcnt(5)
    v_mfma_f32_32x32x16_bf16 v[112:127], v[68:71], a[132:135], v[112:127]
    ds_read_b128 v[92:95], v5 offset:48128
    v_cvt_pk_bf16_f32 v145, v98, v99
    s_waitcnt lgkmcnt(5)
    v_mfma_f32_32x32x16_bf16 v[112:127], v[72:75], a[136:139], v[112:127]
    ds_read_b128 v[64:67], v5 offset:49152
    v_cvt_pk_bf16_f32 v146, v100, v101
    s_waitcnt lgkmcnt(5)
    v_mfma_f32_32x32x16_bf16 v[112:127], v[76:79], a[140:143], v[112:127]
    ds_read_b128 v[68:71], v5 offset:50176
    v_cvt_pk_bf16_f32 v147, v102, v103
    s_waitcnt lgkmcnt(5)
    v_mfma_f32_32x32x16_bf16 v[112:127], v[80:83], a[144:147], v[112:127]
    ds_read_b128 v[72:75], v5 offset:51200
    v_cvt_pk_bf16_f32 v148, v104, v105
    s_waitcnt lgkmcnt(5)
    v_mfma_f32_32x32x16_bf16 v[112:127], v[84:87], a[148:151], v[112:127]
    ds_read_b128 v[76:79], v5 offset:52224
    v_cvt_pk_bf16_f32 v149, v106, v107
    s_waitcnt lgkmcnt(5)
    v_mfma_f32_32x32x16_bf16 v[112:127], v[88:91], a[152:155], v[112:127]
    ds_read_b128 v[80:83], v5 offset:53248
    v_cvt_pk_bf16_f32 v150, v108, v109
    s_waitcnt lgkmcnt(5)
    v_mfma_f32_32x32x16_bf16 v[112:127], v[92:95], a[156:159], v[112:127]
    ds_read_b128 v[84:87], v5 offset:54272
    v_cvt_pk_bf16_f32 v151, v110, v111
    s_waitcnt lgkmcnt(5)
    v_mfma_f32_32x32x16_bf16 v[112:127], v[64:67], a[160:163], v[112:127]
    ds_read_b128 v[88:91], v5 offset:55296
    s_waitcnt lgkmcnt(5)
    v_mfma_f32_32x32x16_bf16 v[112:127], v[68:71], a[164:167], v[112:127]
    ds_read_b128 v[92:95], v5 offset:56320
    s_waitcnt lgkmcnt(5)
    v_mfma_f32_32x32x16_bf16 v[112:127], v[72:75], a[168:171], v[112:127]
    ds_read_b128 v[64:67], v5 offset:57344
    s_waitcnt lgkmcnt(5)
    v_mfma_f32_32x32x16_bf16 v[112:127], v[76:79], a[172:175], v[112:127]
    ds_read_b128 v[68:71], v5 offset:58368
    s_waitcnt lgkmcnt(5)
    v_mfma_f32_32x32x16_bf16 v[112:127], v[80:83], a[176:179], v[112:127]
    ds_read_b128 v[72:75], v5 offset:59392
    s_waitcnt lgkmcnt(5)
    v_mfma_f32_32x32x16_bf16 v[112:127], v[84:87], a[180:183], v[112:127]
    ds_read_b128 v[76:79], v5 offset:60416
    s_waitcnt lgkmcnt(5)
    v_mfma_f32_32x32x16_bf16 v[112:127], v[88:91], a[184:187], v[112:127]
    ds_read_b128 v[80:83], v5 offset:61440
    s_waitcnt lgkmcnt(5)
    v_mfma_f32_32x32x16_bf16 v[112:127], v[92:95], a[188:191], v[112:127]
    ds_read_b128 v[84:87], v5 offset:62464
    s_waitcnt lgkmcnt(5)
    v_mfma_f32_32x32x16_bf16 v[112:127], v[64:67], a[192:195], v[112:127]
    ds_read_b128 v[88:91], v5 offset:63488
    s_waitcnt lgkmcnt(5)
    v_mfma_f32_32x32x16_bf16 v[112:127], v[68:71], a[196:199], v[112:127]
    ds_read_b128 v[92:95], v5 offset:64512
    s_waitcnt lgkmcnt(5)
    v_mfma_f32_32x32x16_bf16 v[112:127], v[72:75], a[200:203], v[112:127]
    s_waitcnt lgkmcnt(4)
    v_mfma_f32_32x32x16_bf16 v[112:127], v[76:79], a[204:207], v[112:127]
    s_waitcnt lgkmcnt(3)
    v_mfma_f32_32x32x16_bf16 v[112:127], v[80:83], a[208:211], v[112:127]
    s_waitcnt lgkmcnt(2)
    v_mfma_f32_32x32x16_bf16 v[112:127], v[84:87], a[212:215], v[112:127]
    s_waitcnt lgkmcnt(1)
    v_mfma_f32_32x32x16_bf16 v[112:127], v[88:91], a[216:219], v[112:127]
    s_waitcnt lgkmcnt(0)
    v_mfma_f32_32x32x16_bf16 v[112:127], v[92:95], a[220:223], v[112:127]
    s_nop 11
    v_cvt_pk_bf16_f32 v152, v112, v113
    v_cvt_pk_bf16_f32 v153, v114, v115
    v_cvt_pk_bf16_f32 v154, v116, v117
    v_cvt_pk_bf16_f32 v155, v118, v119
    v_cvt_pk_bf16_f32 v156, v120, v121
    v_cvt_pk_bf16_f32 v157, v122, v123
    v_cvt_pk_bf16_f32 v158, v124, v125
    v_cvt_pk_bf16_f32 v159, v126, v127
    s_waitcnt vmcnt(0)
    v_cmp_eq_u32 vcc, 0, v30
    s_cbranch_vccnz ATT_20_h_chw
    s_mov_b32 m0, s42
    s_nop 0
    buffer_load_dwordx4 v1, s[8:11], s44 offen offset:0 sc1 lds
    buffer_load_dwordx4 v1, s[8:11], s44 offen offset:1024 sc1 lds
    buffer_load_dwordx4 v1, s[8:11], s44 offen offset:2048 sc1 lds
    buffer_load_dwordx4 v1, s[8:11], s44 offen offset:3072 sc1 lds
    v_mfma_f32_32x32x16_bf16 v[32:47], a[32:35], v[128:131], 0
    v_mfma_f32_32x32x16_bf16 v[32:47], a[36:39], v[132:135], v[32:47]
    v_mfma_f32_32x32x16_bf16 v[32:47], a[40:43], v[136:139], v[32:47]
    v_mfma_f32_32x32x16_bf16 v[32:47], a[44:47], v[140:143], v[32:47]
    v_mfma_f32_32x32x16_bf16 v[32:47], a[48:51], v[144:147], v[32:47]
    v_mfma_f32_32x32x16_bf16 v[32:47], a[52:55], v[148:151], v[32:47]
    v_mfma_f32_32x32x16_bf16 v[32:47], a[56:59], v[152:155], v[32:47]
    v_mfma_f32_32x32x16_bf16 v[32:47], a[60:63], v[156:159], v[32:47]
    s_nop 11
    v_cndmask_b32 v32, v7, v32, s[64:65]
    v_cndmask_b32 v33, v7, v33, s[66:67]
    v_cndmask_b32 v34, v7, v34, s[68:69]
    v_cndmask_b32 v35, v7, v35, s[70:71]
    v_cndmask_b32 v36, v7, v36, s[72:73]
    v_cndmask_b32 v37, v7, v37, s[74:75]
    v_cndmask_b32 v38, v7, v38, s[76:77]
    v_cndmask_b32 v39, v7, v39, s[78:79]
    v_cndmask_b32 v40, v7, v40, s[80:81]
    v_cndmask_b32 v41, v7, v41, s[82:83]
    v_cndmask_b32 v42, v7, v42, s[84:85]
    v_cndmask_b32 v43, v7, v43, s[86:87]
    v_cndmask_b32 v44, v7, v44, s[88:89]
    v_cndmask_b32 v45, v7, v45, s[90:91]
    v_cndmask_b32 v46, v7, v46, s[92:93]
    v_cndmask_b32 v47, v7, v47, s[94:95]
    v_max3_f32 v24, v32, v33, v34
    v_max3_f32 v25, v35, v36, v37
    v_max3_f32 v24, v24, v38, v39
    v_max3_f32 v25, v25, v40, v41
    v_max3_f32 v24, v24, v42, v43
    v_max3_f32 v25, v25, v44, v45
    v_max3_f32 v24, v24, v46, v47
    v_mov_b32 v194, 0
    v_mov_b32 v195, 0
    v_mov_b32 v198, 0
    v_mov_b32 v199, 0
    v_mov_b32 v202, 0
    v_mov_b32 v203, 0
    v_mov_b32 v206, 0
    v_mov_b32 v207, 0
    s_branch ATT_20_h_kmw
ATT_20_h_chw:
    v_mfma_f32_32x32x16_bf16 v[32:47], a[32:35], v[128:131], 0
    v_mfma_f32_32x32x16_bf16 v[32:47], a[36:39], v[132:135], v[32:47]
    v_mfma_f32_32x32x16_bf16 v[32:47], a[40:43], v[136:139], v[32:47]
    v_mfma_f32_32x32x16_bf16 v[32:47], a[44:47], v[140:143], v[32:47]
    v_mfma_f32_32x32x16_bf16 v[32:47], a[48:51], v[144:147], v[32:47]
    v_mfma_f32_32x32x16_bf16 v[32:47], a[52:55], v[148:151], v[32:47]
    v_mfma_f32_32x32x16_bf16 v[32:47], a[56:59], v[152:155], v[32:47]
    v_mfma_f32_32x32x16_bf16 v[32:47], a[60:63], v[156:159], v[32:47]
    s_nop 11
    v_cndmask_b32 v32, v7, v32, s[64:65]
    v_cndmask_b32 v33, v7, v33, s[66:67]
    v_cndmask_b32 v34, v7, v34, s[68:69]
    v_cndmask_b32 v35, v7, v35, s[70:71]
    v_cndmask_b32 v36, v7, v36, s[72:73]
    v_cndmask_b32 v37, v7, v37, s[74:75]
    v_cndmask_b32 v38, v7, v38, s[76:77]
    v_cndmask_b32 v39, v7, v39, s[78:79]
    v_cndmask_b32 v40, v7, v40, s[80:81]
    v_cndmask_b32 v41, v7, v41, s[82:83]
    v_cndmask_b32 v42, v7, v42, s[84:85]
    v_cndmask_b32 v43, v7, v43, s[86:87]
    v_cndmask_b32 v44, v7, v44, s[88:89]
    v_cndmask_b32 v45, v7, v45, s[90:91]
    v_cndmask_b32 v46, v7, v46, s[92:93]
    v_cndmask_b32 v47, v7, v47, s[94:95]
    v_max3_f32 v24, v32, v33, v34
    v_max3_f32 v25, v35, v36, v37
    v_max3_f32 v24, v24, v38, v39
    v_max3_f32 v25, v25, v40, v41
    v_max3_f32 v24, v24, v42, v43
    v_max3_f32 v25, v25, v44, v45
    v_max3_f32 v24, v24, v46, v47
    v_mov_b32 v194, 0
    v_mov_b32 v195, 0
    v_mov_b32 v198, 0
    v_mov_b32 v199, 0
    v_mov_b32 v202, 0
    v_mov_b32 v203, 0
    v_mov_b32 v206, 0
    v_mov_b32 v207, 0
    s_mov_b32 s96, 0
    v_mbcnt_lo_u32_b32 v250, -1, 0
    v_mbcnt_hi_u32_b32 v250, -1, v250
    v_min_u32 v250, 3, v250
    v_lshlrev_b32 v250, 2, v250
ATT_20_hwc_31_spin:
    buffer_load_dword v251, v250, s[8:11], s45 offen sc1
    s_waitcnt vmcnt(0)
    v_cmp_eq_u32 vcc, 0, v251
    s_cbranch_vccz ATT_20_hwc_31_ok
    s_add_u32 s96, s96, 1
    s_cmp_gt_u32 s96, 300000
    s_cbranch_scc1 L_fail
    s_branch ATT_20_hwc_31_spin
ATT_20_hwc_31_ok:
    s_mov_b32 m0, s42
    s_nop 0
    buffer_load_dwordx4 v1, s[8:11], s44 offen offset:0 sc1 lds
    buffer_load_dwordx4 v1, s[8:11], s44 offen offset:1024 sc1 lds
    buffer_load_dwordx4 v1, s[8:11], s44 offen offset:2048 sc1 lds
    buffer_load_dwordx4 v1, s[8:11], s44 offen offset:3072 sc1 lds
ATT_20_h_kmw:
    s_waitcnt vmcnt(0)
    ds_read_b128 v[160:163], v2 offset:0
    ds_read_b128 v[164:167], v2 offset:256
    ds_read_b128 v[168:171], v2 offset:512
    ds_read_b128 v[172:175], v2 offset:768
    ds_read_b128 v[176:179], v2 offset:1024
    ds_read_b128 v[180:183], v2 offset:1280
    ds_read_b128 v[184:187], v2 offset:1536
    ds_read_b128 v[188:191], v2 offset:1792
    ds_read_b64 v[192:193], v3 offset:2048
    ds_read_b64 v[196:197], v3 offset:2560
    ds_read_b64 v[200:201], v3 offset:3072
    ds_read_b64 v[204:205], v3 offset:3584
    s_waitcnt lgkmcnt(11)
    v_mfma_f32_32x32x16_bf16 v[48:63], v[160:163], v[128:131], 0
    s_waitcnt lgkmcnt(10)
    v_mfma_f32_32x32x16_bf16 v[48:63], v[164:167], v[132:135], v[48:63]
    s_waitcnt lgkmcnt(9)
    v_mfma_f32_32x32x16_bf16 v[48:63], v[168:171], v[136:139], v[48:63]
    s_waitcnt lgkmcnt(8)
    v_mfma_f32_32x32x16_bf16 v[48:63], v[172:175], v[140:143], v[48:63]
    s_waitcnt lgkmcnt(7)
    v_mfma_f32_32x32x16_bf16 v[48:63], v[176:179], v[144:147], v[48:63]
    s_waitcnt lgkmcnt(6)
    v_mfma_f32_32x32x16_bf16 v[48:63], v[180:183], v[148:151], v[48:63]
    s_waitcnt lgkmcnt(5)
    v_mfma_f32_32x32x16_bf16 v[48:63], v[184:187], v[152:155], v[48:63]
    s_waitcnt lgkmcnt(4)
    v_mfma_f32_32x32x16_bf16 v[48:63], v[188:191], v[156:159], v[48:63]
    s_nop 11
    v_max3_f32 v25, v25, v48, v49
    v_max3_f32 v24, v24, v50, v51
    v_max_f32 v24, v24, v25
    v_mov_b32 v25, v24
    s_nop 1
    v_permlane32_swap_b32 v24, v25
    v_max_f32 v24, v24, v25
    v_mul_f32 v24, s48, v24
    v_fma_f32 v32, v32, s48, -v24
    v_fma_f32 v33, v33, s48, -v24
    v_fma_f32 v34, v34, s48, -v24
    v_fma_f32 v35, v35, s48, -v24
    v_fma_f32 v36, v36, s48, -v24
    v_fma_f32 v37, v37, s48, -v24
    v_fma_f32 v38, v38, s48, -v24
    v_fma_f32 v39, v39, s48, -v24
    v_fma_f32 v40, v40, s48, -v24
    v_fma_f32 v41, v41, s48, -v24
    v_fma_f32 v42, v42, s48, -v24
    v_fma_f32 v43, v43, s48, -v24
    v_fma_f32 v44, v44, s48, -v24
    v_fma_f32 v45, v45, s48, -v24
    v_fma_f32 v46, v46, s48, -v24
    v_fma_f32 v47, v47, s48, -v24
    v_fma_f32 v48, v48, s48, -v24
    v_fma_f32 v49, v49, s48, -v24
    v_fma_f32 v50, v50, s48, -v24
    v_fma_f32 v51, v51, s48, -v24
    v_exp_f32 v32, v32
    v_exp_f32 v33, v33
    v_exp_f32 v34, v34
    v_exp_f32 v35, v35
    v_exp_f32 v36, v36
    v_exp_f32 v37, v37
    v_exp_f32 v38, v38
    v_exp_f32 v39, v39
    v_exp_f32 v40, v40
    v_exp_f32 v41, v41
    v_exp_f32 v42, v42
    v_exp_f32 v43, v43
    v_exp_f32 v44, v44
    v_exp_f32 v45, v45
    v_exp_f32 v46, v46
    v_exp_f32 v47, v47
    v_exp_f32 v48, v48
    v_exp_f32 v49, v49
    v_exp_f32 v50, v50
    v_exp_f32 v51, v51
    v_add_f32 v24, v32, v33
    v_add_f32 v25, v34, v35
    v_add_f32 v24, v24, v36
    v_add_f32 v25, v25, v37
    v_add_f32 v24, v24, v38
    v_add_f32 v25, v25, v39
    v_add_f32 v24, v24, v40
    v_add_f32 v25, v25, v41
    v_add_f32 v24, v24, v42
    v_add_f32 v25, v25, v43
    v_add_f32 v24, v24, v44
    v_add_f32 v25, v25, v45
    v_add_f32 v24, v24, v46
    v_add_f32 v25, v25, v47
    v_add_f32 v24, v24, v48
    v_add_f32 v25, v25, v49
    v_add_f32 v24, v24, v50
    v_add_f32 v25, v25, v51
    v_add_f32 v24, v24, v25
    v_mov_b32 v25, v24
    s_nop 1
    v_permlane32_swap_b32 v24, v25
    v_add_f32 v24, v24, v25
    v_rcp_f32 v24, v24
    s_nop 0
    v_mul_f32 v32, v32, v24
    v_mul_f32 v33, v33, v24
    v_mul_f32 v34, v34, v24
    v_mul_f32 v35, v35, v24
    v_mul_f32 v36, v36, v24
    v_mul_f32 v37, v37, v24
    v_mul_f32 v38, v38, v24
    v_mul_f32 v39, v39, v24
    v_mul_f32 v40, v40, v24
    v_mul_f32 v41, v41, v24
    v_mul_f32 v42, v42, v24
    v_mul_f32 v43, v43, v24
    v_mul_f32 v44, v44, v24
    v_mul_f32 v45, v45, v24
    v_mul_f32 v46, v46, v24
    v_mul_f32 v47, v47, v24
    v_mul_f32 v48, v48, v24
    v_mul_f32 v49, v49, v24
    v_mul_f32 v50, v50, v24
    v_mul_f32 v51, v51, v24
    v_cvt_pk_bf16_f32 v16, v32, v33
    v_cvt_pk_bf16_f32 v17, v34, v35
    v_cvt_pk_bf16_f32 v18, v36, v37
    v_cvt_pk_bf16_f32 v19, v38, v39
    v_cvt_pk_bf16_f32 v20, v40, v41
    v_cvt_pk_bf16_f32 v21, v42, v43
    v_cvt_pk_bf16_f32 v22, v44, v45
    v_cvt_pk_bf16_f32 v23, v46, v47
    v_cvt_pk_bf16_f32 v8, v48, v49
    v_cvt_pk_bf16_f32 v9, v50, v51
    v_mov_b32 v10, 0
    v_mov_b32 v11, 0
    s_waitcnt lgkmcnt(0)
    v_mfma_f32_32x32x16_bf16 v[64:79], a[64:67], v[16:19], 0
    v_mfma_f32_32x32x16_bf16 v[64:79], a[68:71], v[20:23], v[64:79]
    v_mfma_f32_32x32x16_bf16 v[64:79], v[192:195], v[8:11], v[64:79]
    v_mfma_f32_32x32x16_bf16 v[80:95], a[72:75], v[16:19], 0
    v_mfma_f32_32x32x16_bf16 v[80:95], a[76:79], v[20:23], v[80:95]
    v_mfma_f32_32x32x16_bf16 v[80:95], v[196:199], v[8:11], v[80:95]
    v_mfma_f32_32x32x16_bf16 v[96:111], a[80:83], v[16:19], 0
    v_mfma_f32_32x32x16_bf16 v[96:111], a[84:87], v[20:23], v[96:111]
    v_mfma_f32_32x32x16_bf16 v[96:111], v[200:203], v[8:11], v[96:111]
    s_nop 5
    v_cvt_pk_bf16_f32 v208, v64, v65
    v_cvt_pk_bf16_f32 v209, v66, v67
    v_cvt_pk_bf16_f32 v210, v68, v69
    v_cvt_pk_bf16_f32 v211, v70, v71
    v_cvt_pk_bf16_f32 v212, v72, v73
    v_cvt_pk_bf16_f32 v213, v74, v75
    v_cvt_pk_bf16_f32 v214, v76, v77
    v_cvt_pk_bf16_f32 v215, v78, v79
    v_mfma_f32_32x32x16_bf16 v[112:127], a[88:91], v[16:19], 0
    v_mfma_f32_32x32x16_bf16 v[112:127], a[92:95], v[20:23], v[112:127]
    v_mfma_f32_32x32x16_bf16 v[112:127], v[204:207], v[8:11], v[112:127]
    v_cvt_pk_bf16_f32 v216, v80, v81
    v_cvt_pk_bf16_f32 v217, v82, v83
    v_cvt_pk_bf16_f32 v218, v84, v85
    v_cvt_pk_bf16_f32 v219, v86, v87
    v_cvt_pk_bf16_f32 v220, v88, v89
    v_cvt_pk_bf16_f32 v221, v90, v91
    v_cvt_pk_bf16_f32 v222, v92, v93
    v_cvt_pk_bf16_f32 v223, v94, v95
    v_cvt_pk_bf16_f32 v224, v96, v97
    v_cvt_pk_bf16_f32 v225, v98, v99
    v_cvt_pk_bf16_f32 v226, v100, v101
    v_cvt_pk_bf16_f32 v227, v102, v103
    v_cvt_pk_bf16_f32 v228, v104, v105
    v_cvt_pk_bf16_f32 v229, v106, v107
    v_cvt_pk_bf16_f32 v230, v108, v109
    v_cvt_pk_bf16_f32 v231, v110, v111
    v_cvt_pk_bf16_f32 v232, v112, v113
    v_cvt_pk_bf16_f32 v233, v114, v115
    v_cvt_pk_bf16_f32 v234, v116, v117
    v_cvt_pk_bf16_f32 v235, v118, v119
    v_cvt_pk_bf16_f32 v236, v120, v121
    v_cvt_pk_bf16_f32 v237, v122, v123
    v_cvt_pk_bf16_f32 v238, v124, v125
    v_cvt_pk_bf16_f32 v239, v126, v127
    buffer_store_dwordx4 v[208:211], v1, s[8:11], s47 offen offset:0 sc1
    buffer_store_dwordx4 v[212:215], v1, s[8:11], s47 offen offset:1024 sc1
    buffer_store_dwordx4 v[216:219], v1, s[8:11], s47 offen offset:2048 sc1
    buffer_store_dwordx4 v[220:223], v1, s[8:11], s47 offen offset:3072 sc1
    s_add_u32 s32, s47, 4096
    buffer_store_dwordx4 v[224:227], v1, s[8:11], s32 offen offset:0 sc1
    buffer_store_dwordx4 v[228:231], v1, s[8:11], s32 offen offset:1024 sc1
    buffer_store_dwordx4 v[232:235], v1, s[8:11], s32 offen offset:2048 sc1
    buffer_store_dwordx4 v[236:239], v1, s[8:11], s32 offen offset:3072 sc1
    s_add_u32 s43, s43, 1572864
    s_add_u32 s44, s44, 262144
    s_add_u32 s45, s45, 1024
    s_add_u32 s49, s49, 2048
    s_add_u32 s47, s47, 524288
    s_add_u32 s41, s41, 2
    s_waitcnt vmcnt(0)
    v_mov_b32 v11, 1
    v_mov_b32 v10, 0
    s_mov_b64 exec, 1
    buffer_store_dword v11, v10, s[8:11], s46 offen sc1
    s_mov_b64 exec, -1
    s_add_u32 s46, s46, 256
    s_mov_b32 s52, 0
    s_cmp_ge_u32 s41, 64
    s_cbranch_scc1 ATT_20_done
ATT_20_L:
    s_mov_b32 s96, 0
    v_mbcnt_lo_u32_b32 v250, -1, 0
    v_mbcnt_hi_u32_b32 v250, -1, v250
    v_min_u32 v250, 7, v250
    v_lshlrev_b32 v250, 2, v250
ATT_20wq_32_spin:
    buffer_load_dword v251, v250, s[8:11], s49 offen sc1
    s_waitcnt vmcnt(0)
    v_cmp_eq_u32 vcc, 0, v251
    s_cbranch_vccz ATT_20wq_32_ok
    s_add_u32 s96, s96, 1
    s_cmp_gt_u32 s96, 300000
    s_cbranch_scc1 L_fail
    s_sleep 1
    s_branch ATT_20wq_32_spin
ATT_20wq_32_ok:
    s_add_u32 s32, s43, 0
    buffer_load_dwordx4 v[128:131], v1, s[8:11], s32 offen offset:0 sc1
    buffer_load_dwordx4 v[132:135], v1, s[8:11], s32 offen offset:1024 sc1
    buffer_load_dwordx4 v[136:139], v1, s[8:11], s32 offen offset:2048 sc1
    buffer_load_dwordx4 v[140:143], v1, s[8:11], s32 offen offset:3072 sc1
    s_add_u32 s32, s43, 4096
    buffer_load_dwordx4 v[144:147], v1, s[8:11], s32 offen offset:0 sc1
    buffer_load_dwordx4 v[148:151], v1, s[8:11], s32 offen offset:1024 sc1
    buffer_load_dwordx4 v[152:155], v1, s[8:11], s32 offen offset:2048 sc1
    buffer_load_dwordx4 v[156:159], v1, s[8:11], s32 offen offset:3072 sc1
    s_add_u32 s32, s43, 8192
    buffer_load_dwordx4 a[32:35], v1, s[8:11], s32 offen offset:0 sc1
    buffer_load_dwordx4 a[36:39], v1, s[8:11], s32 offen offset:1024 sc1
    buffer_load_dwordx4 a[40:43], v1, s[8:11], s32 offen offset:2048 sc1
    buffer_load_dwordx4 a[44:47], v1, s[8:11], s32 offen offset:3072 sc1
    s_add_u32 s32, s43, 12288
    buffer_load_dwordx4 a[48:51], v1, s[8:11], s32 offen offset:0 sc1
    buffer_load_dwordx4 a[52:55], v1, s[8:11], s32 offen offset:1024 sc1
    buffer_load_dwordx4 a[56:59], v1, s[8:11], s32 offen offset:2048 sc1
    buffer_load_dwordx4 a[60:63], v1, s[8:11], s32 offen offset:3072 sc1
    s_add_u32 s32, s43, 16384
    buffer_load_dwordx4 a[64:67], v1, s[8:11], s32 offen offset:0 sc1
    buffer_load_dwordx4 a[68:71], v1, s[8:11], s32 offen offset:1024 sc1
    buffer_load_dwordx4 a[72:75], v1, s[8:11], s32 offen offset:2048 sc1
    buffer_load_dwordx4 a[76:79], v1, s[8:11], s32 offen offset:3072 sc1
    s_add_u32 s32, s43, 20480
    buffer_load_dwordx4 a[80:83], v1, s[8:11], s32 offen offset:0 sc1
    buffer_load_dwordx4 a[84:87], v1, s[8:11], s32 offen offset:1024 sc1
    buffer_load_dwordx4 a[88:91], v1, s[8:11], s32 offen offset:2048 sc1
    buffer_load_dwordx4 a[92:95], v1, s[8:11], s32 offen offset:3072 sc1
    v_mbcnt_lo_u32_b32 v11, -1, 0
    v_mbcnt_hi_u32_b32 v11, -1, v11
    v_min_u32 v11, 15, v11
    v_lshlrev_b32 v11, 2, v11
    buffer_load_dword v31, v11, s[8:11], s51 offen sc1
    v_mbcnt_lo_u32_b32 v10, -1, 0
    v_mbcnt_hi_u32_b32 v10, -1, v10
    v_min_u32 v10, 3, v10
    v_lshlrev_b32 v10, 2, v10
    buffer_load_dword v30, v10, s[8:11], s45 offen sc1
    s_waitcnt vmcnt(0)
    s_mov_b32 s53, 0
    s_cmp_ge_u32 s41, 62
    s_cbranch_scc1 ATT_20_np
    v_cmp_eq_u32 vcc, 0, v31
    s_cbranch_vccnz ATT_20_np
    s_mov_b32 s53, 1
ATT_20_np:
    s_waitcnt vmcnt(0)
    v_cmp_eq_u32 vcc, 0, v30
    s_cbranch_vccnz ATT_20_l_chw
    s_mov_b32 m0, s42
    s_nop 0
    buffer_load_dwordx4 v1, s[8:11], s44 offen offset:0 sc1 lds
    buffer_load_dwordx4 v1, s[8:11], s44 offen offset:1024 sc1 lds
    buffer_load_dwordx4 v1, s[8:11], s44 offen offset:2048 sc1 lds
    buffer_load_dwordx4 v1, s[8:11], s44 offen offset:3072 sc1 lds
    v_mfma_f32_32x32x16_bf16 v[32:47], a[32:35], v[128:131], 0
    v_mfma_f32_32x32x16_bf16 v[32:47], a[36:39], v[132:135], v[32:47]
    v_mfma_f32_32x32x16_bf16 v[32:47], a[40:43], v[136:139], v[32:47]
    v_mfma_f32_32x32x16_bf16 v[32:47], a[44:47], v[140:143], v[32:47]
    v_mfma_f32_32x32x16_bf16 v[32:47], a[48:51], v[144:147], v[32:47]
    v_mfma_f32_32x32x16_bf16 v[32:47], a[52:55], v[148:151], v[32:47]
    v_mfma_f32_32x32x16_bf16 v[32:47], a[56:59], v[152:155], v[32:47]
    v_mfma_f32_32x32x16_bf16 v[32:47], a[60:63], v[156:159], v[32:47]
    s_nop 11
    v_cndmask_b32 v32, v7, v32, s[64:65]
    v_cndmask_b32 v33, v7, v33, s[66:67]
    v_cndmask_b32 v34, v7, v34, s[68:69]
    v_cndmask_b32 v35, v7, v35, s[70:71]
    v_cndmask_b32 v36, v7, v36, s[72:73]
    v_cndmask_b32 v37, v7, v37, s[74:75]
    v_cndmask_b32 v38, v7, v38, s[76:77]
    v_cndmask_b32 v39, v7, v39, s[78:79]
    v_cndmask_b32 v40, v7, v40, s[80:81]
    v_cndmask_b32 v41, v7, v41, s[82:83]
    v_cndmask_b32 v42, v7, v42, s[84:85]
    v_cndmask_b32 v43, v7, v43, s[86:87]
    v_cndmask_b32 v44, v7, v44, s[88:89]
    v_cndmask_b32 v45, v7, v45, s[90:91]
    v_cndmask_b32 v46, v7, v46, s[92:93]
    v_cndmask_b32 v47, v7, v47, s[94:95]
    v_max3_f32 v24, v32, v33, v34
    v_max3_f32 v25, v35, v36, v37
    v_max3_f32 v24, v24, v38, v39
    v_max3_f32 v25, v25, v40, v41
    v_max3_f32 v24, v24, v42, v43
    v_max3_f32 v25, v25, v44, v45
    v_max3_f32 v24, v24, v46, v47
    v_mov_b32 v194, 0
    v_mov_b32 v195, 0
    v_mov_b32 v198, 0
    v_mov_b32 v199, 0
    v_mov_b32 v202, 0
    v_mov_b32 v203, 0
    v_mov_b32 v206, 0
    v_mov_b32 v207, 0
    s_branch ATT_20_l_kmw
ATT_20_l_chw:
    v_mfma_f32_32x32x16_bf16 v[32:47], a[32:35], v[128:131], 0
    v_mfma_f32_32x32x16_bf16 v[32:47], a[36:39], v[132:135], v[32:47]
    v_mfma_f32_32x32x16_bf16 v[32:47], a[40:43], v[136:139], v[32:47]
    v_mfma_f32_32x32x16_bf16 v[32:47], a[44:47], v[140:143], v[32:47]
    v_mfma_f32_32x32x16_bf16 v[32:47], a[48:51], v[144:147], v[32:47]
    v_mfma_f32_32x32x16_bf16 v[32:47], a[52:55], v[148:151], v[32:47]
    v_mfma_f32_32x32x16_bf16 v[32:47], a[56:59], v[152:155], v[32:47]
    v_mfma_f32_32x32x16_bf16 v[32:47], a[60:63], v[156:159], v[32:47]
    s_nop 11
    v_cndmask_b32 v32, v7, v32, s[64:65]
    v_cndmask_b32 v33, v7, v33, s[66:67]
    v_cndmask_b32 v34, v7, v34, s[68:69]
    v_cndmask_b32 v35, v7, v35, s[70:71]
    v_cndmask_b32 v36, v7, v36, s[72:73]
    v_cndmask_b32 v37, v7, v37, s[74:75]
    v_cndmask_b32 v38, v7, v38, s[76:77]
    v_cndmask_b32 v39, v7, v39, s[78:79]
    v_cndmask_b32 v40, v7, v40, s[80:81]
    v_cndmask_b32 v41, v7, v41, s[82:83]
    v_cndmask_b32 v42, v7, v42, s[84:85]
    v_cndmask_b32 v43, v7, v43, s[86:87]
    v_cndmask_b32 v44, v7, v44, s[88:89]
    v_cndmask_b32 v45, v7, v45, s[90:91]
    v_cndmask_b32 v46, v7, v46, s[92:93]
    v_cndmask_b32 v47, v7, v47, s[94:95]
    v_max3_f32 v24, v32, v33, v34
    v_max3_f32 v25, v35, v36, v37
    v_max3_f32 v24, v24, v38, v39
    v_max3_f32 v25, v25, v40, v41
    v_max3_f32 v24, v24, v42, v43
    v_max3_f32 v25, v25, v44, v45
    v_max3_f32 v24, v24, v46, v47
    v_mov_b32 v194, 0
    v_mov_b32 v195, 0
    v_mov_b32 v198, 0
    v_mov_b32 v199, 0
    v_mov_b32 v202, 0
    v_mov_b32 v203, 0
    v_mov_b32 v206, 0
    v_mov_b32 v207, 0
    s_cmp_eq_u32 s53, 0
    s_cbranch_scc1 ATT_20_l_b1
    s_add_u32 s32, s50, 0
    buffer_load_dwordx4 a[96:99], v1, s[8:11], s32 offen offset:0 sc1
    buffer_load_dwordx4 a[100:103], v1, s[8:11], s32 offen offset:1024 sc1
    buffer_load_dwordx4 a[104:107], v1, s[8:11], s32 offen offset:2048 sc1
    buffer_load_dwordx4 a[108:111], v1, s[8:11], s32 offen offset:3072 sc1
    s_add_u32 s32, s50, 4096
    buffer_load_dwordx4 a[112:115], v1, s[8:11], s32 offen offset:0 sc1
    buffer_load_dwordx4 a[116:119], v1, s[8:11], s32 offen offset:1024 sc1
    buffer_load_dwordx4 a[120:123], v1, s[8:11], s32 offen offset:2048 sc1
    buffer_load_dwordx4 a[124:127], v1, s[8:11], s32 offen offset:3072 sc1
    s_add_u32 s32, s50, 8192
    buffer_load_dwordx4 a[128:131], v1, s[8:11], s32 offen offset:0 sc1
    buffer_load_dwordx4 a[132:135], v1, s[8:11], s32 offen offset:1024 sc1
    buffer_load_dwordx4 a[136:139], v1, s[8:11], s32 offen offset:2048 sc1
    buffer_load_dwordx4 a[140:143], v1, s[8:11], s32 offen offset:3072 sc1
    s_add_u32 s32, s50, 12288
    buffer_load_dwordx4 a[144:147], v1, s[8:11], s32 offen offset:0 sc1
    buffer_load_dwordx4 a[148:151], v1, s[8:11], s32 offen offset:1024 sc1
    buffer_load_dwordx4 a[152:155], v1, s[8:11], s32 offen offset:2048 sc1
    buffer_load_dwordx4 a[156:159], v1, s[8:11], s32 offen offset:3072 sc1
    s_add_u32 s32, s50, 16384
    buffer_load_dwordx4 a[160:163], v1, s[8:11], s32 offen offset:0 sc1
    buffer_load_dwordx4 a[164:167], v1, s[8:11], s32 offen offset:1024 sc1
    buffer_load_dwordx4 a[168:171], v1, s[8:11], s32 offen offset:2048 sc1
    buffer_load_dwordx4 a[172:175], v1, s[8:11], s32 offen offset:3072 sc1
    s_add_u32 s32, s50, 20480
    buffer_load_dwordx4 a[176:179], v1, s[8:11], s32 offen offset:0 sc1
    buffer_load_dwordx4 a[180:183], v1, s[8:11], s32 offen offset:1024 sc1
    buffer_load_dwordx4 a[184:187], v1, s[8:11], s32 offen offset:2048 sc1
    buffer_load_dwordx4 a[188:191], v1, s[8:11], s32 offen offset:3072 sc1
    s_add_u32 s32, s50, 24576
    buffer_load_dwordx4 a[192:195], v1, s[8:11], s32 offen offset:0 sc1
    buffer_load_dwordx4 a[196:199], v1, s[8:11], s32 offen offset:1024 sc1
    buffer_load_dwordx4 a[200:203], v1, s[8:11], s32 offen offset:2048 sc1
    buffer_load_dwordx4 a[204:207], v1, s[8:11], s32 offen offset:3072 sc1
    s_add_u32 s32, s50, 28672
    buffer_load_dwordx4 a[208:211], v1, s[8:11], s32 offen offset:0 sc1
    buffer_load_dwordx4 a[212:215], v1, s[8:11], s32 offen offset:1024 sc1
    buffer_load_dwordx4 a[216:219], v1, s[8:11], s32 offen offset:2048 sc1
    buffer_load_dwordx4 a[220:223], v1, s[8:11], s32 offen offset:3072 sc1
    s_add_u32 s50, s50, 131072
    s_add_u32 s51, s51, 512
    s_mov_b32 s53, 2
ATT_20_l_b1:
    s_mov_b32 s96, 0
    v_mbcnt_lo_u32_b32 v250, -1, 0
    v_mbcnt_hi_u32_b32 v250, -1, v250
    v_min_u32 v250, 3, v250
    v_lshlrev_b32 v250, 2, v250
ATT_20_lwc_33_spin:
    buffer_load_dword v251, v250, s[8:11], s45 offen sc1
    s_waitcnt vmcnt(0)
    v_cmp_eq_u32 vcc, 0, v251
    s_cbranch_vccz ATT_20_lwc_33_ok
    s_add_u32 s96, s96, 1
    s_cmp_gt_u32 s96, 300000
    s_cbranch_scc1 L_fail
    s_branch ATT_20_lwc_33_spin
ATT_20_lwc_33_ok:
    s_mov_b32 m0, s42
    s_nop 0
    buffer_load_dwordx4 v1, s[8:11], s44 offen offset:0 sc1 lds
    buffer_load_dwordx4 v1, s[8:11], s44 offen offset:1024 sc1 lds
    buffer_load_dwordx4 v1, s[8:11], s44 offen offset:2048 sc1 lds
    buffer_load_dwordx4 v1, s[8:11], s44 offen offset:3072 sc1 lds
ATT_20_l_kmw:
    s_waitcnt vmcnt(0)
    ds_read_b128 v[160:163], v2 offset:0
    ds_read_b128 v[164:167], v2 offset:256
    ds_read_b128 v[168:171], v2 offset:512
    ds_read_b128 v[172:175], v2 offset:768
    ds_read_b128 v[176:179], v2 offset:1024
    ds_read_b128 v[180:183], v2 offset:1280
    ds_read_b128 v[184:187], v2 offset:1536
    ds_read_b128 v[188:191], v2 offset:1792
    ds_read_b64 v[192:193], v3 offset:2048
    ds_read_b64 v[196:197], v3 offset:2560
    ds_read_b64 v[200:201], v3 offset:3072
    ds_read_b64 v[204:205], v3 offset:3584
    s_waitcnt lgkmcnt(11)
    v_mfma_f32_32x32x16_bf16 v[48:63], v[160:163], v[128:131], 0
    s_waitcnt lgkmcnt(10)
    v_mfma_f32_32x32x16_bf16 v[48:63], v[164:167], v[132:135], v[48:63]
    s_waitcnt lgkmcnt(9)
    v_mfma_f32_32x32x16_bf16 v[48:63], v[168:171], v[136:139], v[48:63]
    s_waitcnt lgkmcnt(8)
    v_mfma_f32_32x32x16_bf16 v[48:63], v[172:175], v[140:143], v[48:63]
    s_waitcnt lgkmcnt(7)
    v_mfma_f32_32x32x16_bf16 v[48:63], v[176:179], v[144:147], v[48:63]
    s_waitcnt lgkmcnt(6)
    v_mfma_f32_32x32x16_bf16 v[48:63], v[180:183], v[148:151], v[48:63]
    s_waitcnt lgkmcnt(5)
    v_mfma_f32_32x32x16_bf16 v[48:63], v[184:187], v[152:155], v[48:63]
    s_waitcnt lgkmcnt(4)
    v_mfma_f32_32x32x16_bf16 v[48:63], v[188:191], v[156:159], v[48:63]
    s_nop 11
    v_max3_f32 v25, v25, v48, v49
    v_max3_f32 v24, v24, v50, v51
    v_max_f32 v24, v24, v25
    v_mov_b32 v25, v24
    s_nop 1
    v_permlane32_swap_b32 v24, v25
    v_max_f32 v24, v24, v25
    v_mul_f32 v24, s48, v24
    v_fma_f32 v32, v32, s48, -v24
    v_fma_f32 v33, v33, s48, -v24
    v_fma_f32 v34, v34, s48, -v24
    v_fma_f32 v35, v35, s48, -v24
    v_fma_f32 v36, v36, s48, -v24
    v_fma_f32 v37, v37, s48, -v24
    v_fma_f32 v38, v38, s48, -v24
    v_fma_f32 v39, v39, s48, -v24
    v_fma_f32 v40, v40, s48, -v24
    v_fma_f32 v41, v41, s48, -v24
    v_fma_f32 v42, v42, s48, -v24
    v_fma_f32 v43, v43, s48, -v24
    v_fma_f32 v44, v44, s48, -v24
    v_fma_f32 v45, v45, s48, -v24
    v_fma_f32 v46, v46, s48, -v24
    v_fma_f32 v47, v47, s48, -v24
    v_fma_f32 v48, v48, s48, -v24
    v_fma_f32 v49, v49, s48, -v24
    v_fma_f32 v50, v50, s48, -v24
    v_fma_f32 v51, v51, s48, -v24
    v_exp_f32 v32, v32
    v_exp_f32 v33, v33
    v_exp_f32 v34, v34
    v_exp_f32 v35, v35
    v_exp_f32 v36, v36
    v_exp_f32 v37, v37
    v_exp_f32 v38, v38
    v_exp_f32 v39, v39
    v_exp_f32 v40, v40
    v_exp_f32 v41, v41
    v_exp_f32 v42, v42
    v_exp_f32 v43, v43
    v_exp_f32 v44, v44
    v_exp_f32 v45, v45
    v_exp_f32 v46, v46
    v_exp_f32 v47, v47
    v_exp_f32 v48, v48
    v_exp_f32 v49, v49
    v_exp_f32 v50, v50
    v_exp_f32 v51, v51
    v_add_f32 v24, v32, v33
    v_add_f32 v25, v34, v35
    v_add_f32 v24, v24, v36
    v_add_f32 v25, v25, v37
    v_add_f32 v24, v24, v38
    v_add_f32 v25, v25, v39
    v_add_f32 v24, v24, v40
    v_add_f32 v25, v25, v41
    v_add_f32 v24, v24, v42
    v_add_f32 v25, v25, v43
    v_add_f32 v24, v24, v44
    v_add_f32 v25, v25, v45
    v_add_f32 v24, v24, v46
    v_add_f32 v25, v25, v47
    v_add_f32 v24, v24, v48
    v_add_f32 v25, v25, v49
    v_add_f32 v24, v24, v50
    v_add_f32 v25, v25, v51
    v_add_f32 v24, v24, v25
    v_mov_b32 v25, v24
    s_nop 1
    v_permlane32_swap_b32 v24, v25
    v_add_f32 v24, v24, v25
    v_rcp_f32 v24, v24
    s_nop 0
    v_mul_f32 v32, v32, v24
    v_mul_f32 v33, v33, v24
    v_mul_f32 v34, v34, v24
    v_mul_f32 v35, v35, v24
    v_mul_f32 v36, v36, v24
    v_mul_f32 v37, v37, v24
    v_mul_f32 v38, v38, v24
    v_mul_f32 v39, v39, v24
    v_mul_f32 v40, v40, v24
    v_mul_f32 v41, v41, v24
    v_mul_f32 v42, v42, v24
    v_mul_f32 v43, v43, v24
    v_mul_f32 v44, v44, v24
    v_mul_f32 v45, v45, v24
    v_mul_f32 v46, v46, v24
    v_mul_f32 v47, v47, v24
    v_mul_f32 v48, v48, v24
    v_mul_f32 v49, v49, v24
    v_mul_f32 v50, v50, v24
    v_mul_f32 v51, v51, v24
    v_cvt_pk_bf16_f32 v16, v32, v33
    v_cvt_pk_bf16_f32 v17, v34, v35
    v_cvt_pk_bf16_f32 v18, v36, v37
    v_cvt_pk_bf16_f32 v19, v38, v39
    v_cvt_pk_bf16_f32 v20, v40, v41
    v_cvt_pk_bf16_f32 v21, v42, v43
    v_cvt_pk_bf16_f32 v22, v44, v45
    v_cvt_pk_bf16_f32 v23, v46, v47
    v_cvt_pk_bf16_f32 v8, v48, v49
    v_cvt_pk_bf16_f32 v9, v50, v51
    v_mov_b32 v10, 0
    v_mov_b32 v11, 0
    s_waitcnt lgkmcnt(0)
    s_cmp_eq_u32 s53, 1
    v_mfma_f32_32x32x16_bf16 v[64:79], a[64:67], v[16:19], 0
    s_cbranch_scc0 ATT_20m_34
    s_add_u32 s32, s50, 0
    buffer_load_dwordx4 a[96:99], v1, s[8:11], s32 offen offset:0 sc1
    s_cmp_eq_u32 s53, 1
ATT_20m_34:
    v_mfma_f32_32x32x16_bf16 v[64:79], a[68:71], v[20:23], v[64:79]
    s_cbranch_scc0 ATT_20m_35
    buffer_load_dwordx4 a[100:103], v1, s[8:11], s32 offen offset:1024 sc1
ATT_20m_35:
    v_mfma_f32_32x32x16_bf16 v[64:79], v[192:195], v[8:11], v[64:79]
    s_cbranch_scc0 ATT_20m_36
    buffer_load_dwordx4 a[104:107], v1, s[8:11], s32 offen offset:2048 sc1
ATT_20m_36:
    v_mfma_f32_32x32x16_bf16 v[80:95], a[72:75], v[16:19], 0
    s_cbranch_scc0 ATT_20m_37
    buffer_load_dwordx4 a[108:111], v1, s[8:11], s32 offen offset:3072 sc1
ATT_20m_37:
    v_mfma_f32_32x32x16_bf16 v[80:95], a[76:79], v[20:23], v[80:95]
    s_cbranch_scc0 ATT_20m_38
    s_add_u32 s32, s50, 4096
    buffer_load_dwordx4 a[112:115], v1, s[8:11], s32 offen offset:0 sc1
    s_cmp_eq_u32 s53, 1
ATT_20m_38:
    v_mfma_f32_32x32x16_bf16 v[80:95], v[196:199], v[8:11], v[80:95]
    s_cbranch_scc0 ATT_20m_39
    buffer_load_dwordx4 a[116:119], v1, s[8:11], s32 offen offset:1024 sc1
ATT_20m_39:
    v_mfma_f32_32x32x16_bf16 v[96:111], a[80:83], v[16:19], 0
    s_cbranch_scc0 ATT_20m_40
    buffer_load_dwordx4 a[120:123], v1, s[8:11], s32 offen offset:2048 sc1
ATT_20m_40:
    v_mfma_f32_32x32x16_bf16 v[96:111], a[84:87], v[20:23], v[96:111]
    s_cbranch_scc0 ATT_20m_41
    buffer_load_dwordx4 a[124:127], v1, s[8:11], s32 offen offset:3072 sc1
ATT_20m_41:
    v_mfma_f32_32x32x16_bf16 v[96:111], v[200:203], v[8:11], v[96:111]
    s_cbranch_scc0 ATT_20m_42
    s_add_u32 s32, s50, 8192
    buffer_load_dwordx4 a[128:131], v1, s[8:11], s32 offen offset:0 sc1
    s_cmp_eq_u32 s53, 1
ATT_20m_42:
    v_cvt_pk_bf16_f32 v208, v64, v65
    v_cvt_pk_bf16_f32 v209, v66, v67
    s_cbranch_scc0 ATT_20m_43
    buffer_load_dwordx4 a[132:135], v1, s[8:11], s32 offen offset:1024 sc1
ATT_20m_43:
    v_cvt_pk_bf16_f32 v210, v68, v69
    v_cvt_pk_bf16_f32 v211, v70, v71
    s_cbranch_scc0 ATT_20m_44
    buffer_load_dwordx4 a[136:139], v1, s[8:11], s32 offen offset:2048 sc1
ATT_20m_44:
    v_cvt_pk_bf16_f32 v212, v72, v73
    v_cvt_pk_bf16_f32 v213, v74, v75
    s_cbranch_scc0 ATT_20m_45
    buffer_load_dwordx4 a[140:143], v1, s[8:11], s32 offen offset:3072 sc1
ATT_20m_45:
    v_cvt_pk_bf16_f32 v214, v76, v77
    v_cvt_pk_bf16_f32 v215, v78, v79
    s_cbranch_scc0 ATT_20m_46
    s_add_u32 s32, s50, 12288
    buffer_load_dwordx4 a[144:147], v1, s[8:11], s32 offen offset:0 sc1
    s_cmp_eq_u32 s53, 1
ATT_20m_46:
    v_mfma_f32_32x32x16_bf16 v[112:127], a[88:91], v[16:19], 0
    s_cbranch_scc0 ATT_20m_47
    buffer_load_dwordx4 a[148:151], v1, s[8:11], s32 offen offset:1024 sc1
ATT_20m_47:
    v_mfma_f32_32x32x16_bf16 v[112:127], a[92:95], v[20:23], v[112:127]
    s_cbranch_scc0 ATT_20m_48
    buffer_load_dwordx4 a[152:155], v1, s[8:11], s32 offen offset:2048 sc1
ATT_20m_48:
    v_mfma_f32_32x32x16_bf16 v[112:127], v[204:207], v[8:11], v[112:127]
    s_cbranch_scc0 ATT_20m_49
    buffer_load_dwordx4 a[156:159], v1, s[8:11], s32 offen offset:3072 sc1
ATT_20m_49:
    v_cvt_pk_bf16_f32 v216, v80, v81
    v_cvt_pk_bf16_f32 v217, v82, v83
    s_cbranch_scc0 ATT_20m_50
    s_add_u32 s32, s50, 16384
    buffer_load_dwordx4 a[160:163], v1, s[8:11], s32 offen offset:0 sc1
    s_cmp_eq_u32 s53, 1
ATT_20m_50:
    v_cvt_pk_bf16_f32 v218, v84, v85
    v_cvt_pk_bf16_f32 v219, v86, v87
    s_cbranch_scc0 ATT_20m_51
    buffer_load_dwordx4 a[164:167], v1, s[8:11], s32 offen offset:1024 sc1
ATT_20m_51:
    v_cvt_pk_bf16_f32 v220, v88, v89
    v_cvt_pk_bf16_f32 v221, v90, v91
    s_cbranch_scc0 ATT_20m_52
    buffer_load_dwordx4 a[168:171], v1, s[8:11], s32 offen offset:2048 sc1
ATT_20m_52:
    v_cvt_pk_bf16_f32 v222, v92, v93
    v_cvt_pk_bf16_f32 v223, v94, v95
    s_cbranch_scc0 ATT_20m_53
    buffer_load_dwordx4 a[172:175], v1, s[8:11], s32 offen offset:3072 sc1
ATT_20m_53:
    v_cvt_pk_bf16_f32 v224, v96, v97
    v_cvt_pk_bf16_f32 v225, v98, v99
    s_cbranch_scc0 ATT_20m_54
    s_add_u32 s32, s50, 20480
    buffer_load_dwordx4 a[176:179], v1, s[8:11], s32 offen offset:0 sc1
    s_cmp_eq_u32 s53, 1
ATT_20m_54:
    v_cvt_pk_bf16_f32 v226, v100, v101
    v_cvt_pk_bf16_f32 v227, v102, v103
    s_cbranch_scc0 ATT_20m_55
    buffer_load_dwordx4 a[180:183], v1, s[8:11], s32 offen offset:1024 sc1
ATT_20m_55:
    v_cvt_pk_bf16_f32 v228, v104, v105
    v_cvt_pk_bf16_f32 v229, v106, v107
    s_cbranch_scc0 ATT_20m_56
    buffer_load_dwordx4 a[184:187], v1, s[8:11], s32 offen offset:2048 sc1
ATT_20m_56:
    v_cvt_pk_bf16_f32 v230, v108, v109
    v_cvt_pk_bf16_f32 v231, v110, v111
    s_cbranch_scc0 ATT_20m_57
    buffer_load_dwordx4 a[188:191], v1, s[8:11], s32 offen offset:3072 sc1
ATT_20m_57:
    v_cvt_pk_bf16_f32 v232, v112, v113
    v_cvt_pk_bf16_f32 v233, v114, v115
    s_cbranch_scc0 ATT_20m_58
    s_add_u32 s32, s50, 24576
    buffer_load_dwordx4 a[192:195], v1, s[8:11], s32 offen offset:0 sc1
    s_cmp_eq_u32 s53, 1
ATT_20m_58:
    v_cvt_pk_bf16_f32 v234, v116, v117
    v_cvt_pk_bf16_f32 v235, v118, v119
    s_cbranch_scc0 ATT_20m_59
    buffer_load_dwordx4 a[196:199], v1, s[8:11], s32 offen offset:1024 sc1
ATT_20m_59:
    v_cvt_pk_bf16_f32 v236, v120, v121
    v_cvt_pk_bf16_f32 v237, v122, v123
    s_cbranch_scc0 ATT_20m_60
    buffer_load_dwordx4 a[200:203], v1, s[8:11], s32 offen offset:2048 sc1
ATT_20m_60:
    v_cvt_pk_bf16_f32 v238, v124, v125
    v_cvt_pk_bf16_f32 v239, v126, v127
    s_cbranch_scc0 ATT_20m_61
    buffer_load_dwordx4 a[204:207], v1, s[8:11], s32 offen offset:3072 sc1
ATT_20m_61:
    s_cbranch_scc0 ATT_20m_62
    s_add_u32 s32, s50, 28672
    buffer_load_dwordx4 a[208:211], v1, s[8:11], s32 offen offset:0 sc1
    s_cmp_eq_u32 s53, 1
ATT_20m_62:
    s_cbranch_scc0 ATT_20m_63
    buffer_load_dwordx4 a[212:215], v1, s[8:11], s32 offen offset:1024 sc1
ATT_20m_63:
    s_cbranch_scc0 ATT_20m_64
    buffer_load_dwordx4 a[216:219], v1, s[8:11], s32 offen offset:2048 sc1
ATT_20m_64:
    s_cbranch_scc0 ATT_20m_65
    buffer_load_dwordx4 a[220:223], v1, s[8:11], s32 offen offset:3072 sc1
ATT_20m_65:
    s_cbranch_scc0 ATT_20_l_k2
    s_add_u32 s50, s50, 131072
    s_add_u32 s51, s51, 512
ATT_20_l_k2:
    buffer_store_dwordx4 v[208:211], v1, s[8:11], s47 offen offset:0 sc1
    buffer_store_dwordx4 v[212:215], v1, s[8:11], s47 offen offset:1024 sc1
    buffer_store_dwordx4 v[216:219], v1, s[8:11], s47 offen offset:2048 sc1
    buffer_store_dwordx4 v[220:223], v1, s[8:11], s47 offen offset:3072 sc1
    s_add_u32 s32, s47, 4096
    buffer_store_dwordx4 v[224:227], v1, s[8:11], s32 offen offset:0 sc1
    buffer_store_dwordx4 v[228:231], v1, s[8:11], s32 offen offset:1024 sc1
    buffer_store_dwordx4 v[232:235], v1, s[8:11], s32 offen offset:2048 sc1
    buffer_store_dwordx4 v[236:239], v1, s[8:11], s32 offen offset:3072 sc1
    s_add_u32 s43, s43, 1572864
    s_add_u32 s44, s44, 262144
    s_add_u32 s45, s45, 1024
    s_add_u32 s49, s49, 2048
    s_add_u32 s47, s47, 524288
    s_add_u32 s41, s41, 2
    s_cmp_eq_u32 s53, 1
    s_cbranch_scc0 ATT_20_e1
    s_mov_b32 s52, 1
    s_branch ATT_20_H
ATT_20_e1:
    s_waitcnt vmcnt(0)
    v_mov_b32 v11, 1
    v_mov_b32 v10, 0
    s_mov_b64 exec, 1
    buffer_store_dword v11, v10, s[8:11], s46 offen sc1
    s_mov_b64 exec, -1
    s_add_u32 s46, s46, 256
    s_mov_b32 s52, 0
    s_cmp_ge_u32 s41, 64
    s_cbranch_scc1 ATT_20_done
    s_cmp_eq_u32 s53, 2
    s_cbranch_scc1 ATT_20_H
    s_mov_b32 s96, 0
    v_mbcnt_lo_u32_b32 v250, -1, 0
    v_mbcnt_hi_u32_b32 v250, -1, v250
    v_min_u32 v250, 15, v250
    v_lshlrev_b32 v250, 2, v250
ATT_20wxs_66_spin:
    buffer_load_dword v251, v250, s[8:11], s51 offen sc1
    s_waitcnt vmcnt(0)
    v_cmp_eq_u32 vcc, 0, v251
    s_cbranch_vccz ATT_20wxs_66_ok
    s_add_u32 s96, s96, 1
    s_cmp_gt_u32 s96, 300000
    s_cbranch_scc1 L_fail
    s_sleep 1
    s_branch ATT_20wxs_66_spin
ATT_20wxs_66_ok:
    s_add_u32 s32, s50, 0
    buffer_load_dwordx4 a[96:99], v1, s[8:11], s32 offen offset:0 sc1
    buffer_load_dwordx4 a[100:103], v1, s[8:11], s32 offen offset:1024 sc1
    buffer_load_dwordx4 a[104:107], v1, s[8:11], s32 offen offset:2048 sc1
    buffer_load_dwordx4 a[108:111], v1, s[8:11], s32 offen offset:3072 sc1
    s_add_u32 s32, s50, 4096
    buffer_load_dwordx4 a[112:115], v1, s[8:11], s32 offen offset:0 sc1
    buffer_load_dwordx4 a[116:119], v1, s[8:11], s32 offen offset:1024 sc1
    buffer_load_dwordx4 a[120:123], v1, s[8:11], s32 offen offset:2048 sc1
    buffer_load_dwordx4 a[124:127], v1, s[8:11], s32 offen offset:3072 sc1
    s_add_u32 s32, s50, 8192
    buffer_load_dwordx4 a[128:131], v1, s[8:11], s32 offen offset:0 sc1
    buffer_load_dwordx4 a[132:135], v1, s[8:11], s32 offen offset:1024 sc1
    buffer_load_dwordx4 a[136:139], v1, s[8:11], s32 offen offset:2048 sc1
    buffer_load_dwordx4 a[140:143], v1, s[8:11], s32 offen offset:3072 sc1
    s_add_u32 s32, s50, 12288
    buffer_load_dwordx4 a[144:147], v1, s[8:11], s32 offen offset:0 sc1
    buffer_load_dwordx4 a[148:151], v1, s[8:11], s32 offen offset:1024 sc1
    buffer_load_dwordx4 a[152:155], v1, s[8:11], s32 offen offset:2048 sc1
    buffer_load_dwordx4 a[156:159], v1, s[8:11], s32 offen offset:3072 sc1
    s_add_u32 s32, s50, 16384
    buffer_load_dwordx4 a[160:163], v1, s[8:11], s32 offen offset:0 sc1
    buffer_load_dwordx4 a[164:167], v1, s[8:11], s32 offen offset:1024 sc1
    buffer_load_dwordx4 a[168:171], v1, s[8:11], s32 offen offset:2048 sc1
    buffer_load_dwordx4 a[172:175], v1, s[8:11], s32 offen offset:3072 sc1
    s_add_u32 s32, s50, 20480
    buffer_load_dwordx4 a[176:179], v1, s[8:11], s32 offen offset:0 sc1
    buffer_load_dwordx4 a[180:183], v1, s[8:11], s32 offen offset:1024 sc1
    buffer_load_dwordx4 a[184:187], v1, s[8:11], s32 offen offset:2048 sc1
    buffer_load_dwordx4 a[188:191], v1, s[8:11], s32 offen offset:3072 sc1
    s_add_u32 s32, s50, 24576
    buffer_load_dwordx4 a[192:195], v1, s[8:11], s32 offen offset:0 sc1
    buffer_load_dwordx4 a[196:199], v1, s[8:11], s32 offen offset:1024 sc1
    buffer_load_dwordx4 a[200:203], v1, s[8:11], s32 offen offset:2048 sc1
    buffer_load_dwordx4 a[204:207], v1, s[8:11], s32 offen offset:3072 sc1
    s_add_u32 s32, s50, 28672
    buffer_load_dwordx4 a[208:211], v1, s[8:11], s32 offen offset:0 sc1
    buffer_load_dwordx4 a[212:215], v1, s[8:11], s32 offen offset:1024 sc1
    buffer_load_dwordx4 a[216:219], v1, s[8:11], s32 offen offset:2048 sc1
    buffer_load_dwordx4 a[220:223], v1, s[8:11], s32 offen offset:3072 sc1
    s_add_u32 s50, s50, 131072
    s_add_u32 s51, s51, 512
    s_branch ATT_20_H
ATT_20_done:
LE_ATT:
    s_endpgm
L_AH:
LB_AH:
    s_load_dwordx2 s[12:13], s[0:1], 8
    s_waitcnt lgkmcnt(0)
    s_mov_b32 s14, 1572864
    s_mov_b32 s15, 0x20000
    v_lshrrev_b32 v61, 3, v0
    v_and_b32 v60, 7, v0
    v_bfe_u32 v62, v61, 1, 1
    v_lshlrev_b32 v62, 2, v62
    v_xor_b32 v62, v60, v62
    v_lshrrev_b32 v63, 1, v62
    v_min_u32 v63, 2, v63
    v_and_b32 v62, 1, v62
    v_lshlrev_b32 v62, 4, v62
    v_lshl_add_u32 v62, v63, 10, v62
    v_mul_u32_u24 v63, 3072, v61
    v_add_u32 v62, v62, v63
    s_lshl_b32 s32, s5, 5
    v_add_u32 v40, s32, v62
    s_cmp_lt_u32 s6, 2
    s_cbranch_scc1 AH_67_nw
    s_sub_u32 s36, s6, 2
    s_mul_i32 s33, s36, 786432
    s_lshl_b32 s34, s36, 15
    s_add_u32 m0, s34, 0
    s_add_u32 s35, s33, 0
    buffer_load_dwordx4 v40, s[12:15], s35 offen lds
    s_add_u32 m0, s34, 1024
    s_add_u32 s35, s33, 24576
    buffer_load_dwordx4 v40, s[12:15], s35 offen lds
    s_add_u32 m0, s34, 2048
    s_add_u32 s35, s33, 49152
    buffer_load_dwordx4 v40, s[12:15], s35 offen lds
    s_add_u32 m0, s34, 3072
    s_add_u32 s35, s33, 73728
    buffer_load_dwordx4 v40, s[12:15], s35 offen lds
    s_add_u32 m0, s34, 4096
    s_add_u32 s35, s33, 98304
    buffer_load_dwordx4 v40, s[12:15], s35 offen lds
    s_add_u32 m0, s34, 5120
    s_add_u32 s35, s33, 122880
    buffer_load_dwordx4 v40, s[12:15], s35 offen lds
    s_add_u32 m0, s34, 6144
    s_add_u32 s35, s33, 147456
    buffer_load_dwordx4 v40, s[12:15], s35 offen lds
    s_add_u32 m0, s34, 7168
    s_add_u32 s35, s33, 172032
    buffer_load_dwordx4 v40, s[12:15], s35 offen lds
    s_add_u32 m0, s34, 8192
    s_add_u32 s35, s33, 196608
    buffer_load_dwordx4 v40, s[12:15], s35 offen lds
    s_add_u32 m0, s34, 9216
    s_add_u32 s35, s33, 221184
    buffer_load_dwordx4 v40, s[12:15], s35 offen lds
    s_add_u32 m0, s34, 10240
    s_add_u32 s35, s33, 245760
    buffer_load_dwordx4 v40, s[12:15], s35 offen lds
    s_add_u32 m0, s34, 11264
    s_add_u32 s35, s33, 270336
    buffer_load_dwordx4 v40, s[12:15], s35 offen lds
    s_add_u32 m0, s34, 12288
    s_add_u32 s35, s33, 294912
    buffer_load_dwordx4 v40, s[12:15], s35 offen lds
    s_add_u32 m0, s34, 13312
    s_add_u32 s35, s33, 319488
    buffer_load_dwordx4 v40, s[12:15], s35 offen lds
    s_add_u32 m0, s34, 14336
    s_add_u32 s35, s33, 344064
    buffer_load_dwordx4 v40, s[12:15], s35 offen lds
    s_add_u32 m0, s34, 15360
    s_add_u32 s35, s33, 368640
    buffer_load_dwordx4 v40, s[12:15], s35 offen lds
    s_add_u32 m0, s34, 16384
    s_add_u32 s35, s33, 393216
    buffer_load_dwordx4 v40, s[12:15], s35 offen lds
    s_add_u32 m0, s34, 17408
    s_add_u32 s35, s33, 417792
    buffer_load_dwordx4 v40, s[12:15], s35 offen lds
    s_add_u32 m0, s34, 18432
    s_add_u32 s35, s33, 442368
    buffer_load_dwordx4 v40, s[12:15], s35 offen lds
    s_add_u32 m0, s34, 19456
    s_add_u32 s35, s33, 466944
    buffer_load_dwordx4 v40, s[12:15], s35 offen lds
    s_add_u32 m0, s34, 20480
    s_add_u32 s35, s33, 491520
    buffer_load_dwordx4 v40, s[12:15], s35 offen lds
    s_add_u32 m0, s34, 21504
    s_add_u32 s35, s33, 516096
    buffer_load_dwordx4 v40, s[12:15], s35 offen lds
    s_add_u32 m0, s34, 22528
    s_add_u32 s35, s33, 540672
    buffer_load_dwordx4 v40, s[12:15], s35 offen lds
    s_add_u32 m0, s34, 23552
    s_add_u32 s35, s33, 565248
    buffer_load_dwordx4 v40, s[12:15], s35 offen lds
    s_add_u32 m0, s34, 24576
    s_add_u32 s35, s33, 589824
    buffer_load_dwordx4 v40, s[12:15], s35 offen lds
    s_add_u32 m0, s34, 25600
    s_add_u32 s35, s33, 614400
    buffer_load_dwordx4 v40, s[12:15], s35 offen lds
    s_add_u32 m0, s34, 26624
    s_add_u32 s35, s33, 638976
    buffer_load_dwordx4 v40, s[12:15], s35 offen lds
    s_add_u32 m0, s34, 27648
    s_add_u32 s35, s33, 663552
    buffer_load_dwordx4 v40, s[12:15], s35 offen lds
    s_add_u32 m0, s34, 28672
    s_add_u32 s35, s33, 688128
    buffer_load_dwordx4 v40, s[12:15], s35 offen lds
    s_add_u32 m0, s34, 29696
    s_add_u32 s35, s33, 712704
    buffer_load_dwordx4 v40, s[12:15], s35 offen lds
    s_add_u32 m0, s34, 30720
    s_add_u32 s35, s33, 737280
    buffer_load_dwordx4 v40, s[12:15], s35 offen lds
    s_add_u32 m0, s34, 31744
    s_add_u32 s35, s33, 761856
    buffer_load_dwordx4 v40, s[12:15], s35 offen lds
AH_67_nw:
    v_lshlrev_b32 v1, 4, v0
    s_lshr_b32 s40, s6, 1
    s_and_b32 s41, s6, 1
    s_mul_i32 s32, s40, 12582912
    s_add_u32 s43, s32, 169869312
    s_lshl_b32 s32, s41, 15
    s_add_u32 s43, s43, s32
    s_lshl_b32 s32, s40, 14
    s_add_u32 s45, s32, 205717504
    s_lshl_b32 s32, s41, 7
    s_add_u32 s45, s45, s32
    s_mov_b32 s58, 0
    s_cmp_eq_u32 s40, 0
    s_cbranch_scc0 AH_67_nx0
    s_load_dwordx2 s[16:17], s[0:1], 88
    s_waitcnt lgkmcnt(0)
    s_mov_b32 s18, 256
    s_mov_b32 s19, 0x20000
    s_mov_b32 s20, 0
AH_67e_iw:
    v_mbcnt_lo_u32_b32 v9, -1, 0
    v_mbcnt_hi_u32_b32 v9, -1, v9
    v_min_u32 v9, 7, v9
    v_and_b32 v10, 1, v9
    v_lshlrev_b32 v10, 7, v10
    v_lshrrev_b32 v9, 1, v9
    v_lshl_add_u32 v9, v9, 2, v10
    buffer_load_dword v9, v9, s[16:19], 0 offen sc1
    s_waitcnt vmcnt(0)
    v_cmp_gt_u32 vcc, 32, v9
    s_cmp_eq_u64 vcc, 0
    s_cselect_b32 s21, 256, 0
    s_cmp_ge_u32 s21, 256
    s_cbranch_scc1 AH_67e_iwd
    s_add_u32 s20, s20, 1
    s_cmp_gt_u32 s20, 300000
    s_cbranch_scc1 L_fail
    s_sleep 2
    s_branch AH_67e_iw
AH_67e_iwd:
    s_mov_b32 s96, 0
    v_mbcnt_lo_u32_b32 v250, -1, 0
    v_mbcnt_hi_u32_b32 v250, -1, v250
    v_min_u32 v250, 15, v250
    v_lshlrev_b32 v250, 2, v250
AH_67we_68_spin:
    buffer_load_dword v251, v250, s[8:11], s45 offen sc1
    s_waitcnt vmcnt(0)
    v_cmp_eq_u32 vcc, 0, v251
    s_cbranch_vccz AH_67we_68_ok
    s_add_u32 s96, s96, 1
    s_cmp_gt_u32 s96, 300000
    s_cbranch_scc1 L_fail
    s_sleep 1
    s_branch AH_67we_68_spin
AH_67we_68_ok:
    s_add_u32 s32, s43, 0
    buffer_load_dwordx4 v[64:67], v1, s[8:11], s32 offen offset:0 sc1
    s_add_u32 s32, s43, 0
    buffer_load_dwordx4 v[68:71], v1, s[8:11], s32 offen offset:1024 sc1
    s_add_u32 s32, s43, 0
    buffer_load_dwordx4 v[72:75], v1, s[8:11], s32 offen offset:2048 sc1
    s_add_u32 s32, s43, 0
    buffer_load_dwordx4 v[76:79], v1, s[8:11], s32 offen offset:3072 sc1
    s_add_u32 s32, s43, 4096
    buffer_load_dwordx4 v[80:83], v1, s[8:11], s32 offen offset:0 sc1
    s_add_u32 s32, s43, 4096
    buffer_load_dwordx4 v[84:87], v1, s[8:11], s32 offen offset:1024 sc1
    s_add_u32 s32, s43, 4096
    buffer_load_dwordx4 v[88:91], v1, s[8:11], s32 offen offset:2048 sc1
    s_add_u32 s32, s43, 4096
    buffer_load_dwordx4 v[92:95], v1, s[8:11], s32 offen offset:3072 sc1
    s_add_u32 s32, s43, 8192
    buffer_load_dwordx4 v[96:99], v1, s[8:11], s32 offen offset:0 sc1
    s_add_u32 s32, s43, 8192
    buffer_load_dwordx4 v[100:103], v1, s[8:11], s32 offen offset:1024 sc1
    s_add_u32 s32, s43, 8192
    buffer_load_dwordx4 v[104:107], v1, s[8:11], s32 offen offset:2048 sc1
    s_add_u32 s32, s43, 8192
    buffer_load_dwordx4 v[108:111], v1, s[8:11], s32 offen offset:3072 sc1
    s_add_u32 s32, s43, 12288
    buffer_load_dwordx4 v[112:115], v1, s[8:11], s32 offen offset:0 sc1
    s_add_u32 s32, s43, 12288
    buffer_load_dwordx4 v[116:119], v1, s[8:11], s32 offen offset:1024 sc1
    s_add_u32 s32, s43, 12288
    buffer_load_dwordx4 v[120:123], v1, s[8:11], s32 offen offset:2048 sc1
    s_add_u32 s32, s43, 12288
    buffer_load_dwordx4 v[124:127], v1, s[8:11], s32 offen offset:3072 sc1
    s_add_u32 s32, s43, 16384
    buffer_load_dwordx4 v[128:131], v1, s[8:11], s32 offen offset:0 sc1
    s_add_u32 s32, s43, 16384
    buffer_load_dwordx4 v[132:135], v1, s[8:11], s32 offen offset:1024 sc1
    s_add_u32 s32, s43, 16384
    buffer_load_dwordx4 v[136:139], v1, s[8:11], s32 offen offset:2048 sc1
    s_add_u32 s32, s43, 16384
    buffer_load_dwordx4 v[140:143], v1, s[8:11], s32 offen offset:3072 sc1
    s_add_u32 s32, s43, 20480
    buffer_load_dwordx4 v[144:147], v1, s[8:11], s32 offen offset:0 sc1
    s_add_u32 s32, s43, 20480
    buffer_load_dwordx4 v[148:151], v1, s[8:11], s32 offen offset:1024 sc1
    s_add_u32 s32, s43, 20480
    buffer_load_dwordx4 v[152:155], v1, s[8:11], s32 offen offset:2048 sc1
    s_add_u32 s32, s43, 20480
    buffer_load_dwordx4 v[156:159], v1, s[8:11], s32 offen offset:3072 sc1
    s_add_u32 s32, s43, 24576
    buffer_load_dwordx4 v[160:163], v1, s[8:11], s32 offen offset:0 sc1
    s_add_u32 s32, s43, 24576
    buffer_load_dwordx4 v[164:167], v1, s[8:11], s32 offen offset:1024 sc1
    s_add_u32 s32, s43, 24576
    buffer_load_dwordx4 v[168:171], v1, s[8:11], s32 offen offset:2048 sc1
    s_add_u32 s32, s43, 24576
    buffer_load_dwordx4 v[172:175], v1, s[8:11], s32 offen offset:3072 sc1
    s_add_u32 s32, s43, 28672
    buffer_load_dwordx4 v[176:179], v1, s[8:11], s32 offen offset:0 sc1
    s_add_u32 s32, s43, 28672
    buffer_load_dwordx4 v[180:183], v1, s[8:11], s32 offen offset:1024 sc1
    s_add_u32 s32, s43, 28672
    buffer_load_dwordx4 v[184:187], v1, s[8:11], s32 offen offset:2048 sc1
    s_add_u32 s32, s43, 28672
    buffer_load_dwordx4 v[188:191], v1, s[8:11], s32 offen offset:3072 sc1
    s_mov_b32 s58, 1
AH_67_nx0:
    s_cmp_eq_u32 s58, 1
    s_cbranch_scc1 AH_67_wx2
    s_waitcnt vmcnt(0)
AH_67_wx2:
    s_barrier
    s_mov_b32 s32, 0
    v_lshrrev_b32 v54, 4, v0
    v_and_b32 v55, 1, v54
    v_lshrrev_b32 v54, 1, v54
    v_bfe_u32 v56, v0, 2, 2
    v_and_b32 v57, 3, v0
    v_lshl_add_u32 v54, v54, 2, v56
    v_lshrrev_b32 v58, 1, v57
    v_lshl_add_u32 v58, v55, 1, v58
    v_add_u32 v58, s32, v58
    v_lshrrev_b32 v59, 1, v56
    v_lshlrev_b32 v59, 2, v59
    v_xor_b32 v58, v58, v59
    v_lshlrev_b32 v58, 4, v58
    v_and_b32 v57, 1, v57
    v_lshl_add_u32 v58, v57, 3, v58
    v_mul_u32_u24 v54, 128, v54
    v_add_u32 v44, v54, v58
    v_add_u32 v44, 0, v44
    v_xor_b32 v45, 64, v44
    ds_read_b64_tr_b16 a[0:1], v44 offset:0
    ds_read_b64_tr_b16 a[128:129], v45 offset:0
    ds_read_b64_tr_b16 a[2:3], v44 offset:1024
    ds_read_b64_tr_b16 a[130:131], v45 offset:1024
    ds_read_b64_tr_b16 a[4:5], v44 offset:2048
    ds_read_b64_tr_b16 a[132:133], v45 offset:2048
    ds_read_b64_tr_b16 a[6:7], v44 offset:3072
    ds_read_b64_tr_b16 a[134:135], v45 offset:3072
    s_waitcnt lgkmcnt(4)
    ds_read_b64_tr_b16 a[8:9], v44 offset:4096
    ds_read_b64_tr_b16 a[136:137], v45 offset:4096
    ds_read_b64_tr_b16 a[10:11], v44 offset:5120
    ds_read_b64_tr_b16 a[138:139], v45 offset:5120
    ds_read_b64_tr_b16 a[12:13], v44 offset:6144
    ds_read_b64_tr_b16 a[140:141], v45 offset:6144
    ds_read_b64_tr_b16 a[14:15], v44 offset:7168
    ds_read_b64_tr_b16 a[142:143], v45 offset:7168
    s_waitcnt lgkmcnt(4)
    ds_read_b64_tr_b16 a[16:17], v44 offset:8192
    ds_read_b64_tr_b16 a[144:145], v45 offset:8192
    ds_read_b64_tr_b16 a[18:19], v44 offset:9216
    ds_read_b64_tr_b16 a[146:147], v45 offset:9216
    ds_read_b64_tr_b16 a[20:21], v44 offset:10240
    ds_read_b64_tr_b16 a[148:149], v45 offset:10240
    ds_read_b64_tr_b16 a[22:23], v44 offset:11264
    ds_read_b64_tr_b16 a[150:151], v45 offset:11264
    s_waitcnt lgkmcnt(4)
    ds_read_b64_tr_b16 a[24:25], v44 offset:12288
    ds_read_b64_tr_b16 a[152:153], v45 offset:12288
    ds_read_b64_tr_b16 a[26:27], v44 offset:13312
    ds_read_b64_tr_b16 a[154:155], v45 offset:13312
    ds_read_b64_tr_b16 a[28:29], v44 offset:14336
    ds_read_b64_tr_b16 a[156:157], v45 offset:14336
    ds_read_b64_tr_b16 a[30:31], v44 offset:15360
    ds_read_b64_tr_b16 a[158:159], v45 offset:15360
    s_waitcnt lgkmcnt(4)
    ds_read_b64_tr_b16 a[32:33], v44 offset:16384
    ds_read_b64_tr_b16 a[160:161], v45 offset:16384
    ds_read_b64_tr_b16 a[34:35], v44 offset:17408
    ds_read_b64_tr_b16 a[162:163], v45 offset:17408
    ds_read_b64_tr_b16 a[36:37], v44 offset:18432
    ds_read_b64_tr_b16 a[164:165], v45 offset:18432
    ds_read_b64_tr_b16 a[38:39], v44 offset:19456
    ds_read_b64_tr_b16 a[166:167], v45 offset:19456
    s_waitcnt lgkmcnt(4)
    ds_read_b64_tr_b16 a[40:41], v44 offset:20480
    ds_read_b64_tr_b16 a[168:169], v45 offset:20480
    ds_read_b64_tr_b16 a[42:43], v44 offset:21504
    ds_read_b64_tr_b16 a[170:171], v45 offset:21504
    ds_read_b64_tr_b16 a[44:45], v44 offset:22528
    ds_read_b64_tr_b16 a[172:173], v45 offset:22528
    ds_read_b64_tr_b16 a[46:47], v44 offset:23552
    ds_read_b64_tr_b16 a[174:175], v45 offset:23552
    s_waitcnt lgkmcnt(4)
    ds_read_b64_tr_b16 a[48:49], v44 offset:24576
    ds_read_b64_tr_b16 a[176:177], v45 offset:24576
    ds_read_b64_tr_b16 a[50:51], v44 offset:25600
    ds_read_b64_tr_b16 a[178:179], v45 offset:25600
    ds_read_b64_tr_b16 a[52:53], v44 offset:26624
    ds_read_b64_tr_b16 a[180:181], v45 offset:26624
    ds_read_b64_tr_b16 a[54:55], v44 offset:27648
    ds_read_b64_tr_b16 a[182:183], v45 offset:27648
    s_waitcnt lgkmcnt(4)
    ds_read_b64_tr_b16 a[56:57], v44 offset:28672
    ds_read_b64_tr_b16 a[184:185], v45 offset:28672
    ds_read_b64_tr_b16 a[58:59], v44 offset:29696
    ds_read_b64_tr_b16 a[186:187], v45 offset:29696
    ds_read_b64_tr_b16 a[60:61], v44 offset:30720
    ds_read_b64_tr_b16 a[188:189], v45 offset:30720
    ds_read_b64_tr_b16 a[62:63], v44 offset:31744
    ds_read_b64_tr_b16 a[190:191], v45 offset:31744
    s_waitcnt lgkmcnt(4)
    ds_read_b64_tr_b16 a[64:65], v44 offset:32768
    ds_read_b64_tr_b16 a[192:193], v45 offset:32768
    ds_read_b64_tr_b16 a[66:67], v44 offset:33792
    ds_read_b64_tr_b16 a[194:195], v45 offset:33792
    ds_read_b64_tr_b16 a[68:69], v44 offset:34816
    ds_read_b64_tr_b16 a[196:197], v45 offset:34816
    ds_read_b64_tr_b16 a[70:71], v44 offset:35840
    ds_read_b64_tr_b16 a[198:199], v45 offset:35840
    s_waitcnt lgkmcnt(4)
    ds_read_b64_tr_b16 a[72:73], v44 offset:36864
    ds_read_b64_tr_b16 a[200:201], v45 offset:36864
    ds_read_b64_tr_b16 a[74:75], v44 offset:37888
    ds_read_b64_tr_b16 a[202:203], v45 offset:37888
    ds_read_b64_tr_b16 a[76:77], v44 offset:38912
    ds_read_b64_tr_b16 a[204:205], v45 offset:38912
    ds_read_b64_tr_b16 a[78:79], v44 offset:39936
    ds_read_b64_tr_b16 a[206:207], v45 offset:39936
    s_waitcnt lgkmcnt(4)
    ds_read_b64_tr_b16 a[80:81], v44 offset:40960
    ds_read_b64_tr_b16 a[208:209], v45 offset:40960
    ds_read_b64_tr_b16 a[82:83], v44 offset:41984
    ds_read_b64_tr_b16 a[210:211], v45 offset:41984
    ds_read_b64_tr_b16 a[84:85], v44 offset:43008
    ds_read_b64_tr_b16 a[212:213], v45 offset:43008
    ds_read_b64_tr_b16 a[86:87], v44 offset:44032
    ds_read_b64_tr_b16 a[214:215], v45 offset:44032
    s_waitcnt lgkmcnt(4)
    ds_read_b64_tr_b16 a[88:89], v44 offset:45056
    ds_read_b64_tr_b16 a[216:217], v45 offset:45056
    ds_read_b64_tr_b16 a[90:91], v44 offset:46080
    ds_read_b64_tr_b16 a[218:219], v45 offset:46080
    ds_read_b64_tr_b16 a[92:93], v44 offset:47104
    ds_read_b64_tr_b16 a[220:221], v45 offset:47104
    ds_read_b64_tr_b16 a[94:95], v44 offset:48128
    ds_read_b64_tr_b16 a[222:223], v45 offset:48128
    s_waitcnt lgkmcnt(4)
    ds_read_b64_tr_b16 a[96:97], v44 offset:49152
    ds_read_b64_tr_b16 a[224:225], v45 offset:49152
    ds_read_b64_tr_b16 a[98:99], v44 offset:50176
    ds_read_b64_tr_b16 a[226:227], v45 offset:50176
    ds_read_b64_tr_b16 a[100:101], v44 offset:51200
    ds_read_b64_tr_b16 a[228:229], v45 offset:51200
    ds_read_b64_tr_b16 a[102:103], v44 offset:52224
    ds_read_b64_tr_b16 a[230:231], v45 offset:52224
    s_waitcnt lgkmcnt(4)
    ds_read_b64_tr_b16 a[104:105], v44 offset:53248
    ds_read_b64_tr_b16 a[232:233], v45 offset:53248
    ds_read_b64_tr_b16 a[106:107], v44 offset:54272
    ds_read_b64_tr_b16 a[234:235], v45 offset:54272
    ds_read_b64_tr_b16 a[108:109], v44 offset:55296
    ds_read_b64_tr_b16 a[236:237], v45 offset:55296
    ds_read_b64_tr_b16 a[110:111], v44 offset:56320
    ds_read_b64_tr_b16 a[238:239], v45 offset:56320
    s_waitcnt lgkmcnt(4)
    ds_read_b64_tr_b16 a[112:113], v44 offset:57344
    ds_read_b64_tr_b16 a[240:241], v45 offset:57344
    ds_read_b64_tr_b16 a[114:115], v44 offset:58368
    ds_read_b64_tr_b16 a[242:243], v45 offset:58368
    ds_read_b64_tr_b16 a[116:117], v44 offset:59392
    ds_read_b64_tr_b16 a[244:245], v45 offset:59392
    ds_read_b64_tr_b16 a[118:119], v44 offset:60416
    ds_read_b64_tr_b16 a[246:247], v45 offset:60416
    s_waitcnt lgkmcnt(4)
    ds_read_b64_tr_b16 a[120:121], v44 offset:61440
    ds_read_b64_tr_b16 a[248:249], v45 offset:61440
    ds_read_b64_tr_b16 a[122:123], v44 offset:62464
    ds_read_b64_tr_b16 a[250:251], v45 offset:62464
    ds_read_b64_tr_b16 a[124:125], v44 offset:63488
    ds_read_b64_tr_b16 a[252:253], v45 offset:63488
    ds_read_b64_tr_b16 a[126:127], v44 offset:64512
    ds_read_b64_tr_b16 a[254:255], v45 offset:64512
    s_waitcnt lgkmcnt(4)
    s_waitcnt lgkmcnt(0)
    s_barrier
    v_mov_b32 v1, 98368
    v_mov_b32 v2, 0
    s_lshl_b32 s32, s6, 2
    v_add_u32 v3, s32, v1
    s_xor_b32 s33, s32, 4
    v_add_u32 v4, s33, v1
    ds_write_b32 v3, v2
    s_waitcnt lgkmcnt(0)
    s_barrier
    v_lshlrev_b32 v1, 4, v0
    s_lshr_b32 s40, s6, 1
    s_and_b32 s41, s6, 1
    s_mul_i32 s42, s40, 49152
    s_mul_i32 s32, s40, 12582912
    s_add_u32 s43, s32, 169869312
    s_add_u32 s44, s32, 171966464
    s_lshl_b32 s33, s5, 10
    s_add_u32 s44, s44, s33
    s_lshl_b32 s32, s40, 14
    s_add_u32 s45, s32, 205717504
    s_lshl_b32 s32, s40, 13
    s_add_u32 s46, s32, 205750272
    s_lshl_b32 s33, s5, 2
    s_add_u32 s46, s46, s33
    s_lshl_b32 s32, s41, 15
    s_add_u32 s43, s43, s32
    s_add_u32 s44, s44, s32
    s_lshl_b32 s32, s41, 7
    s_add_u32 s45, s45, s32
    s_add_u32 s46, s46, s32
    v_and_b32 v5, 31, v0
    v_cmp_le_u32 s[62:63], 16, v5
    v_mov_b32 v6, 0x3f803f80
    v_mov_b32 v7, 0xff7fffff
    s_mov_b32 s47, 0x3eb8aa3b
    s_mov_b32 s60, 0x3eb8aa3b
    s_mov_b32 s61, 0x3eb8aa3b
    s_mov_b32 s59, 0
    v_and_b32 v54, 31, v0
    v_lshrrev_b32 v55, 5, v0
    v_lshlrev_b32 v55, 2, v55
    v_sub_u32 v54, v54, v55
    v_cmp_le_i32 s[64:65], 0, v54
    v_cmp_le_i32 s[66:67], 1, v54
    v_cmp_le_i32 s[68:69], 2, v54
    v_cmp_le_i32 s[70:71], 3, v54
    v_cmp_le_i32 s[72:73], 8, v54
    v_cmp_le_i32 s[74:75], 9, v54
    v_cmp_le_i32 s[76:77], 10, v54
    v_cmp_le_i32 s[78:79], 11, v54
    v_cmp_le_i32 s[80:81], 16, v54
    v_cmp_le_i32 s[82:83], 17, v54
    v_cmp_le_i32 s[84:85], 18, v54
    v_cmp_le_i32 s[86:87], 19, v54
    v_cmp_le_i32 s[88:89], 24, v54
    v_cmp_le_i32 s[90:91], 25, v54
    v_cmp_le_i32 s[92:93], 26, v54
    v_cmp_le_i32 s[94:95], 27, v54
    s_cmp_eq_u32 s58, 1
    s_cbranch_scc1 AH_67_x0done
    s_load_dwordx2 s[16:17], s[0:1], 88
    s_waitcnt lgkmcnt(0)
    s_mov_b32 s18, 256
    s_mov_b32 s19, 0x20000
    s_mov_b32 s20, 0
AH_67_iw:
    v_mbcnt_lo_u32_b32 v9, -1, 0
    v_mbcnt_hi_u32_b32 v9, -1, v9
    v_min_u32 v9, 7, v9
    v_and_b32 v10, 1, v9
    v_lshlrev_b32 v10, 7, v10
    v_lshrrev_b32 v9, 1, v9
    v_lshl_add_u32 v9, v9, 2, v10
    buffer_load_dword v9, v9, s[16:19], 0 offen sc1
    s_waitcnt vmcnt(0)
    v_cmp_gt_u32 vcc, 32, v9
    s_cmp_eq_u64 vcc, 0
    s_cselect_b32 s21, 256, 0
    s_cmp_ge_u32 s21, 256
    s_cbranch_scc1 AH_67_iwd
    s_add_u32 s20, s20, 1
    s_cmp_gt_u32 s20, 300000
    s_cbranch_scc1 L_fail
    s_sleep 2
    s_branch AH_67_iw
AH_67_iwd:
    s_mov_b32 s96, 0
    v_mbcnt_lo_u32_b32 v250, -1, 0
    v_mbcnt_hi_u32_b32 v250, -1, v250
    v_min_u32 v250, 15, v250
    v_lshlrev_b32 v250, 2, v250
AH_67w0_69_spin:
    buffer_load_dword v251, v250, s[8:11], s45 offen sc1
    s_waitcnt vmcnt(0)
    v_cmp_eq_u32 vcc, 0, v251
    s_cbranch_vccz AH_67w0_69_ok
    s_add_u32 s96, s96, 1
    s_cmp_gt_u32 s96, 300000
    s_cbranch_scc1 L_fail
    s_sleep 1
    s_branch AH_67w0_69_spin
AH_67w0_69_ok:
    s_add_u32 s32, s43, 0
    buffer_load_dwordx4 v[64:67], v1, s[8:11], s32 offen offset:0 sc1
    s_add_u32 s32, s43, 0
    buffer_load_dwordx4 v[68:71], v1, s[8:11], s32 offen offset:1024 sc1
    s_add_u32 s32, s43, 0
    buffer_load_dwordx4 v[72:75], v1, s[8:11], s32 offen offset:2048 sc1
    s_add_u32 s32, s43, 0
    buffer_load_dwordx4 v[76:79], v1, s[8:11], s32 offen offset:3072 sc1
    s_add_u32 s32, s43, 4096
    buffer_load_dwordx4 v[80:83], v1, s[8:11], s32 offen offset:0 sc1
    s_add_u32 s32, s43, 4096
    buffer_load_dwordx4 v[84:87], v1, s[8:11], s32 offen offset:1024 sc1
    s_add_u32 s32, s43, 4096
    buffer_load_dwordx4 v[88:91], v1, s[8:11], s32 offen offset:2048 sc1
    s_add_u32 s32, s43, 4096
    buffer_load_dwordx4 v[92:95], v1, s[8:11], s32 offen offset:3072 sc1
    s_add_u32 s32, s43, 8192
    buffer_load_dwordx4 v[96:99], v1, s[8:11], s32 offen offset:0 sc1
    s_add_u32 s32, s43, 8192
    buffer_load_dwordx4 v[100:103], v1, s[8:11], s32 offen offset:1024 sc1
    s_add_u32 s32, s43, 8192
    buffer_load_dwordx4 v[104:107], v1, s[8:11], s32 offen offset:2048 sc1
    s_add_u32 s32, s43, 8192
    buffer_load_dwordx4 v[108:111], v1, s[8:11], s32 offen offset:3072 sc1
    s_add_u32 s32, s43, 12288
    buffer_load_dwordx4 v[112:115], v1, s[8:11], s32 offen offset:0 sc1
    s_add_u32 s32, s43, 12288
    buffer_load_dwordx4 v[116:119], v1, s[8:11], s32 offen offset:1024 sc1
    s_add_u32 s32, s43, 12288
    buffer_load_dwordx4 v[120:123], v1, s[8:11], s32 offen offset:2048 sc1
    s_add_u32 s32, s43, 12288
    buffer_load_dwordx4 v[124:127], v1, s[8:11], s32 offen offset:3072 sc1
    s_add_u32 s32, s43, 16384
    buffer_load_dwordx4 v[128:131], v1, s[8:11], s32 offen offset:0 sc1
    s_add_u32 s32, s43, 16384
    buffer_load_dwordx4 v[132:135], v1, s[8:11], s32 offen offset:1024 sc1
    s_add_u32 s32, s43, 16384
    buffer_load_dwordx4 v[136:139], v1, s[8:11], s32 offen offset:2048 sc1
    s_add_u32 s32, s43, 16384
    buffer_load_dwordx4 v[140:143], v1, s[8:11], s32 offen offset:3072 sc1
    s_add_u32 s32, s43, 20480
    buffer_load_dwordx4 v[144:147], v1, s[8:11], s32 offen offset:0 sc1
    s_add_u32 s32, s43, 20480
    buffer_load_dwordx4 v[148:151], v1, s[8:11], s32 offen offset:1024 sc1
    s_add_u32 s32, s43, 20480
    buffer_load_dwordx4 v[152:155], v1, s[8:11], s32 offen offset:2048 sc1
    s_add_u32 s32, s43, 20480
    buffer_load_dwordx4 v[156:159], v1, s[8:11], s32 offen offset:3072 sc1
    s_add_u32 s32, s43, 24576
    buffer_load_dwordx4 v[160:163], v1, s[8:11], s32 offen offset:0 sc1
    s_add_u32 s32, s43, 24576
    buffer_load_dwordx4 v[164:167], v1, s[8:11], s32 offen offset:1024 sc1
    s_add_u32 s32, s43, 24576
    buffer_load_dwordx4 v[168:171], v1, s[8:11], s32 offen offset:2048 sc1
    s_add_u32 s32, s43, 24576
    buffer_load_dwordx4 v[172:175], v1, s[8:11], s32 offen offset:3072 sc1
    s_add_u32 s32, s43, 28672
    buffer_load_dwordx4 v[176:179], v1, s[8:11], s32 offen offset:0 sc1
    s_add_u32 s32, s43, 28672
    buffer_load_dwordx4 v[180:183], v1, s[8:11], s32 offen offset:1024 sc1
    s_add_u32 s32, s43, 28672
    buffer_load_dwordx4 v[184:187], v1, s[8:11], s32 offen offset:2048 sc1
    s_add_u32 s32, s43, 28672
    buffer_load_dwordx4 v[188:191], v1, s[8:11], s32 offen offset:3072 sc1
AH_67_x0done:
    s_add_u32 s43, s43, 65536
    s_add_u32 s45, s45, 256
AH_67_loop:
    s_cmp_eq_u32 s59, 0
    s_cbranch_scc1 AH_67x_70_0
    s_waitcnt vmcnt(32)
    s_branch AH_67x_70_1
AH_67x_70_0:
    s_waitcnt vmcnt(31)
AH_67x_70_1:
    v_mfma_f32_32x32x16_bf16 v[32:47], a[0:3], v[64:67], 0
    v_mfma_f32_32x32x16_bf16 v[48:63], v[64:67], a[128:131], 0
    s_cmp_eq_u32 s59, 0
    s_cbranch_scc1 AH_67x_71_0
    s_waitcnt vmcnt(31)
    s_branch AH_67x_71_1
AH_67x_71_0:
    s_waitcnt vmcnt(30)
AH_67x_71_1:
    v_mfma_f32_32x32x16_bf16 v[32:47], a[4:7], v[68:71], v[32:47]
    v_mfma_f32_32x32x16_bf16 v[48:63], v[68:71], a[132:135], v[48:63]
    s_cmp_eq_u32 s59, 0
    s_cbranch_scc1 AH_67x_72_0
    s_waitcnt vmcnt(30)
    s_branch AH_67x_72_1
AH_67x_72_0:
    s_waitcnt vmcnt(29)
AH_67x_72_1:
    v_mfma_f32_32x32x16_bf16 v[32:47], a[8:11], v[72:75], v[32:47]
    v_mfma_f32_32x32x16_bf16 v[48:63], v[72:75], a[136:139], v[48:63]
    s_cmp_eq_u32 s59, 0
    s_cbranch_scc1 AH_67x_73_0
    s_waitcnt vmcnt(29)
    s_branch AH_67x_73_1
AH_67x_73_0:
    s_waitcnt vmcnt(28)
AH_67x_73_1:
    v_mfma_f32_32x32x16_bf16 v[32:47], a[12:15], v[76:79], v[32:47]
    v_mfma_f32_32x32x16_bf16 v[48:63], v[76:79], a[140:143], v[48:63]
    s_waitcnt vmcnt(27)
    v_mfma_f32_32x32x16_bf16 v[32:47], a[16:19], v[80:83], v[32:47]
    v_mfma_f32_32x32x16_bf16 v[48:63], v[80:83], a[144:147], v[48:63]
    s_waitcnt vmcnt(26)
    v_mfma_f32_32x32x16_bf16 v[32:47], a[20:23], v[84:87], v[32:47]
    v_mfma_f32_32x32x16_bf16 v[48:63], v[84:87], a[148:151], v[48:63]
    s_waitcnt vmcnt(25)
    v_mfma_f32_32x32x16_bf16 v[32:47], a[24:27], v[88:91], v[32:47]
    v_mfma_f32_32x32x16_bf16 v[48:63], v[88:91], a[152:155], v[48:63]
    s_waitcnt vmcnt(24)
    v_mfma_f32_32x32x16_bf16 v[32:47], a[28:31], v[92:95], v[32:47]
    v_mfma_f32_32x32x16_bf16 v[48:63], v[92:95], a[156:159], v[48:63]
    s_waitcnt vmcnt(23)
    v_mfma_f32_32x32x16_bf16 v[32:47], a[32:35], v[96:99], v[32:47]
    v_mfma_f32_32x32x16_bf16 v[48:63], v[96:99], a[160:163], v[48:63]
    s_waitcnt vmcnt(22)
    v_mfma_f32_32x32x16_bf16 v[32:47], a[36:39], v[100:103], v[32:47]
    v_mfma_f32_32x32x16_bf16 v[48:63], v[100:103], a[164:167], v[48:63]
    s_waitcnt vmcnt(21)
    v_mfma_f32_32x32x16_bf16 v[32:47], a[40:43], v[104:107], v[32:47]
    v_mfma_f32_32x32x16_bf16 v[48:63], v[104:107], a[168:171], v[48:63]
    s_waitcnt vmcnt(20)
    v_mfma_f32_32x32x16_bf16 v[32:47], a[44:47], v[108:111], v[32:47]
    v_mfma_f32_32x32x16_bf16 v[48:63], v[108:111], a[172:175], v[48:63]
    s_waitcnt vmcnt(19)
    v_mfma_f32_32x32x16_bf16 v[32:47], a[48:51], v[112:115], v[32:47]
    v_mfma_f32_32x32x16_bf16 v[48:63], v[112:115], a[176:179], v[48:63]
    s_waitcnt vmcnt(18)
    v_mfma_f32_32x32x16_bf16 v[32:47], a[52:55], v[116:119], v[32:47]
    v_mfma_f32_32x32x16_bf16 v[48:63], v[116:119], a[180:183], v[48:63]
    s_waitcnt vmcnt(17)
    s_cmp_eq_u32 s59, 0
    s_cbranch_scc1 AH_67_nf
    s_waitcnt vmcnt(0)
    v_mov_b32 v25, 1
    v_mov_b32 v24, 0
    s_mov_b64 exec, 1
    buffer_store_dword v25, v24, s[8:11], s46 offen sc1
    s_mov_b64 exec, -1
    s_add_u32 s46, s46, 256
    s_mov_b32 s59, 0
AH_67_nf:
    v_mfma_f32_32x32x16_bf16 v[32:47], a[56:59], v[120:123], v[32:47]
    v_mfma_f32_32x32x16_bf16 v[48:63], v[120:123], a[184:187], v[48:63]
    s_waitcnt vmcnt(16)
    v_mfma_f32_32x32x16_bf16 v[32:47], a[60:63], v[124:127], v[32:47]
    v_mfma_f32_32x32x16_bf16 v[48:63], v[124:127], a[188:191], v[48:63]
    s_waitcnt vmcnt(15)
    v_mfma_f32_32x32x16_bf16 v[32:47], a[64:67], v[128:131], v[32:47]
    v_mfma_f32_32x32x16_bf16 v[48:63], v[128:131], a[192:195], v[48:63]
    s_waitcnt vmcnt(14)
    v_mfma_f32_32x32x16_bf16 v[32:47], a[68:71], v[132:135], v[32:47]
    v_mfma_f32_32x32x16_bf16 v[48:63], v[132:135], a[196:199], v[48:63]
    s_waitcnt vmcnt(13)
    v_mfma_f32_32x32x16_bf16 v[32:47], a[72:75], v[136:139], v[32:47]
    v_mfma_f32_32x32x16_bf16 v[48:63], v[136:139], a[200:203], v[48:63]
    s_waitcnt vmcnt(12)
    v_mfma_f32_32x32x16_bf16 v[32:47], a[76:79], v[140:143], v[32:47]
    v_mfma_f32_32x32x16_bf16 v[48:63], v[140:143], a[204:207], v[48:63]
    s_waitcnt vmcnt(11)
    v_mfma_f32_32x32x16_bf16 v[32:47], a[80:83], v[144:147], v[32:47]
    v_mfma_f32_32x32x16_bf16 v[48:63], v[144:147], a[208:211], v[48:63]
    s_waitcnt vmcnt(10)
    v_mfma_f32_32x32x16_bf16 v[32:47], a[84:87], v[148:151], v[32:47]
    v_mfma_f32_32x32x16_bf16 v[48:63], v[148:151], a[212:215], v[48:63]
    s_waitcnt vmcnt(9)
    v_mfma_f32_32x32x16_bf16 v[32:47], a[88:91], v[152:155], v[32:47]
    v_mfma_f32_32x32x16_bf16 v[48:63], v[152:155], a[216:219], v[48:63]
    s_waitcnt vmcnt(8)
    v_mfma_f32_32x32x16_bf16 v[32:47], a[92:95], v[156:159], v[32:47]
    v_mfma_f32_32x32x16_bf16 v[48:63], v[156:159], a[220:223], v[48:63]
    s_waitcnt vmcnt(7)
    v_mfma_f32_32x32x16_bf16 v[32:47], a[96:99], v[160:163], v[32:47]
    v_mfma_f32_32x32x16_bf16 v[48:63], v[160:163], a[224:227], v[48:63]
    s_waitcnt vmcnt(6)
    v_mfma_f32_32x32x16_bf16 v[32:47], a[100:103], v[164:167], v[32:47]
    v_mfma_f32_32x32x16_bf16 v[48:63], v[164:167], a[228:231], v[48:63]
    s_waitcnt vmcnt(5)
    v_mfma_f32_32x32x16_bf16 v[32:47], a[104:107], v[168:171], v[32:47]
    v_mfma_f32_32x32x16_bf16 v[48:63], v[168:171], a[232:235], v[48:63]
    s_waitcnt vmcnt(4)
    v_mfma_f32_32x32x16_bf16 v[32:47], a[108:111], v[172:175], v[32:47]
    v_mfma_f32_32x32x16_bf16 v[48:63], v[172:175], a[236:239], v[48:63]
    s_waitcnt vmcnt(3)
    v_mfma_f32_32x32x16_bf16 v[32:47], a[112:115], v[176:179], v[32:47]
    v_mfma_f32_32x32x16_bf16 v[48:63], v[176:179], a[240:243], v[48:63]
    s_waitcnt vmcnt(2)
    v_mfma_f32_32x32x16_bf16 v[32:47], a[116:119], v[180:183], v[32:47]
    v_mfma_f32_32x32x16_bf16 v[48:63], v[180:183], a[244:247], v[48:63]
    s_waitcnt vmcnt(1)
    v_mfma_f32_32x32x16_bf16 v[32:47], a[120:123], v[184:187], v[32:47]
    v_mfma_f32_32x32x16_bf16 v[48:63], v[184:187], a[248:251], v[48:63]
    s_waitcnt vmcnt(0)
    v_mfma_f32_32x32x16_bf16 v[32:47], a[124:127], v[188:191], v[32:47]
    v_mfma_f32_32x32x16_bf16 v[48:63], v[188:191], a[252:255], v[48:63]
    v_mbcnt_lo_u32_b32 v24, -1, 0
    v_mbcnt_hi_u32_b32 v24, -1, v24
    v_min_u32 v24, 15, v24
    v_lshlrev_b32 v24, 2, v24
    buffer_load_dword v31, v24, s[8:11], s45 offen sc1
    s_nop 5
    v_cvt_pk_bf16_f32 v8, v32, v33
    v_cvt_pk_bf16_f32 v9, v34, v35
    v_cvt_pk_bf16_f32 v10, v36, v37
    v_cvt_pk_bf16_f32 v11, v38, v39
    v_cvt_pk_bf16_f32 v12, v40, v41
    v_cvt_pk_bf16_f32 v13, v42, v43
    v_cvt_pk_bf16_f32 v14, v44, v45
    v_cvt_pk_bf16_f32 v15, v46, v47
    v_cvt_pk_bf16_f32 v16, v48, v49
    v_cvt_pk_bf16_f32 v17, v50, v51
    v_cvt_pk_bf16_f32 v18, v52, v53
    v_cvt_pk_bf16_f32 v19, v54, v55
    v_cvt_pk_bf16_f32 v20, v56, v57
    v_cvt_pk_bf16_f32 v21, v58, v59
    v_cvt_pk_bf16_f32 v22, v60, v61
    v_cvt_pk_bf16_f32 v23, v62, v63
    v_cndmask_b32 v16, v16, v6, s[62:63]
    v_cndmask_b32 v17, v17, v6, s[62:63]
    v_cndmask_b32 v18, v18, v6, s[62:63]
    v_cndmask_b32 v19, v19, v6, s[62:63]
    v_cndmask_b32 v20, v20, v6, s[62:63]
    v_cndmask_b32 v21, v21, v6, s[62:63]
    v_cndmask_b32 v22, v22, v6, s[62:63]
    v_cndmask_b32 v23, v23, v6, s[62:63]
    s_and_b32 s32, s41, 15
    s_mul_i32 s32, s32, 3072
    s_add_u32 s32, s32, s42
    v_add_u32 v24, s32, v1
    ds_write_b128 v24, v[12:15]
    ds_write_b128 v24, v[16:19] offset:1024
    ds_write_b128 v24, v[20:23] offset:2048
    s_add_u32 s33, s41, 1
    v_mov_b32 v25, s33
    s_waitcnt lgkmcnt(0)
    ds_write_b32 v3, v25
    s_cmp_ge_u32 s41, 8
    s_cbranch_scc1 AH_67_fast
    s_mov_b32 s48, 0
AH_67_pw:
    ds_read_b32 v26, v4
    s_waitcnt lgkmcnt(0)
    v_readfirstlane_b32 s49, v26
    s_cmp_ge_u32 s49, s41
    s_cbranch_scc1 AH_67_pok
    s_add_u32 s48, s48, 1
    s_cmp_gt_u32 s48, 2400000
    s_cbranch_scc1 L_fail
    s_sleep 1
    s_branch AH_67_pw
AH_67_pok:
    s_add_u32 s32, s41, 8
    s_and_b32 s32, s32, 15
    s_mul_i32 s32, s32, 3072
    s_add_u32 s50, s32, s42
    s_add_u32 s32, s41, 9
    s_and_b32 s32, s32, 15
    s_mul_i32 s32, s32, 3072
    s_add_u32 s51, s32, s42
    s_add_u32 s32, s41, 10
    s_and_b32 s32, s32, 15
    s_mul_i32 s32, s32, 3072
    s_add_u32 s52, s32, s42
    s_add_u32 s32, s41, 11
    s_and_b32 s32, s32, 15
    s_mul_i32 s32, s32, 3072
    s_add_u32 s53, s32, s42
    s_add_u32 s32, s41, 12
    s_and_b32 s32, s32, 15
    s_mul_i32 s32, s32, 3072
    s_add_u32 s54, s32, s42
    s_add_u32 s32, s41, 13
    s_and_b32 s32, s32, 15
    s_mul_i32 s32, s32, 3072
    s_add_u32 s55, s32, s42
    s_add_u32 s32, s41, 14
    s_and_b32 s32, s32, 15
    s_mul_i32 s32, s32, 3072
    s_add_u32 s56, s32, s42
    s_add_u32 s32, s41, 15
    s_and_b32 s32, s32, 15
    s_mul_i32 s32, s32, 3072
    s_add_u32 s57, s32, s42
    s_add_u32 s32, s41, 16
    s_and_b32 s32, s32, 15
    s_mul_i32 s32, s32, 3072
    s_add_u32 s58, s32, s42
    s_add_u32 s32, s41, 0
    s_cmp_lt_u32 s32, 8
    s_cselect_b32 s50, s58, s50
    s_add_u32 s32, s41, 1
    s_cmp_lt_u32 s32, 8
    s_cselect_b32 s51, s58, s51
    s_add_u32 s32, s41, 2
    s_cmp_lt_u32 s32, 8
    s_cselect_b32 s52, s58, s52
    s_add_u32 s32, s41, 3
    s_cmp_lt_u32 s32, 8
    s_cselect_b32 s53, s58, s53
    s_add_u32 s32, s41, 4
    s_cmp_lt_u32 s32, 8
    s_cselect_b32 s54, s58, s54
    s_add_u32 s32, s41, 5
    s_cmp_lt_u32 s32, 8
    s_cselect_b32 s55, s58, s55
    s_add_u32 s32, s41, 6
    s_cmp_lt_u32 s32, 8
    s_cselect_b32 s56, s58, s56
    s_add_u32 s32, s41, 7
    s_cmp_lt_u32 s32, 8
    s_cselect_b32 s57, s58, s57
    v_add_u32 v24, s50, v1
    ds_read_b128 v[208:211], v24
    v_add_u32 v24, s51, v1
    ds_read_b128 v[212:215], v24
    v_add_u32 v24, s52, v1
    ds_read_b128 v[216:219], v24
    v_add_u32 v24, s53, v1
    ds_read_b128 v[220:223], v24
    v_add_u32 v24, s54, v1
    ds_read_b128 v[224:227], v24
    v_add_u32 v24, s55, v1
    ds_read_b128 v[228:231], v24
    v_add_u32 v24, s56, v1
    ds_read_b128 v[232:235], v24
    v_add_u32 v24, s57, v1
    ds_read_b128 v[236:239], v24
    v_add_u32 v24, s58, v1
    ds_read_b128 v[240:243], v24
    s_waitcnt lgkmcnt(8)
    v_mfma_f32_32x32x16_bf16 v[64:79], v[208:211], v[8:11], 0
    s_waitcnt lgkmcnt(7)
    v_mfma_f32_32x32x16_bf16 v[80:95], v[212:215], v[8:11], 0
    s_waitcnt lgkmcnt(6)
    v_mfma_f32_32x32x16_bf16 v[96:111], v[216:219], v[8:11], 0
    s_waitcnt lgkmcnt(5)
    v_mfma_f32_32x32x16_bf16 v[112:127], v[220:223], v[8:11], 0
    s_waitcnt lgkmcnt(4)
    v_mfma_f32_32x32x16_bf16 v[128:143], v[224:227], v[8:11], 0
    s_waitcnt lgkmcnt(3)
    v_mfma_f32_32x32x16_bf16 v[144:159], v[228:231], v[8:11], 0
    s_waitcnt lgkmcnt(2)
    v_mfma_f32_32x32x16_bf16 v[160:175], v[232:235], v[8:11], 0
    s_waitcnt lgkmcnt(1)
    v_mfma_f32_32x32x16_bf16 v[176:191], v[236:239], v[8:11], 0
    s_waitcnt lgkmcnt(0)
    v_mfma_f32_32x32x16_bf16 v[192:207], v[240:243], v[8:11], 0
    s_cmp_ge_u32 s41, 8
    s_cbranch_scc1 AH_67_allv
    s_add_u32 s32, s41, 0
    s_cmp_ge_u32 s32, 8
    s_cbranch_scc1 AH_67iv_74
    v_mov_b32 v64, v7
    v_mov_b32 v65, v7
    v_mov_b32 v66, v7
    v_mov_b32 v67, v7
    v_mov_b32 v68, v7
    v_mov_b32 v69, v7
    v_mov_b32 v70, v7
    v_mov_b32 v71, v7
    v_mov_b32 v72, v7
    v_mov_b32 v73, v7
    v_mov_b32 v74, v7
    v_mov_b32 v75, v7
    v_mov_b32 v76, v7
    v_mov_b32 v77, v7
    v_mov_b32 v78, v7
    v_mov_b32 v79, v7
AH_67iv_74:
    s_add_u32 s32, s41, 1
    s_cmp_ge_u32 s32, 8
    s_cbranch_scc1 AH_67iv_75
    v_mov_b32 v80, v7
    v_mov_b32 v81, v7
    v_mov_b32 v82, v7
    v_mov_b32 v83, v7
    v_mov_b32 v84, v7
    v_mov_b32 v85, v7
    v_mov_b32 v86, v7
    v_mov_b32 v87, v7
    v_mov_b32 v88, v7
    v_mov_b32 v89, v7
    v_mov_b32 v90, v7
    v_mov_b32 v91, v7
    v_mov_b32 v92, v7
    v_mov_b32 v93, v7
    v_mov_b32 v94, v7
    v_mov_b32 v95, v7
AH_67iv_75:
    s_add_u32 s32, s41, 2
    s_cmp_ge_u32 s32, 8
    s_cbranch_scc1 AH_67iv_76
    v_mov_b32 v96, v7
    v_mov_b32 v97, v7
    v_mov_b32 v98, v7
    v_mov_b32 v99, v7
    v_mov_b32 v100, v7
    v_mov_b32 v101, v7
    v_mov_b32 v102, v7
    v_mov_b32 v103, v7
    v_mov_b32 v104, v7
    v_mov_b32 v105, v7
    v_mov_b32 v106, v7
    v_mov_b32 v107, v7
    v_mov_b32 v108, v7
    v_mov_b32 v109, v7
    v_mov_b32 v110, v7
    v_mov_b32 v111, v7
AH_67iv_76:
    s_add_u32 s32, s41, 3
    s_cmp_ge_u32 s32, 8
    s_cbranch_scc1 AH_67iv_77
    v_mov_b32 v112, v7
    v_mov_b32 v113, v7
    v_mov_b32 v114, v7
    v_mov_b32 v115, v7
    v_mov_b32 v116, v7
    v_mov_b32 v117, v7
    v_mov_b32 v118, v7
    v_mov_b32 v119, v7
    v_mov_b32 v120, v7
    v_mov_b32 v121, v7
    v_mov_b32 v122, v7
    v_mov_b32 v123, v7
    v_mov_b32 v124, v7
    v_mov_b32 v125, v7
    v_mov_b32 v126, v7
    v_mov_b32 v127, v7
AH_67iv_77:
    s_add_u32 s32, s41, 4
    s_cmp_ge_u32 s32, 8
    s_cbranch_scc1 AH_67iv_78
    v_mov_b32 v128, v7
    v_mov_b32 v129, v7
    v_mov_b32 v130, v7
    v_mov_b32 v131, v7
    v_mov_b32 v132, v7
    v_mov_b32 v133, v7
    v_mov_b32 v134, v7
    v_mov_b32 v135, v7
    v_mov_b32 v136, v7
    v_mov_b32 v137, v7
    v_mov_b32 v138, v7
    v_mov_b32 v139, v7
    v_mov_b32 v140, v7
    v_mov_b32 v141, v7
    v_mov_b32 v142, v7
    v_mov_b32 v143, v7
AH_67iv_78:
    s_add_u32 s32, s41, 5
    s_cmp_ge_u32 s32, 8
    s_cbranch_scc1 AH_67iv_79
    v_mov_b32 v144, v7
    v_mov_b32 v145, v7
    v_mov_b32 v146, v7
    v_mov_b32 v147, v7
    v_mov_b32 v148, v7
    v_mov_b32 v149, v7
    v_mov_b32 v150, v7
    v_mov_b32 v151, v7
    v_mov_b32 v152, v7
    v_mov_b32 v153, v7
    v_mov_b32 v154, v7
    v_mov_b32 v155, v7
    v_mov_b32 v156, v7
    v_mov_b32 v157, v7
    v_mov_b32 v158, v7
    v_mov_b32 v159, v7
AH_67iv_79:
    s_add_u32 s32, s41, 6
    s_cmp_ge_u32 s32, 8
    s_cbranch_scc1 AH_67iv_80
    v_mov_b32 v160, v7
    v_mov_b32 v161, v7
    v_mov_b32 v162, v7
    v_mov_b32 v163, v7
    v_mov_b32 v164, v7
    v_mov_b32 v165, v7
    v_mov_b32 v166, v7
    v_mov_b32 v167, v7
    v_mov_b32 v168, v7
    v_mov_b32 v169, v7
    v_mov_b32 v170, v7
    v_mov_b32 v171, v7
    v_mov_b32 v172, v7
    v_mov_b32 v173, v7
    v_mov_b32 v174, v7
    v_mov_b32 v175, v7
AH_67iv_80:
    s_add_u32 s32, s41, 7
    s_cmp_ge_u32 s32, 8
    s_cbranch_scc1 AH_67iv_81
    v_mov_b32 v176, v7
    v_mov_b32 v177, v7
    v_mov_b32 v178, v7
    v_mov_b32 v179, v7
    v_mov_b32 v180, v7
    v_mov_b32 v181, v7
    v_mov_b32 v182, v7
    v_mov_b32 v183, v7
    v_mov_b32 v184, v7
    v_mov_b32 v185, v7
    v_mov_b32 v186, v7
    v_mov_b32 v187, v7
    v_mov_b32 v188, v7
    v_mov_b32 v189, v7
    v_mov_b32 v190, v7
    v_mov_b32 v191, v7
AH_67iv_81:
AH_67_allv:
    v_add_u32 v26, s50, v1
    ds_read_b128 v[208:211], v26 offset:1024
    ds_read_b128 v[212:215], v26 offset:2048
    v_add_u32 v26, s51, v1
    ds_read_b128 v[216:219], v26 offset:1024
    ds_read_b128 v[220:223], v26 offset:2048
    s_nop 3
    v_cndmask_b32 v192, v7, v192, s[64:65]
    v_cndmask_b32 v193, v7, v193, s[66:67]
    v_cndmask_b32 v194, v7, v194, s[68:69]
    v_cndmask_b32 v195, v7, v195, s[70:71]
    v_cndmask_b32 v196, v7, v196, s[72:73]
    v_cndmask_b32 v197, v7, v197, s[74:75]
    v_cndmask_b32 v198, v7, v198, s[76:77]
    v_cndmask_b32 v199, v7, v199, s[78:79]
    v_cndmask_b32 v200, v7, v200, s[80:81]
    v_cndmask_b32 v201, v7, v201, s[82:83]
    v_cndmask_b32 v202, v7, v202, s[84:85]
    v_cndmask_b32 v203, v7, v203, s[86:87]
    v_cndmask_b32 v204, v7, v204, s[88:89]
    v_cndmask_b32 v205, v7, v205, s[90:91]
    v_cndmask_b32 v206, v7, v206, s[92:93]
    v_cndmask_b32 v207, v7, v207, s[94:95]
    v_cndmask_b32 v64, v64, v7, s[64:65]
    v_cndmask_b32 v65, v65, v7, s[66:67]
    v_cndmask_b32 v66, v66, v7, s[68:69]
    v_cndmask_b32 v67, v67, v7, s[70:71]
    v_cndmask_b32 v68, v68, v7, s[72:73]
    v_cndmask_b32 v69, v69, v7, s[74:75]
    v_cndmask_b32 v70, v70, v7, s[76:77]
    v_cndmask_b32 v71, v71, v7, s[78:79]
    v_cndmask_b32 v72, v72, v7, s[80:81]
    v_cndmask_b32 v73, v73, v7, s[82:83]
    v_cndmask_b32 v74, v74, v7, s[84:85]
    v_cndmask_b32 v75, v75, v7, s[86:87]
    v_cndmask_b32 v76, v76, v7, s[88:89]
    v_cndmask_b32 v77, v77, v7, s[90:91]
    v_cndmask_b32 v78, v78, v7, s[92:93]
    v_cndmask_b32 v79, v79, v7, s[94:95]
    v_max3_f32 v24, v64, v65, v66
    v_max3_f32 v25, v67, v68, v69
    v_max3_f32 v24, v24, v70, v71
    v_max3_f32 v25, v25, v72, v73
    v_max3_f32 v24, v24, v74, v75
    v_max3_f32 v25, v25, v76, v77
    v_max3_f32 v24, v24, v78, v79
    v_max3_f32 v25, v25, v80, v81
    v_max3_f32 v24, v24, v82, v83
    v_max3_f32 v25, v25, v84, v85
    v_max3_f32 v24, v24, v86, v87
    v_max3_f32 v25, v25, v88, v89
    v_max3_f32 v24, v24, v90, v91
    v_max3_f32 v25, v25, v92, v93
    v_max3_f32 v24, v24, v94, v95
    v_max3_f32 v25, v25, v96, v97
    v_max3_f32 v24, v24, v98, v99
    v_max3_f32 v25, v25, v100, v101
    v_max3_f32 v24, v24, v102, v103
    v_max3_f32 v25, v25, v104, v105
    v_max3_f32 v24, v24, v106, v107
    v_max3_f32 v25, v25, v108, v109
    v_max3_f32 v24, v24, v110, v111
    v_max3_f32 v25, v25, v112, v113
    v_max3_f32 v24, v24, v114, v115
    v_max3_f32 v25, v25, v116, v117
    v_max3_f32 v24, v24, v118, v119
    v_max3_f32 v25, v25, v120, v121
    v_max3_f32 v24, v24, v122, v123
    v_max3_f32 v25, v25, v124, v125
    v_max3_f32 v24, v24, v126, v127
    v_max3_f32 v25, v25, v128, v129
    v_max3_f32 v24, v24, v130, v131
    v_max3_f32 v25, v25, v132, v133
    v_max3_f32 v24, v24, v134, v135
    v_max3_f32 v25, v25, v136, v137
    v_max3_f32 v24, v24, v138, v139
    v_max3_f32 v25, v25, v140, v141
    v_max3_f32 v24, v24, v142, v143
    v_max3_f32 v25, v25, v144, v145
    v_max3_f32 v24, v24, v146, v147
    v_max3_f32 v25, v25, v148, v149
    v_max3_f32 v24, v24, v150, v151
    v_max3_f32 v25, v25, v152, v153
    v_max3_f32 v24, v24, v154, v155
    v_max3_f32 v25, v25, v156, v157
    v_max3_f32 v24, v24, v158, v159
    v_max3_f32 v25, v25, v160, v161
    v_max3_f32 v24, v24, v162, v163
    v_max3_f32 v25, v25, v164, v165
    v_max3_f32 v24, v24, v166, v167
    v_max3_f32 v25, v25, v168, v169
    v_max3_f32 v24, v24, v170, v171
    v_max3_f32 v25, v25, v172, v173
    v_max3_f32 v24, v24, v174, v175
    v_max3_f32 v25, v25, v176, v177
    v_max3_f32 v24, v24, v178, v179
    v_max3_f32 v25, v25, v180, v181
    v_max3_f32 v24, v24, v182, v183
    v_max3_f32 v25, v25, v184, v185
    v_max3_f32 v24, v24, v186, v187
    v_max3_f32 v25, v25, v188, v189
    v_max3_f32 v24, v24, v190, v191
    v_max3_f32 v25, v25, v192, v193
    v_max3_f32 v24, v24, v194, v195
    v_max3_f32 v25, v25, v196, v197
    v_max3_f32 v24, v24, v198, v199
    v_max3_f32 v25, v25, v200, v201
    v_max3_f32 v24, v24, v202, v203
    v_max3_f32 v25, v25, v204, v205
    v_max3_f32 v24, v24, v206, v207
    v_max_f32 v24, v24, v25
    v_mov_b32 v25, v24
    s_nop 1
    v_permlane32_swap_b32 v24, v25
    v_max_f32 v24, v24, v25
    v_mul_f32 v24, s47, v24
    v_mov_b32 v25, v24
    s_waitcnt vmcnt(0)
    s_mov_b32 s48, 0
    s_cmp_ge_u32 s41, 62
    s_cbranch_scc1 AH_67_np
    v_cmp_eq_u32 vcc, 0, v31
    s_cbranch_vccnz AH_67_np
    s_mov_b32 s48, 1
AH_67_np:
    v_mov_b64 v[32:33], 0
    v_mov_b64 v[34:35], 0
    v_mov_b64 v[36:37], 0
    v_mov_b64 v[38:39], 0
    v_mov_b64 v[40:41], 0
    v_mov_b64 v[42:43], 0
    v_mov_b64 v[44:45], 0
    v_mov_b64 v[46:47], 0
    s_add_u32 s32, s41, 0
    s_cmp_lt_u32 s32, 8
    s_cbranch_scc1 AH_67k_82
    v_fma_f32 v64, v64, s47, -v24
    v_fma_f32 v65, v65, s47, -v24
    v_fma_f32 v66, v66, s47, -v24
    v_fma_f32 v67, v67, s47, -v24
    v_fma_f32 v68, v68, s47, -v24
    v_fma_f32 v69, v69, s47, -v24
    v_fma_f32 v70, v70, s47, -v24
    v_fma_f32 v71, v71, s47, -v24
    v_fma_f32 v72, v72, s47, -v24
    v_fma_f32 v73, v73, s47, -v24
    v_fma_f32 v74, v74, s47, -v24
    v_fma_f32 v75, v75, s47, -v24
    v_fma_f32 v76, v76, s47, -v24
    v_fma_f32 v77, v77, s47, -v24
    v_fma_f32 v78, v78, s47, -v24
    v_fma_f32 v79, v79, s47, -v24
    v_exp_f32 v64, v64
    v_exp_f32 v65, v65
    v_exp_f32 v66, v66
    v_exp_f32 v67, v67
    v_exp_f32 v68, v68
    v_exp_f32 v69, v69
    v_exp_f32 v70, v70
    v_exp_f32 v71, v71
    v_exp_f32 v72, v72
    v_exp_f32 v73, v73
    v_exp_f32 v74, v74
    v_exp_f32 v75, v75
    v_exp_f32 v76, v76
    v_exp_f32 v77, v77
    v_exp_f32 v78, v78
    v_exp_f32 v79, v79
    v_cvt_pk_bf16_f32 v240, v64, v65
    v_cvt_pk_bf16_f32 v241, v66, v67
    v_cvt_pk_bf16_f32 v242, v68, v69
    v_cvt_pk_bf16_f32 v243, v70, v71
    v_cvt_pk_bf16_f32 v244, v72, v73
    v_cvt_pk_bf16_f32 v245, v74, v75
    v_cvt_pk_bf16_f32 v246, v76, v77
    v_cvt_pk_bf16_f32 v247, v78, v79
    s_waitcnt lgkmcnt(2)
    v_mfma_f32_32x32x16_bf16 v[32:47], v[208:211], v[240:243], v[32:47]
    v_mfma_f32_32x32x16_bf16 v[32:47], v[212:215], v[244:247], v[32:47]
AH_67k_82:
    s_waitcnt lgkmcnt(2)
    v_add_u32 v26, s52, v1
    ds_read_b128 v[224:227], v26 offset:1024
    ds_read_b128 v[228:231], v26 offset:2048
    s_cmp_eq_u32 s48, 0
    s_cbranch_scc1 AH_67s_83
    s_add_u32 s32, s43, 0
    buffer_load_dwordx4 v[64:67], v1, s[8:11], s32 offen offset:0 sc1
    s_add_u32 s32, s43, 0
    buffer_load_dwordx4 v[68:71], v1, s[8:11], s32 offen offset:1024 sc1
    s_add_u32 s32, s43, 0
    buffer_load_dwordx4 v[72:75], v1, s[8:11], s32 offen offset:2048 sc1
    s_add_u32 s32, s43, 0
    buffer_load_dwordx4 v[76:79], v1, s[8:11], s32 offen offset:3072 sc1
AH_67s_83:
    s_add_u32 s32, s41, 1
    s_cmp_lt_u32 s32, 8
    s_cbranch_scc1 AH_67k_84
    v_fma_f32 v80, v80, s47, -v24
    v_fma_f32 v81, v81, s47, -v24
    v_fma_f32 v82, v82, s47, -v24
    v_fma_f32 v83, v83, s47, -v24
    v_fma_f32 v84, v84, s47, -v24
    v_fma_f32 v85, v85, s47, -v24
    v_fma_f32 v86, v86, s47, -v24
    v_fma_f32 v87, v87, s47, -v24
    v_fma_f32 v88, v88, s47, -v24
    v_fma_f32 v89, v89, s47, -v24
    v_fma_f32 v90, v90, s47, -v24
    v_fma_f32 v91, v91, s47, -v24
    v_fma_f32 v92, v92, s47, -v24
    v_fma_f32 v93, v93, s47, -v24
    v_fma_f32 v94, v94, s47, -v24
    v_fma_f32 v95, v95, s47, -v24
    v_exp_f32 v80, v80
    v_exp_f32 v81, v81
    v_exp_f32 v82, v82
    v_exp_f32 v83, v83
    v_exp_f32 v84, v84
    v_exp_f32 v85, v85
    v_exp_f32 v86, v86
    v_exp_f32 v87, v87
    v_exp_f32 v88, v88
    v_exp_f32 v89, v89
    v_exp_f32 v90, v90
    v_exp_f32 v91, v91
    v_exp_f32 v92, v92
    v_exp_f32 v93, v93
    v_exp_f32 v94, v94
    v_exp_f32 v95, v95
    v_cvt_pk_bf16_f32 v12, v80, v81
    v_cvt_pk_bf16_f32 v13, v82, v83
    v_cvt_pk_bf16_f32 v14, v84, v85
    v_cvt_pk_bf16_f32 v15, v86, v87
    v_cvt_pk_bf16_f32 v16, v88, v89
    v_cvt_pk_bf16_f32 v17, v90, v91
    v_cvt_pk_bf16_f32 v18, v92, v93
    v_cvt_pk_bf16_f32 v19, v94, v95
    s_waitcnt lgkmcnt(2)
    v_mfma_f32_32x32x16_bf16 v[32:47], v[216:219], v[12:15], v[32:47]
    v_mfma_f32_32x32x16_bf16 v[32:47], v[220:223], v[16:19], v[32:47]
AH_67k_84:
    s_waitcnt lgkmcnt(2)
    v_add_u32 v26, s53, v1
    ds_read_b128 v[208:211], v26 offset:1024
    ds_read_b128 v[212:215], v26 offset:2048
    s_cmp_eq_u32 s48, 0
    s_cbranch_scc1 AH_67s_85
    s_add_u32 s32, s43, 4096
    buffer_load_dwordx4 v[80:83], v1, s[8:11], s32 offen offset:0 sc1
    s_add_u32 s32, s43, 4096
    buffer_load_dwordx4 v[84:87], v1, s[8:11], s32 offen offset:1024 sc1
    s_add_u32 s32, s43, 4096
    buffer_load_dwordx4 v[88:91], v1, s[8:11], s32 offen offset:2048 sc1
    s_add_u32 s32, s43, 4096
    buffer_load_dwordx4 v[92:95], v1, s[8:11], s32 offen offset:3072 sc1
AH_67s_85:
    s_add_u32 s32, s41, 2
    s_cmp_lt_u32 s32, 8
    s_cbranch_scc1 AH_67k_86
    v_fma_f32 v96, v96, s47, -v24
    v_fma_f32 v97, v97, s47, -v24
    v_fma_f32 v98, v98, s47, -v24
    v_fma_f32 v99, v99, s47, -v24
    v_fma_f32 v100, v100, s47, -v24
    v_fma_f32 v101, v101, s47, -v24
    v_fma_f32 v102, v102, s47, -v24
    v_fma_f32 v103, v103, s47, -v24
    v_fma_f32 v104, v104, s47, -v24
    v_fma_f32 v105, v105, s47, -v24
    v_fma_f32 v106, v106, s47, -v24
    v_fma_f32 v107, v107, s47, -v24
    v_fma_f32 v108, v108, s47, -v24
    v_fma_f32 v109, v109, s47, -v24
    v_fma_f32 v110, v110, s47, -v24
    v_fma_f32 v111, v111, s47, -v24
    v_exp_f32 v96, v96
    v_exp_f32 v97, v97
    v_exp_f32 v98, v98
    v_exp_f32 v99, v99
    v_exp_f32 v100, v100
    v_exp_f32 v101, v101
    v_exp_f32 v102, v102
    v_exp_f32 v103, v103
    v_exp_f32 v104, v104
    v_exp_f32 v105, v105
    v_exp_f32 v106, v106
    v_exp_f32 v107, v107
    v_exp_f32 v108, v108
    v_exp_f32 v109, v109
    v_exp_f32 v110, v110
    v_exp_f32 v111, v111
    v_cvt_pk_bf16_f32 v240, v96, v97
    v_cvt_pk_bf16_f32 v241, v98, v99
    v_cvt_pk_bf16_f32 v242, v100, v101
    v_cvt_pk_bf16_f32 v243, v102, v103
    v_cvt_pk_bf16_f32 v244, v104, v105
    v_cvt_pk_bf16_f32 v245, v106, v107
    v_cvt_pk_bf16_f32 v246, v108, v109
    v_cvt_pk_bf16_f32 v247, v110, v111
    s_waitcnt lgkmcnt(2)
    v_mfma_f32_32x32x16_bf16 v[32:47], v[224:227], v[240:243], v[32:47]
    v_mfma_f32_32x32x16_bf16 v[32:47], v[228:231], v[244:247], v[32:47]
AH_67k_86:
    s_waitcnt lgkmcnt(2)
    v_add_u32 v26, s54, v1
    ds_read_b128 v[216:219], v26 offset:1024
    ds_read_b128 v[220:223], v26 offset:2048
    s_cmp_eq_u32 s48, 0
    s_cbranch_scc1 AH_67s_87
    s_add_u32 s32, s43, 8192
    buffer_load_dwordx4 v[96:99], v1, s[8:11], s32 offen offset:0 sc1
    s_add_u32 s32, s43, 8192
    buffer_load_dwordx4 v[100:103], v1, s[8:11], s32 offen offset:1024 sc1
    s_add_u32 s32, s43, 8192
    buffer_load_dwordx4 v[104:107], v1, s[8:11], s32 offen offset:2048 sc1
    s_add_u32 s32, s43, 8192
    buffer_load_dwordx4 v[108:111], v1, s[8:11], s32 offen offset:3072 sc1
AH_67s_87:
    s_add_u32 s32, s41, 3
    s_cmp_lt_u32 s32, 8
    s_cbranch_scc1 AH_67k_88
    v_fma_f32 v112, v112, s47, -v24
    v_fma_f32 v113, v113, s47, -v24
    v_fma_f32 v114, v114, s47, -v24
    v_fma_f32 v115, v115, s47, -v24
    v_fma_f32 v116, v116, s47, -v24
    v_fma_f32 v117, v117, s47, -v24
    v_fma_f32 v118, v118, s47, -v24
    v_fma_f32 v119, v119, s47, -v24
    v_fma_f32 v120, v120, s47, -v24
    v_fma_f32 v121, v121, s47, -v24
    v_fma_f32 v122, v122, s47, -v24
    v_fma_f32 v123, v123, s47, -v24
    v_fma_f32 v124, v124, s47, -v24
    v_fma_f32 v125, v125, s47, -v24
    v_fma_f32 v126, v126, s47, -v24
    v_fma_f32 v127, v127, s47, -v24
    v_exp_f32 v112, v112
    v_exp_f32 v113, v113
    v_exp_f32 v114, v114
    v_exp_f32 v115, v115
    v_exp_f32 v116, v116
    v_exp_f32 v117, v117
    v_exp_f32 v118, v118
    v_exp_f32 v119, v119
    v_exp_f32 v120, v120
    v_exp_f32 v121, v121
    v_exp_f32 v122, v122
    v_exp_f32 v123, v123
    v_exp_f32 v124, v124
    v_exp_f32 v125, v125
    v_exp_f32 v126, v126
    v_exp_f32 v127, v127
    v_cvt_pk_bf16_f32 v12, v112, v113
    v_cvt_pk_bf16_f32 v13, v114, v115
    v_cvt_pk_bf16_f32 v14, v116, v117
    v_cvt_pk_bf16_f32 v15, v118, v119
    v_cvt_pk_bf16_f32 v16, v120, v121
    v_cvt_pk_bf16_f32 v17, v122, v123
    v_cvt_pk_bf16_f32 v18, v124, v125
    v_cvt_pk_bf16_f32 v19, v126, v127
    s_waitcnt lgkmcnt(2)
    v_mfma_f32_32x32x16_bf16 v[32:47], v[208:211], v[12:15], v[32:47]
    v_mfma_f32_32x32x16_bf16 v[32:47], v[212:215], v[16:19], v[32:47]
AH_67k_88:
    s_waitcnt lgkmcnt(2)
    v_add_u32 v26, s55, v1
    ds_read_b128 v[224:227], v26 offset:1024
    ds_read_b128 v[228:231], v26 offset:2048
    s_cmp_eq_u32 s48, 0
    s_cbranch_scc1 AH_67s_89
    s_add_u32 s32, s43, 12288
    buffer_load_dwordx4 v[112:115], v1, s[8:11], s32 offen offset:0 sc1
    s_add_u32 s32, s43, 12288
    buffer_load_dwordx4 v[116:119], v1, s[8:11], s32 offen offset:1024 sc1
    s_add_u32 s32, s43, 12288
    buffer_load_dwordx4 v[120:123], v1, s[8:11], s32 offen offset:2048 sc1
    s_add_u32 s32, s43, 12288
    buffer_load_dwordx4 v[124:127], v1, s[8:11], s32 offen offset:3072 sc1
AH_67s_89:
    s_add_u32 s32, s41, 4
    s_cmp_lt_u32 s32, 8
    s_cbranch_scc1 AH_67k_90
    v_fma_f32 v128, v128, s47, -v24
    v_fma_f32 v129, v129, s47, -v24
    v_fma_f32 v130, v130, s47, -v24
    v_fma_f32 v131, v131, s47, -v24
    v_fma_f32 v132, v132, s47, -v24
    v_fma_f32 v133, v133, s47, -v24
    v_fma_f32 v134, v134, s47, -v24
    v_fma_f32 v135, v135, s47, -v24
    v_fma_f32 v136, v136, s47, -v24
    v_fma_f32 v137, v137, s47, -v24
    v_fma_f32 v138, v138, s47, -v24
    v_fma_f32 v139, v139, s47, -v24
    v_fma_f32 v140, v140, s47, -v24
    v_fma_f32 v141, v141, s47, -v24
    v_fma_f32 v142, v142, s47, -v24
    v_fma_f32 v143, v143, s47, -v24
    v_exp_f32 v128, v128
    v_exp_f32 v129, v129
    v_exp_f32 v130, v130
    v_exp_f32 v131, v131
    v_exp_f32 v132, v132
    v_exp_f32 v133, v133
    v_exp_f32 v134, v134
    v_exp_f32 v135, v135
    v_exp_f32 v136, v136
    v_exp_f32 v137, v137
    v_exp_f32 v138, v138
    v_exp_f32 v139, v139
    v_exp_f32 v140, v140
    v_exp_f32 v141, v141
    v_exp_f32 v142, v142
    v_exp_f32 v143, v143
    v_cvt_pk_bf16_f32 v240, v128, v129
    v_cvt_pk_bf16_f32 v241, v130, v131
    v_cvt_pk_bf16_f32 v242, v132, v133
    v_cvt_pk_bf16_f32 v243, v134, v135
    v_cvt_pk_bf16_f32 v244, v136, v137
    v_cvt_pk_bf16_f32 v245, v138, v139
    v_cvt_pk_bf16_f32 v246, v140, v141
    v_cvt_pk_bf16_f32 v247, v142, v143
    s_waitcnt lgkmcnt(2)
    v_mfma_f32_32x32x16_bf16 v[32:47], v[216:219], v[240:243], v[32:47]
    v_mfma_f32_32x32x16_bf16 v[32:47], v[220:223], v[244:247], v[32:47]
AH_67k_90:
    s_waitcnt lgkmcnt(2)
    v_add_u32 v26, s56, v1
    ds_read_b128 v[208:211], v26 offset:1024
    ds_read_b128 v[212:215], v26 offset:2048
    s_cmp_eq_u32 s48, 0
    s_cbranch_scc1 AH_67s_91
    s_add_u32 s32, s43, 16384
    buffer_load_dwordx4 v[128:131], v1, s[8:11], s32 offen offset:0 sc1
    s_add_u32 s32, s43, 16384
    buffer_load_dwordx4 v[132:135], v1, s[8:11], s32 offen offset:1024 sc1
    s_add_u32 s32, s43, 16384
    buffer_load_dwordx4 v[136:139], v1, s[8:11], s32 offen offset:2048 sc1
    s_add_u32 s32, s43, 16384
    buffer_load_dwordx4 v[140:143], v1, s[8:11], s32 offen offset:3072 sc1
AH_67s_91:
    s_add_u32 s32, s41, 5
    s_cmp_lt_u32 s32, 8
    s_cbranch_scc1 AH_67k_92
    v_fma_f32 v144, v144, s47, -v24
    v_fma_f32 v145, v145, s47, -v24
    v_fma_f32 v146, v146, s47, -v24
    v_fma_f32 v147, v147, s47, -v24
    v_fma_f32 v148, v148, s47, -v24
    v_fma_f32 v149, v149, s47, -v24
    v_fma_f32 v150, v150, s47, -v24
    v_fma_f32 v151, v151, s47, -v24
    v_fma_f32 v152, v152, s47, -v24
    v_fma_f32 v153, v153, s47, -v24
    v_fma_f32 v154, v154, s47, -v24
    v_fma_f32 v155, v155, s47, -v24
    v_fma_f32 v156, v156, s47, -v24
    v_fma_f32 v157, v157, s47, -v24
    v_fma_f32 v158, v158, s47, -v24
    v_fma_f32 v159, v159, s47, -v24
    v_exp_f32 v144, v144
    v_exp_f32 v145, v145
    v_exp_f32 v146, v146
    v_exp_f32 v147, v147
    v_exp_f32 v148, v148
    v_exp_f32 v149, v149
    v_exp_f32 v150, v150
    v_exp_f32 v151, v151
    v_exp_f32 v152, v152
    v_exp_f32 v153, v153
    v_exp_f32 v154, v154
    v_exp_f32 v155, v155
    v_exp_f32 v156, v156
    v_exp_f32 v157, v157
    v_exp_f32 v158, v158
    v_exp_f32 v159, v159
    v_cvt_pk_bf16_f32 v12, v144, v145
    v_cvt_pk_bf16_f32 v13, v146, v147
    v_cvt_pk_bf16_f32 v14, v148, v149
    v_cvt_pk_bf16_f32 v15, v150, v151
    v_cvt_pk_bf16_f32 v16, v152, v153
    v_cvt_pk_bf16_f32 v17, v154, v155
    v_cvt_pk_bf16_f32 v18, v156, v157
    v_cvt_pk_bf16_f32 v19, v158, v159
    s_waitcnt lgkmcnt(2)
    v_mfma_f32_32x32x16_bf16 v[32:47], v[224:227], v[12:15], v[32:47]
    v_mfma_f32_32x32x16_bf16 v[32:47], v[228:231], v[16:19], v[32:47]
AH_67k_92:
    s_waitcnt lgkmcnt(2)
    v_add_u32 v26, s57, v1
    ds_read_b128 v[216:219], v26 offset:1024
    ds_read_b128 v[220:223], v26 offset:2048
    s_cmp_eq_u32 s48, 0
    s_cbranch_scc1 AH_67s_93
    s_add_u32 s32, s43, 20480
    buffer_load_dwordx4 v[144:147], v1, s[8:11], s32 offen offset:0 sc1
    s_add_u32 s32, s43, 20480
    buffer_load_dwordx4 v[148:151], v1, s[8:11], s32 offen offset:1024 sc1
    s_add_u32 s32, s43, 20480
    buffer_load_dwordx4 v[152:155], v1, s[8:11], s32 offen offset:2048 sc1
    s_add_u32 s32, s43, 20480
    buffer_load_dwordx4 v[156:159], v1, s[8:11], s32 offen offset:3072 sc1
AH_67s_93:
    s_add_u32 s32, s41, 6
    s_cmp_lt_u32 s32, 8
    s_cbranch_scc1 AH_67k_94
    v_fma_f32 v160, v160, s47, -v24
    v_fma_f32 v161, v161, s47, -v24
    v_fma_f32 v162, v162, s47, -v24
    v_fma_f32 v163, v163, s47, -v24
    v_fma_f32 v164, v164, s47, -v24
    v_fma_f32 v165, v165, s47, -v24
    v_fma_f32 v166, v166, s47, -v24
    v_fma_f32 v167, v167, s47, -v24
    v_fma_f32 v168, v168, s47, -v24
    v_fma_f32 v169, v169, s47, -v24
    v_fma_f32 v170, v170, s47, -v24
    v_fma_f32 v171, v171, s47, -v24
    v_fma_f32 v172, v172, s47, -v24
    v_fma_f32 v173, v173, s47, -v24
    v_fma_f32 v174, v174, s47, -v24
    v_fma_f32 v175, v175, s47, -v24
    v_exp_f32 v160, v160
    v_exp_f32 v161, v161
    v_exp_f32 v162, v162
    v_exp_f32 v163, v163
    v_exp_f32 v164, v164
    v_exp_f32 v165, v165
    v_exp_f32 v166, v166
    v_exp_f32 v167, v167
    v_exp_f32 v168, v168
    v_exp_f32 v169, v169
    v_exp_f32 v170, v170
    v_exp_f32 v171, v171
    v_exp_f32 v172, v172
    v_exp_f32 v173, v173
    v_exp_f32 v174, v174
    v_exp_f32 v175, v175
    v_cvt_pk_bf16_f32 v240, v160, v161
    v_cvt_pk_bf16_f32 v241, v162, v163
    v_cvt_pk_bf16_f32 v242, v164, v165
    v_cvt_pk_bf16_f32 v243, v166, v167
    v_cvt_pk_bf16_f32 v244, v168, v169
    v_cvt_pk_bf16_f32 v245, v170, v171
    v_cvt_pk_bf16_f32 v246, v172, v173
    v_cvt_pk_bf16_f32 v247, v174, v175
    s_waitcnt lgkmcnt(2)
    v_mfma_f32_32x32x16_bf16 v[32:47], v[208:211], v[240:243], v[32:47]
    v_mfma_f32_32x32x16_bf16 v[32:47], v[212:215], v[244:247], v[32:47]
AH_67k_94:
    s_waitcnt lgkmcnt(2)
    v_add_u32 v26, s58, v1
    ds_read_b128 v[224:227], v26 offset:1024
    ds_read_b128 v[228:231], v26 offset:2048
    s_cmp_eq_u32 s48, 0
    s_cbranch_scc1 AH_67s_95
    s_add_u32 s32, s43, 24576
    buffer_load_dwordx4 v[160:163], v1, s[8:11], s32 offen offset:0 sc1
    s_add_u32 s32, s43, 24576
    buffer_load_dwordx4 v[164:167], v1, s[8:11], s32 offen offset:1024 sc1
    s_add_u32 s32, s43, 24576
    buffer_load_dwordx4 v[168:171], v1, s[8:11], s32 offen offset:2048 sc1
    s_add_u32 s32, s43, 24576
    buffer_load_dwordx4 v[172:175], v1, s[8:11], s32 offen offset:3072 sc1
AH_67s_95:
    s_add_u32 s32, s41, 7
    s_cmp_lt_u32 s32, 8
    s_cbranch_scc1 AH_67k_96
    v_fma_f32 v176, v176, s47, -v24
    v_fma_f32 v177, v177, s47, -v24
    v_fma_f32 v178, v178, s47, -v24
    v_fma_f32 v179, v179, s47, -v24
    v_fma_f32 v180, v180, s47, -v24
    v_fma_f32 v181, v181, s47, -v24
    v_fma_f32 v182, v182, s47, -v24
    v_fma_f32 v183, v183, s47, -v24
    v_fma_f32 v184, v184, s47, -v24
    v_fma_f32 v185, v185, s47, -v24
    v_fma_f32 v186, v186, s47, -v24
    v_fma_f32 v187, v187, s47, -v24
    v_fma_f32 v188, v188, s47, -v24
    v_fma_f32 v189, v189, s47, -v24
    v_fma_f32 v190, v190, s47, -v24
    v_fma_f32 v191, v191, s47, -v24
    v_exp_f32 v176, v176
    v_exp_f32 v177, v177
    v_exp_f32 v178, v178
    v_exp_f32 v179, v179
    v_exp_f32 v180, v180
    v_exp_f32 v181, v181
    v_exp_f32 v182, v182
    v_exp_f32 v183, v183
    v_exp_f32 v184, v184
    v_exp_f32 v185, v185
    v_exp_f32 v186, v186
    v_exp_f32 v187, v187
    v_exp_f32 v188, v188
    v_exp_f32 v189, v189
    v_exp_f32 v190, v190
    v_exp_f32 v191, v191
    v_cvt_pk_bf16_f32 v12, v176, v177
    v_cvt_pk_bf16_f32 v13, v178, v179
    v_cvt_pk_bf16_f32 v14, v180, v181
    v_cvt_pk_bf16_f32 v15, v182, v183
    v_cvt_pk_bf16_f32 v16, v184, v185
    v_cvt_pk_bf16_f32 v17, v186, v187
    v_cvt_pk_bf16_f32 v18, v188, v189
    v_cvt_pk_bf16_f32 v19, v190, v191
    s_waitcnt lgkmcnt(2)
    v_mfma_f32_32x32x16_bf16 v[32:47], v[216:219], v[12:15], v[32:47]
    v_mfma_f32_32x32x16_bf16 v[32:47], v[220:223], v[16:19], v[32:47]
AH_67k_96:
    s_waitcnt lgkmcnt(2)
    s_cmp_eq_u32 s48, 0
    s_cbranch_scc1 AH_67s_97
    s_add_u32 s32, s43, 28672
    buffer_load_dwordx4 v[176:179], v1, s[8:11], s32 offen offset:0 sc1
    s_add_u32 s32, s43, 28672
    buffer_load_dwordx4 v[180:183], v1, s[8:11], s32 offen offset:1024 sc1
    s_add_u32 s32, s43, 28672
    buffer_load_dwordx4 v[184:187], v1, s[8:11], s32 offen offset:2048 sc1
    s_add_u32 s32, s43, 28672
    buffer_load_dwordx4 v[188:191], v1, s[8:11], s32 offen offset:3072 sc1
AH_67s_97:
    v_fma_f32 v192, v192, s47, -v24
    v_fma_f32 v193, v193, s47, -v24
    v_fma_f32 v194, v194, s47, -v24
    v_fma_f32 v195, v195, s47, -v24
    v_fma_f32 v196, v196, s47, -v24
    v_fma_f32 v197, v197, s47, -v24
    v_fma_f32 v198, v198, s47, -v24
    v_fma_f32 v199, v199, s47, -v24
    v_fma_f32 v200, v200, s47, -v24
    v_fma_f32 v201, v201, s47, -v24
    v_fma_f32 v202, v202, s47, -v24
    v_fma_f32 v203, v203, s47, -v24
    v_fma_f32 v204, v204, s47, -v24
    v_fma_f32 v205, v205, s47, -v24
    v_fma_f32 v206, v206, s47, -v24
    v_fma_f32 v207, v207, s47, -v24
    v_exp_f32 v192, v192
    v_exp_f32 v193, v193
    v_exp_f32 v194, v194
    v_exp_f32 v195, v195
    v_exp_f32 v196, v196
    v_exp_f32 v197, v197
    v_exp_f32 v198, v198
    v_exp_f32 v199, v199
    v_exp_f32 v200, v200
    v_exp_f32 v201, v201
    v_exp_f32 v202, v202
    v_exp_f32 v203, v203
    v_exp_f32 v204, v204
    v_exp_f32 v205, v205
    v_exp_f32 v206, v206
    v_exp_f32 v207, v207
    v_cvt_pk_bf16_f32 v240, v192, v193
    v_cvt_pk_bf16_f32 v241, v194, v195
    v_cvt_pk_bf16_f32 v242, v196, v197
    v_cvt_pk_bf16_f32 v243, v198, v199
    v_cvt_pk_bf16_f32 v244, v200, v201
    v_cvt_pk_bf16_f32 v245, v202, v203
    v_cvt_pk_bf16_f32 v246, v204, v205
    v_cvt_pk_bf16_f32 v247, v206, v207
    s_waitcnt lgkmcnt(0)
    v_mfma_f32_32x32x16_bf16 v[32:47], v[224:227], v[240:243], v[32:47]
    v_mfma_f32_32x32x16_bf16 v[32:47], v[228:231], v[244:247], v[32:47]
AH_67k_98:
    s_waitcnt lgkmcnt(0)
    s_branch AH_67_tail
AH_67_fast:
    s_cmp_ge_u32 s41, 10
    s_cbranch_scc1 AH_67_rot
    s_add_u32 s32, s41, 8
    s_and_b32 s32, s32, 15
    s_mul_i32 s32, s32, 3072
    s_add_u32 s32, s32, s42
    v_add_u32 v241, s32, v1
    s_add_u32 s32, s41, 9
    s_and_b32 s32, s32, 15
    s_mul_i32 s32, s32, 3072
    s_add_u32 s32, s32, s42
    v_add_u32 v242, s32, v1
    s_add_u32 s32, s41, 10
    s_and_b32 s32, s32, 15
    s_mul_i32 s32, s32, 3072
    s_add_u32 s32, s32, s42
    v_add_u32 v243, s32, v1
    s_add_u32 s32, s41, 11
    s_and_b32 s32, s32, 15
    s_mul_i32 s32, s32, 3072
    s_add_u32 s32, s32, s42
    v_add_u32 v244, s32, v1
    s_add_u32 s32, s41, 12
    s_and_b32 s32, s32, 15
    s_mul_i32 s32, s32, 3072
    s_add_u32 s32, s32, s42
    v_add_u32 v245, s32, v1
    s_add_u32 s32, s41, 13
    s_and_b32 s32, s32, 15
    s_mul_i32 s32, s32, 3072
    s_add_u32 s32, s32, s42
    v_add_u32 v246, s32, v1
    s_add_u32 s32, s41, 14
    s_and_b32 s32, s32, 15
    s_mul_i32 s32, s32, 3072
    s_add_u32 s32, s32, s42
    v_add_u32 v247, s32, v1
    s_add_u32 s32, s41, 15
    s_and_b32 s32, s32, 15
    s_mul_i32 s32, s32, 3072
    s_add_u32 s32, s32, s42
    v_add_u32 v248, s32, v1
    s_add_u32 s32, s41, 16
    s_and_b32 s32, s32, 15
    s_mul_i32 s32, s32, 3072
    s_add_u32 s32, s32, s42
    v_add_u32 v249, s32, v1
    s_branch AH_67_rote
AH_67_rot:
    v_mov_b32 v241, v243
    v_mov_b32 v242, v244
    v_mov_b32 v243, v245
    v_mov_b32 v244, v246
    v_mov_b32 v245, v247
    v_mov_b32 v246, v248
    v_mov_b32 v247, v249
    s_add_u32 s32, s41, 15
    s_and_b32 s32, s32, 15
    s_mul_i32 s32, s32, 3072
    s_add_u32 s32, s32, s42
    v_add_u32 v248, s32, v1
    s_add_u32 s32, s41, 16
    s_and_b32 s32, s32, 15
    s_mul_i32 s32, s32, 3072
    s_add_u32 s32, s32, s42
    v_add_u32 v249, s32, v1
AH_67_rote:
    ds_read_b128 v[208:211], v249
    ds_read_b128 v[212:215], v241
    ds_read_b128 v[216:219], v242
    ds_read_b128 v[220:223], v243
    ds_read_b128 v[224:227], v244
    ds_read_b128 v[228:231], v245
    ds_read_b128 v[232:235], v246
    ds_read_b128 v[236:239], v247
    s_mov_b32 s48, 0
AH_67_pw2:
    ds_read_b32 v26, v4
    s_waitcnt lgkmcnt(0)
    v_readfirstlane_b32 s49, v26
    s_cmp_ge_u32 s49, s41
    s_cbranch_scc1 AH_67_pok2
    s_add_u32 s48, s48, 1
    s_cmp_gt_u32 s48, 2400000
    s_cbranch_scc1 L_fail
    s_branch AH_67_pw2
AH_67_pok2:
    ds_read_b128 v[16:19], v248
    v_mfma_f32_32x32x16_bf16 v[192:207], v[208:211], v[8:11], 0
    v_mfma_f32_32x32x16_bf16 v[64:79], v[212:215], v[8:11], 0
    v_mfma_f32_32x32x16_bf16 v[80:95], v[216:219], v[8:11], 0
    v_mfma_f32_32x32x16_bf16 v[96:111], v[220:223], v[8:11], 0
    v_mfma_f32_32x32x16_bf16 v[112:127], v[224:227], v[8:11], 0
    v_mfma_f32_32x32x16_bf16 v[128:143], v[228:231], v[8:11], 0
    v_mfma_f32_32x32x16_bf16 v[144:159], v[232:235], v[8:11], 0
    v_mfma_f32_32x32x16_bf16 v[160:175], v[236:239], v[8:11], 0
    s_waitcnt lgkmcnt(0)
    v_mfma_f32_32x32x16_bf16 v[176:191], v[16:19], v[8:11], 0
    ds_read_b128 v[208:211], v241 offset:1024
    ds_read_b128 v[212:215], v241 offset:2048
    ds_read_b128 v[216:219], v242 offset:1024
    ds_read_b128 v[220:223], v242 offset:2048
    v_cndmask_b32 v192, v7, v192, s[64:65]
    v_cndmask_b32 v193, v7, v193, s[66:67]
    v_cndmask_b32 v194, v7, v194, s[68:69]
    v_cndmask_b32 v195, v7, v195, s[70:71]
    v_cndmask_b32 v196, v7, v196, s[72:73]
    v_cndmask_b32 v197, v7, v197, s[74:75]
    v_cndmask_b32 v198, v7, v198, s[76:77]
    v_cndmask_b32 v199, v7, v199, s[78:79]
    v_cndmask_b32 v200, v7, v200, s[80:81]
    v_cndmask_b32 v201, v7, v201, s[82:83]
    v_cndmask_b32 v202, v7, v202, s[84:85]
    v_cndmask_b32 v203, v7, v203, s[86:87]
    v_cndmask_b32 v204, v7, v204, s[88:89]
    v_cndmask_b32 v205, v7, v205, s[90:91]
    v_cndmask_b32 v206, v7, v206, s[92:93]
    v_cndmask_b32 v207, v7, v207, s[94:95]
    v_cndmask_b32 v64, v64, v7, s[64:65]
    v_cndmask_b32 v65, v65, v7, s[66:67]
    v_cndmask_b32 v66, v66, v7, s[68:69]
    v_cndmask_b32 v67, v67, v7, s[70:71]
    v_cndmask_b32 v68, v68, v7, s[72:73]
    v_cndmask_b32 v69, v69, v7, s[74:75]
    v_cndmask_b32 v70, v70, v7, s[76:77]
    v_cndmask_b32 v71, v71, v7, s[78:79]
    v_cndmask_b32 v72, v72, v7, s[80:81]
    v_cndmask_b32 v73, v73, v7, s[82:83]
    v_cndmask_b32 v74, v74, v7, s[84:85]
    v_cndmask_b32 v75, v75, v7, s[86:87]
    v_cndmask_b32 v76, v76, v7, s[88:89]
    v_cndmask_b32 v77, v77, v7, s[90:91]
    v_cndmask_b32 v78, v78, v7, s[92:93]
    v_cndmask_b32 v79, v79, v7, s[94:95]
    v_max3_f32 v24, v192, v193, v194
    v_max3_f32 v25, v195, v196, v197
    v_max3_f32 v24, v24, v198, v199
    v_max3_f32 v25, v25, v200, v201
    v_max3_f32 v24, v24, v202, v203
    v_max3_f32 v25, v25, v204, v205
    v_max3_f32 v24, v24, v206, v207
    v_max3_f32 v25, v25, v64, v65
    v_max3_f32 v24, v24, v66, v67
    v_max3_f32 v25, v25, v68, v69
    v_max3_f32 v24, v24, v70, v71
    v_max3_f32 v25, v25, v72, v73
    v_max3_f32 v24, v24, v74, v75
    v_max3_f32 v25, v25, v76, v77
    v_max3_f32 v24, v24, v78, v79
    v_max3_f32 v25, v25, v80, v81
    v_max3_f32 v24, v24, v82, v83
    v_max3_f32 v25, v25, v84, v85
    v_max3_f32 v24, v24, v86, v87
    v_max3_f32 v25, v25, v88, v89
    v_max3_f32 v24, v24, v90, v91
    v_max3_f32 v25, v25, v92, v93
    v_max3_f32 v24, v24, v94, v95
    v_max3_f32 v25, v25, v96, v97
    v_max3_f32 v24, v24, v98, v99
    v_max3_f32 v25, v25, v100, v101
    v_max3_f32 v24, v24, v102, v103
    v_max3_f32 v25, v25, v104, v105
    v_max3_f32 v24, v24, v106, v107
    v_max3_f32 v25, v25, v108, v109
    v_max3_f32 v24, v24, v110, v111
    v_max3_f32 v25, v25, v112, v113
    v_max3_f32 v24, v24, v114, v115
    v_max3_f32 v25, v25, v116, v117
    v_max3_f32 v24, v24, v118, v119
    v_max3_f32 v25, v25, v120, v121
    v_max3_f32 v24, v24, v122, v123
    v_max3_f32 v25, v25, v124, v125
    v_max3_f32 v24, v24, v126, v127
    v_max3_f32 v25, v25, v128, v129
    v_max3_f32 v24, v24, v130, v131
    v_max3_f32 v25, v25, v132, v133
    v_max3_f32 v24, v24, v134, v135
    v_max3_f32 v25, v25, v136, v137
    v_max3_f32 v24, v24, v138, v139
    v_max3_f32 v25, v25, v140, v141
    v_max3_f32 v24, v24, v142, v143
    v_max3_f32 v25, v25, v144, v145
    v_max3_f32 v24, v24, v146, v147
    v_max3_f32 v25, v25, v148, v149
    v_max3_f32 v24, v24, v150, v151
    v_max3_f32 v25, v25, v152, v153
    v_max3_f32 v24, v24, v154, v155
    v_max3_f32 v25, v25, v156, v157
    v_max3_f32 v24, v24, v158, v159
    v_max3_f32 v25, v25, v160, v161
    v_max3_f32 v24, v24, v162, v163
    v_max3_f32 v25, v25, v164, v165
    v_max3_f32 v24, v24, v166, v167
    v_max3_f32 v25, v25, v168, v169
    v_max3_f32 v24, v24, v170, v171
    v_max3_f32 v25, v25, v172, v173
    v_max3_f32 v24, v24, v174, v175
    v_max3_f32 v25, v25, v176, v177
    v_max3_f32 v24, v24, v178, v179
    v_max3_f32 v25, v25, v180, v181
    v_max3_f32 v24, v24, v182, v183
    v_max3_f32 v25, v25, v184, v185
    v_max3_f32 v24, v24, v186, v187
    v_max3_f32 v25, v25, v188, v189
    v_max3_f32 v24, v24, v190, v191
    v_max_f32 v24, v24, v25
    v_mov_b32 v25, v24
    s_nop 1
    v_permlane32_swap_b32 v24, v25
    v_max_f32 v24, v24, v25
    v_mul_f32 v24, s47, v24
    s_waitcnt vmcnt(0)
    s_mov_b32 s48, 0
    s_cmp_ge_u32 s41, 62
    s_cbranch_scc1 AH_67_np2
    v_cmp_eq_u32 vcc, 0, v31
    s_cbranch_vccnz AH_67_np2
    s_mov_b32 s48, 1
AH_67_np2:
    s_cmp_eq_u32 s48, 1
    v_fma_f32 v64, v64, s47, -v24
    v_fma_f32 v65, v65, s47, -v24
    v_fma_f32 v66, v66, s47, -v24
    v_fma_f32 v67, v67, s47, -v24
    v_fma_f32 v68, v68, s47, -v24
    v_fma_f32 v69, v69, s47, -v24
    v_fma_f32 v70, v70, s47, -v24
    v_fma_f32 v71, v71, s47, -v24
    v_fma_f32 v72, v72, s47, -v24
    v_fma_f32 v73, v73, s47, -v24
    v_fma_f32 v74, v74, s47, -v24
    v_fma_f32 v75, v75, s47, -v24
    v_fma_f32 v76, v76, s47, -v24
    v_fma_f32 v77, v77, s47, -v24
    v_fma_f32 v78, v78, s47, -v24
    v_fma_f32 v79, v79, s47, -v24
    v_exp_f32 v64, v64
    v_exp_f32 v65, v65
    v_exp_f32 v66, v66
    v_exp_f32 v67, v67
    v_exp_f32 v68, v68
    v_exp_f32 v69, v69
    v_exp_f32 v70, v70
    v_exp_f32 v71, v71
    v_exp_f32 v72, v72
    v_exp_f32 v73, v73
    v_exp_f32 v74, v74
    v_exp_f32 v75, v75
    v_exp_f32 v76, v76
    v_exp_f32 v77, v77
    v_exp_f32 v78, v78
    v_exp_f32 v79, v79
    v_cvt_pk_bf16_f32 v232, v64, v65
    v_cvt_pk_bf16_f32 v233, v66, v67
    v_cvt_pk_bf16_f32 v234, v68, v69
    v_cvt_pk_bf16_f32 v235, v70, v71
    v_cvt_pk_bf16_f32 v236, v72, v73
    v_cvt_pk_bf16_f32 v237, v74, v75
    v_cvt_pk_bf16_f32 v238, v76, v77
    v_cvt_pk_bf16_f32 v239, v78, v79
    s_waitcnt lgkmcnt(2)
    v_mfma_f32_32x32x16_bf16 v[32:47], v[208:211], v[232:235], 0
    v_mfma_f32_32x32x16_bf16 v[32:47], v[212:215], v[236:239], v[32:47]
    ds_read_b128 v[224:227], v243 offset:1024
    ds_read_b128 v[228:231], v243 offset:2048
    s_cbranch_scc0 AH_67s_99
    s_add_u32 s32, s43, 0
    buffer_load_dwordx4 v[64:67], v1, s[8:11], s32 offen offset:0 sc1
    buffer_load_dwordx4 v[68:71], v1, s[8:11], s32 offen offset:1024 sc1
    buffer_load_dwordx4 v[72:75], v1, s[8:11], s32 offen offset:2048 sc1
    buffer_load_dwordx4 v[76:79], v1, s[8:11], s32 offen offset:3072 sc1
    s_cmp_eq_u32 s48, 1
AH_67s_99:
    v_fma_f32 v80, v80, s47, -v24
    v_fma_f32 v81, v81, s47, -v24
    v_fma_f32 v82, v82, s47, -v24
    v_fma_f32 v83, v83, s47, -v24
    v_fma_f32 v84, v84, s47, -v24
    v_fma_f32 v85, v85, s47, -v24
    v_fma_f32 v86, v86, s47, -v24
    v_fma_f32 v87, v87, s47, -v24
    v_fma_f32 v88, v88, s47, -v24
    v_fma_f32 v89, v89, s47, -v24
    v_fma_f32 v90, v90, s47, -v24
    v_fma_f32 v91, v91, s47, -v24
    v_fma_f32 v92, v92, s47, -v24
    v_fma_f32 v93, v93, s47, -v24
    v_fma_f32 v94, v94, s47, -v24
    v_fma_f32 v95, v95, s47, -v24
    v_exp_f32 v80, v80
    v_exp_f32 v81, v81
    v_exp_f32 v82, v82
    v_exp_f32 v83, v83
    v_exp_f32 v84, v84
    v_exp_f32 v85, v85
    v_exp_f32 v86, v86
    v_exp_f32 v87, v87
    v_exp_f32 v88, v88
    v_exp_f32 v89, v89
    v_exp_f32 v90, v90
    v_exp_f32 v91, v91
    v_exp_f32 v92, v92
    v_exp_f32 v93, v93
    v_exp_f32 v94, v94
    v_exp_f32 v95, v95
    v_cvt_pk_bf16_f32 v12, v80, v81
    v_cvt_pk_bf16_f32 v13, v82, v83
    v_cvt_pk_bf16_f32 v14, v84, v85
    v_cvt_pk_bf16_f32 v15, v86, v87
    v_cvt_pk_bf16_f32 v16, v88, v89
    v_cvt_pk_bf16_f32 v17, v90, v91
    v_cvt_pk_bf16_f32 v18, v92, v93
    v_cvt_pk_bf16_f32 v19, v94, v95
    s_waitcnt lgkmcnt(2)
    v_mfma_f32_32x32x16_bf16 v[32:47], v[216:219], v[12:15], v[32:47]
    v_mfma_f32_32x32x16_bf16 v[32:47], v[220:223], v[16:19], v[32:47]
    ds_read_b128 v[208:211], v244 offset:1024
    ds_read_b128 v[212:215], v244 offset:2048
    s_cbranch_scc0 AH_67s_100
    s_add_u32 s32, s43, 4096
    buffer_load_dwordx4 v[80:83], v1, s[8:11], s32 offen offset:0 sc1
    buffer_load_dwordx4 v[84:87], v1, s[8:11], s32 offen offset:1024 sc1
    buffer_load_dwordx4 v[88:91], v1, s[8:11], s32 offen offset:2048 sc1
    buffer_load_dwordx4 v[92:95], v1, s[8:11], s32 offen offset:3072 sc1
    s_cmp_eq_u32 s48, 1
AH_67s_100:
    v_fma_f32 v96, v96, s47, -v24
    v_fma_f32 v97, v97, s47, -v24
    v_fma_f32 v98, v98, s47, -v24
    v_fma_f32 v99, v99, s47, -v24
    v_fma_f32 v100, v100, s47, -v24
    v_fma_f32 v101, v101, s47, -v24
    v_fma_f32 v102, v102, s47, -v24
    v_fma_f32 v103, v103, s47, -v24
    v_fma_f32 v104, v104, s47, -v24
    v_fma_f32 v105, v105, s47, -v24
    v_fma_f32 v106, v106, s47, -v24
    v_fma_f32 v107, v107, s47, -v24
    v_fma_f32 v108, v108, s47, -v24
    v_fma_f32 v109, v109, s47, -v24
    v_fma_f32 v110, v110, s47, -v24
    v_fma_f32 v111, v111, s47, -v24
    v_exp_f32 v96, v96
    v_exp_f32 v97, v97
    v_exp_f32 v98, v98
    v_exp_f32 v99, v99
    v_exp_f32 v100, v100
    v_exp_f32 v101, v101
    v_exp_f32 v102, v102
    v_exp_f32 v103, v103
    v_exp_f32 v104, v104
    v_exp_f32 v105, v105
    v_exp_f32 v106, v106
    v_exp_f32 v107, v107
    v_exp_f32 v108, v108
    v_exp_f32 v109, v109
    v_exp_f32 v110, v110
    v_exp_f32 v111, v111
    v_cvt_pk_bf16_f32 v232, v96, v97
    v_cvt_pk_bf16_f32 v233, v98, v99
    v_cvt_pk_bf16_f32 v234, v100, v101
    v_cvt_pk_bf16_f32 v235, v102, v103
    v_cvt_pk_bf16_f32 v236, v104, v105
    v_cvt_pk_bf16_f32 v237, v106, v107
    v_cvt_pk_bf16_f32 v238, v108, v109
    v_cvt_pk_bf16_f32 v239, v110, v111
    s_waitcnt lgkmcnt(2)
    v_mfma_f32_32x32x16_bf16 v[32:47], v[224:227], v[232:235], v[32:47]
    v_mfma_f32_32x32x16_bf16 v[32:47], v[228:231], v[236:239], v[32:47]
    ds_read_b128 v[216:219], v245 offset:1024
    ds_read_b128 v[220:223], v245 offset:2048
    s_cbranch_scc0 AH_67s_101
    s_add_u32 s32, s43, 8192
    buffer_load_dwordx4 v[96:99], v1, s[8:11], s32 offen offset:0 sc1
    buffer_load_dwordx4 v[100:103], v1, s[8:11], s32 offen offset:1024 sc1
    buffer_load_dwordx4 v[104:107], v1, s[8:11], s32 offen offset:2048 sc1
    buffer_load_dwordx4 v[108:111], v1, s[8:11], s32 offen offset:3072 sc1
    s_cmp_eq_u32 s48, 1
AH_67s_101:
    v_fma_f32 v112, v112, s47, -v24
    v_fma_f32 v113, v113, s47, -v24
    v_fma_f32 v114, v114, s47, -v24
    v_fma_f32 v115, v115, s47, -v24
    v_fma_f32 v116, v116, s47, -v24
    v_fma_f32 v117, v117, s47, -v24
    v_fma_f32 v118, v118, s47, -v24
    v_fma_f32 v119, v119, s47, -v24
    v_fma_f32 v120, v120, s47, -v24
    v_fma_f32 v121, v121, s47, -v24
    v_fma_f32 v122, v122, s47, -v24
    v_fma_f32 v123, v123, s47, -v24
    v_fma_f32 v124, v124, s47, -v24
    v_fma_f32 v125, v125, s47, -v24
    v_fma_f32 v126, v126, s47, -v24
    v_fma_f32 v127, v127, s47, -v24
    v_exp_f32 v112, v112
    v_exp_f32 v113, v113
    v_exp_f32 v114, v114
    v_exp_f32 v115, v115
    v_exp_f32 v116, v116
    v_exp_f32 v117, v117
    v_exp_f32 v118, v118
    v_exp_f32 v119, v119
    v_exp_f32 v120, v120
    v_exp_f32 v121, v121
    v_exp_f32 v122, v122
    v_exp_f32 v123, v123
    v_exp_f32 v124, v124
    v_exp_f32 v125, v125
    v_exp_f32 v126, v126
    v_exp_f32 v127, v127
    v_cvt_pk_bf16_f32 v12, v112, v113
    v_cvt_pk_bf16_f32 v13, v114, v115
    v_cvt_pk_bf16_f32 v14, v116, v117
    v_cvt_pk_bf16_f32 v15, v118, v119
    v_cvt_pk_bf16_f32 v16, v120, v121
    v_cvt_pk_bf16_f32 v17, v122, v123
    v_cvt_pk_bf16_f32 v18, v124, v125
    v_cvt_pk_bf16_f32 v19, v126, v127
    s_waitcnt lgkmcnt(2)
    v_mfma_f32_32x32x16_bf16 v[32:47], v[208:211], v[12:15], v[32:47]
    v_mfma_f32_32x32x16_bf16 v[32:47], v[212:215], v[16:19], v[32:47]
    ds_read_b128 v[224:227], v246 offset:1024
    ds_read_b128 v[228:231], v246 offset:2048
    s_cbranch_scc0 AH_67s_102
    s_add_u32 s32, s43, 12288
    buffer_load_dwordx4 v[112:115], v1, s[8:11], s32 offen offset:0 sc1
    buffer_load_dwordx4 v[116:119], v1, s[8:11], s32 offen offset:1024 sc1
    buffer_load_dwordx4 v[120:123], v1, s[8:11], s32 offen offset:2048 sc1
    buffer_load_dwordx4 v[124:127], v1, s[8:11], s32 offen offset:3072 sc1
    s_cmp_eq_u32 s48, 1
AH_67s_102:
    v_fma_f32 v128, v128, s47, -v24
    v_fma_f32 v129, v129, s47, -v24
    v_fma_f32 v130, v130, s47, -v24
    v_fma_f32 v131, v131, s47, -v24
    v_fma_f32 v132, v132, s47, -v24
    v_fma_f32 v133, v133, s47, -v24
    v_fma_f32 v134, v134, s47, -v24
    v_fma_f32 v135, v135, s47, -v24
    v_fma_f32 v136, v136, s47, -v24
    v_fma_f32 v137, v137, s47, -v24
    v_fma_f32 v138, v138, s47, -v24
    v_fma_f32 v139, v139, s47, -v24
    v_fma_f32 v140, v140, s47, -v24
    v_fma_f32 v141, v141, s47, -v24
    v_fma_f32 v142, v142, s47, -v24
    v_fma_f32 v143, v143, s47, -v24
    v_exp_f32 v128, v128
    v_exp_f32 v129, v129
    v_exp_f32 v130, v130
    v_exp_f32 v131, v131
    v_exp_f32 v132, v132
    v_exp_f32 v133, v133
    v_exp_f32 v134, v134
    v_exp_f32 v135, v135
    v_exp_f32 v136, v136
    v_exp_f32 v137, v137
    v_exp_f32 v138, v138
    v_exp_f32 v139, v139
    v_exp_f32 v140, v140
    v_exp_f32 v141, v141
    v_exp_f32 v142, v142
    v_exp_f32 v143, v143
    v_cvt_pk_bf16_f32 v232, v128, v129
    v_cvt_pk_bf16_f32 v233, v130, v131
    v_cvt_pk_bf16_f32 v234, v132, v133
    v_cvt_pk_bf16_f32 v235, v134, v135
    v_cvt_pk_bf16_f32 v236, v136, v137
    v_cvt_pk_bf16_f32 v237, v138, v139
    v_cvt_pk_bf16_f32 v238, v140, v141
    v_cvt_pk_bf16_f32 v239, v142, v143
    s_waitcnt lgkmcnt(2)
    v_mfma_f32_32x32x16_bf16 v[32:47], v[216:219], v[232:235], v[32:47]
    v_mfma_f32_32x32x16_bf16 v[32:47], v[220:223], v[236:239], v[32:47]
    ds_read_b128 v[208:211], v247 offset:1024
    ds_read_b128 v[212:215], v247 offset:2048
    s_cbranch_scc0 AH_67s_103
    s_add_u32 s32, s43, 16384
    buffer_load_dwordx4 v[128:131], v1, s[8:11], s32 offen offset:0 sc1
    buffer_load_dwordx4 v[132:135], v1, s[8:11], s32 offen offset:1024 sc1
    buffer_load_dwordx4 v[136:139], v1, s[8:11], s32 offen offset:2048 sc1
    buffer_load_dwordx4 v[140:143], v1, s[8:11], s32 offen offset:3072 sc1
    s_cmp_eq_u32 s48, 1
AH_67s_103:
    v_fma_f32 v144, v144, s47, -v24
    v_fma_f32 v145, v145, s47, -v24
    v_fma_f32 v146, v146, s47, -v24
    v_fma_f32 v147, v147, s47, -v24
    v_fma_f32 v148, v148, s47, -v24
    v_fma_f32 v149, v149, s47, -v24
    v_fma_f32 v150, v150, s47, -v24
    v_fma_f32 v151, v151, s47, -v24
    v_fma_f32 v152, v152, s47, -v24
    v_fma_f32 v153, v153, s47, -v24
    v_fma_f32 v154, v154, s47, -v24
    v_fma_f32 v155, v155, s47, -v24
    v_fma_f32 v156, v156, s47, -v24
    v_fma_f32 v157, v157, s47, -v24
    v_fma_f32 v158, v158, s47, -v24
    v_fma_f32 v159, v159, s47, -v24
    v_exp_f32 v144, v144
    v_exp_f32 v145, v145
    v_exp_f32 v146, v146
    v_exp_f32 v147, v147
    v_exp_f32 v148, v148
    v_exp_f32 v149, v149
    v_exp_f32 v150, v150
    v_exp_f32 v151, v151
    v_exp_f32 v152, v152
    v_exp_f32 v153, v153
    v_exp_f32 v154, v154
    v_exp_f32 v155, v155
    v_exp_f32 v156, v156
    v_exp_f32 v157, v157
    v_exp_f32 v158, v158
    v_exp_f32 v159, v159
    v_cvt_pk_bf16_f32 v12, v144, v145
    v_cvt_pk_bf16_f32 v13, v146, v147
    v_cvt_pk_bf16_f32 v14, v148, v149
    v_cvt_pk_bf16_f32 v15, v150, v151
    v_cvt_pk_bf16_f32 v16, v152, v153
    v_cvt_pk_bf16_f32 v17, v154, v155
    v_cvt_pk_bf16_f32 v18, v156, v157
    v_cvt_pk_bf16_f32 v19, v158, v159
    s_waitcnt lgkmcnt(2)
    v_mfma_f32_32x32x16_bf16 v[32:47], v[224:227], v[12:15], v[32:47]
    v_mfma_f32_32x32x16_bf16 v[32:47], v[228:231], v[16:19], v[32:47]
    ds_read_b128 v[216:219], v248 offset:1024
    ds_read_b128 v[220:223], v248 offset:2048
    s_cbranch_scc0 AH_67s_104
    s_add_u32 s32, s43, 20480
    buffer_load_dwordx4 v[144:147], v1, s[8:11], s32 offen offset:0 sc1
    buffer_load_dwordx4 v[148:151], v1, s[8:11], s32 offen offset:1024 sc1
    buffer_load_dwordx4 v[152:155], v1, s[8:11], s32 offen offset:2048 sc1
    buffer_load_dwordx4 v[156:159], v1, s[8:11], s32 offen offset:3072 sc1
    s_cmp_eq_u32 s48, 1
AH_67s_104:
    v_fma_f32 v160, v160, s47, -v24
    v_fma_f32 v161, v161, s47, -v24
    v_fma_f32 v162, v162, s47, -v24
    v_fma_f32 v163, v163, s47, -v24
    v_fma_f32 v164, v164, s47, -v24
    v_fma_f32 v165, v165, s47, -v24
    v_fma_f32 v166, v166, s47, -v24
    v_fma_f32 v167, v167, s47, -v24
    v_fma_f32 v168, v168, s47, -v24
    v_fma_f32 v169, v169, s47, -v24
    v_fma_f32 v170, v170, s47, -v24
    v_fma_f32 v171, v171, s47, -v24
    v_fma_f32 v172, v172, s47, -v24
    v_fma_f32 v173, v173, s47, -v24
    v_fma_f32 v174, v174, s47, -v24
    v_fma_f32 v175, v175, s47, -v24
    v_exp_f32 v160, v160
    v_exp_f32 v161, v161
    v_exp_f32 v162, v162
    v_exp_f32 v163, v163
    v_exp_f32 v164, v164
    v_exp_f32 v165, v165
    v_exp_f32 v166, v166
    v_exp_f32 v167, v167
    v_exp_f32 v168, v168
    v_exp_f32 v169, v169
    v_exp_f32 v170, v170
    v_exp_f32 v171, v171
    v_exp_f32 v172, v172
    v_exp_f32 v173, v173
    v_exp_f32 v174, v174
    v_exp_f32 v175, v175
    v_cvt_pk_bf16_f32 v232, v160, v161
    v_cvt_pk_bf16_f32 v233, v162, v163
    v_cvt_pk_bf16_f32 v234, v164, v165
    v_cvt_pk_bf16_f32 v235, v166, v167
    v_cvt_pk_bf16_f32 v236, v168, v169
    v_cvt_pk_bf16_f32 v237, v170, v171
    v_cvt_pk_bf16_f32 v238, v172, v173
    v_cvt_pk_bf16_f32 v239, v174, v175
    s_waitcnt lgkmcnt(2)
    v_mfma_f32_32x32x16_bf16 v[32:47], v[208:211], v[232:235], v[32:47]
    v_mfma_f32_32x32x16_bf16 v[32:47], v[212:215], v[236:239], v[32:47]
    ds_read_b128 v[224:227], v249 offset:1024
    ds_read_b128 v[228:231], v249 offset:2048
    s_cbranch_scc0 AH_67s_105
    s_add_u32 s32, s43, 24576
    buffer_load_dwordx4 v[160:163], v1, s[8:11], s32 offen offset:0 sc1
    buffer_load_dwordx4 v[164:167], v1, s[8:11], s32 offen offset:1024 sc1
    buffer_load_dwordx4 v[168:171], v1, s[8:11], s32 offen offset:2048 sc1
    buffer_load_dwordx4 v[172:175], v1, s[8:11], s32 offen offset:3072 sc1
    s_cmp_eq_u32 s48, 1
AH_67s_105:
    v_fma_f32 v176, v176, s47, -v24
    v_fma_f32 v177, v177, s47, -v24
    v_fma_f32 v178, v178, s47, -v24
    v_fma_f32 v179, v179, s47, -v24
    v_fma_f32 v180, v180, s47, -v24
    v_fma_f32 v181, v181, s47, -v24
    v_fma_f32 v182, v182, s47, -v24
    v_fma_f32 v183, v183, s47, -v24
    v_fma_f32 v184, v184, s47, -v24
    v_fma_f32 v185, v185, s47, -v24
    v_fma_f32 v186, v186, s47, -v24
    v_fma_f32 v187, v187, s47, -v24
    v_fma_f32 v188, v188, s47, -v24
    v_fma_f32 v189, v189, s47, -v24
    v_fma_f32 v190, v190, s47, -v24
    v_fma_f32 v191, v191, s47, -v24
    v_exp_f32 v176, v176
    v_exp_f32 v177, v177
    v_exp_f32 v178, v178
    v_exp_f32 v179, v179
    v_exp_f32 v180, v180
    v_exp_f32 v181, v181
    v_exp_f32 v182, v182
    v_exp_f32 v183, v183
    v_exp_f32 v184, v184
    v_exp_f32 v185, v185
    v_exp_f32 v186, v186
    v_exp_f32 v187, v187
    v_exp_f32 v188, v188
    v_exp_f32 v189, v189
    v_exp_f32 v190, v190
    v_exp_f32 v191, v191
    v_cvt_pk_bf16_f32 v12, v176, v177
    v_cvt_pk_bf16_f32 v13, v178, v179
    v_cvt_pk_bf16_f32 v14, v180, v181
    v_cvt_pk_bf16_f32 v15, v182, v183
    v_cvt_pk_bf16_f32 v16, v184, v185
    v_cvt_pk_bf16_f32 v17, v186, v187
    v_cvt_pk_bf16_f32 v18, v188, v189
    v_cvt_pk_bf16_f32 v19, v190, v191
    s_waitcnt lgkmcnt(2)
    v_mfma_f32_32x32x16_bf16 v[32:47], v[216:219], v[12:15], v[32:47]
    v_mfma_f32_32x32x16_bf16 v[32:47], v[220:223], v[16:19], v[32:47]
    s_cbranch_scc0 AH_67s_106
    s_add_u32 s32, s43, 28672
    buffer_load_dwordx4 v[176:179], v1, s[8:11], s32 offen offset:0 sc1
    buffer_load_dwordx4 v[180:183], v1, s[8:11], s32 offen offset:1024 sc1
    buffer_load_dwordx4 v[184:187], v1, s[8:11], s32 offen offset:2048 sc1
    buffer_load_dwordx4 v[188:191], v1, s[8:11], s32 offen offset:3072 sc1
    s_cmp_eq_u32 s48, 1
AH_67s_106:
    v_fma_f32 v192, v192, s47, -v24
    v_fma_f32 v193, v193, s47, -v24
    v_fma_f32 v194, v194, s47, -v24
    v_fma_f32 v195, v195, s47, -v24
    v_fma_f32 v196, v196, s47, -v24
    v_fma_f32 v197, v197, s47, -v24
    v_fma_f32 v198, v198, s47, -v24
    v_fma_f32 v199, v199, s47, -v24
    v_fma_f32 v200, v200, s47, -v24
    v_fma_f32 v201, v201, s47, -v24
    v_fma_f32 v202, v202, s47, -v24
    v_fma_f32 v203, v203, s47, -v24
    v_fma_f32 v204, v204, s47, -v24
    v_fma_f32 v205, v205, s47, -v24
    v_fma_f32 v206, v206, s47, -v24
    v_fma_f32 v207, v207, s47, -v24
    v_exp_f32 v192, v192
    v_exp_f32 v193, v193
    v_exp_f32 v194, v194
    v_exp_f32 v195, v195
    v_exp_f32 v196, v196
    v_exp_f32 v197, v197
    v_exp_f32 v198, v198
    v_exp_f32 v199, v199
    v_exp_f32 v200, v200
    v_exp_f32 v201, v201
    v_exp_f32 v202, v202
    v_exp_f32 v203, v203
    v_exp_f32 v204, v204
    v_exp_f32 v205, v205
    v_exp_f32 v206, v206
    v_exp_f32 v207, v207
    v_cvt_pk_bf16_f32 v232, v192, v193
    v_cvt_pk_bf16_f32 v233, v194, v195
    v_cvt_pk_bf16_f32 v234, v196, v197
    v_cvt_pk_bf16_f32 v235, v198, v199
    v_cvt_pk_bf16_f32 v236, v200, v201
    v_cvt_pk_bf16_f32 v237, v202, v203
    v_cvt_pk_bf16_f32 v238, v204, v205
    v_cvt_pk_bf16_f32 v239, v206, v207
    s_waitcnt lgkmcnt(0)
    v_mfma_f32_32x32x16_bf16 v[32:47], v[224:227], v[232:235], v[32:47]
    v_mfma_f32_32x32x16_bf16 v[32:47], v[228:231], v[236:239], v[32:47]
AH_67_tail:
    s_nop 11
    v_rcp_f32 v24, v40
    s_nop 0
    v_mul_f32 v32, v32, v24
    v_mul_f32 v33, v33, v24
    v_mul_f32 v34, v34, v24
    v_mul_f32 v35, v35, v24
    v_mul_f32 v36, v36, v24
    v_mul_f32 v37, v37, v24
    v_mul_f32 v38, v38, v24
    v_mul_f32 v39, v39, v24
    v_cvt_pk_bf16_f32 v8, v32, v33
    v_cvt_pk_bf16_f32 v9, v34, v35
    v_cvt_pk_bf16_f32 v10, v36, v37
    v_cvt_pk_bf16_f32 v11, v38, v39
    buffer_store_dwordx4 v[8:11], v1, s[8:11], s44 offen sc1
    s_add_u32 s44, s44, 65536
    s_add_u32 s41, s41, 2
    s_mov_b32 s59, 1
    s_cmp_eq_u32 s48, 0
    s_cbranch_scc1 AH_67_slow
    s_add_u32 s43, s43, 65536
    s_add_u32 s45, s45, 256
    s_cmp_ge_u32 s41, 12
    s_cbranch_scc1 AH_67_loop
    s_waitcnt vmcnt(0)
    v_mov_b32 v25, 1
    v_mov_b32 v24, 0
    s_mov_b64 exec, 1
    buffer_store_dword v25, v24, s[8:11], s46 offen sc1
    s_mov_b64 exec, -1
    s_add_u32 s46, s46, 256
    s_mov_b32 s59, 0
    s_branch AH_67_loop
AH_67_slow:
    s_waitcnt vmcnt(0)
    v_mov_b32 v25, 1
    v_mov_b32 v24, 0
    s_mov_b64 exec, 1
    buffer_store_dword v25, v24, s[8:11], s46 offen sc1
    s_mov_b64 exec, -1
    s_add_u32 s46, s46, 256
    s_mov_b32 s59, 0
    s_cmp_ge_u32 s41, 64
    s_cbranch_scc1 AH_67_done
    s_mov_b32 s96, 0
    v_mbcnt_lo_u32_b32 v250, -1, 0
    v_mbcnt_hi_u32_b32 v250, -1, v250
    v_min_u32 v250, 15, v250
    v_lshlrev_b32 v250, 2, v250
AH_67ws_107_spin:
    buffer_load_dword v251, v250, s[8:11], s45 offen sc1
    s_waitcnt vmcnt(0)
    v_cmp_eq_u32 vcc, 0, v251
    s_cbranch_vccz AH_67ws_107_ok
    s_add_u32 s96, s96, 1
    s_cmp_gt_u32 s96, 300000
    s_cbranch_scc1 L_fail
    s_sleep 1
    s_branch AH_67ws_107_spin
AH_67ws_107_ok:
    s_add_u32 s32, s43, 0
    buffer_load_dwordx4 v[64:67], v1, s[8:11], s32 offen offset:0 sc1
    s_add_u32 s32, s43, 0
    buffer_load_dwordx4 v[68:71], v1, s[8:11], s32 offen offset:1024 sc1
    s_add_u32 s32, s43, 0
    buffer_load_dwordx4 v[72:75], v1, s[8:11], s32 offen offset:2048 sc1
    s_add_u32 s32, s43, 0
    buffer_load_dwordx4 v[76:79], v1, s[8:11], s32 offen offset:3072 sc1
    s_add_u32 s32, s43, 4096
    buffer_load_dwordx4 v[80:83], v1, s[8:11], s32 offen offset:0 sc1
    s_add_u32 s32, s43, 4096
    buffer_load_dwordx4 v[84:87], v1, s[8:11], s32 offen offset:1024 sc1
    s_add_u32 s32, s43, 4096
    buffer_load_dwordx4 v[88:91], v1, s[8:11], s32 offen offset:2048 sc1
    s_add_u32 s32, s43, 4096
    buffer_load_dwordx4 v[92:95], v1, s[8:11], s32 offen offset:3072 sc1
    s_add_u32 s32, s43, 8192
    buffer_load_dwordx4 v[96:99], v1, s[8:11], s32 offen offset:0 sc1
    s_add_u32 s32, s43, 8192
    buffer_load_dwordx4 v[100:103], v1, s[8:11], s32 offen offset:1024 sc1
    s_add_u32 s32, s43, 8192
    buffer_load_dwordx4 v[104:107], v1, s[8:11], s32 offen offset:2048 sc1
    s_add_u32 s32, s43, 8192
    buffer_load_dwordx4 v[108:111], v1, s[8:11], s32 offen offset:3072 sc1
    s_add_u32 s32, s43, 12288
    buffer_load_dwordx4 v[112:115], v1, s[8:11], s32 offen offset:0 sc1
    s_add_u32 s32, s43, 12288
    buffer_load_dwordx4 v[116:119], v1, s[8:11], s32 offen offset:1024 sc1
    s_add_u32 s32, s43, 12288
    buffer_load_dwordx4 v[120:123], v1, s[8:11], s32 offen offset:2048 sc1
    s_add_u32 s32, s43, 12288
    buffer_load_dwordx4 v[124:127], v1, s[8:11], s32 offen offset:3072 sc1
    s_add_u32 s32, s43, 16384
    buffer_load_dwordx4 v[128:131], v1, s[8:11], s32 offen offset:0 sc1
    s_add_u32 s32, s43, 16384
    buffer_load_dwordx4 v[132:135], v1, s[8:11], s32 offen offset:1024 sc1
    s_add_u32 s32, s43, 16384
    buffer_load_dwordx4 v[136:139], v1, s[8:11], s32 offen offset:2048 sc1
    s_add_u32 s32, s43, 16384
    buffer_load_dwordx4 v[140:143], v1, s[8:11], s32 offen offset:3072 sc1
    s_add_u32 s32, s43, 20480
    buffer_load_dwordx4 v[144:147], v1, s[8:11], s32 offen offset:0 sc1
    s_add_u32 s32, s43, 20480
    buffer_load_dwordx4 v[148:151], v1, s[8:11], s32 offen offset:1024 sc1
    s_add_u32 s32, s43, 20480
    buffer_load_dwordx4 v[152:155], v1, s[8:11], s32 offen offset:2048 sc1
    s_add_u32 s32, s43, 20480
    buffer_load_dwordx4 v[156:159], v1, s[8:11], s32 offen offset:3072 sc1
    s_add_u32 s32, s43, 24576
    buffer_load_dwordx4 v[160:163], v1, s[8:11], s32 offen offset:0 sc1
    s_add_u32 s32, s43, 24576
    buffer_load_dwordx4 v[164:167], v1, s[8:11], s32 offen offset:1024 sc1
    s_add_u32 s32, s43, 24576
    buffer_load_dwordx4 v[168:171], v1, s[8:11], s32 offen offset:2048 sc1
    s_add_u32 s32, s43, 24576
    buffer_load_dwordx4 v[172:175], v1, s[8:11], s32 offen offset:3072 sc1
    s_add_u32 s32, s43, 28672
    buffer_load_dwordx4 v[176:179], v1, s[8:11], s32 offen offset:0 sc1
    s_add_u32 s32, s43, 28672
    buffer_load_dwordx4 v[180:183], v1, s[8:11], s32 offen offset:1024 sc1
    s_add_u32 s32, s43, 28672
    buffer_load_dwordx4 v[184:187], v1, s[8:11], s32 offen offset:2048 sc1
    s_add_u32 s32, s43, 28672
    buffer_load_dwordx4 v[188:191], v1, s[8:11], s32 offen offset:3072 sc1
    s_add_u32 s43, s43, 65536
    s_add_u32 s45, s45, 256
    s_branch AH_67_loop
AH_67_done:
LE_AH:
    s_endpgm
L_O:
    s_lshr_b32 s4, s5, 4
    s_and_b32 s5, s5, 15
    s_cmp_eq_u32 s4, 0
    s_cbranch_scc1 L_O_ng0
    s_load_dwordx2 s[92:93], s[0:1], 88
    s_waitcnt lgkmcnt(0)
    s_mov_b32 s94, 256
    s_mov_b32 s95, 0x20000
    s_mov_b32 s96, 0
L_Ogi_iw:
    v_mbcnt_lo_u32_b32 v9, -1, 0
    v_mbcnt_hi_u32_b32 v9, -1, v9
    v_min_u32 v9, 7, v9
    v_and_b32 v10, 1, v9
    v_lshlrev_b32 v10, 7, v10
    v_lshrrev_b32 v9, 1, v9
    v_lshl_add_u32 v9, v9, 2, v10
    buffer_load_dword v9, v9, s[92:95], 0 offen sc1
    s_waitcnt vmcnt(0)
    v_cmp_gt_u32 vcc, 32, v9
    s_cmp_eq_u64 vcc, 0
    s_cselect_b32 s97, 256, 0
    s_cmp_ge_u32 s97, 256
    s_cbranch_scc1 L_Ogi_iwd
    s_add_u32 s96, s96, 1
    s_cmp_gt_u32 s96, 300000
    s_cbranch_scc1 L_fail
    s_sleep 2
    s_branch L_Ogi_iw
L_Ogi_iwd:
L_O_ng0:
    s_cmp_eq_u32 s4, 0
    s_cbranch_scc1 L_O_ng
    s_mov_b32 s12, 205725696
    s_mov_b32 s96, 0
    v_mbcnt_lo_u32_b32 v8, -1, 0
    v_mbcnt_hi_u32_b32 v8, -1, v8
    v_min_u32 v8, 15, v8
    v_lshlrev_b32 v8, 2, v8
L_Og_108_spin:
    buffer_load_dword v9, v8, s[8:11], s12 offen sc1
    s_waitcnt vmcnt(0)
    v_cmp_eq_u32 vcc, 0, v9
    s_cbranch_vccz L_Og_108_ok
    s_add_u32 s96, s96, 1
    s_cmp_gt_u32 s96, 300000
    s_cbranch_scc1 L_fail
    s_sleep 8
    s_branch L_Og_108_spin
L_Og_108_ok:
L_O_ng:
LB_O:
    s_load_dwordx2 s[12:13], s[0:1], 64
    s_waitcnt lgkmcnt(0)
    s_mov_b32 s14, 4194304
    s_mov_b32 s15, 0x20000
    s_lshr_b32 s40, s5, 2
    s_and_b32 s41, s5, 3
    v_lshrrev_b32 v61, 4, v0
    v_and_b32 v60, 15, v0
    v_lshlrev_b32 v62, 2, v61
    v_xor_b32 v62, v60, v62
    v_lshlrev_b32 v62, 4, v62
    v_lshl_add_u32 v62, v61, 10, v62
    s_lshl_b32 s32, s41, 8
    v_add_u32 v40, s32, v62
    s_and_b32 s54, s6, 1
    s_lshr_b32 s55, s6, 1
    s_lshl_b32 s32, s54, 3
    v_lshrrev_b32 v60, 4, v0
    v_and_b32 v61, 1, v60
    v_lshrrev_b32 v60, 1, v60
    v_bfe_u32 v62, v0, 2, 2
    v_and_b32 v63, 3, v0
    v_lshl_add_u32 v60, v60, 2, v62
    v_lshrrev_b32 v64, 1, v63
    v_lshl_add_u32 v64, v61, 1, v64
    v_add_u32 v64, s32, v64
    v_lshlrev_b32 v65, 2, v62
    v_xor_b32 v64, v64, v65
    v_lshlrev_b32 v64, 4, v64
    v_and_b32 v63, 1, v63
    v_lshl_add_u32 v64, v63, 3, v64
    v_mul_u32_u24 v60, 256, v60
    v_add_u32 v44, v60, v64
    v_add_u32 v44, 0, v44
    v_xor_b32 v45, 64, v44
    v_add_u32 v46, 0x10000, v44
    v_add_u32 v47, 0x10000, v45
    s_lshl_b32 s33, s40, 20
    s_lshl_b32 s35, s6, 16
    s_add_u32 s33, s33, s35
    s_add_u32 s33, s33, 0
    s_lshl_b32 s34, s6, 14
    s_add_u32 s34, s34, 0
    s_add_u32 m0, s34, 0
    s_add_u32 s35, s33, 0
    buffer_load_dwordx4 v40, s[12:15], s35 offen lds
    s_add_u32 m0, s34, 1024
    s_add_u32 s35, s33, 4096
    buffer_load_dwordx4 v40, s[12:15], s35 offen lds
    s_add_u32 m0, s34, 2048
    s_add_u32 s35, s33, 8192
    buffer_load_dwordx4 v40, s[12:15], s35 offen lds
    s_add_u32 m0, s34, 3072
    s_add_u32 s35, s33, 12288
    buffer_load_dwordx4 v40, s[12:15], s35 offen lds
    s_add_u32 m0, s34, 4096
    s_add_u32 s35, s33, 16384
    buffer_load_dwordx4 v40, s[12:15], s35 offen lds
    s_add_u32 m0, s34, 5120
    s_add_u32 s35, s33, 20480
    buffer_load_dwordx4 v40, s[12:15], s35 offen lds
    s_add_u32 m0, s34, 6144
    s_add_u32 s35, s33, 24576
    buffer_load_dwordx4 v40, s[12:15], s35 offen lds
    s_add_u32 m0, s34, 7168
    s_add_u32 s35, s33, 28672
    buffer_load_dwordx4 v40, s[12:15], s35 offen lds
    s_add_u32 m0, s34, 8192
    s_add_u32 s35, s33, 32768
    buffer_load_dwordx4 v40, s[12:15], s35 offen lds
    s_add_u32 m0, s34, 9216
    s_add_u32 s35, s33, 36864
    buffer_load_dwordx4 v40, s[12:15], s35 offen lds
    s_add_u32 m0, s34, 10240
    s_add_u32 s35, s33, 40960
    buffer_load_dwordx4 v40, s[12:15], s35 offen lds
    s_add_u32 m0, s34, 11264
    s_add_u32 s35, s33, 45056
    buffer_load_dwordx4 v40, s[12:15], s35 offen lds
    s_add_u32 m0, s34, 12288
    s_add_u32 s35, s33, 49152
    buffer_load_dwordx4 v40, s[12:15], s35 offen lds
    s_add_u32 m0, s34, 13312
    s_add_u32 s35, s33, 53248
    buffer_load_dwordx4 v40, s[12:15], s35 offen lds
    s_add_u32 m0, s34, 14336
    s_add_u32 s35, s33, 57344
    buffer_load_dwordx4 v40, s[12:15], s35 offen lds
    s_add_u32 m0, s34, 15360
    s_add_u32 s35, s33, 61440
    buffer_load_dwordx4 v40, s[12:15], s35 offen lds
    s_lshl_b32 s33, s40, 20
    s_lshl_b32 s35, s6, 16
    s_add_u32 s33, s33, s35
    s_add_u32 s33, s33, 262144
    s_lshl_b32 s34, s6, 14
    s_add_u32 s34, s34, 65536
    s_add_u32 m0, s34, 0
    s_add_u32 s35, s33, 0
    buffer_load_dwordx4 v40, s[12:15], s35 offen lds
    s_add_u32 m0, s34, 1024
    s_add_u32 s35, s33, 4096
    buffer_load_dwordx4 v40, s[12:15], s35 offen lds
    s_add_u32 m0, s34, 2048
    s_add_u32 s35, s33, 8192
    buffer_load_dwordx4 v40, s[12:15], s35 offen lds
    s_add_u32 m0, s34, 3072
    s_add_u32 s35, s33, 12288
    buffer_load_dwordx4 v40, s[12:15], s35 offen lds
    s_add_u32 m0, s34, 4096
    s_add_u32 s35, s33, 16384
    buffer_load_dwordx4 v40, s[12:15], s35 offen lds
    s_add_u32 m0, s34, 5120
    s_add_u32 s35, s33, 20480
    buffer_load_dwordx4 v40, s[12:15], s35 offen lds
    s_add_u32 m0, s34, 6144
    s_add_u32 s35, s33, 24576
    buffer_load_dwordx4 v40, s[12:15], s35 offen lds
    s_add_u32 m0, s34, 7168
    s_add_u32 s35, s33, 28672
    buffer_load_dwordx4 v40, s[12:15], s35 offen lds
    s_add_u32 m0, s34, 8192
    s_add_u32 s35, s33, 32768
    buffer_load_dwordx4 v40, s[12:15], s35 offen lds
    s_add_u32 m0, s34, 9216
    s_add_u32 s35, s33, 36864
    buffer_load_dwordx4 v40, s[12:15], s35 offen lds
    s_add_u32 m0, s34, 10240
    s_add_u32 s35, s33, 40960
    buffer_load_dwordx4 v40, s[12:15], s35 offen lds
    s_add_u32 m0, s34, 11264
    s_add_u32 s35, s33, 45056
    buffer_load_dwordx4 v40, s[12:15], s35 offen lds
    s_add_u32 m0, s34, 12288
    s_add_u32 s35, s33, 49152
    buffer_load_dwordx4 v40, s[12:15], s35 offen lds
    s_add_u32 m0, s34, 13312
    s_add_u32 s35, s33, 53248
    buffer_load_dwordx4 v40, s[12:15], s35 offen lds
    s_add_u32 m0, s34, 14336
    s_add_u32 s35, s33, 57344
    buffer_load_dwordx4 v40, s[12:15], s35 offen lds
    s_add_u32 m0, s34, 15360
    s_add_u32 s35, s33, 61440
    buffer_load_dwordx4 v40, s[12:15], s35 offen lds
    s_waitcnt vmcnt(16)
    s_barrier
    s_cmp_lg_u32 s55, 0
    s_cbranch_scc1 O_109w_110
    ds_read_b64_tr_b16 a[0:1], v44 offset:0
    ds_read_b64_tr_b16 a[2:3], v44 offset:2048
    ds_read_b64_tr_b16 a[128:129], v45 offset:0
    ds_read_b64_tr_b16 a[130:131], v45 offset:2048
    ds_read_b64_tr_b16 a[4:5], v44 offset:4096
    ds_read_b64_tr_b16 a[6:7], v44 offset:6144
    ds_read_b64_tr_b16 a[132:133], v45 offset:4096
    ds_read_b64_tr_b16 a[134:135], v45 offset:6144
    s_waitcnt lgkmcnt(4)
    ds_read_b64_tr_b16 a[8:9], v44 offset:8192
    ds_read_b64_tr_b16 a[10:11], v44 offset:10240
    ds_read_b64_tr_b16 a[136:137], v45 offset:8192
    ds_read_b64_tr_b16 a[138:139], v45 offset:10240
    ds_read_b64_tr_b16 a[12:13], v44 offset:12288
    ds_read_b64_tr_b16 a[14:15], v44 offset:14336
    ds_read_b64_tr_b16 a[140:141], v45 offset:12288
    ds_read_b64_tr_b16 a[142:143], v45 offset:14336
    s_waitcnt lgkmcnt(4)
    ds_read_b64_tr_b16 a[16:17], v44 offset:16384
    ds_read_b64_tr_b16 a[18:19], v44 offset:18432
    ds_read_b64_tr_b16 a[144:145], v45 offset:16384
    ds_read_b64_tr_b16 a[146:147], v45 offset:18432
    ds_read_b64_tr_b16 a[20:21], v44 offset:20480
    ds_read_b64_tr_b16 a[22:23], v44 offset:22528
    ds_read_b64_tr_b16 a[148:149], v45 offset:20480
    ds_read_b64_tr_b16 a[150:151], v45 offset:22528
    s_waitcnt lgkmcnt(4)
    ds_read_b64_tr_b16 a[24:25], v44 offset:24576
    ds_read_b64_tr_b16 a[26:27], v44 offset:26624
    ds_read_b64_tr_b16 a[152:153], v45 offset:24576
    ds_read_b64_tr_b16 a[154:155], v45 offset:26624
    ds_read_b64_tr_b16 a[28:29], v44 offset:28672
    ds_read_b64_tr_b16 a[30:31], v44 offset:30720
    ds_read_b64_tr_b16 a[156:157], v45 offset:28672
    ds_read_b64_tr_b16 a[158:159], v45 offset:30720
    s_waitcnt lgkmcnt(4)
    ds_read_b64_tr_b16 a[32:33], v44 offset:32768
    ds_read_b64_tr_b16 a[34:35], v44 offset:34816
    ds_read_b64_tr_b16 a[160:161], v45 offset:32768
    ds_read_b64_tr_b16 a[162:163], v45 offset:34816
    ds_read_b64_tr_b16 a[36:37], v44 offset:36864
    ds_read_b64_tr_b16 a[38:39], v44 offset:38912
    ds_read_b64_tr_b16 a[164:165], v45 offset:36864
    ds_read_b64_tr_b16 a[166:167], v45 offset:38912
    s_waitcnt lgkmcnt(4)
    ds_read_b64_tr_b16 a[40:41], v44 offset:40960
    ds_read_b64_tr_b16 a[42:43], v44 offset:43008
    ds_read_b64_tr_b16 a[168:169], v45 offset:40960
    ds_read_b64_tr_b16 a[170:171], v45 offset:43008
    ds_read_b64_tr_b16 a[44:45], v44 offset:45056
    ds_read_b64_tr_b16 a[46:47], v44 offset:47104
    ds_read_b64_tr_b16 a[172:173], v45 offset:45056
    ds_read_b64_tr_b16 a[174:175], v45 offset:47104
    s_waitcnt lgkmcnt(4)
    ds_read_b64_tr_b16 a[48:49], v44 offset:49152
    ds_read_b64_tr_b16 a[50:51], v44 offset:51200
    ds_read_b64_tr_b16 a[176:177], v45 offset:49152
    ds_read_b64_tr_b16 a[178:179], v45 offset:51200
    ds_read_b64_tr_b16 a[52:53], v44 offset:53248
    ds_read_b64_tr_b16 a[54:55], v44 offset:55296
    ds_read_b64_tr_b16 a[180:181], v45 offset:53248
    ds_read_b64_tr_b16 a[182:183], v45 offset:55296
    s_waitcnt lgkmcnt(4)
    ds_read_b64_tr_b16 a[56:57], v44 offset:57344
    ds_read_b64_tr_b16 a[58:59], v44 offset:59392
    ds_read_b64_tr_b16 a[184:185], v45 offset:57344
    ds_read_b64_tr_b16 a[186:187], v45 offset:59392
    ds_read_b64_tr_b16 a[60:61], v44 offset:61440
    ds_read_b64_tr_b16 a[62:63], v44 offset:63488
    ds_read_b64_tr_b16 a[188:189], v45 offset:61440
    ds_read_b64_tr_b16 a[190:191], v45 offset:63488
    s_waitcnt lgkmcnt(4)
O_109w_110:
    s_waitcnt lgkmcnt(0)
    s_barrier
    s_lshl_b32 s33, s40, 20
    s_lshl_b32 s35, s6, 16
    s_add_u32 s33, s33, s35
    s_add_u32 s33, s33, 524288
    s_lshl_b32 s34, s6, 14
    s_add_u32 s34, s34, 0
    s_add_u32 m0, s34, 0
    s_add_u32 s35, s33, 0
    buffer_load_dwordx4 v40, s[12:15], s35 offen lds
    s_add_u32 m0, s34, 1024
    s_add_u32 s35, s33, 4096
    buffer_load_dwordx4 v40, s[12:15], s35 offen lds
    s_add_u32 m0, s34, 2048
    s_add_u32 s35, s33, 8192
    buffer_load_dwordx4 v40, s[12:15], s35 offen lds
    s_add_u32 m0, s34, 3072
    s_add_u32 s35, s33, 12288
    buffer_load_dwordx4 v40, s[12:15], s35 offen lds
    s_add_u32 m0, s34, 4096
    s_add_u32 s35, s33, 16384
    buffer_load_dwordx4 v40, s[12:15], s35 offen lds
    s_add_u32 m0, s34, 5120
    s_add_u32 s35, s33, 20480
    buffer_load_dwordx4 v40, s[12:15], s35 offen lds
    s_add_u32 m0, s34, 6144
    s_add_u32 s35, s33, 24576
    buffer_load_dwordx4 v40, s[12:15], s35 offen lds
    s_add_u32 m0, s34, 7168
    s_add_u32 s35, s33, 28672
    buffer_load_dwordx4 v40, s[12:15], s35 offen lds
    s_add_u32 m0, s34, 8192
    s_add_u32 s35, s33, 32768
    buffer_load_dwordx4 v40, s[12:15], s35 offen lds
    s_add_u32 m0, s34, 9216
    s_add_u32 s35, s33, 36864
    buffer_load_dwordx4 v40, s[12:15], s35 offen lds
    s_add_u32 m0, s34, 10240
    s_add_u32 s35, s33, 40960
    buffer_load_dwordx4 v40, s[12:15], s35 offen lds
    s_add_u32 m0, s34, 11264
    s_add_u32 s35, s33, 45056
    buffer_load_dwordx4 v40, s[12:15], s35 offen lds
    s_add_u32 m0, s34, 12288
    s_add_u32 s35, s33, 49152
    buffer_load_dwordx4 v40, s[12:15], s35 offen lds
    s_add_u32 m0, s34, 13312
    s_add_u32 s35, s33, 53248
    buffer_load_dwordx4 v40, s[12:15], s35 offen lds
    s_add_u32 m0, s34, 14336
    s_add_u32 s35, s33, 57344
    buffer_load_dwordx4 v40, s[12:15], s35 offen lds
    s_add_u32 m0, s34, 15360
    s_add_u32 s35, s33, 61440
    buffer_load_dwordx4 v40, s[12:15], s35 offen lds
    s_waitcnt vmcnt(16)
    s_barrier
    s_cmp_lg_u32 s55, 0
    s_cbranch_scc1 O_109w_111
    ds_read_b64_tr_b16 a[64:65], v46 offset:0
    ds_read_b64_tr_b16 a[66:67], v46 offset:2048
    ds_read_b64_tr_b16 a[192:193], v47 offset:0
    ds_read_b64_tr_b16 a[194:195], v47 offset:2048
    ds_read_b64_tr_b16 a[68:69], v46 offset:4096
    ds_read_b64_tr_b16 a[70:71], v46 offset:6144
    ds_read_b64_tr_b16 a[196:197], v47 offset:4096
    ds_read_b64_tr_b16 a[198:199], v47 offset:6144
    s_waitcnt lgkmcnt(4)
    ds_read_b64_tr_b16 a[72:73], v46 offset:8192
    ds_read_b64_tr_b16 a[74:75], v46 offset:10240
    ds_read_b64_tr_b16 a[200:201], v47 offset:8192
    ds_read_b64_tr_b16 a[202:203], v47 offset:10240
    ds_read_b64_tr_b16 a[76:77], v46 offset:12288
    ds_read_b64_tr_b16 a[78:79], v46 offset:14336
    ds_read_b64_tr_b16 a[204:205], v47 offset:12288
    ds_read_b64_tr_b16 a[206:207], v47 offset:14336
    s_waitcnt lgkmcnt(4)
    ds_read_b64_tr_b16 a[80:81], v46 offset:16384
    ds_read_b64_tr_b16 a[82:83], v46 offset:18432
    ds_read_b64_tr_b16 a[208:209], v47 offset:16384
    ds_read_b64_tr_b16 a[210:211], v47 offset:18432
    ds_read_b64_tr_b16 a[84:85], v46 offset:20480
    ds_read_b64_tr_b16 a[86:87], v46 offset:22528
    ds_read_b64_tr_b16 a[212:213], v47 offset:20480
    ds_read_b64_tr_b16 a[214:215], v47 offset:22528
    s_waitcnt lgkmcnt(4)
    ds_read_b64_tr_b16 a[88:89], v46 offset:24576
    ds_read_b64_tr_b16 a[90:91], v46 offset:26624
    ds_read_b64_tr_b16 a[216:217], v47 offset:24576
    ds_read_b64_tr_b16 a[218:219], v47 offset:26624
    ds_read_b64_tr_b16 a[92:93], v46 offset:28672
    ds_read_b64_tr_b16 a[94:95], v46 offset:30720
    ds_read_b64_tr_b16 a[220:221], v47 offset:28672
    ds_read_b64_tr_b16 a[222:223], v47 offset:30720
    s_waitcnt lgkmcnt(4)
    ds_read_b64_tr_b16 a[96:97], v46 offset:32768
    ds_read_b64_tr_b16 a[98:99], v46 offset:34816
    ds_read_b64_tr_b16 a[224:225], v47 offset:32768
    ds_read_b64_tr_b16 a[226:227], v47 offset:34816
    ds_read_b64_tr_b16 a[100:101], v46 offset:36864
    ds_read_b64_tr_b16 a[102:103], v46 offset:38912
    ds_read_b64_tr_b16 a[228:229], v47 offset:36864
    ds_read_b64_tr_b16 a[230:231], v47 offset:38912
    s_waitcnt lgkmcnt(4)
    ds_read_b64_tr_b16 a[104:105], v46 offset:40960
    ds_read_b64_tr_b16 a[106:107], v46 offset:43008
    ds_read_b64_tr_b16 a[232:233], v47 offset:40960
    ds_read_b64_tr_b16 a[234:235], v47 offset:43008
    ds_read_b64_tr_b16 a[108:109], v46 offset:45056
    ds_read_b64_tr_b16 a[110:111], v46 offset:47104
    ds_read_b64_tr_b16 a[236:237], v47 offset:45056
    ds_read_b64_tr_b16 a[238:239], v47 offset:47104
    s_waitcnt lgkmcnt(4)
    ds_read_b64_tr_b16 a[112:113], v46 offset:49152
    ds_read_b64_tr_b16 a[114:115], v46 offset:51200
    ds_read_b64_tr_b16 a[240:241], v47 offset:49152
    ds_read_b64_tr_b16 a[242:243], v47 offset:51200
    ds_read_b64_tr_b16 a[116:117], v46 offset:53248
    ds_read_b64_tr_b16 a[118:119], v46 offset:55296
    ds_read_b64_tr_b16 a[244:245], v47 offset:53248
    ds_read_b64_tr_b16 a[246:247], v47 offset:55296
    s_waitcnt lgkmcnt(4)
    ds_read_b64_tr_b16 a[120:121], v46 offset:57344
    ds_read_b64_tr_b16 a[122:123], v46 offset:59392
    ds_read_b64_tr_b16 a[248:249], v47 offset:57344
    ds_read_b64_tr_b16 a[250:251], v47 offset:59392
    ds_read_b64_tr_b16 a[124:125], v46 offset:61440
    ds_read_b64_tr_b16 a[126:127], v46 offset:63488
    ds_read_b64_tr_b16 a[252:253], v47 offset:61440
    ds_read_b64_tr_b16 a[254:255], v47 offset:63488
    s_waitcnt lgkmcnt(4)
O_109w_111:
    s_waitcnt lgkmcnt(0)
    s_barrier
    s_lshl_b32 s33, s40, 20
    s_lshl_b32 s35, s6, 16
    s_add_u32 s33, s33, s35
    s_add_u32 s33, s33, 786432
    s_lshl_b32 s34, s6, 14
    s_add_u32 s34, s34, 65536
    s_add_u32 m0, s34, 0
    s_add_u32 s35, s33, 0
    buffer_load_dwordx4 v40, s[12:15], s35 offen lds
    s_add_u32 m0, s34, 1024
    s_add_u32 s35, s33, 4096
    buffer_load_dwordx4 v40, s[12:15], s35 offen lds
    s_add_u32 m0, s34, 2048
    s_add_u32 s35, s33, 8192
    buffer_load_dwordx4 v40, s[12:15], s35 offen lds
    s_add_u32 m0, s34, 3072
    s_add_u32 s35, s33, 12288
    buffer_load_dwordx4 v40, s[12:15], s35 offen lds
    s_add_u32 m0, s34, 4096
    s_add_u32 s35, s33, 16384
    buffer_load_dwordx4 v40, s[12:15], s35 offen lds
    s_add_u32 m0, s34, 5120
    s_add_u32 s35, s33, 20480
    buffer_load_dwordx4 v40, s[12:15], s35 offen lds
    s_add_u32 m0, s34, 6144
    s_add_u32 s35, s33, 24576
    buffer_load_dwordx4 v40, s[12:15], s35 offen lds
    s_add_u32 m0, s34, 7168
    s_add_u32 s35, s33, 28672
    buffer_load_dwordx4 v40, s[12:15], s35 offen lds
    s_add_u32 m0, s34, 8192
    s_add_u32 s35, s33, 32768
    buffer_load_dwordx4 v40, s[12:15], s35 offen lds
    s_add_u32 m0, s34, 9216
    s_add_u32 s35, s33, 36864
    buffer_load_dwordx4 v40, s[12:15], s35 offen lds
    s_add_u32 m0, s34, 10240
    s_add_u32 s35, s33, 40960
    buffer_load_dwordx4 v40, s[12:15], s35 offen lds
    s_add_u32 m0, s34, 11264
    s_add_u32 s35, s33, 45056
    buffer_load_dwordx4 v40, s[12:15], s35 offen lds
    s_add_u32 m0, s34, 12288
    s_add_u32 s35, s33, 49152
    buffer_load_dwordx4 v40, s[12:15], s35 offen lds
    s_add_u32 m0, s34, 13312
    s_add_u32 s35, s33, 53248
    buffer_load_dwordx4 v40, s[12:15], s35 offen lds
    s_add_u32 m0, s34, 14336
    s_add_u32 s35, s33, 57344
    buffer_load_dwordx4 v40, s[12:15], s35 offen lds
    s_add_u32 m0, s34, 15360
    s_add_u32 s35, s33, 61440
    buffer_load_dwordx4 v40, s[12:15], s35 offen lds
    s_waitcnt vmcnt(16)
    s_barrier
    s_cmp_lg_u32 s55, 1
    s_cbranch_scc1 O_109w_112
    ds_read_b64_tr_b16 a[0:1], v44 offset:0
    ds_read_b64_tr_b16 a[2:3], v44 offset:2048
    ds_read_b64_tr_b16 a[128:129], v45 offset:0
    ds_read_b64_tr_b16 a[130:131], v45 offset:2048
    ds_read_b64_tr_b16 a[4:5], v44 offset:4096
    ds_read_b64_tr_b16 a[6:7], v44 offset:6144
    ds_read_b64_tr_b16 a[132:133], v45 offset:4096
    ds_read_b64_tr_b16 a[134:135], v45 offset:6144
    s_waitcnt lgkmcnt(4)
    ds_read_b64_tr_b16 a[8:9], v44 offset:8192
    ds_read_b64_tr_b16 a[10:11], v44 offset:10240
    ds_read_b64_tr_b16 a[136:137], v45 offset:8192
    ds_read_b64_tr_b16 a[138:139], v45 offset:10240
    ds_read_b64_tr_b16 a[12:13], v44 offset:12288
    ds_read_b64_tr_b16 a[14:15], v44 offset:14336
    ds_read_b64_tr_b16 a[140:141], v45 offset:12288
    ds_read_b64_tr_b16 a[142:143], v45 offset:14336
    s_waitcnt lgkmcnt(4)
    ds_read_b64_tr_b16 a[16:17], v44 offset:16384
    ds_read_b64_tr_b16 a[18:19], v44 offset:18432
    ds_read_b64_tr_b16 a[144:145], v45 offset:16384
    ds_read_b64_tr_b16 a[146:147], v45 offset:18432
    ds_read_b64_tr_b16 a[20:21], v44 offset:20480
    ds_read_b64_tr_b16 a[22:23], v44 offset:22528
    ds_read_b64_tr_b16 a[148:149], v45 offset:20480
    ds_read_b64_tr_b16 a[150:151], v45 offset:22528
    s_waitcnt lgkmcnt(4)
    ds_read_b64_tr_b16 a[24:25], v44 offset:24576
    ds_read_b64_tr_b16 a[26:27], v44 offset:26624
    ds_read_b64_tr_b16 a[152:153], v45 offset:24576
    ds_read_b64_tr_b16 a[154:155], v45 offset:26624
    ds_read_b64_tr_b16 a[28:29], v44 offset:28672
    ds_read_b64_tr_b16 a[30:31], v44 offset:30720
    ds_read_b64_tr_b16 a[156:157], v45 offset:28672
    ds_read_b64_tr_b16 a[158:159], v45 offset:30720
    s_waitcnt lgkmcnt(4)
    ds_read_b64_tr_b16 a[32:33], v44 offset:32768
    ds_read_b64_tr_b16 a[34:35], v44 offset:34816
    ds_read_b64_tr_b16 a[160:161], v45 offset:32768
    ds_read_b64_tr_b16 a[162:163], v45 offset:34816
    ds_read_b64_tr_b16 a[36:37], v44 offset:36864
    ds_read_b64_tr_b16 a[38:39], v44 offset:38912
    ds_read_b64_tr_b16 a[164:165], v45 offset:36864
    ds_read_b64_tr_b16 a[166:167], v45 offset:38912
    s_waitcnt lgkmcnt(4)
    ds_read_b64_tr_b16 a[40:41], v44 offset:40960
    ds_read_b64_tr_b16 a[42:43], v44 offset:43008
    ds_read_b64_tr_b16 a[168:169], v45 offset:40960
    ds_read_b64_tr_b16 a[170:171], v45 offset:43008
    ds_read_b64_tr_b16 a[44:45], v44 offset:45056
    ds_read_b64_tr_b16 a[46:47], v44 offset:47104
    ds_read_b64_tr_b16 a[172:173], v45 offset:45056
    ds_read_b64_tr_b16 a[174:175], v45 offset:47104
    s_waitcnt lgkmcnt(4)
    ds_read_b64_tr_b16 a[48:49], v44 offset:49152
    ds_read_b64_tr_b16 a[50:51], v44 offset:51200
    ds_read_b64_tr_b16 a[176:177], v45 offset:49152
    ds_read_b64_tr_b16 a[178:179], v45 offset:51200
    ds_read_b64_tr_b16 a[52:53], v44 offset:53248
    ds_read_b64_tr_b16 a[54:55], v44 offset:55296
    ds_read_b64_tr_b16 a[180:181], v45 offset:53248
    ds_read_b64_tr_b16 a[182:183], v45 offset:55296
    s_waitcnt lgkmcnt(4)
    ds_read_b64_tr_b16 a[56:57], v44 offset:57344
    ds_read_b64_tr_b16 a[58:59], v44 offset:59392
    ds_read_b64_tr_b16 a[184:185], v45 offset:57344
    ds_read_b64_tr_b16 a[186:187], v45 offset:59392
    ds_read_b64_tr_b16 a[60:61], v44 offset:61440
    ds_read_b64_tr_b16 a[62:63], v44 offset:63488
    ds_read_b64_tr_b16 a[188:189], v45 offset:61440
    ds_read_b64_tr_b16 a[190:191], v45 offset:63488
    s_waitcnt lgkmcnt(4)
O_109w_112:
    s_waitcnt lgkmcnt(0)
    s_barrier
    s_waitcnt vmcnt(0)
    s_barrier
    s_cmp_lg_u32 s55, 1
    s_cbranch_scc1 O_109w_113
    ds_read_b64_tr_b16 a[64:65], v46 offset:0
    ds_read_b64_tr_b16 a[66:67], v46 offset:2048
    ds_read_b64_tr_b16 a[192:193], v47 offset:0
    ds_read_b64_tr_b16 a[194:195], v47 offset:2048
    ds_read_b64_tr_b16 a[68:69], v46 offset:4096
    ds_read_b64_tr_b16 a[70:71], v46 offset:6144
    ds_read_b64_tr_b16 a[196:197], v47 offset:4096
    ds_read_b64_tr_b16 a[198:199], v47 offset:6144
    s_waitcnt lgkmcnt(4)
    ds_read_b64_tr_b16 a[72:73], v46 offset:8192
    ds_read_b64_tr_b16 a[74:75], v46 offset:10240
    ds_read_b64_tr_b16 a[200:201], v47 offset:8192
    ds_read_b64_tr_b16 a[202:203], v47 offset:10240
    ds_read_b64_tr_b16 a[76:77], v46 offset:12288
    ds_read_b64_tr_b16 a[78:79], v46 offset:14336
    ds_read_b64_tr_b16 a[204:205], v47 offset:12288
    ds_read_b64_tr_b16 a[206:207], v47 offset:14336
    s_waitcnt lgkmcnt(4)
    ds_read_b64_tr_b16 a[80:81], v46 offset:16384
    ds_read_b64_tr_b16 a[82:83], v46 offset:18432
    ds_read_b64_tr_b16 a[208:209], v47 offset:16384
    ds_read_b64_tr_b16 a[210:211], v47 offset:18432
    ds_read_b64_tr_b16 a[84:85], v46 offset:20480
    ds_read_b64_tr_b16 a[86:87], v46 offset:22528
    ds_read_b64_tr_b16 a[212:213], v47 offset:20480
    ds_read_b64_tr_b16 a[214:215], v47 offset:22528
    s_waitcnt lgkmcnt(4)
    ds_read_b64_tr_b16 a[88:89], v46 offset:24576
    ds_read_b64_tr_b16 a[90:91], v46 offset:26624
    ds_read_b64_tr_b16 a[216:217], v47 offset:24576
    ds_read_b64_tr_b16 a[218:219], v47 offset:26624
    ds_read_b64_tr_b16 a[92:93], v46 offset:28672
    ds_read_b64_tr_b16 a[94:95], v46 offset:30720
    ds_read_b64_tr_b16 a[220:221], v47 offset:28672
    ds_read_b64_tr_b16 a[222:223], v47 offset:30720
    s_waitcnt lgkmcnt(4)
    ds_read_b64_tr_b16 a[96:97], v46 offset:32768
    ds_read_b64_tr_b16 a[98:99], v46 offset:34816
    ds_read_b64_tr_b16 a[224:225], v47 offset:32768
    ds_read_b64_tr_b16 a[226:227], v47 offset:34816
    ds_read_b64_tr_b16 a[100:101], v46 offset:36864
    ds_read_b64_tr_b16 a[102:103], v46 offset:38912
    ds_read_b64_tr_b16 a[228:229], v47 offset:36864
    ds_read_b64_tr_b16 a[230:231], v47 offset:38912
    s_waitcnt lgkmcnt(4)
    ds_read_b64_tr_b16 a[104:105], v46 offset:40960
    ds_read_b64_tr_b16 a[106:107], v46 offset:43008
    ds_read_b64_tr_b16 a[232:233], v47 offset:40960
    ds_read_b64_tr_b16 a[234:235], v47 offset:43008
    ds_read_b64_tr_b16 a[108:109], v46 offset:45056
    ds_read_b64_tr_b16 a[110:111], v46 offset:47104
    ds_read_b64_tr_b16 a[236:237], v47 offset:45056
    ds_read_b64_tr_b16 a[238:239], v47 offset:47104
    s_waitcnt lgkmcnt(4)
    ds_read_b64_tr_b16 a[112:113], v46 offset:49152
    ds_read_b64_tr_b16 a[114:115], v46 offset:51200
    ds_read_b64_tr_b16 a[240:241], v47 offset:49152
    ds_read_b64_tr_b16 a[242:243], v47 offset:51200
    ds_read_b64_tr_b16 a[116:117], v46 offset:53248
    ds_read_b64_tr_b16 a[118:119], v46 offset:55296
    ds_read_b64_tr_b16 a[244:245], v47 offset:53248
    ds_read_b64_tr_b16 a[246:247], v47 offset:55296
    s_waitcnt lgkmcnt(4)
    ds_read_b64_tr_b16 a[120:121], v46 offset:57344
    ds_read_b64_tr_b16 a[122:123], v46 offset:59392
    ds_read_b64_tr_b16 a[248:249], v47 offset:57344
    ds_read_b64_tr_b16 a[250:251], v47 offset:59392
    ds_read_b64_tr_b16 a[124:125], v46 offset:61440
    ds_read_b64_tr_b16 a[126:127], v46 offset:63488
    ds_read_b64_tr_b16 a[252:253], v47 offset:61440
    ds_read_b64_tr_b16 a[254:255], v47 offset:63488
    s_waitcnt lgkmcnt(4)
O_109w_113:
    s_waitcnt lgkmcnt(0)
    s_barrier
    v_lshlrev_b32 v1, 4, v0
    s_lshl_b32 s32, s6, 14
    v_add_u32 v2, s32, v1
    s_lshl_b32 s32, s4, 24
    s_lshl_b32 s33, s40, 16
    s_add_u32 s43, s32, s33
    s_add_u32 s43, s43, 117440512
    s_lshl_b32 s32, s4, 23
    s_lshl_b32 s33, s40, 15
    s_lshl_b32 s34, s41, 13
    s_add_u32 s44, s32, s33
    s_add_u32 s44, s44, s34
    s_lshl_b32 s34, s54, 12
    s_add_u32 s44, s44, s34
    s_lshl_b32 s34, s55, 11
    s_add_u32 s44, s44, s34
    s_add_u32 s44, s44, 150994944
    s_lshl_b32 s32, s4, 13
    s_lshl_b32 s33, s40, 5
    s_lshl_b32 s34, s6, 3
    s_add_u32 s45, s32, s33
    s_add_u32 s45, s45, s34
    s_add_u32 s45, s45, 205783040
    s_lshl_b32 s32, s4, 14
    s_lshl_b32 s33, s5, 4
    s_lshl_b32 s34, s6, 2
    s_add_u32 s46, s32, s33
    s_add_u32 s46, s46, s34
    s_add_u32 s46, s46, 205799424
    s_mov_b32 s47, 0
    s_mov_b32 s42, 0
    s_mov_b32 s52, 0
    s_load_dwordx2 s[92:93], s[0:1], 88
    s_waitcnt lgkmcnt(0)
    s_mov_b32 s94, 256
    s_mov_b32 s95, 0x20000
    s_mov_b32 s96, 0
O_109_iw:
    v_mbcnt_lo_u32_b32 v9, -1, 0
    v_mbcnt_hi_u32_b32 v9, -1, v9
    v_min_u32 v9, 7, v9
    v_and_b32 v10, 1, v9
    v_lshlrev_b32 v10, 7, v10
    v_lshrrev_b32 v9, 1, v9
    v_lshl_add_u32 v9, v9, 2, v10
    buffer_load_dword v9, v9, s[92:95], 0 offen sc1
    s_waitcnt vmcnt(0)
    v_cmp_gt_u32 vcc, 32, v9
    s_cmp_eq_u64 vcc, 0
    s_cselect_b32 s97, 256, 0
    s_cmp_ge_u32 s97, 256
    s_cbranch_scc1 O_109_iwd
    s_add_u32 s96, s96, 1
    s_cmp_gt_u32 s96, 300000
    s_cbranch_scc1 L_fail
    s_sleep 2
    s_branch O_109_iw
O_109_iwd:
    s_mov_b32 s96, 0
    v_mbcnt_lo_u32_b32 v250, -1, 0
    v_mbcnt_hi_u32_b32 v250, -1, v250
    v_min_u32 v250, 1, v250
    v_lshlrev_b32 v250, 2, v250
O_109w0_114_spin:
    buffer_load_dword v251, v250, s[8:11], s45 offen sc1
    s_waitcnt vmcnt(0)
    v_cmp_eq_u32 vcc, 0, v251
    s_cbranch_vccz O_109w0_114_ok
    s_add_u32 s96, s96, 1
    s_cmp_gt_u32 s96, 300000
    s_cbranch_scc1 L_fail
    s_sleep 1
    s_branch O_109w0_114_spin
O_109w0_114_ok:
    s_lshl_b32 s53, s6, 14
    s_add_u32 s53, s53, s42
    s_add_u32 m0, s53, 0
    s_add_u32 s33, s43, 0
    buffer_load_dwordx4 v2, s[8:11], s33 offen offset:0 sc1 lds
    buffer_load_dwordx4 v2, s[8:11], s33 offen offset:1024 sc1 lds
    buffer_load_dwordx4 v2, s[8:11], s33 offen offset:2048 sc1 lds
    buffer_load_dwordx4 v2, s[8:11], s33 offen offset:3072 sc1 lds
    s_add_u32 m0, s53, 4096
    s_add_u32 s33, s43, 4096
    buffer_load_dwordx4 v2, s[8:11], s33 offen offset:0 sc1 lds
    buffer_load_dwordx4 v2, s[8:11], s33 offen offset:1024 sc1 lds
    buffer_load_dwordx4 v2, s[8:11], s33 offen offset:2048 sc1 lds
    buffer_load_dwordx4 v2, s[8:11], s33 offen offset:3072 sc1 lds
    s_add_u32 m0, s53, 8192
    s_add_u32 s33, s43, 8192
    buffer_load_dwordx4 v2, s[8:11], s33 offen offset:0 sc1 lds
    buffer_load_dwordx4 v2, s[8:11], s33 offen offset:1024 sc1 lds
    buffer_load_dwordx4 v2, s[8:11], s33 offen offset:2048 sc1 lds
    buffer_load_dwordx4 v2, s[8:11], s33 offen offset:3072 sc1 lds
    s_add_u32 m0, s53, 12288
    s_add_u32 s33, s43, 12288
    buffer_load_dwordx4 v2, s[8:11], s33 offen offset:0 sc1 lds
    buffer_load_dwordx4 v2, s[8:11], s33 offen offset:1024 sc1 lds
    buffer_load_dwordx4 v2, s[8:11], s33 offen offset:2048 sc1 lds
    buffer_load_dwordx4 v2, s[8:11], s33 offen offset:3072 sc1 lds
    s_add_u32 s43, s43, 262144
    s_add_u32 s45, s45, 128
    s_waitcnt vmcnt(0)
    s_barrier
O_109_unit:
    s_lshl_b32 s32, s55, 15
    s_add_u32 s32, s32, s42
    v_add_u32 v5, s32, v1
    s_xor_b32 s50, s42, 65536
    v_mbcnt_lo_u32_b32 v10, -1, 0
    v_mbcnt_hi_u32_b32 v10, -1, v10
    v_min_u32 v10, 1, v10
    v_lshlrev_b32 v10, 2, v10
    buffer_load_dword v9, v10, s[8:11], s45 offen sc1
    ds_read_b128 v[64:67], v5 offset:0
    ds_read_b128 v[68:71], v5 offset:1024
    ds_read_b128 v[72:75], v5 offset:2048
    ds_read_b128 v[76:79], v5 offset:3072
    ds_read_b128 v[80:83], v5 offset:4096
    ds_read_b128 v[84:87], v5 offset:5120
    s_waitcnt lgkmcnt(5)
    v_mfma_f32_32x32x16_bf16 v[32:47], a[0:3], v[64:67], 0
    v_mfma_f32_32x32x16_bf16 v[48:63], a[128:131], v[64:67], 0
    ds_read_b128 v[88:91], v5 offset:6144
    s_waitcnt lgkmcnt(5)
    v_mfma_f32_32x32x16_bf16 v[32:47], a[4:7], v[68:71], v[32:47]
    v_mfma_f32_32x32x16_bf16 v[48:63], a[132:135], v[68:71], v[48:63]
    ds_read_b128 v[92:95], v5 offset:7168
    s_waitcnt lgkmcnt(5)
    v_mfma_f32_32x32x16_bf16 v[32:47], a[8:11], v[72:75], v[32:47]
    v_mfma_f32_32x32x16_bf16 v[48:63], a[136:139], v[72:75], v[48:63]
    ds_read_b128 v[64:67], v5 offset:8192
    s_waitcnt lgkmcnt(5)
    v_mfma_f32_32x32x16_bf16 v[32:47], a[12:15], v[76:79], v[32:47]
    v_mfma_f32_32x32x16_bf16 v[48:63], a[140:143], v[76:79], v[48:63]
    ds_read_b128 v[68:71], v5 offset:9216
    s_waitcnt lgkmcnt(5)
    v_mfma_f32_32x32x16_bf16 v[32:47], a[16:19], v[80:83], v[32:47]
    v_mfma_f32_32x32x16_bf16 v[48:63], a[144:147], v[80:83], v[48:63]
    ds_read_b128 v[72:75], v5 offset:10240
    s_waitcnt lgkmcnt(5)
    v_mfma_f32_32x32x16_bf16 v[32:47], a[20:23], v[84:87], v[32:47]
    v_mfma_f32_32x32x16_bf16 v[48:63], a[148:151], v[84:87], v[48:63]
    ds_read_b128 v[76:79], v5 offset:11264
    s_waitcnt lgkmcnt(5)
    v_mfma_f32_32x32x16_bf16 v[32:47], a[24:27], v[88:91], v[32:47]
    v_mfma_f32_32x32x16_bf16 v[48:63], a[152:155], v[88:91], v[48:63]
    ds_read_b128 v[80:83], v5 offset:12288
    s_waitcnt lgkmcnt(5)
    v_mfma_f32_32x32x16_bf16 v[32:47], a[28:31], v[92:95], v[32:47]
    v_mfma_f32_32x32x16_bf16 v[48:63], a[156:159], v[92:95], v[48:63]
    ds_read_b128 v[84:87], v5 offset:13312
    s_waitcnt lgkmcnt(5)
    v_mfma_f32_32x32x16_bf16 v[32:47], a[32:35], v[64:67], v[32:47]
    v_mfma_f32_32x32x16_bf16 v[48:63], a[160:163], v[64:67], v[48:63]
    ds_read_b128 v[88:91], v5 offset:14336
    s_waitcnt lgkmcnt(5)
    v_mfma_f32_32x32x16_bf16 v[32:47], a[36:39], v[68:71], v[32:47]
    v_mfma_f32_32x32x16_bf16 v[48:63], a[164:167], v[68:71], v[48:63]
    ds_read_b128 v[92:95], v5 offset:15360
    s_waitcnt lgkmcnt(5)
    v_mfma_f32_32x32x16_bf16 v[32:47], a[40:43], v[72:75], v[32:47]
    v_mfma_f32_32x32x16_bf16 v[48:63], a[168:171], v[72:75], v[48:63]
    ds_read_b128 v[64:67], v5 offset:16384
    s_waitcnt lgkmcnt(5)
    v_mfma_f32_32x32x16_bf16 v[32:47], a[44:47], v[76:79], v[32:47]
    v_mfma_f32_32x32x16_bf16 v[48:63], a[172:175], v[76:79], v[48:63]
    ds_read_b128 v[68:71], v5 offset:17408
    s_waitcnt lgkmcnt(5)
    v_mfma_f32_32x32x16_bf16 v[32:47], a[48:51], v[80:83], v[32:47]
    v_mfma_f32_32x32x16_bf16 v[48:63], a[176:179], v[80:83], v[48:63]
    ds_read_b128 v[72:75], v5 offset:18432
    s_cmp_eq_u32 s52, 0
    s_cbranch_scc1 O_109_nq0
    s_waitcnt vmcnt(1)
    v_mov_b32 v12, 1
    v_mov_b32 v11, 0
    s_mov_b64 exec, 1
    buffer_store_dword v12, v11, s[8:11], s46 offen sc1
    s_mov_b64 exec, -1
    s_add_u32 s46, s46, 256
    s_mov_b32 s52, 0
    s_waitcnt vmcnt(1)
    s_branch O_109_nq
O_109_nq0:
    s_waitcnt vmcnt(0)
O_109_nq:
    s_mov_b32 s48, 0
    s_cmp_ge_u32 s47, 63
    s_cselect_b32 s49, 1, 0
    v_cmp_eq_u32 vcc, 0, v9
    s_cmp_eq_u64 vcc, 0
    s_cselect_b32 s48, 1, 0
    s_cmp_eq_u32 s49, 1
    s_cselect_b32 s48, 0, s48
    s_cmp_eq_u32 s48, 0
    s_cbranch_scc1 O_109v_115_n
    s_waitcnt lgkmcnt(5)
    v_mfma_f32_32x32x16_bf16 v[32:47], a[52:55], v[84:87], v[32:47]
    v_mfma_f32_32x32x16_bf16 v[48:63], a[180:183], v[84:87], v[48:63]
    ds_read_b128 v[76:79], v5 offset:19456
    s_lshl_b32 s53, s6, 14
    s_add_u32 s53, s53, s50
    s_add_u32 m0, s53, 0
    s_add_u32 s33, s43, 0
    buffer_load_dwordx4 v2, s[8:11], s33 offen offset:0 sc1 lds
    s_waitcnt lgkmcnt(5)
    v_mfma_f32_32x32x16_bf16 v[32:47], a[56:59], v[88:91], v[32:47]
    v_mfma_f32_32x32x16_bf16 v[48:63], a[184:187], v[88:91], v[48:63]
    ds_read_b128 v[80:83], v5 offset:20480
    buffer_load_dwordx4 v2, s[8:11], s33 offen offset:1024 sc1 lds
    s_waitcnt lgkmcnt(5)
    v_mfma_f32_32x32x16_bf16 v[32:47], a[60:63], v[92:95], v[32:47]
    v_mfma_f32_32x32x16_bf16 v[48:63], a[188:191], v[92:95], v[48:63]
    ds_read_b128 v[84:87], v5 offset:21504
    buffer_load_dwordx4 v2, s[8:11], s33 offen offset:2048 sc1 lds
    s_waitcnt lgkmcnt(5)
    v_mfma_f32_32x32x16_bf16 v[32:47], a[64:67], v[64:67], v[32:47]
    v_mfma_f32_32x32x16_bf16 v[48:63], a[192:195], v[64:67], v[48:63]
    ds_read_b128 v[88:91], v5 offset:22528
    buffer_load_dwordx4 v2, s[8:11], s33 offen offset:3072 sc1 lds
    s_waitcnt lgkmcnt(5)
    v_mfma_f32_32x32x16_bf16 v[32:47], a[68:71], v[68:71], v[32:47]
    v_mfma_f32_32x32x16_bf16 v[48:63], a[196:199], v[68:71], v[48:63]
    ds_read_b128 v[92:95], v5 offset:23552
    s_add_u32 m0, s53, 4096
    s_add_u32 s33, s43, 4096
    buffer_load_dwordx4 v2, s[8:11], s33 offen offset:0 sc1 lds
    s_waitcnt lgkmcnt(5)
    v_mfma_f32_32x32x16_bf16 v[32:47], a[72:75], v[72:75], v[32:47]
    v_mfma_f32_32x32x16_bf16 v[48:63], a[200:203], v[72:75], v[48:63]
    ds_read_b128 v[64:67], v5 offset:24576
    buffer_load_dwordx4 v2, s[8:11], s33 offen offset:1024 sc1 lds
    s_waitcnt lgkmcnt(5)
    v_mfma_f32_32x32x16_bf16 v[32:47], a[76:79], v[76:79], v[32:47]
    v_mfma_f32_32x32x16_bf16 v[48:63], a[204:207], v[76:79], v[48:63]
    ds_read_b128 v[68:71], v5 offset:25600
    buffer_load_dwordx4 v2, s[8:11], s33 offen offset:2048 sc1 lds
    s_waitcnt lgkmcnt(5)
    v_mfma_f32_32x32x16_bf16 v[32:47], a[80:83], v[80:83], v[32:47]
    v_mfma_f32_32x32x16_bf16 v[48:63], a[208:211], v[80:83], v[48:63]
    ds_read_b128 v[72:75], v5 offset:26624
    buffer_load_dwordx4 v2, s[8:11], s33 offen offset:3072 sc1 lds
    s_waitcnt lgkmcnt(5)
    v_mfma_f32_32x32x16_bf16 v[32:47], a[84:87], v[84:87], v[32:47]
    v_mfma_f32_32x32x16_bf16 v[48:63], a[212:215], v[84:87], v[48:63]
    ds_read_b128 v[76:79], v5 offset:27648
    s_add_u32 m0, s53, 8192
    s_add_u32 s33, s43, 8192
    buffer_load_dwordx4 v2, s[8:11], s33 offen offset:0 sc1 lds
    s_waitcnt lgkmcnt(5)
    v_mfma_f32_32x32x16_bf16 v[32:47], a[88:91], v[88:91], v[32:47]
    v_mfma_f32_32x32x16_bf16 v[48:63], a[216:219], v[88:91], v[48:63]
    ds_read_b128 v[80:83], v5 offset:28672
    buffer_load_dwordx4 v2, s[8:11], s33 offen offset:1024 sc1 lds
    s_waitcnt lgkmcnt(5)
    v_mfma_f32_32x32x16_bf16 v[32:47], a[92:95], v[92:95], v[32:47]
    v_mfma_f32_32x32x16_bf16 v[48:63], a[220:223], v[92:95], v[48:63]
    ds_read_b128 v[84:87], v5 offset:29696
    buffer_load_dwordx4 v2, s[8:11], s33 offen offset:2048 sc1 lds
    s_waitcnt lgkmcnt(5)
    v_mfma_f32_32x32x16_bf16 v[32:47], a[96:99], v[64:67], v[32:47]
    v_mfma_f32_32x32x16_bf16 v[48:63], a[224:227], v[64:67], v[48:63]
    ds_read_b128 v[88:91], v5 offset:30720
    buffer_load_dwordx4 v2, s[8:11], s33 offen offset:3072 sc1 lds
    s_waitcnt lgkmcnt(5)
    v_mfma_f32_32x32x16_bf16 v[32:47], a[100:103], v[68:71], v[32:47]
    v_mfma_f32_32x32x16_bf16 v[48:63], a[228:231], v[68:71], v[48:63]
    ds_read_b128 v[92:95], v5 offset:31744
    s_add_u32 m0, s53, 12288
    s_add_u32 s33, s43, 12288
    buffer_load_dwordx4 v2, s[8:11], s33 offen offset:0 sc1 lds
    s_waitcnt lgkmcnt(5)
    v_mfma_f32_32x32x16_bf16 v[32:47], a[104:107], v[72:75], v[32:47]
    v_mfma_f32_32x32x16_bf16 v[48:63], a[232:235], v[72:75], v[48:63]
    buffer_load_dwordx4 v2, s[8:11], s33 offen offset:1024 sc1 lds
    s_waitcnt lgkmcnt(4)
    v_mfma_f32_32x32x16_bf16 v[32:47], a[108:111], v[76:79], v[32:47]
    v_mfma_f32_32x32x16_bf16 v[48:63], a[236:239], v[76:79], v[48:63]
    buffer_load_dwordx4 v2, s[8:11], s33 offen offset:2048 sc1 lds
    s_waitcnt lgkmcnt(3)
    v_mfma_f32_32x32x16_bf16 v[32:47], a[112:115], v[80:83], v[32:47]
    v_mfma_f32_32x32x16_bf16 v[48:63], a[240:243], v[80:83], v[48:63]
    buffer_load_dwordx4 v2, s[8:11], s33 offen offset:3072 sc1 lds
    s_branch O_109v_115_e
O_109v_115_n:
    s_waitcnt lgkmcnt(5)
    v_mfma_f32_32x32x16_bf16 v[32:47], a[52:55], v[84:87], v[32:47]
    v_mfma_f32_32x32x16_bf16 v[48:63], a[180:183], v[84:87], v[48:63]
    ds_read_b128 v[76:79], v5 offset:19456
    s_waitcnt lgkmcnt(5)
    v_mfma_f32_32x32x16_bf16 v[32:47], a[56:59], v[88:91], v[32:47]
    v_mfma_f32_32x32x16_bf16 v[48:63], a[184:187], v[88:91], v[48:63]
    ds_read_b128 v[80:83], v5 offset:20480
    s_waitcnt lgkmcnt(5)
    v_mfma_f32_32x32x16_bf16 v[32:47], a[60:63], v[92:95], v[32:47]
    v_mfma_f32_32x32x16_bf16 v[48:63], a[188:191], v[92:95], v[48:63]
    ds_read_b128 v[84:87], v5 offset:21504
    s_waitcnt lgkmcnt(5)
    v_mfma_f32_32x32x16_bf16 v[32:47], a[64:67], v[64:67], v[32:47]
    v_mfma_f32_32x32x16_bf16 v[48:63], a[192:195], v[64:67], v[48:63]
    ds_read_b128 v[88:91], v5 offset:22528
    s_waitcnt lgkmcnt(5)
    v_mfma_f32_32x32x16_bf16 v[32:47], a[68:71], v[68:71], v[32:47]
    v_mfma_f32_32x32x16_bf16 v[48:63], a[196:199], v[68:71], v[48:63]
    ds_read_b128 v[92:95], v5 offset:23552
    s_waitcnt lgkmcnt(5)
    v_mfma_f32_32x32x16_bf16 v[32:47], a[72:75], v[72:75], v[32:47]
    v_mfma_f32_32x32x16_bf16 v[48:63], a[200:203], v[72:75], v[48:63]
    ds_read_b128 v[64:67], v5 offset:24576
    s_waitcnt lgkmcnt(5)
    v_mfma_f32_32x32x16_bf16 v[32:47], a[76:79], v[76:79], v[32:47]
    v_mfma_f32_32x32x16_bf16 v[48:63], a[204:207], v[76:79], v[48:63]
    ds_read_b128 v[68:71], v5 offset:25600
    s_waitcnt lgkmcnt(5)
    v_mfma_f32_32x32x16_bf16 v[32:47], a[80:83], v[80:83], v[32:47]
    v_mfma_f32_32x32x16_bf16 v[48:63], a[208:211], v[80:83], v[48:63]
    ds_read_b128 v[72:75], v5 offset:26624
    s_waitcnt lgkmcnt(5)
    v_mfma_f32_32x32x16_bf16 v[32:47], a[84:87], v[84:87], v[32:47]
    v_mfma_f32_32x32x16_bf16 v[48:63], a[212:215], v[84:87], v[48:63]
    ds_read_b128 v[76:79], v5 offset:27648
    s_waitcnt lgkmcnt(5)
    v_mfma_f32_32x32x16_bf16 v[32:47], a[88:91], v[88:91], v[32:47]
    v_mfma_f32_32x32x16_bf16 v[48:63], a[216:219], v[88:91], v[48:63]
    ds_read_b128 v[80:83], v5 offset:28672
    s_waitcnt lgkmcnt(5)
    v_mfma_f32_32x32x16_bf16 v[32:47], a[92:95], v[92:95], v[32:47]
    v_mfma_f32_32x32x16_bf16 v[48:63], a[220:223], v[92:95], v[48:63]
    ds_read_b128 v[84:87], v5 offset:29696
    s_waitcnt lgkmcnt(5)
    v_mfma_f32_32x32x16_bf16 v[32:47], a[96:99], v[64:67], v[32:47]
    v_mfma_f32_32x32x16_bf16 v[48:63], a[224:227], v[64:67], v[48:63]
    ds_read_b128 v[88:91], v5 offset:30720
    s_waitcnt lgkmcnt(5)
    v_mfma_f32_32x32x16_bf16 v[32:47], a[100:103], v[68:71], v[32:47]
    v_mfma_f32_32x32x16_bf16 v[48:63], a[228:231], v[68:71], v[48:63]
    ds_read_b128 v[92:95], v5 offset:31744
    s_waitcnt lgkmcnt(5)
    v_mfma_f32_32x32x16_bf16 v[32:47], a[104:107], v[72:75], v[32:47]
    v_mfma_f32_32x32x16_bf16 v[48:63], a[232:235], v[72:75], v[48:63]
    s_waitcnt lgkmcnt(4)
    v_mfma_f32_32x32x16_bf16 v[32:47], a[108:111], v[76:79], v[32:47]
    v_mfma_f32_32x32x16_bf16 v[48:63], a[236:239], v[76:79], v[48:63]
    s_waitcnt lgkmcnt(3)
    v_mfma_f32_32x32x16_bf16 v[32:47], a[112:115], v[80:83], v[32:47]
    v_mfma_f32_32x32x16_bf16 v[48:63], a[240:243], v[80:83], v[48:63]
O_109v_115_e:
    s_waitcnt lgkmcnt(2)
    v_mfma_f32_32x32x16_bf16 v[32:47], a[116:119], v[84:87], v[32:47]
    v_mfma_f32_32x32x16_bf16 v[48:63], a[244:247], v[84:87], v[48:63]
    s_waitcnt lgkmcnt(1)
    v_mfma_f32_32x32x16_bf16 v[32:47], a[120:123], v[88:91], v[32:47]
    v_mfma_f32_32x32x16_bf16 v[48:63], a[248:251], v[88:91], v[48:63]
    s_waitcnt lgkmcnt(0)
    v_mfma_f32_32x32x16_bf16 v[32:47], a[124:127], v[92:95], v[32:47]
    v_mfma_f32_32x32x16_bf16 v[48:63], a[252:255], v[92:95], v[48:63]
    s_lshl_b32 s32, s6, 12
    s_add_u32 s32, s32, 131072
    v_add_u32 v6, s32, v1
    s_xor_b32 s32, s6, 2
    s_lshl_b32 s32, s32, 12
    s_add_u32 s32, s32, 131072
    v_add_u32 v7, s32, v1
    s_cmp_eq_u32 s55, 0
    s_cbranch_scc1 O_109r_116_0
    s_nop 1
    ds_write_b128 v6, v[32:35] offset:0
    ds_write_b128 v6, v[36:39] offset:1024
    ds_write_b128 v6, v[40:43] offset:2048
    ds_write_b128 v6, v[44:47] offset:3072
    v_mov_b32 v32, v48
    v_mov_b32 v33, v49
    v_mov_b32 v34, v50
    v_mov_b32 v35, v51
    v_mov_b32 v36, v52
    v_mov_b32 v37, v53
    v_mov_b32 v38, v54
    v_mov_b32 v39, v55
    v_mov_b32 v40, v56
    v_mov_b32 v41, v57
    v_mov_b32 v42, v58
    v_mov_b32 v43, v59
    v_mov_b32 v44, v60
    v_mov_b32 v45, v61
    v_mov_b32 v46, v62
    v_mov_b32 v47, v63
    s_branch O_109r_116_1
O_109r_116_0:
    s_nop 2
    ds_write_b128 v6, v[48:51] offset:0
    ds_write_b128 v6, v[52:55] offset:1024
    ds_write_b128 v6, v[56:59] offset:2048
    ds_write_b128 v6, v[60:63] offset:3072
O_109r_116_1:
    s_waitcnt lgkmcnt(0)
    s_barrier
    ds_read_b128 v[48:51], v7 offset:0
    ds_read_b128 v[52:55], v7 offset:1024
    ds_read_b128 v[56:59], v7 offset:2048
    ds_read_b128 v[60:63], v7 offset:3072
    s_waitcnt lgkmcnt(0)
    v_pk_add_f32 v[32:33], v[32:33], v[48:49]
    v_pk_add_f32 v[34:35], v[34:35], v[50:51]
    v_pk_add_f32 v[36:37], v[36:37], v[52:53]
    v_pk_add_f32 v[38:39], v[38:39], v[54:55]
    v_pk_add_f32 v[40:41], v[40:41], v[56:57]
    v_pk_add_f32 v[42:43], v[42:43], v[58:59]
    v_pk_add_f32 v[44:45], v[44:45], v[60:61]
    v_pk_add_f32 v[46:47], v[46:47], v[62:63]
    v_cvt_pk_bf16_f32 v96, v32, v33
    v_cvt_pk_bf16_f32 v97, v34, v35
    v_cvt_pk_bf16_f32 v98, v36, v37
    v_cvt_pk_bf16_f32 v99, v38, v39
    v_cvt_pk_bf16_f32 v100, v40, v41
    v_cvt_pk_bf16_f32 v101, v42, v43
    v_cvt_pk_bf16_f32 v102, v44, v45
    v_cvt_pk_bf16_f32 v103, v46, v47
    buffer_store_dwordx4 v[96:99], v1, s[8:11], s44 offen offset:0 sc1
    buffer_store_dwordx4 v[100:103], v1, s[8:11], s44 offen offset:1024 sc1
    s_add_u32 s44, s44, 131072
    s_add_u32 s47, s47, 1
    s_mov_b32 s42, s50
    s_cmp_eq_u32 s48, 0
    s_cbranch_scc1 O_109_slow
    s_mov_b32 s52, 1
    s_add_u32 s43, s43, 262144
    s_add_u32 s45, s45, 128
    s_waitcnt vmcnt(2)
    s_barrier
    s_branch O_109_unit
O_109_slow:
    s_waitcnt vmcnt(0)
    v_mov_b32 v12, 1
    v_mov_b32 v11, 0
    s_mov_b64 exec, 1
    buffer_store_dword v12, v11, s[8:11], s46 offen sc1
    s_mov_b64 exec, -1
    s_add_u32 s46, s46, 256
    s_cmp_ge_u32 s47, 64
    s_cbranch_scc1 O_109_done
    s_mov_b32 s96, 0
    v_mbcnt_lo_u32_b32 v250, -1, 0
    v_mbcnt_hi_u32_b32 v250, -1, v250
    v_min_u32 v250, 1, v250
    v_lshlrev_b32 v250, 2, v250
O_109ws_117_spin:
    buffer_load_dword v251, v250, s[8:11], s45 offen sc1
    s_waitcnt vmcnt(0)
    v_cmp_eq_u32 vcc, 0, v251
    s_cbranch_vccz O_109ws_117_ok
    s_add_u32 s96, s96, 1
    s_cmp_gt_u32 s96, 300000
    s_cbranch_scc1 L_fail
    s_sleep 1
    s_branch O_109ws_117_spin
O_109ws_117_ok:
    s_lshl_b32 s53, s6, 14
    s_add_u32 s53, s53, s42
    s_add_u32 m0, s53, 0
    s_add_u32 s33, s43, 0
    buffer_load_dwordx4 v2, s[8:11], s33 offen offset:0 sc1 lds
    buffer_load_dwordx4 v2, s[8:11], s33 offen offset:1024 sc1 lds
    buffer_load_dwordx4 v2, s[8:11], s33 offen offset:2048 sc1 lds
    buffer_load_dwordx4 v2, s[8:11], s33 offen offset:3072 sc1 lds
    s_add_u32 m0, s53, 4096
    s_add_u32 s33, s43, 4096
    buffer_load_dwordx4 v2, s[8:11], s33 offen offset:0 sc1 lds
    buffer_load_dwordx4 v2, s[8:11], s33 offen offset:1024 sc1 lds
    buffer_load_dwordx4 v2, s[8:11], s33 offen offset:2048 sc1 lds
    buffer_load_dwordx4 v2, s[8:11], s33 offen offset:3072 sc1 lds
    s_add_u32 m0, s53, 8192
    s_add_u32 s33, s43, 8192
    buffer_load_dwordx4 v2, s[8:11], s33 offen offset:0 sc1 lds
    buffer_load_dwordx4 v2, s[8:11], s33 offen offset:1024 sc1 lds
    buffer_load_dwordx4 v2, s[8:11], s33 offen offset:2048 sc1 lds
    buffer_load_dwordx4 v2, s[8:11], s33 offen offset:3072 sc1 lds
    s_add_u32 m0, s53, 12288
    s_add_u32 s33, s43, 12288
    buffer_load_dwordx4 v2, s[8:11], s33 offen offset:0 sc1 lds
    buffer_load_dwordx4 v2, s[8:11], s33 offen offset:1024 sc1 lds
    buffer_load_dwordx4 v2, s[8:11], s33 offen offset:2048 sc1 lds
    buffer_load_dwordx4 v2, s[8:11], s33 offen offset:3072 sc1 lds
    s_add_u32 s43, s43, 262144
    s_add_u32 s45, s45, 128
    s_waitcnt vmcnt(0)
    s_barrier
    s_branch O_109_unit
O_109_done:
LE_O:
    s_endpgm
L_P:
    s_sub_u32 s4, s3, 2
    s_cmp_eq_u32 s4, 0
    s_cbranch_scc1 L_P_ng0
    s_load_dwordx2 s[92:93], s[0:1], 88
    s_waitcnt lgkmcnt(0)
    s_mov_b32 s94, 256
    s_mov_b32 s95, 0x20000
    s_mov_b32 s96, 0
L_Pgi_iw:
    v_mbcnt_lo_u32_b32 v9, -1, 0
    v_mbcnt_hi_u32_b32 v9, -1, v9
    v_min_u32 v9, 7, v9
    v_and_b32 v10, 1, v9
    v_lshlrev_b32 v10, 7, v10
    v_lshrrev_b32 v9, 1, v9
    v_lshl_add_u32 v9, v9, 2, v10
    buffer_load_dword v9, v9, s[92:95], 0 offen sc1
    s_waitcnt vmcnt(0)
    v_cmp_gt_u32 vcc, 32, v9
    s_cmp_eq_u64 vcc, 0
    s_cselect_b32 s97, 256, 0
    s_cmp_ge_u32 s97, 256
    s_cbranch_scc1 L_Pgi_iwd
    s_add_u32 s96, s96, 1
    s_cmp_gt_u32 s96, 300000
    s_cbranch_scc1 L_fail
    s_sleep 2
    s_branch L_Pgi_iw
L_Pgi_iwd:
L_P_ng0:
    s_cmp_eq_u32 s4, 0
    s_cbranch_scc1 L_P_ng
    s_mov_b32 s12, 205725696
    s_mov_b32 s96, 0
    v_mbcnt_lo_u32_b32 v8, -1, 0
    v_mbcnt_hi_u32_b32 v8, -1, v8
    v_min_u32 v8, 15, v8
    v_lshlrev_b32 v8, 2, v8
L_Pg_118_spin:
    buffer_load_dword v9, v8, s[8:11], s12 offen sc1
    s_waitcnt vmcnt(0)
    v_cmp_eq_u32 vcc, 0, v9
    s_cbranch_vccz L_Pg_118_ok
    s_add_u32 s96, s96, 1
    s_cmp_gt_u32 s96, 300000
    s_cbranch_scc1 L_fail
    s_sleep 8
    s_branch L_Pg_118_spin
L_Pg_118_ok:
L_P_ng:
LB_P:
    s_load_dwordx2 s[12:13], s[0:1], 40
    s_load_dwordx2 s[16:17], s[0:1], 48
    s_load_dwordx2 s[20:21], s[0:1], 56
    s_waitcnt lgkmcnt(0)
    s_mov_b32 s14, 4194304
    s_mov_b32 s15, 0x20000
    s_mov_b32 s18, 4194304
    s_mov_b32 s19, 0x20000
    s_mov_b32 s22, 4194304
    s_mov_b32 s23, 0x20000
    v_lshrrev_b32 v61, 4, v0
    v_and_b32 v60, 15, v0
    v_lshlrev_b32 v62, 2, v61
    v_xor_b32 v62, v60, v62
    v_lshlrev_b32 v62, 4, v62
    v_lshl_add_u32 v62, v61, 13, v62
    s_lshl_b32 s32, s5, 8
    v_add_u32 v40, s32, v62
    s_lshl_b32 s32, s6, 2
    v_lshrrev_b32 v60, 4, v0
    v_and_b32 v61, 1, v60
    v_lshrrev_b32 v60, 1, v60
    v_bfe_u32 v62, v0, 2, 2
    v_and_b32 v63, 3, v0
    v_lshl_add_u32 v60, v60, 2, v62
    v_lshrrev_b32 v64, 1, v63
    v_lshl_add_u32 v64, v61, 1, v64
    v_add_u32 v64, s32, v64
    v_lshlrev_b32 v65, 2, v62
    v_xor_b32 v64, v64, v65
    v_lshlrev_b32 v64, 4, v64
    v_and_b32 v63, 1, v63
    v_lshl_add_u32 v64, v63, 3, v64
    v_mul_u32_u24 v60, 256, v60
    v_add_u32 v44, v60, v64
    v_add_u32 v44, 0, v44
    v_add_u32 v45, 0x10000, v44
    s_lshl_b32 s33, s6, 19
    s_add_u32 s33, s33, 0
    s_lshl_b32 s34, s6, 14
    s_add_u32 s34, s34, 0
    s_add_u32 m0, s34, 0
    s_add_u32 s35, s33, 0
    buffer_load_dwordx4 v40, s[16:19], s35 offen lds
    s_add_u32 m0, s34, 1024
    s_add_u32 s35, s33, 32768
    buffer_load_dwordx4 v40, s[16:19], s35 offen lds
    s_add_u32 m0, s34, 2048
    s_add_u32 s35, s33, 65536
    buffer_load_dwordx4 v40, s[16:19], s35 offen lds
    s_add_u32 m0, s34, 3072
    s_add_u32 s35, s33, 98304
    buffer_load_dwordx4 v40, s[16:19], s35 offen lds
    s_add_u32 m0, s34, 4096
    s_add_u32 s35, s33, 131072
    buffer_load_dwordx4 v40, s[16:19], s35 offen lds
    s_add_u32 m0, s34, 5120
    s_add_u32 s35, s33, 163840
    buffer_load_dwordx4 v40, s[16:19], s35 offen lds
    s_add_u32 m0, s34, 6144
    s_add_u32 s35, s33, 196608
    buffer_load_dwordx4 v40, s[16:19], s35 offen lds
    s_add_u32 m0, s34, 7168
    s_add_u32 s35, s33, 229376
    buffer_load_dwordx4 v40, s[16:19], s35 offen lds
    s_add_u32 m0, s34, 8192
    s_add_u32 s35, s33, 262144
    buffer_load_dwordx4 v40, s[16:19], s35 offen lds
    s_add_u32 m0, s34, 9216
    s_add_u32 s35, s33, 294912
    buffer_load_dwordx4 v40, s[16:19], s35 offen lds
    s_add_u32 m0, s34, 10240
    s_add_u32 s35, s33, 327680
    buffer_load_dwordx4 v40, s[16:19], s35 offen lds
    s_add_u32 m0, s34, 11264
    s_add_u32 s35, s33, 360448
    buffer_load_dwordx4 v40, s[16:19], s35 offen lds
    s_add_u32 m0, s34, 12288
    s_add_u32 s35, s33, 393216
    buffer_load_dwordx4 v40, s[16:19], s35 offen lds
    s_add_u32 m0, s34, 13312
    s_add_u32 s35, s33, 425984
    buffer_load_dwordx4 v40, s[16:19], s35 offen lds
    s_add_u32 m0, s34, 14336
    s_add_u32 s35, s33, 458752
    buffer_load_dwordx4 v40, s[16:19], s35 offen lds
    s_add_u32 m0, s34, 15360
    s_add_u32 s35, s33, 491520
    buffer_load_dwordx4 v40, s[16:19], s35 offen lds
    s_lshl_b32 s33, s6, 19
    s_add_u32 s33, s33, 2097152
    s_lshl_b32 s34, s6, 14
    s_add_u32 s34, s34, 65536
    s_add_u32 m0, s34, 0
    s_add_u32 s35, s33, 0
    buffer_load_dwordx4 v40, s[16:19], s35 offen lds
    s_add_u32 m0, s34, 1024
    s_add_u32 s35, s33, 32768
    buffer_load_dwordx4 v40, s[16:19], s35 offen lds
    s_add_u32 m0, s34, 2048
    s_add_u32 s35, s33, 65536
    buffer_load_dwordx4 v40, s[16:19], s35 offen lds
    s_add_u32 m0, s34, 3072
    s_add_u32 s35, s33, 98304
    buffer_load_dwordx4 v40, s[16:19], s35 offen lds
    s_add_u32 m0, s34, 4096
    s_add_u32 s35, s33, 131072
    buffer_load_dwordx4 v40, s[16:19], s35 offen lds
    s_add_u32 m0, s34, 5120
    s_add_u32 s35, s33, 163840
    buffer_load_dwordx4 v40, s[16:19], s35 offen lds
    s_add_u32 m0, s34, 6144
    s_add_u32 s35, s33, 196608
    buffer_load_dwordx4 v40, s[16:19], s35 offen lds
    s_add_u32 m0, s34, 7168
    s_add_u32 s35, s33, 229376
    buffer_load_dwordx4 v40, s[16:19], s35 offen lds
    s_add_u32 m0, s34, 8192
    s_add_u32 s35, s33, 262144
    buffer_load_dwordx4 v40, s[16:19], s35 offen lds
    s_add_u32 m0, s34, 9216
    s_add_u32 s35, s33, 294912
    buffer_load_dwordx4 v40, s[16:19], s35 offen lds
    s_add_u32 m0, s34, 10240
    s_add_u32 s35, s33, 327680
    buffer_load_dwordx4 v40, s[16:19], s35 offen lds
    s_add_u32 m0, s34, 11264
    s_add_u32 s35, s33, 360448
    buffer_load_dwordx4 v40, s[16:19], s35 offen lds
    s_add_u32 m0, s34, 12288
    s_add_u32 s35, s33, 393216
    buffer_load_dwordx4 v40, s[16:19], s35 offen lds
    s_add_u32 m0, s34, 13312
    s_add_u32 s35, s33, 425984
    buffer_load_dwordx4 v40, s[16:19], s35 offen lds
    s_add_u32 m0, s34, 14336
    s_add_u32 s35, s33, 458752
    buffer_load_dwordx4 v40, s[16:19], s35 offen lds
    s_add_u32 m0, s34, 15360
    s_add_u32 s35, s33, 491520
    buffer_load_dwordx4 v40, s[16:19], s35 offen lds
    s_waitcnt vmcnt(16)
    s_barrier
    ds_read_b64_tr_b16 a[0:1], v44 offset:0
    ds_read_b64_tr_b16 a[2:3], v44 offset:2048
    ds_read_b64_tr_b16 a[4:5], v44 offset:4096
    ds_read_b64_tr_b16 a[6:7], v44 offset:6144
    ds_read_b64_tr_b16 a[8:9], v44 offset:8192
    ds_read_b64_tr_b16 a[10:11], v44 offset:10240
    ds_read_b64_tr_b16 a[12:13], v44 offset:12288
    ds_read_b64_tr_b16 a[14:15], v44 offset:14336
    s_waitcnt lgkmcnt(4)
    ds_read_b64_tr_b16 a[16:17], v44 offset:16384
    ds_read_b64_tr_b16 a[18:19], v44 offset:18432
    ds_read_b64_tr_b16 a[20:21], v44 offset:20480
    ds_read_b64_tr_b16 a[22:23], v44 offset:22528
    ds_read_b64_tr_b16 a[24:25], v44 offset:24576
    ds_read_b64_tr_b16 a[26:27], v44 offset:26624
    ds_read_b64_tr_b16 a[28:29], v44 offset:28672
    ds_read_b64_tr_b16 a[30:31], v44 offset:30720
    s_waitcnt lgkmcnt(4)
    ds_read_b64_tr_b16 a[32:33], v44 offset:32768
    ds_read_b64_tr_b16 a[34:35], v44 offset:34816
    ds_read_b64_tr_b16 a[36:37], v44 offset:36864
    ds_read_b64_tr_b16 a[38:39], v44 offset:38912
    ds_read_b64_tr_b16 a[40:41], v44 offset:40960
    ds_read_b64_tr_b16 a[42:43], v44 offset:43008
    ds_read_b64_tr_b16 a[44:45], v44 offset:45056
    ds_read_b64_tr_b16 a[46:47], v44 offset:47104
    s_waitcnt lgkmcnt(4)
    ds_read_b64_tr_b16 a[48:49], v44 offset:49152
    ds_read_b64_tr_b16 a[50:51], v44 offset:51200
    ds_read_b64_tr_b16 a[52:53], v44 offset:53248
    ds_read_b64_tr_b16 a[54:55], v44 offset:55296
    ds_read_b64_tr_b16 a[56:57], v44 offset:57344
    ds_read_b64_tr_b16 a[58:59], v44 offset:59392
    ds_read_b64_tr_b16 a[60:61], v44 offset:61440
    ds_read_b64_tr_b16 a[62:63], v44 offset:63488
    s_waitcnt lgkmcnt(4)
    s_waitcnt lgkmcnt(0)
    s_barrier
    s_lshl_b32 s33, s6, 19
    s_add_u32 s33, s33, 0
    s_lshl_b32 s34, s6, 14
    s_add_u32 s34, s34, 0
    s_add_u32 m0, s34, 0
    s_add_u32 s35, s33, 0
    buffer_load_dwordx4 v40, s[20:23], s35 offen lds
    s_add_u32 m0, s34, 1024
    s_add_u32 s35, s33, 32768
    buffer_load_dwordx4 v40, s[20:23], s35 offen lds
    s_add_u32 m0, s34, 2048
    s_add_u32 s35, s33, 65536
    buffer_load_dwordx4 v40, s[20:23], s35 offen lds
    s_add_u32 m0, s34, 3072
    s_add_u32 s35, s33, 98304
    buffer_load_dwordx4 v40, s[20:23], s35 offen lds
    s_add_u32 m0, s34, 4096
    s_add_u32 s35, s33, 131072
    buffer_load_dwordx4 v40, s[20:23], s35 offen lds
    s_add_u32 m0, s34, 5120
    s_add_u32 s35, s33, 163840
    buffer_load_dwordx4 v40, s[20:23], s35 offen lds
    s_add_u32 m0, s34, 6144
    s_add_u32 s35, s33, 196608
    buffer_load_dwordx4 v40, s[20:23], s35 offen lds
    s_add_u32 m0, s34, 7168
    s_add_u32 s35, s33, 229376
    buffer_load_dwordx4 v40, s[20:23], s35 offen lds
    s_add_u32 m0, s34, 8192
    s_add_u32 s35, s33, 262144
    buffer_load_dwordx4 v40, s[20:23], s35 offen lds
    s_add_u32 m0, s34, 9216
    s_add_u32 s35, s33, 294912
    buffer_load_dwordx4 v40, s[20:23], s35 offen lds
    s_add_u32 m0, s34, 10240
    s_add_u32 s35, s33, 327680
    buffer_load_dwordx4 v40, s[20:23], s35 offen lds
    s_add_u32 m0, s34, 11264
    s_add_u32 s35, s33, 360448
    buffer_load_dwordx4 v40, s[20:23], s35 offen lds
    s_add_u32 m0, s34, 12288
    s_add_u32 s35, s33, 393216
    buffer_load_dwordx4 v40, s[20:23], s35 offen lds
    s_add_u32 m0, s34, 13312
    s_add_u32 s35, s33, 425984
    buffer_load_dwordx4 v40, s[20:23], s35 offen lds
    s_add_u32 m0, s34, 14336
    s_add_u32 s35, s33, 458752
    buffer_load_dwordx4 v40, s[20:23], s35 offen lds
    s_add_u32 m0, s34, 15360
    s_add_u32 s35, s33, 491520
    buffer_load_dwordx4 v40, s[20:23], s35 offen lds
    s_waitcnt vmcnt(16)
    s_barrier
    ds_read_b64_tr_b16 a[64:65], v45 offset:0
    ds_read_b64_tr_b16 a[66:67], v45 offset:2048
    ds_read_b64_tr_b16 a[68:69], v45 offset:4096
    ds_read_b64_tr_b16 a[70:71], v45 offset:6144
    ds_read_b64_tr_b16 a[72:73], v45 offset:8192
    ds_read_b64_tr_b16 a[74:75], v45 offset:10240
    ds_read_b64_tr_b16 a[76:77], v45 offset:12288
    ds_read_b64_tr_b16 a[78:79], v45 offset:14336
    s_waitcnt lgkmcnt(4)
    ds_read_b64_tr_b16 a[80:81], v45 offset:16384
    ds_read_b64_tr_b16 a[82:83], v45 offset:18432
    ds_read_b64_tr_b16 a[84:85], v45 offset:20480
    ds_read_b64_tr_b16 a[86:87], v45 offset:22528
    ds_read_b64_tr_b16 a[88:89], v45 offset:24576
    ds_read_b64_tr_b16 a[90:91], v45 offset:26624
    ds_read_b64_tr_b16 a[92:93], v45 offset:28672
    ds_read_b64_tr_b16 a[94:95], v45 offset:30720
    s_waitcnt lgkmcnt(4)
    ds_read_b64_tr_b16 a[96:97], v45 offset:32768
    ds_read_b64_tr_b16 a[98:99], v45 offset:34816
    ds_read_b64_tr_b16 a[100:101], v45 offset:36864
    ds_read_b64_tr_b16 a[102:103], v45 offset:38912
    ds_read_b64_tr_b16 a[104:105], v45 offset:40960
    ds_read_b64_tr_b16 a[106:107], v45 offset:43008
    ds_read_b64_tr_b16 a[108:109], v45 offset:45056
    ds_read_b64_tr_b16 a[110:111], v45 offset:47104
    s_waitcnt lgkmcnt(4)
    ds_read_b64_tr_b16 a[112:113], v45 offset:49152
    ds_read_b64_tr_b16 a[114:115], v45 offset:51200
    ds_read_b64_tr_b16 a[116:117], v45 offset:53248
    ds_read_b64_tr_b16 a[118:119], v45 offset:55296
    ds_read_b64_tr_b16 a[120:121], v45 offset:57344
    ds_read_b64_tr_b16 a[122:123], v45 offset:59392
    ds_read_b64_tr_b16 a[124:125], v45 offset:61440
    ds_read_b64_tr_b16 a[126:127], v45 offset:63488
    s_waitcnt lgkmcnt(4)
    s_waitcnt lgkmcnt(0)
    s_barrier
    s_lshl_b32 s33, s6, 19
    s_add_u32 s33, s33, 2097152
    s_lshl_b32 s34, s6, 14
    s_add_u32 s34, s34, 65536
    s_add_u32 m0, s34, 0
    s_add_u32 s35, s33, 0
    buffer_load_dwordx4 v40, s[20:23], s35 offen lds
    s_add_u32 m0, s34, 1024
    s_add_u32 s35, s33, 32768
    buffer_load_dwordx4 v40, s[20:23], s35 offen lds
    s_add_u32 m0, s34, 2048
    s_add_u32 s35, s33, 65536
    buffer_load_dwordx4 v40, s[20:23], s35 offen lds
    s_add_u32 m0, s34, 3072
    s_add_u32 s35, s33, 98304
    buffer_load_dwordx4 v40, s[20:23], s35 offen lds
    s_add_u32 m0, s34, 4096
    s_add_u32 s35, s33, 131072
    buffer_load_dwordx4 v40, s[20:23], s35 offen lds
    s_add_u32 m0, s34, 5120
    s_add_u32 s35, s33, 163840
    buffer_load_dwordx4 v40, s[20:23], s35 offen lds
    s_add_u32 m0, s34, 6144
    s_add_u32 s35, s33, 196608
    buffer_load_dwordx4 v40, s[20:23], s35 offen lds
    s_add_u32 m0, s34, 7168
    s_add_u32 s35, s33, 229376
    buffer_load_dwordx4 v40, s[20:23], s35 offen lds
    s_add_u32 m0, s34, 8192
    s_add_u32 s35, s33, 262144
    buffer_load_dwordx4 v40, s[20:23], s35 offen lds
    s_add_u32 m0, s34, 9216
    s_add_u32 s35, s33, 294912
    buffer_load_dwordx4 v40, s[20:23], s35 offen lds
    s_add_u32 m0, s34, 10240
    s_add_u32 s35, s33, 327680
    buffer_load_dwordx4 v40, s[20:23], s35 offen lds
    s_add_u32 m0, s34, 11264
    s_add_u32 s35, s33, 360448
    buffer_load_dwordx4 v40, s[20:23], s35 offen lds
    s_add_u32 m0, s34, 12288
    s_add_u32 s35, s33, 393216
    buffer_load_dwordx4 v40, s[20:23], s35 offen lds
    s_add_u32 m0, s34, 13312
    s_add_u32 s35, s33, 425984
    buffer_load_dwordx4 v40, s[20:23], s35 offen lds
    s_add_u32 m0, s34, 14336
    s_add_u32 s35, s33, 458752
    buffer_load_dwordx4 v40, s[20:23], s35 offen lds
    s_add_u32 m0, s34, 15360
    s_add_u32 s35, s33, 491520
    buffer_load_dwordx4 v40, s[20:23], s35 offen lds
    s_waitcnt vmcnt(16)
    s_barrier
    ds_read_b64_tr_b16 a[128:129], v44 offset:0
    ds_read_b64_tr_b16 a[130:131], v44 offset:2048
    ds_read_b64_tr_b16 a[132:133], v44 offset:4096
    ds_read_b64_tr_b16 a[134:135], v44 offset:6144
    ds_read_b64_tr_b16 a[136:137], v44 offset:8192
    ds_read_b64_tr_b16 a[138:139], v44 offset:10240
    ds_read_b64_tr_b16 a[140:141], v44 offset:12288
    ds_read_b64_tr_b16 a[142:143], v44 offset:14336
    s_waitcnt lgkmcnt(4)
    ds_read_b64_tr_b16 a[144:145], v44 offset:16384
    ds_read_b64_tr_b16 a[146:147], v44 offset:18432
    ds_read_b64_tr_b16 a[148:149], v44 offset:20480
    ds_read_b64_tr_b16 a[150:151], v44 offset:22528
    ds_read_b64_tr_b16 a[152:153], v44 offset:24576
    ds_read_b64_tr_b16 a[154:155], v44 offset:26624
    ds_read_b64_tr_b16 a[156:157], v44 offset:28672
    ds_read_b64_tr_b16 a[158:159], v44 offset:30720
    s_waitcnt lgkmcnt(4)
    ds_read_b64_tr_b16 a[160:161], v44 offset:32768
    ds_read_b64_tr_b16 a[162:163], v44 offset:34816
    ds_read_b64_tr_b16 a[164:165], v44 offset:36864
    ds_read_b64_tr_b16 a[166:167], v44 offset:38912
    ds_read_b64_tr_b16 a[168:169], v44 offset:40960
    ds_read_b64_tr_b16 a[170:171], v44 offset:43008
    ds_read_b64_tr_b16 a[172:173], v44 offset:45056
    ds_read_b64_tr_b16 a[174:175], v44 offset:47104
    s_waitcnt lgkmcnt(4)
    ds_read_b64_tr_b16 a[176:177], v44 offset:49152
    ds_read_b64_tr_b16 a[178:179], v44 offset:51200
    ds_read_b64_tr_b16 a[180:181], v44 offset:53248
    ds_read_b64_tr_b16 a[182:183], v44 offset:55296
    ds_read_b64_tr_b16 a[184:185], v44 offset:57344
    ds_read_b64_tr_b16 a[186:187], v44 offset:59392
    ds_read_b64_tr_b16 a[188:189], v44 offset:61440
    ds_read_b64_tr_b16 a[190:191], v44 offset:63488
    s_waitcnt lgkmcnt(4)
    s_waitcnt lgkmcnt(0)
    s_barrier
    s_lshl_b32 s33, s6, 19
    s_add_u32 s33, s33, 0
    s_lshl_b32 s34, s6, 14
    s_add_u32 s34, s34, 0
    s_add_u32 m0, s34, 0
    s_add_u32 s35, s33, 0
    buffer_load_dwordx4 v40, s[12:15], s35 offen lds
    s_add_u32 m0, s34, 1024
    s_add_u32 s35, s33, 32768
    buffer_load_dwordx4 v40, s[12:15], s35 offen lds
    s_add_u32 m0, s34, 2048
    s_add_u32 s35, s33, 65536
    buffer_load_dwordx4 v40, s[12:15], s35 offen lds
    s_add_u32 m0, s34, 3072
    s_add_u32 s35, s33, 98304
    buffer_load_dwordx4 v40, s[12:15], s35 offen lds
    s_add_u32 m0, s34, 4096
    s_add_u32 s35, s33, 131072
    buffer_load_dwordx4 v40, s[12:15], s35 offen lds
    s_add_u32 m0, s34, 5120
    s_add_u32 s35, s33, 163840
    buffer_load_dwordx4 v40, s[12:15], s35 offen lds
    s_add_u32 m0, s34, 6144
    s_add_u32 s35, s33, 196608
    buffer_load_dwordx4 v40, s[12:15], s35 offen lds
    s_add_u32 m0, s34, 7168
    s_add_u32 s35, s33, 229376
    buffer_load_dwordx4 v40, s[12:15], s35 offen lds
    s_add_u32 m0, s34, 8192
    s_add_u32 s35, s33, 262144
    buffer_load_dwordx4 v40, s[12:15], s35 offen lds
    s_add_u32 m0, s34, 9216
    s_add_u32 s35, s33, 294912
    buffer_load_dwordx4 v40, s[12:15], s35 offen lds
    s_add_u32 m0, s34, 10240
    s_add_u32 s35, s33, 327680
    buffer_load_dwordx4 v40, s[12:15], s35 offen lds
    s_add_u32 m0, s34, 11264
    s_add_u32 s35, s33, 360448
    buffer_load_dwordx4 v40, s[12:15], s35 offen lds
    s_add_u32 m0, s34, 12288
    s_add_u32 s35, s33, 393216
    buffer_load_dwordx4 v40, s[12:15], s35 offen lds
    s_add_u32 m0, s34, 13312
    s_add_u32 s35, s33, 425984
    buffer_load_dwordx4 v40, s[12:15], s35 offen lds
    s_add_u32 m0, s34, 14336
    s_add_u32 s35, s33, 458752
    buffer_load_dwordx4 v40, s[12:15], s35 offen lds
    s_add_u32 m0, s34, 15360
    s_add_u32 s35, s33, 491520
    buffer_load_dwordx4 v40, s[12:15], s35 offen lds
    s_waitcnt vmcnt(16)
    s_barrier
    ds_read_b64_tr_b16 a[192:193], v45 offset:0
    ds_read_b64_tr_b16 a[194:195], v45 offset:2048
    ds_read_b64_tr_b16 a[196:197], v45 offset:4096
    ds_read_b64_tr_b16 a[198:199], v45 offset:6144
    ds_read_b64_tr_b16 a[200:201], v45 offset:8192
    ds_read_b64_tr_b16 a[202:203], v45 offset:10240
    ds_read_b64_tr_b16 a[204:205], v45 offset:12288
    ds_read_b64_tr_b16 a[206:207], v45 offset:14336
    s_waitcnt lgkmcnt(4)
    ds_read_b64_tr_b16 a[208:209], v45 offset:16384
    ds_read_b64_tr_b16 a[210:211], v45 offset:18432
    ds_read_b64_tr_b16 a[212:213], v45 offset:20480
    ds_read_b64_tr_b16 a[214:215], v45 offset:22528
    ds_read_b64_tr_b16 a[216:217], v45 offset:24576
    ds_read_b64_tr_b16 a[218:219], v45 offset:26624
    ds_read_b64_tr_b16 a[220:221], v45 offset:28672
    ds_read_b64_tr_b16 a[222:223], v45 offset:30720
    s_waitcnt lgkmcnt(4)
    ds_read_b64_tr_b16 a[224:225], v45 offset:32768
    ds_read_b64_tr_b16 a[226:227], v45 offset:34816
    ds_read_b64_tr_b16 a[228:229], v45 offset:36864
    ds_read_b64_tr_b16 a[230:231], v45 offset:38912
    ds_read_b64_tr_b16 a[232:233], v45 offset:40960
    ds_read_b64_tr_b16 a[234:235], v45 offset:43008
    ds_read_b64_tr_b16 a[236:237], v45 offset:45056
    ds_read_b64_tr_b16 a[238:239], v45 offset:47104
    s_waitcnt lgkmcnt(4)
    ds_read_b64_tr_b16 a[240:241], v45 offset:49152
    ds_read_b64_tr_b16 a[242:243], v45 offset:51200
    ds_read_b64_tr_b16 a[244:245], v45 offset:53248
    ds_read_b64_tr_b16 a[246:247], v45 offset:55296
    ds_read_b64_tr_b16 a[248:249], v45 offset:57344
    ds_read_b64_tr_b16 a[250:251], v45 offset:59392
    ds_read_b64_tr_b16 a[252:253], v45 offset:61440
    ds_read_b64_tr_b16 a[254:255], v45 offset:63488
    s_waitcnt lgkmcnt(4)
    s_waitcnt lgkmcnt(0)
    s_barrier
    s_lshl_b32 s33, s6, 19
    s_add_u32 s33, s33, 2097152
    s_lshl_b32 s34, s6, 14
    s_add_u32 s34, s34, 65536
    s_add_u32 m0, s34, 0
    s_add_u32 s35, s33, 0
    buffer_load_dwordx4 v40, s[12:15], s35 offen lds
    s_add_u32 m0, s34, 1024
    s_add_u32 s35, s33, 32768
    buffer_load_dwordx4 v40, s[12:15], s35 offen lds
    s_add_u32 m0, s34, 2048
    s_add_u32 s35, s33, 65536
    buffer_load_dwordx4 v40, s[12:15], s35 offen lds
    s_add_u32 m0, s34, 3072
    s_add_u32 s35, s33, 98304
    buffer_load_dwordx4 v40, s[12:15], s35 offen lds
    s_add_u32 m0, s34, 4096
    s_add_u32 s35, s33, 131072
    buffer_load_dwordx4 v40, s[12:15], s35 offen lds
    s_add_u32 m0, s34, 5120
    s_add_u32 s35, s33, 163840
    buffer_load_dwordx4 v40, s[12:15], s35 offen lds
    s_add_u32 m0, s34, 6144
    s_add_u32 s35, s33, 196608
    buffer_load_dwordx4 v40, s[12:15], s35 offen lds
    s_add_u32 m0, s34, 7168
    s_add_u32 s35, s33, 229376
    buffer_load_dwordx4 v40, s[12:15], s35 offen lds
    s_add_u32 m0, s34, 8192
    s_add_u32 s35, s33, 262144
    buffer_load_dwordx4 v40, s[12:15], s35 offen lds
    s_add_u32 m0, s34, 9216
    s_add_u32 s35, s33, 294912
    buffer_load_dwordx4 v40, s[12:15], s35 offen lds
    s_add_u32 m0, s34, 10240
    s_add_u32 s35, s33, 327680
    buffer_load_dwordx4 v40, s[12:15], s35 offen lds
    s_add_u32 m0, s34, 11264
    s_add_u32 s35, s33, 360448
    buffer_load_dwordx4 v40, s[12:15], s35 offen lds
    s_add_u32 m0, s34, 12288
    s_add_u32 s35, s33, 393216
    buffer_load_dwordx4 v40, s[12:15], s35 offen lds
    s_add_u32 m0, s34, 13312
    s_add_u32 s35, s33, 425984
    buffer_load_dwordx4 v40, s[12:15], s35 offen lds
    s_add_u32 m0, s34, 14336
    s_add_u32 s35, s33, 458752
    buffer_load_dwordx4 v40, s[12:15], s35 offen lds
    s_add_u32 m0, s34, 15360
    s_add_u32 s35, s33, 491520
    buffer_load_dwordx4 v40, s[12:15], s35 offen lds
    s_waitcnt vmcnt(16)
    s_barrier
    ds_read_b64_tr_b16 v[128:129], v44 offset:0
    ds_read_b64_tr_b16 v[130:131], v44 offset:2048
    ds_read_b64_tr_b16 v[132:133], v44 offset:4096
    ds_read_b64_tr_b16 v[134:135], v44 offset:6144
    ds_read_b64_tr_b16 v[136:137], v44 offset:8192
    ds_read_b64_tr_b16 v[138:139], v44 offset:10240
    ds_read_b64_tr_b16 v[140:141], v44 offset:12288
    ds_read_b64_tr_b16 v[142:143], v44 offset:14336
    s_waitcnt lgkmcnt(4)
    ds_read_b64_tr_b16 v[144:145], v44 offset:16384
    ds_read_b64_tr_b16 v[146:147], v44 offset:18432
    ds_read_b64_tr_b16 v[148:149], v44 offset:20480
    ds_read_b64_tr_b16 v[150:151], v44 offset:22528
    ds_read_b64_tr_b16 v[152:153], v44 offset:24576
    ds_read_b64_tr_b16 v[154:155], v44 offset:26624
    ds_read_b64_tr_b16 v[156:157], v44 offset:28672
    ds_read_b64_tr_b16 v[158:159], v44 offset:30720
    s_waitcnt lgkmcnt(4)
    ds_read_b64_tr_b16 v[160:161], v44 offset:32768
    ds_read_b64_tr_b16 v[162:163], v44 offset:34816
    ds_read_b64_tr_b16 v[164:165], v44 offset:36864
    ds_read_b64_tr_b16 v[166:167], v44 offset:38912
    ds_read_b64_tr_b16 v[168:169], v44 offset:40960
    ds_read_b64_tr_b16 v[170:171], v44 offset:43008
    ds_read_b64_tr_b16 v[172:173], v44 offset:45056
    ds_read_b64_tr_b16 v[174:175], v44 offset:47104
    s_waitcnt lgkmcnt(4)
    ds_read_b64_tr_b16 v[176:177], v44 offset:49152
    ds_read_b64_tr_b16 v[178:179], v44 offset:51200
    ds_read_b64_tr_b16 v[180:181], v44 offset:53248
    ds_read_b64_tr_b16 v[182:183], v44 offset:55296
    ds_read_b64_tr_b16 v[184:185], v44 offset:57344
    ds_read_b64_tr_b16 v[186:187], v44 offset:59392
    ds_read_b64_tr_b16 v[188:189], v44 offset:61440
    ds_read_b64_tr_b16 v[190:191], v44 offset:63488
    s_waitcnt lgkmcnt(4)
    s_waitcnt lgkmcnt(0)
    s_barrier
    s_waitcnt vmcnt(0)
    s_barrier
    ds_read_b64_tr_b16 v[192:193], v45 offset:0
    ds_read_b64_tr_b16 v[194:195], v45 offset:2048
    ds_read_b64_tr_b16 v[196:197], v45 offset:4096
    ds_read_b64_tr_b16 v[198:199], v45 offset:6144
    ds_read_b64_tr_b16 v[200:201], v45 offset:8192
    ds_read_b64_tr_b16 v[202:203], v45 offset:10240
    ds_read_b64_tr_b16 v[204:205], v45 offset:12288
    ds_read_b64_tr_b16 v[206:207], v45 offset:14336
    s_waitcnt lgkmcnt(4)
    ds_read_b64_tr_b16 v[208:209], v45 offset:16384
    ds_read_b64_tr_b16 v[210:211], v45 offset:18432
    ds_read_b64_tr_b16 v[212:213], v45 offset:20480
    ds_read_b64_tr_b16 v[214:215], v45 offset:22528
    ds_read_b64_tr_b16 v[216:217], v45 offset:24576
    ds_read_b64_tr_b16 v[218:219], v45 offset:26624
    ds_read_b64_tr_b16 v[220:221], v45 offset:28672
    ds_read_b64_tr_b16 v[222:223], v45 offset:30720
    s_waitcnt lgkmcnt(4)
    ds_read_b64_tr_b16 v[224:225], v45 offset:32768
    ds_read_b64_tr_b16 v[226:227], v45 offset:34816
    ds_read_b64_tr_b16 v[228:229], v45 offset:36864
    ds_read_b64_tr_b16 v[230:231], v45 offset:38912
    ds_read_b64_tr_b16 v[232:233], v45 offset:40960
    ds_read_b64_tr_b16 v[234:235], v45 offset:43008
    ds_read_b64_tr_b16 v[236:237], v45 offset:45056
    ds_read_b64_tr_b16 v[238:239], v45 offset:47104
    s_waitcnt lgkmcnt(4)
    ds_read_b64_tr_b16 v[240:241], v45 offset:49152
    ds_read_b64_tr_b16 v[242:243], v45 offset:51200
    ds_read_b64_tr_b16 v[244:245], v45 offset:53248
    ds_read_b64_tr_b16 v[246:247], v45 offset:55296
    ds_read_b64_tr_b16 v[248:249], v45 offset:57344
    ds_read_b64_tr_b16 v[250:251], v45 offset:59392
    ds_read_b64_tr_b16 v[252:253], v45 offset:61440
    ds_read_b64_tr_b16 v[254:255], v45 offset:63488
    s_waitcnt lgkmcnt(4)
    s_waitcnt lgkmcnt(0)
    s_barrier
    v_lshlrev_b32 v1, 4, v0
    s_lshl_b32 s32, s6, 13
    v_add_u32 v2, s32, v1
    s_lshl_b32 s32, s6, 11
    v_add_u32 v3, s32, v1
    s_mul_i32 s32, s4, 12582912
    s_add_u32 s43, s32, 178257920
    s_lshl_b32 s32, s4, 14
    s_add_u32 s45, s32, 205725696
    s_lshl_b32 s32, s4, 11
    s_add_u32 s32, s32, s5
    s_mul_i32 s48, s32, 24576
    s_lshl_b32 s49, s32, 5
    s_lshl_b32 s33, s6, 2
    s_add_u32 s49, s49, s33
    s_add_u32 s49, s49, 205520896
    s_mov_b32 s40, 0
    s_mov_b32 s42, 0
    s_mov_b32 s47, 0
    s_load_dwordx2 s[92:93], s[0:1], 88
    s_waitcnt lgkmcnt(0)
    s_mov_b32 s94, 256
    s_mov_b32 s95, 0x20000
    s_mov_b32 s96, 0
P_119_iw:
    v_mbcnt_lo_u32_b32 v9, -1, 0
    v_mbcnt_hi_u32_b32 v9, -1, v9
    v_min_u32 v9, 7, v9
    v_and_b32 v10, 1, v9
    v_lshlrev_b32 v10, 7, v10
    v_lshrrev_b32 v9, 1, v9
    v_lshl_add_u32 v9, v9, 2, v10
    buffer_load_dword v9, v9, s[92:95], 0 offen sc1
    s_waitcnt vmcnt(0)
    v_cmp_gt_u32 vcc, 32, v9
    s_cmp_eq_u64 vcc, 0
    s_cselect_b32 s97, 256, 0
    s_cmp_ge_u32 s97, 256
    s_cbranch_scc1 P_119_iwd
    s_add_u32 s96, s96, 1
    s_cmp_gt_u32 s96, 300000
    s_cbranch_scc1 L_fail
    s_sleep 2
    s_branch P_119_iw
P_119_iwd:
    s_mov_b32 s96, 0
    v_mbcnt_lo_u32_b32 v8, -1, 0
    v_mbcnt_hi_u32_b32 v8, -1, v8
    v_min_u32 v8, 15, v8
    v_lshlrev_b32 v8, 2, v8
P_119w0_120_spin:
    buffer_load_dword v9, v8, s[8:11], s45 offen sc1
    s_waitcnt vmcnt(0)
    v_cmp_eq_u32 vcc, 0, v9
    s_cbranch_vccz P_119w0_120_ok
    s_add_u32 s96, s96, 1
    s_cmp_gt_u32 s96, 300000
    s_cbranch_scc1 L_fail
    s_sleep 1
    s_branch P_119w0_120_spin
P_119w0_120_ok:
    s_lshl_b32 s53, s6, 13
    s_add_u32 s53, s53, s42
    s_add_u32 m0, s53, 0
    s_add_u32 s33, s43, 0
    buffer_load_dwordx4 v2, s[8:11], s33 offen offset:0 sc1 lds
    buffer_load_dwordx4 v2, s[8:11], s33 offen offset:1024 sc1 lds
    buffer_load_dwordx4 v2, s[8:11], s33 offen offset:2048 sc1 lds
    buffer_load_dwordx4 v2, s[8:11], s33 offen offset:3072 sc1 lds
    s_add_u32 m0, s53, 4096
    s_add_u32 s33, s43, 4096
    buffer_load_dwordx4 v2, s[8:11], s33 offen offset:0 sc1 lds
    buffer_load_dwordx4 v2, s[8:11], s33 offen offset:1024 sc1 lds
    buffer_load_dwordx4 v2, s[8:11], s33 offen offset:2048 sc1 lds
    buffer_load_dwordx4 v2, s[8:11], s33 offen offset:3072 sc1 lds
    s_add_u32 s43, s43, 32768
    s_add_u32 s45, s45, 128
    s_waitcnt vmcnt(0)
    s_barrier
P_119_unit:
    v_add_u32 v5, s42, v1
    s_xor_b32 s50, s42, 32768
    v_mbcnt_lo_u32_b32 v10, -1, 0
    v_mbcnt_hi_u32_b32 v10, -1, v10
    v_min_u32 v10, 15, v10
    v_lshlrev_b32 v10, 2, v10
    buffer_load_dword v9, v10, s[8:11], s45 offen sc1
    ds_read_b128 v[64:67], v5 offset:0
    ds_read_b128 v[68:71], v5 offset:1024
    ds_read_b128 v[72:75], v5 offset:2048
    ds_read_b128 v[76:79], v5 offset:3072
    ds_read_b128 v[80:83], v5 offset:4096
    ds_read_b128 v[84:87], v5 offset:5120
    s_waitcnt lgkmcnt(5)
    v_mfma_f32_32x32x16_bf16 v[32:47], a[0:3], v[64:67], 0
    v_mfma_f32_32x32x16_bf16 v[48:63], v[64:67], a[128:131], 0
    ds_read_b128 v[88:91], v5 offset:6144
    s_waitcnt lgkmcnt(5)
    v_mfma_f32_32x32x16_bf16 v[32:47], a[4:7], v[68:71], v[32:47]
    v_mfma_f32_32x32x16_bf16 v[48:63], v[68:71], a[132:135], v[48:63]
    ds_read_b128 v[92:95], v5 offset:7168
    s_waitcnt lgkmcnt(5)
    v_mfma_f32_32x32x16_bf16 v[32:47], a[8:11], v[72:75], v[32:47]
    v_mfma_f32_32x32x16_bf16 v[48:63], v[72:75], a[136:139], v[48:63]
    ds_read_b128 v[64:67], v5 offset:8192
    s_waitcnt lgkmcnt(5)
    v_mfma_f32_32x32x16_bf16 v[32:47], a[12:15], v[76:79], v[32:47]
    v_mfma_f32_32x32x16_bf16 v[48:63], v[76:79], a[140:143], v[48:63]
    ds_read_b128 v[68:71], v5 offset:9216
    s_waitcnt lgkmcnt(5)
    v_mfma_f32_32x32x16_bf16 v[32:47], a[16:19], v[80:83], v[32:47]
    v_mfma_f32_32x32x16_bf16 v[48:63], v[80:83], a[144:147], v[48:63]
    ds_read_b128 v[72:75], v5 offset:10240
    s_waitcnt lgkmcnt(5)
    v_mfma_f32_32x32x16_bf16 v[32:47], a[20:23], v[84:87], v[32:47]
    v_mfma_f32_32x32x16_bf16 v[48:63], v[84:87], a[148:151], v[48:63]
    ds_read_b128 v[76:79], v5 offset:11264
    s_waitcnt lgkmcnt(5)
    v_mfma_f32_32x32x16_bf16 v[32:47], a[24:27], v[88:91], v[32:47]
    v_mfma_f32_32x32x16_bf16 v[48:63], v[88:91], a[152:155], v[48:63]
    ds_read_b128 v[80:83], v5 offset:12288
    s_waitcnt lgkmcnt(5)
    v_mfma_f32_32x32x16_bf16 v[32:47], a[28:31], v[92:95], v[32:47]
    v_mfma_f32_32x32x16_bf16 v[48:63], v[92:95], a[156:159], v[48:63]
    ds_read_b128 v[84:87], v5 offset:13312
    s_waitcnt lgkmcnt(5)
    v_mfma_f32_32x32x16_bf16 v[32:47], a[32:35], v[64:67], v[32:47]
    v_mfma_f32_32x32x16_bf16 v[48:63], v[64:67], a[160:163], v[48:63]
    ds_read_b128 v[88:91], v5 offset:14336
    s_waitcnt lgkmcnt(5)
    v_mfma_f32_32x32x16_bf16 v[32:47], a[36:39], v[68:71], v[32:47]
    v_mfma_f32_32x32x16_bf16 v[48:63], v[68:71], a[164:167], v[48:63]
    ds_read_b128 v[92:95], v5 offset:15360
    s_waitcnt lgkmcnt(5)
    v_mfma_f32_32x32x16_bf16 v[32:47], a[40:43], v[72:75], v[32:47]
    v_mfma_f32_32x32x16_bf16 v[48:63], v[72:75], a[168:171], v[48:63]
    ds_read_b128 v[64:67], v5 offset:16384
    s_waitcnt lgkmcnt(5)
    v_mfma_f32_32x32x16_bf16 v[32:47], a[44:47], v[76:79], v[32:47]
    v_mfma_f32_32x32x16_bf16 v[48:63], v[76:79], a[172:175], v[48:63]
    ds_read_b128 v[68:71], v5 offset:17408
    s_waitcnt lgkmcnt(5)
    v_mfma_f32_32x32x16_bf16 v[32:47], a[48:51], v[80:83], v[32:47]
    v_mfma_f32_32x32x16_bf16 v[48:63], v[80:83], a[176:179], v[48:63]
    ds_read_b128 v[72:75], v5 offset:18432
    s_cmp_eq_u32 s47, 0
    s_cbranch_scc1 P_119_nq0
    s_waitcnt vmcnt(1)
    s_sub_u32 s33, s49, 1024
    s_add_u32 s34, s33, 16
    s_cmp_eq_u32 s47, 2
    s_cselect_b32 s33, s34, s33
    v_mov_b32 v12, 1
    v_mov_b32 v11, 0
    s_mov_b64 exec, 1
    buffer_store_dword v12, v11, s[8:11], s33 offen sc1
    s_mov_b64 exec, -1
    s_mov_b32 s47, 0
    s_waitcnt vmcnt(1)
    s_branch P_119_nq
P_119_nq0:
    s_waitcnt vmcnt(0)
P_119_nq:
    s_mov_b32 s51, 0
    s_cmp_ge_u32 s40, 63
    s_cselect_b32 s52, 1, 0
    v_cmp_eq_u32 vcc, 0, v9
    s_cmp_eq_u64 vcc, 0
    s_cselect_b32 s51, 1, 0
    s_cmp_eq_u32 s52, 1
    s_cselect_b32 s51, 0, s51
    s_cmp_eq_u32 s51, 0
    s_cbranch_scc1 P_119_vn
    s_waitcnt lgkmcnt(5)
    v_mfma_f32_32x32x16_bf16 v[32:47], a[52:55], v[84:87], v[32:47]
    v_mfma_f32_32x32x16_bf16 v[48:63], v[84:87], a[180:183], v[48:63]
    ds_read_b128 v[76:79], v5 offset:19456
    s_lshl_b32 s53, s6, 13
    s_add_u32 s53, s53, s50
    s_add_u32 m0, s53, 0
    s_add_u32 s33, s43, 0
    buffer_load_dwordx4 v2, s[8:11], s33 offen offset:0 sc1 lds
    s_waitcnt lgkmcnt(5)
    v_mfma_f32_32x32x16_bf16 v[32:47], a[56:59], v[88:91], v[32:47]
    v_mfma_f32_32x32x16_bf16 v[48:63], v[88:91], a[184:187], v[48:63]
    ds_read_b128 v[80:83], v5 offset:20480
    buffer_load_dwordx4 v2, s[8:11], s33 offen offset:1024 sc1 lds
    s_waitcnt lgkmcnt(5)
    v_mfma_f32_32x32x16_bf16 v[32:47], a[60:63], v[92:95], v[32:47]
    v_mfma_f32_32x32x16_bf16 v[48:63], v[92:95], a[188:191], v[48:63]
    ds_read_b128 v[84:87], v5 offset:21504
    buffer_load_dwordx4 v2, s[8:11], s33 offen offset:2048 sc1 lds
    s_waitcnt lgkmcnt(5)
    v_mfma_f32_32x32x16_bf16 v[32:47], a[64:67], v[64:67], v[32:47]
    v_mfma_f32_32x32x16_bf16 v[48:63], v[64:67], a[192:195], v[48:63]
    ds_read_b128 v[88:91], v5 offset:22528
    buffer_load_dwordx4 v2, s[8:11], s33 offen offset:3072 sc1 lds
    s_waitcnt lgkmcnt(5)
    v_mfma_f32_32x32x16_bf16 v[32:47], a[68:71], v[68:71], v[32:47]
    v_mfma_f32_32x32x16_bf16 v[48:63], v[68:71], a[196:199], v[48:63]
    ds_read_b128 v[92:95], v5 offset:23552
    s_add_u32 m0, s53, 4096
    s_add_u32 s33, s43, 4096
    buffer_load_dwordx4 v2, s[8:11], s33 offen offset:0 sc1 lds
    s_waitcnt lgkmcnt(5)
    v_mfma_f32_32x32x16_bf16 v[32:47], a[72:75], v[72:75], v[32:47]
    v_mfma_f32_32x32x16_bf16 v[48:63], v[72:75], a[200:203], v[48:63]
    ds_read_b128 v[64:67], v5 offset:24576
    buffer_load_dwordx4 v2, s[8:11], s33 offen offset:1024 sc1 lds
    s_waitcnt lgkmcnt(5)
    v_mfma_f32_32x32x16_bf16 v[32:47], a[76:79], v[76:79], v[32:47]
    v_mfma_f32_32x32x16_bf16 v[48:63], v[76:79], a[204:207], v[48:63]
    ds_read_b128 v[68:71], v5 offset:25600
    buffer_load_dwordx4 v2, s[8:11], s33 offen offset:2048 sc1 lds
    s_waitcnt lgkmcnt(5)
    v_mfma_f32_32x32x16_bf16 v[32:47], a[80:83], v[80:83], v[32:47]
    v_mfma_f32_32x32x16_bf16 v[48:63], v[80:83], a[208:211], v[48:63]
    ds_read_b128 v[72:75], v5 offset:26624
    buffer_load_dwordx4 v2, s[8:11], s33 offen offset:3072 sc1 lds
    s_branch P_119_ve
P_119_vn:
    s_waitcnt lgkmcnt(5)
    v_mfma_f32_32x32x16_bf16 v[32:47], a[52:55], v[84:87], v[32:47]
    v_mfma_f32_32x32x16_bf16 v[48:63], v[84:87], a[180:183], v[48:63]
    ds_read_b128 v[76:79], v5 offset:19456
    s_waitcnt lgkmcnt(5)
    v_mfma_f32_32x32x16_bf16 v[32:47], a[56:59], v[88:91], v[32:47]
    v_mfma_f32_32x32x16_bf16 v[48:63], v[88:91], a[184:187], v[48:63]
    ds_read_b128 v[80:83], v5 offset:20480
    s_waitcnt lgkmcnt(5)
    v_mfma_f32_32x32x16_bf16 v[32:47], a[60:63], v[92:95], v[32:47]
    v_mfma_f32_32x32x16_bf16 v[48:63], v[92:95], a[188:191], v[48:63]
    ds_read_b128 v[84:87], v5 offset:21504
    s_waitcnt lgkmcnt(5)
    v_mfma_f32_32x32x16_bf16 v[32:47], a[64:67], v[64:67], v[32:47]
    v_mfma_f32_32x32x16_bf16 v[48:63], v[64:67], a[192:195], v[48:63]
    ds_read_b128 v[88:91], v5 offset:22528
    s_waitcnt lgkmcnt(5)
    v_mfma_f32_32x32x16_bf16 v[32:47], a[68:71], v[68:71], v[32:47]
    v_mfma_f32_32x32x16_bf16 v[48:63], v[68:71], a[196:199], v[48:63]
    ds_read_b128 v[92:95], v5 offset:23552
    s_waitcnt lgkmcnt(5)
    v_mfma_f32_32x32x16_bf16 v[32:47], a[72:75], v[72:75], v[32:47]
    v_mfma_f32_32x32x16_bf16 v[48:63], v[72:75], a[200:203], v[48:63]
    ds_read_b128 v[64:67], v5 offset:24576
    s_waitcnt lgkmcnt(5)
    v_mfma_f32_32x32x16_bf16 v[32:47], a[76:79], v[76:79], v[32:47]
    v_mfma_f32_32x32x16_bf16 v[48:63], v[76:79], a[204:207], v[48:63]
    ds_read_b128 v[68:71], v5 offset:25600
    s_waitcnt lgkmcnt(5)
    v_mfma_f32_32x32x16_bf16 v[32:47], a[80:83], v[80:83], v[32:47]
    v_mfma_f32_32x32x16_bf16 v[48:63], v[80:83], a[208:211], v[48:63]
    ds_read_b128 v[72:75], v5 offset:26624
P_119_ve:
    s_waitcnt lgkmcnt(5)
    v_mfma_f32_32x32x16_bf16 v[32:47], a[84:87], v[84:87], v[32:47]
    v_mfma_f32_32x32x16_bf16 v[48:63], v[84:87], a[212:215], v[48:63]
    ds_read_b128 v[76:79], v5 offset:27648
    s_waitcnt lgkmcnt(5)
    v_mfma_f32_32x32x16_bf16 v[32:47], a[88:91], v[88:91], v[32:47]
    v_mfma_f32_32x32x16_bf16 v[48:63], v[88:91], a[216:219], v[48:63]
    ds_read_b128 v[80:83], v5 offset:28672
    s_waitcnt lgkmcnt(5)
    v_mfma_f32_32x32x16_bf16 v[32:47], a[92:95], v[92:95], v[32:47]
    v_mfma_f32_32x32x16_bf16 v[48:63], v[92:95], a[220:223], v[48:63]
    ds_read_b128 v[84:87], v5 offset:29696
    s_waitcnt lgkmcnt(5)
    v_mfma_f32_32x32x16_bf16 v[32:47], a[96:99], v[64:67], v[32:47]
    v_mfma_f32_32x32x16_bf16 v[48:63], v[64:67], a[224:227], v[48:63]
    ds_read_b128 v[88:91], v5 offset:30720
    s_waitcnt lgkmcnt(5)
    v_mfma_f32_32x32x16_bf16 v[32:47], a[100:103], v[68:71], v[32:47]
    v_mfma_f32_32x32x16_bf16 v[48:63], v[68:71], a[228:231], v[48:63]
    ds_read_b128 v[92:95], v5 offset:31744
    s_waitcnt lgkmcnt(5)
    v_mfma_f32_32x32x16_bf16 v[32:47], a[104:107], v[72:75], v[32:47]
    v_mfma_f32_32x32x16_bf16 v[48:63], v[72:75], a[232:235], v[48:63]
    s_waitcnt lgkmcnt(4)
    v_mfma_f32_32x32x16_bf16 v[32:47], a[108:111], v[76:79], v[32:47]
    v_mfma_f32_32x32x16_bf16 v[48:63], v[76:79], a[236:239], v[48:63]
    s_waitcnt lgkmcnt(3)
    v_mfma_f32_32x32x16_bf16 v[32:47], a[112:115], v[80:83], v[32:47]
    v_mfma_f32_32x32x16_bf16 v[48:63], v[80:83], a[240:243], v[48:63]
    s_waitcnt lgkmcnt(2)
    v_mfma_f32_32x32x16_bf16 v[32:47], a[116:119], v[84:87], v[32:47]
    v_mfma_f32_32x32x16_bf16 v[48:63], v[84:87], a[244:247], v[48:63]
    s_waitcnt lgkmcnt(1)
    v_mfma_f32_32x32x16_bf16 v[32:47], a[120:123], v[88:91], v[32:47]
    v_mfma_f32_32x32x16_bf16 v[48:63], v[88:91], a[248:251], v[48:63]
    s_waitcnt lgkmcnt(0)
    v_mfma_f32_32x32x16_bf16 v[32:47], a[124:127], v[92:95], v[32:47]
    v_mfma_f32_32x32x16_bf16 v[48:63], v[92:95], a[252:255], v[48:63]
    s_nop 10
    v_cvt_pk_bf16_f32 v96, v32, v33
    v_cvt_pk_bf16_f32 v97, v34, v35
    v_cvt_pk_bf16_f32 v98, v36, v37
    v_cvt_pk_bf16_f32 v99, v38, v39
    v_cvt_pk_bf16_f32 v100, v40, v41
    v_cvt_pk_bf16_f32 v101, v42, v43
    v_cvt_pk_bf16_f32 v102, v44, v45
    v_cvt_pk_bf16_f32 v103, v46, v47
    s_add_u32 s33, s48, 8192
    buffer_store_dwordx4 v[96:99], v3, s[8:11], s33 offen sc1
    buffer_store_dwordx4 v[100:103], v3, s[8:11], s33 offen offset:1024 sc1
    v_cvt_pk_bf16_f32 v104, v48, v49
    v_cvt_pk_bf16_f32 v105, v50, v51
    v_cvt_pk_bf16_f32 v106, v52, v53
    v_cvt_pk_bf16_f32 v107, v54, v55
    v_cvt_pk_bf16_f32 v108, v56, v57
    v_cvt_pk_bf16_f32 v109, v58, v59
    v_cvt_pk_bf16_f32 v110, v60, v61
    v_cvt_pk_bf16_f32 v111, v62, v63
    s_add_u32 s33, s48, 16384
    buffer_store_dwordx4 v[104:107], v3, s[8:11], s33 offen sc1
    buffer_store_dwordx4 v[108:111], v3, s[8:11], s33 offen offset:1024 sc1
    s_mov_b32 s54, 1
    s_and_b32 s32, s40, 2
    s_cmp_eq_u32 s32, 0
    s_cbranch_scc1 P_119_noq
    ds_read_b128 v[64:67], v5 offset:0
    ds_read_b128 v[68:71], v5 offset:1024
    ds_read_b128 v[72:75], v5 offset:2048
    ds_read_b128 v[76:79], v5 offset:3072
    ds_read_b128 v[80:83], v5 offset:4096
    ds_read_b128 v[84:87], v5 offset:5120
    s_waitcnt lgkmcnt(5)
    v_mfma_f32_32x32x16_bf16 v[32:47], v[128:131], v[64:67], 0
    ds_read_b128 v[88:91], v5 offset:6144
    s_waitcnt lgkmcnt(5)
    v_mfma_f32_32x32x16_bf16 v[32:47], v[132:135], v[68:71], v[32:47]
    ds_read_b128 v[92:95], v5 offset:7168
    s_waitcnt lgkmcnt(5)
    v_mfma_f32_32x32x16_bf16 v[32:47], v[136:139], v[72:75], v[32:47]
    ds_read_b128 v[64:67], v5 offset:8192
    s_waitcnt lgkmcnt(5)
    v_mfma_f32_32x32x16_bf16 v[32:47], v[140:143], v[76:79], v[32:47]
    ds_read_b128 v[68:71], v5 offset:9216
    s_waitcnt lgkmcnt(5)
    v_mfma_f32_32x32x16_bf16 v[32:47], v[144:147], v[80:83], v[32:47]
    ds_read_b128 v[72:75], v5 offset:10240
    s_waitcnt lgkmcnt(5)
    v_mfma_f32_32x32x16_bf16 v[32:47], v[148:151], v[84:87], v[32:47]
    ds_read_b128 v[76:79], v5 offset:11264
    s_waitcnt lgkmcnt(5)
    v_mfma_f32_32x32x16_bf16 v[32:47], v[152:155], v[88:91], v[32:47]
    ds_read_b128 v[80:83], v5 offset:12288
    s_waitcnt lgkmcnt(5)
    v_mfma_f32_32x32x16_bf16 v[32:47], v[156:159], v[92:95], v[32:47]
    ds_read_b128 v[84:87], v5 offset:13312
    s_waitcnt lgkmcnt(5)
    v_mfma_f32_32x32x16_bf16 v[32:47], v[160:163], v[64:67], v[32:47]
    ds_read_b128 v[88:91], v5 offset:14336
    s_waitcnt lgkmcnt(5)
    v_mfma_f32_32x32x16_bf16 v[32:47], v[164:167], v[68:71], v[32:47]
    ds_read_b128 v[92:95], v5 offset:15360
    s_waitcnt lgkmcnt(5)
    v_mfma_f32_32x32x16_bf16 v[32:47], v[168:171], v[72:75], v[32:47]
    ds_read_b128 v[64:67], v5 offset:16384
    s_waitcnt lgkmcnt(5)
    v_mfma_f32_32x32x16_bf16 v[32:47], v[172:175], v[76:79], v[32:47]
    ds_read_b128 v[68:71], v5 offset:17408
    s_waitcnt lgkmcnt(5)
    v_mfma_f32_32x32x16_bf16 v[32:47], v[176:179], v[80:83], v[32:47]
    ds_read_b128 v[72:75], v5 offset:18432
    s_waitcnt lgkmcnt(5)
    v_mfma_f32_32x32x16_bf16 v[32:47], v[180:183], v[84:87], v[32:47]
    ds_read_b128 v[76:79], v5 offset:19456
    s_waitcnt lgkmcnt(5)
    v_mfma_f32_32x32x16_bf16 v[32:47], v[184:187], v[88:91], v[32:47]
    ds_read_b128 v[80:83], v5 offset:20480
    s_waitcnt lgkmcnt(5)
    v_mfma_f32_32x32x16_bf16 v[32:47], v[188:191], v[92:95], v[32:47]
    ds_read_b128 v[84:87], v5 offset:21504
    s_waitcnt lgkmcnt(5)
    v_mfma_f32_32x32x16_bf16 v[32:47], v[192:195], v[64:67], v[32:47]
    ds_read_b128 v[88:91], v5 offset:22528
    s_waitcnt lgkmcnt(5)
    v_mfma_f32_32x32x16_bf16 v[32:47], v[196:199], v[68:71], v[32:47]
    ds_read_b128 v[92:95], v5 offset:23552
    s_waitcnt lgkmcnt(5)
    v_mfma_f32_32x32x16_bf16 v[32:47], v[200:203], v[72:75], v[32:47]
    ds_read_b128 v[64:67], v5 offset:24576
    s_waitcnt lgkmcnt(5)
    v_mfma_f32_32x32x16_bf16 v[32:47], v[204:207], v[76:79], v[32:47]
    ds_read_b128 v[68:71], v5 offset:25600
    s_waitcnt lgkmcnt(5)
    v_mfma_f32_32x32x16_bf16 v[32:47], v[208:211], v[80:83], v[32:47]
    ds_read_b128 v[72:75], v5 offset:26624
    s_waitcnt lgkmcnt(5)
    v_mfma_f32_32x32x16_bf16 v[32:47], v[212:215], v[84:87], v[32:47]
    ds_read_b128 v[76:79], v5 offset:27648
    s_waitcnt lgkmcnt(5)
    v_mfma_f32_32x32x16_bf16 v[32:47], v[216:219], v[88:91], v[32:47]
    ds_read_b128 v[80:83], v5 offset:28672
    s_waitcnt vmcnt(0)
    v_mov_b32 v12, 1
    v_mov_b32 v11, 0
    s_mov_b64 exec, 1
    buffer_store_dword v12, v11, s[8:11], s49 offen sc1
    s_mov_b64 exec, -1
    s_waitcnt lgkmcnt(5)
    v_mfma_f32_32x32x16_bf16 v[32:47], v[220:223], v[92:95], v[32:47]
    ds_read_b128 v[84:87], v5 offset:29696
    s_waitcnt lgkmcnt(5)
    v_mfma_f32_32x32x16_bf16 v[32:47], v[224:227], v[64:67], v[32:47]
    ds_read_b128 v[88:91], v5 offset:30720
    s_waitcnt lgkmcnt(5)
    v_mfma_f32_32x32x16_bf16 v[32:47], v[228:231], v[68:71], v[32:47]
    ds_read_b128 v[92:95], v5 offset:31744
    s_waitcnt lgkmcnt(5)
    v_mfma_f32_32x32x16_bf16 v[32:47], v[232:235], v[72:75], v[32:47]
    s_waitcnt lgkmcnt(4)
    v_mfma_f32_32x32x16_bf16 v[32:47], v[236:239], v[76:79], v[32:47]
    s_waitcnt lgkmcnt(3)
    v_mfma_f32_32x32x16_bf16 v[32:47], v[240:243], v[80:83], v[32:47]
    s_waitcnt lgkmcnt(2)
    v_mfma_f32_32x32x16_bf16 v[32:47], v[244:247], v[84:87], v[32:47]
    s_waitcnt lgkmcnt(1)
    v_mfma_f32_32x32x16_bf16 v[32:47], v[248:251], v[88:91], v[32:47]
    s_waitcnt lgkmcnt(0)
    v_mfma_f32_32x32x16_bf16 v[32:47], v[252:255], v[92:95], v[32:47]
    s_nop 11
    v_cvt_pk_bf16_f32 v96, v32, v33
    v_cvt_pk_bf16_f32 v97, v34, v35
    v_cvt_pk_bf16_f32 v98, v36, v37
    v_cvt_pk_bf16_f32 v99, v38, v39
    v_cvt_pk_bf16_f32 v100, v40, v41
    v_cvt_pk_bf16_f32 v101, v42, v43
    v_cvt_pk_bf16_f32 v102, v44, v45
    v_cvt_pk_bf16_f32 v103, v46, v47
    buffer_store_dwordx4 v[96:99], v3, s[8:11], s48 offen sc1
    buffer_store_dwordx4 v[100:103], v3, s[8:11], s48 offen offset:1024 sc1
    s_mov_b32 s54, 2
P_119_noq:
    s_add_u32 s48, s48, 786432
    s_add_u32 s49, s49, 1024
    s_add_u32 s40, s40, 1
    s_mov_b32 s42, s50
    s_cmp_eq_u32 s51, 0
    s_cbranch_scc1 P_119_slow
    s_mov_b32 s47, s54
    s_add_u32 s43, s43, 32768
    s_add_u32 s45, s45, 128
    s_cmp_eq_u32 s54, 2
    s_cbranch_scc1 P_119_fq
    s_waitcnt vmcnt(4)
P_119_fq:
    s_barrier
    s_branch P_119_unit
P_119_slow:
    s_waitcnt vmcnt(0)
    s_sub_u32 s33, s49, 1024
    s_add_u32 s34, s33, 16
    s_cmp_eq_u32 s54, 2
    s_cselect_b32 s33, s34, s33
    v_mov_b32 v12, 1
    v_mov_b32 v11, 0
    s_mov_b64 exec, 1
    buffer_store_dword v12, v11, s[8:11], s33 offen sc1
    s_mov_b64 exec, -1
    s_mov_b32 s47, 0
    s_cmp_ge_u32 s40, 64
    s_cbranch_scc1 P_119_done
    s_mov_b32 s96, 0
    v_mbcnt_lo_u32_b32 v8, -1, 0
    v_mbcnt_hi_u32_b32 v8, -1, v8
    v_min_u32 v8, 15, v8
    v_lshlrev_b32 v8, 2, v8
P_119ws_121_spin:
    buffer_load_dword v9, v8, s[8:11], s45 offen sc1
    s_waitcnt vmcnt(0)
    v_cmp_eq_u32 vcc, 0, v9
    s_cbranch_vccz P_119ws_121_ok
    s_add_u32 s96, s96, 1
    s_cmp_gt_u32 s96, 300000
    s_cbranch_scc1 L_fail
    s_sleep 1
    s_branch P_119ws_121_spin
P_119ws_121_ok:
    s_lshl_b32 s53, s6, 13
    s_add_u32 s53, s53, s42
    s_add_u32 m0, s53, 0
    s_add_u32 s33, s43, 0
    buffer_load_dwordx4 v2, s[8:11], s33 offen offset:0 sc1 lds
    buffer_load_dwordx4 v2, s[8:11], s33 offen offset:1024 sc1 lds
    buffer_load_dwordx4 v2, s[8:11], s33 offen offset:2048 sc1 lds
    buffer_load_dwordx4 v2, s[8:11], s33 offen offset:3072 sc1 lds
    s_add_u32 m0, s53, 4096
    s_add_u32 s33, s43, 4096
    buffer_load_dwordx4 v2, s[8:11], s33 offen offset:0 sc1 lds
    buffer_load_dwordx4 v2, s[8:11], s33 offen offset:1024 sc1 lds
    buffer_load_dwordx4 v2, s[8:11], s33 offen offset:2048 sc1 lds
    buffer_load_dwordx4 v2, s[8:11], s33 offen offset:3072 sc1 lds
    s_add_u32 s43, s43, 32768
    s_add_u32 s45, s45, 128
    s_waitcnt vmcnt(0)
    s_barrier
    s_branch P_119_unit
P_119_done:
LE_P:
    s_endpgm
L_CH:
    s_mov_b32 s4, s3
    s_cmp_eq_u32 s4, 0
    s_cbranch_scc1 L_CH_ng0
    s_load_dwordx2 s[92:93], s[0:1], 88
    s_waitcnt lgkmcnt(0)
    s_mov_b32 s94, 256
    s_mov_b32 s95, 0x20000
    s_mov_b32 s96, 0
L_CHgi_iw:
    v_mbcnt_lo_u32_b32 v9, -1, 0
    v_mbcnt_hi_u32_b32 v9, -1, v9
    v_min_u32 v9, 7, v9
    v_and_b32 v10, 1, v9
    v_lshlrev_b32 v10, 7, v10
    v_lshrrev_b32 v9, 1, v9
    v_lshl_add_u32 v9, v9, 2, v10
    buffer_load_dword v9, v9, s[92:95], 0 offen sc1
    s_waitcnt vmcnt(0)
    v_cmp_gt_u32 vcc, 32, v9
    s_cmp_eq_u64 vcc, 0
    s_cselect_b32 s97, 256, 0
    s_cmp_ge_u32 s97, 256
    s_cbranch_scc1 L_CHgi_iwd
    s_add_u32 s96, s96, 1
    s_cmp_gt_u32 s96, 300000
    s_cbranch_scc1 L_fail
    s_sleep 2
    s_branch L_CHgi_iw
L_CHgi_iwd:
L_CH_ng0:
    s_cmp_eq_u32 s4, 0
    s_cbranch_scc1 L_CH_ng
    s_mov_b32 s12, 205725696
    s_mov_b32 s96, 0
    v_mbcnt_lo_u32_b32 v8, -1, 0
    v_mbcnt_hi_u32_b32 v8, -1, v8
    v_min_u32 v8, 15, v8
    v_lshlrev_b32 v8, 2, v8
L_CHg_122_spin:
    buffer_load_dword v9, v8, s[8:11], s12 offen sc1
    s_waitcnt vmcnt(0)
    v_cmp_eq_u32 vcc, 0, v9
    s_cbranch_vccz L_CHg_122_ok
    s_add_u32 s96, s96, 1
    s_cmp_gt_u32 s96, 300000
    s_cbranch_scc1 L_fail
    s_sleep 8
    s_branch L_CHg_122_spin
L_CHg_122_ok:
L_CH_ng:
LB_CH:
    s_lshl_b32 s24, s4, 20
    s_lshl_b32 s25, s5, 13
    s_add_u32 s24, s24, s25
    s_lshl_b32 s25, s6, 11
    s_add_u32 s24, s24, s25
    s_add_u32 s24, s24, 202375168
    v_lshlrev_b32 v2, 4, v0
    v_mov_b32 v4, -1
    v_mov_b32 v5, -1
    v_mov_b32 v6, -1
    v_mov_b32 v7, -1
    buffer_store_dwordx4 v[4:7], v2, s[8:11], s24 offen
    buffer_store_dwordx4 v[4:7], v2, s[8:11], s24 offen offset:1024
    s_lshl_b32 s24, s4, 15
    s_lshl_b32 s25, s5, 8
    s_add_u32 s24, s24, s25
    s_add_u32 s24, s24, 201326592
    s_mul_i32 s25, s6, 8192
    s_add_u32 s24, s24, s25
    s_cmp_eq_u32 s6, 3
    s_cbranch_scc1 ch_123_ci0
    s_mov_b64 exec, 0xffff
    buffer_store_dwordx4 v[4:7], v2, s[8:11], s24 offen
    s_mov_b64 exec, -1
ch_123_ci0:
    s_waitcnt vmcnt(0)
    s_barrier
    s_cmp_lg_u32 s6, 0
    s_cbranch_scc1 ch_123_ci1
    s_load_dwordx2 s[12:13], s[0:1], 88
    s_waitcnt lgkmcnt(0)
    s_mov_b32 s14, 256
    s_mov_b32 s15, 0x20000
    s_lshl_b32 s24, s4, 2
    s_add_u32 s24, s24, 64
    v_mov_b32 v3, 1
    v_mov_b32 v4, s24
    s_mov_b64 exec, 1
    buffer_atomic_add v3, v4, s[12:15], 0 offen
    s_mov_b64 exec, -1
ch_123_ci1:
    s_load_dwordx2 s[12:13], s[0:1], 40
    s_load_dwordx2 s[16:17], s[0:1], 48
    s_load_dwordx2 s[20:21], s[0:1], 56
    s_load_dwordx2 s[24:25], s[0:1], 64
    s_load_dwordx2 s[28:29], s[0:1], 32
    s_waitcnt lgkmcnt(0)
    s_mov_b32 s14, 4194304
    s_mov_b32 s15, 0x20000
    s_mov_b32 s18, 4194304
    s_mov_b32 s19, 0x20000
    s_mov_b32 s22, 4194304
    s_mov_b32 s23, 0x20000
    s_mov_b32 s26, 4194304
    s_mov_b32 s27, 0x20000
    s_mov_b32 s30, 8192
    s_mov_b32 s31, 0x20000
    v_and_b32 v60, 15, v0
    v_lshrrev_b32 v61, 4, v0
    v_and_b32 v62, 1, v61
    v_lshlrev_b32 v63, 13, v61
    s_lshl_b32 s32, s5, 8
    v_add_u32 v63, s32, v63
    v_lshlrev_b32 v64, 1, v62
    v_or_b32 v64, 0, v64
    v_xor_b32 v64, v60, v64
    v_lshl_add_u32 v40, v64, 4, v63
    v_lshlrev_b32 v64, 1, v62
    v_or_b32 v64, 4, v64
    v_xor_b32 v64, v60, v64
    v_lshl_add_u32 v41, v64, 4, v63
    v_lshlrev_b32 v64, 1, v62
    v_or_b32 v64, 8, v64
    v_xor_b32 v64, v60, v64
    v_lshl_add_u32 v42, v64, 4, v63
    v_lshlrev_b32 v64, 1, v62
    v_or_b32 v64, 12, v64
    v_xor_b32 v64, v60, v64
    v_lshl_add_u32 v43, v64, 4, v63
    v_lshrrev_b32 v62, 2, v60
    v_and_b32 v63, 3, v60
    v_lshrrev_b32 v64, 1, v61
    v_and_b32 v65, 1, v61
    v_lshrrev_b32 v66, 1, v62
    v_and_b32 v67, 1, v62
    v_lshlrev_b32 v68, 4, v64
    v_lshl_add_u32 v68, v66, 3, v68
    v_lshl_add_u32 v68, v65, 2, v68
    v_add_u32 v68, v68, v67
    v_lshl_add_u32 v69, v65, 1, v67
    v_lshl_add_u32 v69, v66, 2, v69
    v_lshlrev_b32 v69, 1, v69
    s_lshl_b32 s32, s6, 2
    v_lshrrev_b32 v70, 1, v63
    v_add_u32 v70, s32, v70
    v_xor_b32 v70, v70, v69
    v_lshlrev_b32 v70, 4, v70
    v_and_b32 v71, 1, v63
    v_lshl_add_u32 v70, v71, 3, v70
    v_lshl_add_u32 v72, v68, 8, v70
    v_xor_b32 v73, 32, v72
    v_and_b32 v62, 1, v61
    v_lshlrev_b32 v63, 10, v61
    s_lshl_b32 s32, s5, 17
    v_add_u32 v63, s32, v63
    v_lshlrev_b32 v64, 1, v62
    v_or_b32 v64, 0, v64
    v_xor_b32 v64, v60, v64
    v_lshl_add_u32 v50, v64, 4, v63
    v_lshlrev_b32 v64, 1, v62
    v_or_b32 v64, 4, v64
    v_xor_b32 v64, v60, v64
    v_lshl_add_u32 v51, v64, 4, v63
    v_lshlrev_b32 v64, 1, v62
    v_or_b32 v64, 8, v64
    v_xor_b32 v64, v60, v64
    v_lshl_add_u32 v52, v64, 4, v63
    v_lshlrev_b32 v64, 1, v62
    v_or_b32 v64, 12, v64
    v_xor_b32 v64, v60, v64
    v_lshl_add_u32 v53, v64, 4, v63
    v_lshrrev_b32 v62, 2, v60
    v_lshrrev_b32 v64, 1, v61
    v_and_b32 v65, 1, v61
    v_lshrrev_b32 v66, 1, v62
    v_and_b32 v67, 1, v62
    v_lshlrev_b32 v68, 5, v66
    v_lshl_add_u32 v68, v65, 4, v68
    v_lshl_add_u32 v68, v64, 2, v68
    v_add_u32 v68, v68, v67
    v_lshl_add_u32 v54, v68, 8, v70
    v_xor_b32 v55, 32, v54
    v_lshlrev_b32 v56, 4, v0
    s_and_b32 s36, s6, 1
    s_cmp_eq_u32 s36, 0
    s_cselect_b64 vcc, -1, 0
    v_cndmask_b32 v58, v52, v50, vcc
    v_cndmask_b32 v59, v53, v51, vcc
    s_lshl_b32 s33, s6, 19
    s_add_u32 s33, s33, 0
    s_lshl_b32 s34, s6, 14
    s_add_u32 s34, s34, 32768
    s_add_u32 m0, s34, 0
    s_add_u32 s35, s33, 0
    buffer_load_dwordx4 v40, s[12:15], s35 offen lds
    s_add_u32 m0, s34, 1024
    s_add_u32 s35, s33, 32768
    buffer_load_dwordx4 v41, s[12:15], s35 offen lds
    s_add_u32 m0, s34, 2048
    s_add_u32 s35, s33, 65536
    buffer_load_dwordx4 v42, s[12:15], s35 offen lds
    s_add_u32 m0, s34, 3072
    s_add_u32 s35, s33, 98304
    buffer_load_dwordx4 v43, s[12:15], s35 offen lds
    s_add_u32 m0, s34, 4096
    s_add_u32 s35, s33, 131072
    buffer_load_dwordx4 v40, s[12:15], s35 offen lds
    s_add_u32 m0, s34, 5120
    s_add_u32 s35, s33, 163840
    buffer_load_dwordx4 v41, s[12:15], s35 offen lds
    s_add_u32 m0, s34, 6144
    s_add_u32 s35, s33, 196608
    buffer_load_dwordx4 v42, s[12:15], s35 offen lds
    s_add_u32 m0, s34, 7168
    s_add_u32 s35, s33, 229376
    buffer_load_dwordx4 v43, s[12:15], s35 offen lds
    s_add_u32 m0, s34, 8192
    s_add_u32 s35, s33, 262144
    buffer_load_dwordx4 v40, s[12:15], s35 offen lds
    s_add_u32 m0, s34, 9216
    s_add_u32 s35, s33, 294912
    buffer_load_dwordx4 v41, s[12:15], s35 offen lds
    s_add_u32 m0, s34, 10240
    s_add_u32 s35, s33, 327680
    buffer_load_dwordx4 v42, s[12:15], s35 offen lds
    s_add_u32 m0, s34, 11264
    s_add_u32 s35, s33, 360448
    buffer_load_dwordx4 v43, s[12:15], s35 offen lds
    s_add_u32 m0, s34, 12288
    s_add_u32 s35, s33, 393216
    buffer_load_dwordx4 v40, s[12:15], s35 offen lds
    s_add_u32 m0, s34, 13312
    s_add_u32 s35, s33, 425984
    buffer_load_dwordx4 v41, s[12:15], s35 offen lds
    s_add_u32 m0, s34, 14336
    s_add_u32 s35, s33, 458752
    buffer_load_dwordx4 v42, s[12:15], s35 offen lds
    s_add_u32 m0, s34, 15360
    s_add_u32 s35, s33, 491520
    buffer_load_dwordx4 v43, s[12:15], s35 offen lds
    s_lshl_b32 s33, s6, 19
    s_add_u32 s33, s33, 2097152
    s_lshl_b32 s34, s6, 14
    s_add_u32 s34, s34, 98304
    s_add_u32 m0, s34, 0
    s_add_u32 s35, s33, 0
    buffer_load_dwordx4 v40, s[12:15], s35 offen lds
    s_add_u32 m0, s34, 1024
    s_add_u32 s35, s33, 32768
    buffer_load_dwordx4 v41, s[12:15], s35 offen lds
    s_add_u32 m0, s34, 2048
    s_add_u32 s35, s33, 65536
    buffer_load_dwordx4 v42, s[12:15], s35 offen lds
    s_add_u32 m0, s34, 3072
    s_add_u32 s35, s33, 98304
    buffer_load_dwordx4 v43, s[12:15], s35 offen lds
    s_add_u32 m0, s34, 4096
    s_add_u32 s35, s33, 131072
    buffer_load_dwordx4 v40, s[12:15], s35 offen lds
    s_add_u32 m0, s34, 5120
    s_add_u32 s35, s33, 163840
    buffer_load_dwordx4 v41, s[12:15], s35 offen lds
    s_add_u32 m0, s34, 6144
    s_add_u32 s35, s33, 196608
    buffer_load_dwordx4 v42, s[12:15], s35 offen lds
    s_add_u32 m0, s34, 7168
    s_add_u32 s35, s33, 229376
    buffer_load_dwordx4 v43, s[12:15], s35 offen lds
    s_add_u32 m0, s34, 8192
    s_add_u32 s35, s33, 262144
    buffer_load_dwordx4 v40, s[12:15], s35 offen lds
    s_add_u32 m0, s34, 9216
    s_add_u32 s35, s33, 294912
    buffer_load_dwordx4 v41, s[12:15], s35 offen lds
    s_add_u32 m0, s34, 10240
    s_add_u32 s35, s33, 327680
    buffer_load_dwordx4 v42, s[12:15], s35 offen lds
    s_add_u32 m0, s34, 11264
    s_add_u32 s35, s33, 360448
    buffer_load_dwordx4 v43, s[12:15], s35 offen lds
    s_add_u32 m0, s34, 12288
    s_add_u32 s35, s33, 393216
    buffer_load_dwordx4 v40, s[12:15], s35 offen lds
    s_add_u32 m0, s34, 13312
    s_add_u32 s35, s33, 425984
    buffer_load_dwordx4 v41, s[12:15], s35 offen lds
    s_add_u32 m0, s34, 14336
    s_add_u32 s35, s33, 458752
    buffer_load_dwordx4 v42, s[12:15], s35 offen lds
    s_add_u32 m0, s34, 15360
    s_add_u32 s35, s33, 491520
    buffer_load_dwordx4 v43, s[12:15], s35 offen lds
    s_lshl_b32 s33, s6, 15
    s_add_u32 s33, s33, 0
    s_lshl_b32 s34, s6, 13
    s_add_u32 m0, s34, 0
    s_add_u32 s35, s33, 0
    buffer_load_dwordx4 v58, s[24:27], s35 offen lds
    s_add_u32 m0, s34, 1024
    s_add_u32 s35, s33, 4096
    buffer_load_dwordx4 v58, s[24:27], s35 offen lds
    s_add_u32 m0, s34, 2048
    s_add_u32 s35, s33, 8192
    buffer_load_dwordx4 v58, s[24:27], s35 offen lds
    s_add_u32 m0, s34, 3072
    s_add_u32 s35, s33, 12288
    buffer_load_dwordx4 v58, s[24:27], s35 offen lds
    s_add_u32 m0, s34, 4096
    s_add_u32 s35, s33, 16384
    buffer_load_dwordx4 v59, s[24:27], s35 offen lds
    s_add_u32 m0, s34, 5120
    s_add_u32 s35, s33, 20480
    buffer_load_dwordx4 v59, s[24:27], s35 offen lds
    s_add_u32 m0, s34, 6144
    s_add_u32 s35, s33, 24576
    buffer_load_dwordx4 v59, s[24:27], s35 offen lds
    s_add_u32 m0, s34, 7168
    s_add_u32 s35, s33, 28672
    buffer_load_dwordx4 v59, s[24:27], s35 offen lds
    s_waitcnt vmcnt(24)
    s_barrier
    v_add_u32 v44, 32768, v72
    v_add_u32 v45, 32768, v73
    ds_read_b64_tr_b16 a[0:1], v44 offset:0
    ds_read_b64_tr_b16 a[2:3], v44 offset:512
    ds_read_b64_tr_b16 a[4:5], v44 offset:8192
    ds_read_b64_tr_b16 a[6:7], v44 offset:8704
    s_waitcnt lgkmcnt(8)
    ds_read_b64_tr_b16 a[8:9], v44 offset:16384
    ds_read_b64_tr_b16 a[10:11], v44 offset:16896
    ds_read_b64_tr_b16 a[12:13], v44 offset:24576
    ds_read_b64_tr_b16 a[14:15], v44 offset:25088
    s_waitcnt lgkmcnt(8)
    ds_read_b64_tr_b16 a[16:17], v44 offset:32768
    ds_read_b64_tr_b16 a[18:19], v44 offset:33280
    ds_read_b64_tr_b16 a[20:21], v44 offset:40960
    ds_read_b64_tr_b16 a[22:23], v44 offset:41472
    s_waitcnt lgkmcnt(8)
    ds_read_b64_tr_b16 a[24:25], v44 offset:49152
    ds_read_b64_tr_b16 a[26:27], v44 offset:49664
    ds_read_b64_tr_b16 a[28:29], v44 offset:57344
    ds_read_b64_tr_b16 a[30:31], v44 offset:57856
    s_waitcnt lgkmcnt(8)
    ds_read_b64_tr_b16 a[64:65], v45 offset:0
    ds_read_b64_tr_b16 a[66:67], v45 offset:512
    ds_read_b64_tr_b16 a[68:69], v45 offset:8192
    ds_read_b64_tr_b16 a[70:71], v45 offset:8704
    s_waitcnt lgkmcnt(8)
    ds_read_b64_tr_b16 a[72:73], v45 offset:16384
    ds_read_b64_tr_b16 a[74:75], v45 offset:16896
    ds_read_b64_tr_b16 a[76:77], v45 offset:24576
    ds_read_b64_tr_b16 a[78:79], v45 offset:25088
    s_waitcnt lgkmcnt(8)
    ds_read_b64_tr_b16 a[80:81], v45 offset:32768
    ds_read_b64_tr_b16 a[82:83], v45 offset:33280
    ds_read_b64_tr_b16 a[84:85], v45 offset:40960
    ds_read_b64_tr_b16 a[86:87], v45 offset:41472
    s_waitcnt lgkmcnt(8)
    ds_read_b64_tr_b16 a[88:89], v45 offset:49152
    ds_read_b64_tr_b16 a[90:91], v45 offset:49664
    ds_read_b64_tr_b16 a[92:93], v45 offset:57344
    ds_read_b64_tr_b16 a[94:95], v45 offset:57856
    s_waitcnt lgkmcnt(8)
    s_waitcnt lgkmcnt(0)
    s_barrier
    s_lshl_b32 s33, s6, 19
    s_add_u32 s33, s33, 0
    s_lshl_b32 s34, s6, 14
    s_add_u32 s34, s34, 32768
    s_add_u32 m0, s34, 0
    s_add_u32 s35, s33, 0
    buffer_load_dwordx4 v40, s[16:19], s35 offen lds
    s_add_u32 m0, s34, 1024
    s_add_u32 s35, s33, 32768
    buffer_load_dwordx4 v41, s[16:19], s35 offen lds
    s_add_u32 m0, s34, 2048
    s_add_u32 s35, s33, 65536
    buffer_load_dwordx4 v42, s[16:19], s35 offen lds
    s_add_u32 m0, s34, 3072
    s_add_u32 s35, s33, 98304
    buffer_load_dwordx4 v43, s[16:19], s35 offen lds
    s_add_u32 m0, s34, 4096
    s_add_u32 s35, s33, 131072
    buffer_load_dwordx4 v40, s[16:19], s35 offen lds
    s_add_u32 m0, s34, 5120
    s_add_u32 s35, s33, 163840
    buffer_load_dwordx4 v41, s[16:19], s35 offen lds
    s_add_u32 m0, s34, 6144
    s_add_u32 s35, s33, 196608
    buffer_load_dwordx4 v42, s[16:19], s35 offen lds
    s_add_u32 m0, s34, 7168
    s_add_u32 s35, s33, 229376
    buffer_load_dwordx4 v43, s[16:19], s35 offen lds
    s_add_u32 m0, s34, 8192
    s_add_u32 s35, s33, 262144
    buffer_load_dwordx4 v40, s[16:19], s35 offen lds
    s_add_u32 m0, s34, 9216
    s_add_u32 s35, s33, 294912
    buffer_load_dwordx4 v41, s[16:19], s35 offen lds
    s_add_u32 m0, s34, 10240
    s_add_u32 s35, s33, 327680
    buffer_load_dwordx4 v42, s[16:19], s35 offen lds
    s_add_u32 m0, s34, 11264
    s_add_u32 s35, s33, 360448
    buffer_load_dwordx4 v43, s[16:19], s35 offen lds
    s_add_u32 m0, s34, 12288
    s_add_u32 s35, s33, 393216
    buffer_load_dwordx4 v40, s[16:19], s35 offen lds
    s_add_u32 m0, s34, 13312
    s_add_u32 s35, s33, 425984
    buffer_load_dwordx4 v41, s[16:19], s35 offen lds
    s_add_u32 m0, s34, 14336
    s_add_u32 s35, s33, 458752
    buffer_load_dwordx4 v42, s[16:19], s35 offen lds
    s_add_u32 m0, s34, 15360
    s_add_u32 s35, s33, 491520
    buffer_load_dwordx4 v43, s[16:19], s35 offen lds
    s_waitcnt vmcnt(24)
    s_barrier
    v_add_u32 v44, 98304, v72
    v_add_u32 v45, 98304, v73
    ds_read_b64_tr_b16 a[32:33], v44 offset:0
    ds_read_b64_tr_b16 a[34:35], v44 offset:512
    ds_read_b64_tr_b16 a[36:37], v44 offset:8192
    ds_read_b64_tr_b16 a[38:39], v44 offset:8704
    s_waitcnt lgkmcnt(8)
    ds_read_b64_tr_b16 a[40:41], v44 offset:16384
    ds_read_b64_tr_b16 a[42:43], v44 offset:16896
    ds_read_b64_tr_b16 a[44:45], v44 offset:24576
    ds_read_b64_tr_b16 a[46:47], v44 offset:25088
    s_waitcnt lgkmcnt(8)
    ds_read_b64_tr_b16 a[48:49], v44 offset:32768
    ds_read_b64_tr_b16 a[50:51], v44 offset:33280
    ds_read_b64_tr_b16 a[52:53], v44 offset:40960
    ds_read_b64_tr_b16 a[54:55], v44 offset:41472
    s_waitcnt lgkmcnt(8)
    ds_read_b64_tr_b16 a[56:57], v44 offset:49152
    ds_read_b64_tr_b16 a[58:59], v44 offset:49664
    ds_read_b64_tr_b16 a[60:61], v44 offset:57344
    ds_read_b64_tr_b16 a[62:63], v44 offset:57856
    s_waitcnt lgkmcnt(8)
    ds_read_b64_tr_b16 a[96:97], v45 offset:0
    ds_read_b64_tr_b16 a[98:99], v45 offset:512
    ds_read_b64_tr_b16 a[100:101], v45 offset:8192
    ds_read_b64_tr_b16 a[102:103], v45 offset:8704
    s_waitcnt lgkmcnt(8)
    ds_read_b64_tr_b16 a[104:105], v45 offset:16384
    ds_read_b64_tr_b16 a[106:107], v45 offset:16896
    ds_read_b64_tr_b16 a[108:109], v45 offset:24576
    ds_read_b64_tr_b16 a[110:111], v45 offset:25088
    s_waitcnt lgkmcnt(8)
    ds_read_b64_tr_b16 a[112:113], v45 offset:32768
    ds_read_b64_tr_b16 a[114:115], v45 offset:33280
    ds_read_b64_tr_b16 a[116:117], v45 offset:40960
    ds_read_b64_tr_b16 a[118:119], v45 offset:41472
    s_waitcnt lgkmcnt(8)
    ds_read_b64_tr_b16 a[120:121], v45 offset:49152
    ds_read_b64_tr_b16 a[122:123], v45 offset:49664
    ds_read_b64_tr_b16 a[124:125], v45 offset:57344
    ds_read_b64_tr_b16 a[126:127], v45 offset:57856
    s_waitcnt lgkmcnt(8)
    s_waitcnt lgkmcnt(0)
    s_barrier
    s_lshl_b32 s33, s6, 19
    s_add_u32 s33, s33, 2097152
    s_lshl_b32 s34, s6, 14
    s_add_u32 s34, s34, 98304
    s_add_u32 m0, s34, 0
    s_add_u32 s35, s33, 0
    buffer_load_dwordx4 v40, s[16:19], s35 offen lds
    s_add_u32 m0, s34, 1024
    s_add_u32 s35, s33, 32768
    buffer_load_dwordx4 v41, s[16:19], s35 offen lds
    s_add_u32 m0, s34, 2048
    s_add_u32 s35, s33, 65536
    buffer_load_dwordx4 v42, s[16:19], s35 offen lds
    s_add_u32 m0, s34, 3072
    s_add_u32 s35, s33, 98304
    buffer_load_dwordx4 v43, s[16:19], s35 offen lds
    s_add_u32 m0, s34, 4096
    s_add_u32 s35, s33, 131072
    buffer_load_dwordx4 v40, s[16:19], s35 offen lds
    s_add_u32 m0, s34, 5120
    s_add_u32 s35, s33, 163840
    buffer_load_dwordx4 v41, s[16:19], s35 offen lds
    s_add_u32 m0, s34, 6144
    s_add_u32 s35, s33, 196608
    buffer_load_dwordx4 v42, s[16:19], s35 offen lds
    s_add_u32 m0, s34, 7168
    s_add_u32 s35, s33, 229376
    buffer_load_dwordx4 v43, s[16:19], s35 offen lds
    s_add_u32 m0, s34, 8192
    s_add_u32 s35, s33, 262144
    buffer_load_dwordx4 v40, s[16:19], s35 offen lds
    s_add_u32 m0, s34, 9216
    s_add_u32 s35, s33, 294912
    buffer_load_dwordx4 v41, s[16:19], s35 offen lds
    s_add_u32 m0, s34, 10240
    s_add_u32 s35, s33, 327680
    buffer_load_dwordx4 v42, s[16:19], s35 offen lds
    s_add_u32 m0, s34, 11264
    s_add_u32 s35, s33, 360448
    buffer_load_dwordx4 v43, s[16:19], s35 offen lds
    s_add_u32 m0, s34, 12288
    s_add_u32 s35, s33, 393216
    buffer_load_dwordx4 v40, s[16:19], s35 offen lds
    s_add_u32 m0, s34, 13312
    s_add_u32 s35, s33, 425984
    buffer_load_dwordx4 v41, s[16:19], s35 offen lds
    s_add_u32 m0, s34, 14336
    s_add_u32 s35, s33, 458752
    buffer_load_dwordx4 v42, s[16:19], s35 offen lds
    s_add_u32 m0, s34, 15360
    s_add_u32 s35, s33, 491520
    buffer_load_dwordx4 v43, s[16:19], s35 offen lds
    s_waitcnt vmcnt(16)
    s_barrier
    v_add_u32 v44, 32768, v72
    v_add_u32 v45, 32768, v73
    ds_read_b64_tr_b16 a[128:129], v44 offset:0
    ds_read_b64_tr_b16 a[130:131], v44 offset:512
    ds_read_b64_tr_b16 a[132:133], v44 offset:8192
    ds_read_b64_tr_b16 a[134:135], v44 offset:8704
    s_waitcnt lgkmcnt(8)
    ds_read_b64_tr_b16 a[136:137], v44 offset:16384
    ds_read_b64_tr_b16 a[138:139], v44 offset:16896
    ds_read_b64_tr_b16 a[140:141], v44 offset:24576
    ds_read_b64_tr_b16 a[142:143], v44 offset:25088
    s_waitcnt lgkmcnt(8)
    ds_read_b64_tr_b16 a[144:145], v44 offset:32768
    ds_read_b64_tr_b16 a[146:147], v44 offset:33280
    ds_read_b64_tr_b16 a[148:149], v44 offset:40960
    ds_read_b64_tr_b16 a[150:151], v44 offset:41472
    s_waitcnt lgkmcnt(8)
    ds_read_b64_tr_b16 a[152:153], v44 offset:49152
    ds_read_b64_tr_b16 a[154:155], v44 offset:49664
    ds_read_b64_tr_b16 a[156:157], v44 offset:57344
    ds_read_b64_tr_b16 a[158:159], v44 offset:57856
    s_waitcnt lgkmcnt(8)
    ds_read_b64_tr_b16 a[192:193], v45 offset:0
    ds_read_b64_tr_b16 a[194:195], v45 offset:512
    ds_read_b64_tr_b16 a[196:197], v45 offset:8192
    ds_read_b64_tr_b16 a[198:199], v45 offset:8704
    s_waitcnt lgkmcnt(8)
    ds_read_b64_tr_b16 a[200:201], v45 offset:16384
    ds_read_b64_tr_b16 a[202:203], v45 offset:16896
    ds_read_b64_tr_b16 a[204:205], v45 offset:24576
    ds_read_b64_tr_b16 a[206:207], v45 offset:25088
    s_waitcnt lgkmcnt(8)
    ds_read_b64_tr_b16 a[208:209], v45 offset:32768
    ds_read_b64_tr_b16 a[210:211], v45 offset:33280
    ds_read_b64_tr_b16 a[212:213], v45 offset:40960
    ds_read_b64_tr_b16 a[214:215], v45 offset:41472
    s_waitcnt lgkmcnt(8)
    ds_read_b64_tr_b16 a[216:217], v45 offset:49152
    ds_read_b64_tr_b16 a[218:219], v45 offset:49664
    ds_read_b64_tr_b16 a[220:221], v45 offset:57344
    ds_read_b64_tr_b16 a[222:223], v45 offset:57856
    s_waitcnt lgkmcnt(8)
    s_waitcnt lgkmcnt(0)
    s_barrier
    s_waitcnt vmcnt(0)
    s_barrier
    v_add_u32 v44, 98304, v72
    v_add_u32 v45, 98304, v73
    ds_read_b64_tr_b16 a[160:161], v44 offset:0
    ds_read_b64_tr_b16 a[162:163], v44 offset:512
    ds_read_b64_tr_b16 a[164:165], v44 offset:8192
    ds_read_b64_tr_b16 a[166:167], v44 offset:8704
    s_waitcnt lgkmcnt(8)
    ds_read_b64_tr_b16 a[168:169], v44 offset:16384
    ds_read_b64_tr_b16 a[170:171], v44 offset:16896
    ds_read_b64_tr_b16 a[172:173], v44 offset:24576
    ds_read_b64_tr_b16 a[174:175], v44 offset:25088
    s_waitcnt lgkmcnt(8)
    ds_read_b64_tr_b16 a[176:177], v44 offset:32768
    ds_read_b64_tr_b16 a[178:179], v44 offset:33280
    ds_read_b64_tr_b16 a[180:181], v44 offset:40960
    ds_read_b64_tr_b16 a[182:183], v44 offset:41472
    s_waitcnt lgkmcnt(8)
    ds_read_b64_tr_b16 a[184:185], v44 offset:49152
    ds_read_b64_tr_b16 a[186:187], v44 offset:49664
    ds_read_b64_tr_b16 a[188:189], v44 offset:57344
    ds_read_b64_tr_b16 a[190:191], v44 offset:57856
    s_waitcnt lgkmcnt(8)
    ds_read_b64_tr_b16 a[224:225], v45 offset:0
    ds_read_b64_tr_b16 a[226:227], v45 offset:512
    ds_read_b64_tr_b16 a[228:229], v45 offset:8192
    ds_read_b64_tr_b16 a[230:231], v45 offset:8704
    s_waitcnt lgkmcnt(8)
    ds_read_b64_tr_b16 a[232:233], v45 offset:16384
    ds_read_b64_tr_b16 a[234:235], v45 offset:16896
    ds_read_b64_tr_b16 a[236:237], v45 offset:24576
    ds_read_b64_tr_b16 a[238:239], v45 offset:25088
    s_waitcnt lgkmcnt(8)
    ds_read_b64_tr_b16 a[240:241], v45 offset:32768
    ds_read_b64_tr_b16 a[242:243], v45 offset:33280
    ds_read_b64_tr_b16 a[244:245], v45 offset:40960
    ds_read_b64_tr_b16 a[246:247], v45 offset:41472
    s_waitcnt lgkmcnt(8)
    ds_read_b64_tr_b16 a[248:249], v45 offset:49152
    ds_read_b64_tr_b16 a[250:251], v45 offset:49664
    ds_read_b64_tr_b16 a[252:253], v45 offset:57344
    ds_read_b64_tr_b16 a[254:255], v45 offset:57856
    s_waitcnt lgkmcnt(8)
    s_waitcnt lgkmcnt(0)
    s_barrier
    s_lshl_b32 s33, s6, 18
    s_add_u32 s33, s33, 0
    s_lshl_b32 s34, s6, 13
    s_add_u32 s34, s34, 98304
    s_add_u32 m0, s34, 0
    s_add_u32 s35, s33, 0
    buffer_load_dwordx4 v40, s[20:23], s35 offen lds
    s_add_u32 m0, s34, 1024
    s_add_u32 s35, s33, 32768
    buffer_load_dwordx4 v41, s[20:23], s35 offen lds
    s_add_u32 m0, s34, 2048
    s_add_u32 s35, s33, 65536
    buffer_load_dwordx4 v42, s[20:23], s35 offen lds
    s_add_u32 m0, s34, 3072
    s_add_u32 s35, s33, 98304
    buffer_load_dwordx4 v43, s[20:23], s35 offen lds
    s_add_u32 m0, s34, 4096
    s_add_u32 s35, s33, 131072
    buffer_load_dwordx4 v40, s[20:23], s35 offen lds
    s_add_u32 m0, s34, 5120
    s_add_u32 s35, s33, 163840
    buffer_load_dwordx4 v41, s[20:23], s35 offen lds
    s_add_u32 m0, s34, 6144
    s_add_u32 s35, s33, 196608
    buffer_load_dwordx4 v42, s[20:23], s35 offen lds
    s_add_u32 m0, s34, 7168
    s_add_u32 s35, s33, 229376
    buffer_load_dwordx4 v43, s[20:23], s35 offen lds
    s_lshl_b32 s33, s6, 18
    s_add_u32 s33, s33, 1048576
    s_lshl_b32 s34, s6, 13
    s_add_u32 s34, s34, 131072
    s_add_u32 m0, s34, 0
    s_add_u32 s35, s33, 0
    buffer_load_dwordx4 v40, s[20:23], s35 offen lds
    s_add_u32 m0, s34, 1024
    s_add_u32 s35, s33, 32768
    buffer_load_dwordx4 v41, s[20:23], s35 offen lds
    s_add_u32 m0, s34, 2048
    s_add_u32 s35, s33, 65536
    buffer_load_dwordx4 v42, s[20:23], s35 offen lds
    s_add_u32 m0, s34, 3072
    s_add_u32 s35, s33, 98304
    buffer_load_dwordx4 v43, s[20:23], s35 offen lds
    s_add_u32 m0, s34, 4096
    s_add_u32 s35, s33, 131072
    buffer_load_dwordx4 v40, s[20:23], s35 offen lds
    s_add_u32 m0, s34, 5120
    s_add_u32 s35, s33, 163840
    buffer_load_dwordx4 v41, s[20:23], s35 offen lds
    s_add_u32 m0, s34, 6144
    s_add_u32 s35, s33, 196608
    buffer_load_dwordx4 v42, s[20:23], s35 offen lds
    s_add_u32 m0, s34, 7168
    s_add_u32 s35, s33, 229376
    buffer_load_dwordx4 v43, s[20:23], s35 offen lds
    s_waitcnt vmcnt(8)
    s_barrier
    v_add_u32 v44, 98304, v72
    v_add_u32 v45, 98304, v73
    ds_read_b64_tr_b16 v[128:129], v44 offset:0
    ds_read_b64_tr_b16 v[130:131], v44 offset:512
    ds_read_b64_tr_b16 v[132:133], v44 offset:8192
    ds_read_b64_tr_b16 v[134:135], v44 offset:8704
    ds_read_b64_tr_b16 v[136:137], v44 offset:16384
    ds_read_b64_tr_b16 v[138:139], v44 offset:16896
    ds_read_b64_tr_b16 v[140:141], v44 offset:24576
    ds_read_b64_tr_b16 v[142:143], v44 offset:25088
    ds_read_b64_tr_b16 v[192:193], v45 offset:0
    ds_read_b64_tr_b16 v[194:195], v45 offset:512
    ds_read_b64_tr_b16 v[196:197], v45 offset:8192
    ds_read_b64_tr_b16 v[198:199], v45 offset:8704
    ds_read_b64_tr_b16 v[200:201], v45 offset:16384
    ds_read_b64_tr_b16 v[202:203], v45 offset:16896
    ds_read_b64_tr_b16 v[204:205], v45 offset:24576
    ds_read_b64_tr_b16 v[206:207], v45 offset:25088
    s_waitcnt lgkmcnt(0)
    s_waitcnt lgkmcnt(0)
    s_barrier
    s_lshl_b32 s33, s6, 18
    s_add_u32 s33, s33, 2097152
    s_lshl_b32 s34, s6, 13
    s_add_u32 s34, s34, 98304
    s_add_u32 m0, s34, 0
    s_add_u32 s35, s33, 0
    buffer_load_dwordx4 v40, s[20:23], s35 offen lds
    s_add_u32 m0, s34, 1024
    s_add_u32 s35, s33, 32768
    buffer_load_dwordx4 v41, s[20:23], s35 offen lds
    s_add_u32 m0, s34, 2048
    s_add_u32 s35, s33, 65536
    buffer_load_dwordx4 v42, s[20:23], s35 offen lds
    s_add_u32 m0, s34, 3072
    s_add_u32 s35, s33, 98304
    buffer_load_dwordx4 v43, s[20:23], s35 offen lds
    s_add_u32 m0, s34, 4096
    s_add_u32 s35, s33, 131072
    buffer_load_dwordx4 v40, s[20:23], s35 offen lds
    s_add_u32 m0, s34, 5120
    s_add_u32 s35, s33, 163840
    buffer_load_dwordx4 v41, s[20:23], s35 offen lds
    s_add_u32 m0, s34, 6144
    s_add_u32 s35, s33, 196608
    buffer_load_dwordx4 v42, s[20:23], s35 offen lds
    s_add_u32 m0, s34, 7168
    s_add_u32 s35, s33, 229376
    buffer_load_dwordx4 v43, s[20:23], s35 offen lds
    s_waitcnt vmcnt(8)
    s_barrier
    v_add_u32 v44, 131072, v72
    v_add_u32 v45, 131072, v73
    ds_read_b64_tr_b16 v[144:145], v44 offset:0
    ds_read_b64_tr_b16 v[146:147], v44 offset:512
    ds_read_b64_tr_b16 v[148:149], v44 offset:8192
    ds_read_b64_tr_b16 v[150:151], v44 offset:8704
    ds_read_b64_tr_b16 v[152:153], v44 offset:16384
    ds_read_b64_tr_b16 v[154:155], v44 offset:16896
    ds_read_b64_tr_b16 v[156:157], v44 offset:24576
    ds_read_b64_tr_b16 v[158:159], v44 offset:25088
    ds_read_b64_tr_b16 v[208:209], v45 offset:0
    ds_read_b64_tr_b16 v[210:211], v45 offset:512
    ds_read_b64_tr_b16 v[212:213], v45 offset:8192
    ds_read_b64_tr_b16 v[214:215], v45 offset:8704
    ds_read_b64_tr_b16 v[216:217], v45 offset:16384
    ds_read_b64_tr_b16 v[218:219], v45 offset:16896
    ds_read_b64_tr_b16 v[220:221], v45 offset:24576
    ds_read_b64_tr_b16 v[222:223], v45 offset:25088
    s_waitcnt lgkmcnt(0)
    s_waitcnt lgkmcnt(0)
    s_barrier
    s_lshl_b32 s33, s6, 18
    s_add_u32 s33, s33, 3145728
    s_lshl_b32 s34, s6, 13
    s_add_u32 s34, s34, 131072
    s_add_u32 m0, s34, 0
    s_add_u32 s35, s33, 0
    buffer_load_dwordx4 v40, s[20:23], s35 offen lds
    s_add_u32 m0, s34, 1024
    s_add_u32 s35, s33, 32768
    buffer_load_dwordx4 v41, s[20:23], s35 offen lds
    s_add_u32 m0, s34, 2048
    s_add_u32 s35, s33, 65536
    buffer_load_dwordx4 v42, s[20:23], s35 offen lds
    s_add_u32 m0, s34, 3072
    s_add_u32 s35, s33, 98304
    buffer_load_dwordx4 v43, s[20:23], s35 offen lds
    s_add_u32 m0, s34, 4096
    s_add_u32 s35, s33, 131072
    buffer_load_dwordx4 v40, s[20:23], s35 offen lds
    s_add_u32 m0, s34, 5120
    s_add_u32 s35, s33, 163840
    buffer_load_dwordx4 v41, s[20:23], s35 offen lds
    s_add_u32 m0, s34, 6144
    s_add_u32 s35, s33, 196608
    buffer_load_dwordx4 v42, s[20:23], s35 offen lds
    s_add_u32 m0, s34, 7168
    s_add_u32 s35, s33, 229376
    buffer_load_dwordx4 v43, s[20:23], s35 offen lds
    ds_read_b64_tr_b16 v[96:97], v54 offset:0
    ds_read_b64_tr_b16 v[98:99], v54 offset:512
    ds_read_b64_tr_b16 v[100:101], v54 offset:2048
    ds_read_b64_tr_b16 v[102:103], v54 offset:2560
    ds_read_b64_tr_b16 v[104:105], v54 offset:16384
    ds_read_b64_tr_b16 v[106:107], v54 offset:16896
    ds_read_b64_tr_b16 v[108:109], v54 offset:18432
    ds_read_b64_tr_b16 v[110:111], v54 offset:18944
    ds_read_b64_tr_b16 v[112:113], v55 offset:0
    ds_read_b64_tr_b16 v[114:115], v55 offset:512
    ds_read_b64_tr_b16 v[116:117], v55 offset:2048
    ds_read_b64_tr_b16 v[118:119], v55 offset:2560
    ds_read_b64_tr_b16 v[120:121], v55 offset:16384
    ds_read_b64_tr_b16 v[122:123], v55 offset:16896
    ds_read_b64_tr_b16 v[124:125], v55 offset:18432
    ds_read_b64_tr_b16 v[126:127], v55 offset:18944
    s_lshl_b32 s36, s6, 13
    s_add_u32 s36, s36, 32768
    v_add_u32 v47, s36, v56
    s_waitcnt lgkmcnt(0)
    ds_write_b128 v47, v[96:99] offset:0
    ds_write_b128 v47, v[100:103] offset:1024
    ds_write_b128 v47, v[104:107] offset:2048
    ds_write_b128 v47, v[108:111] offset:3072
    ds_write_b128 v47, v[112:115] offset:4096
    ds_write_b128 v47, v[116:119] offset:5120
    ds_write_b128 v47, v[120:123] offset:6144
    ds_write_b128 v47, v[124:127] offset:7168
    s_waitcnt lgkmcnt(0)
    s_barrier
    s_lshl_b32 s33, s6, 15
    s_add_u32 s33, s33, 256
    s_lshl_b32 s34, s6, 13
    s_add_u32 m0, s34, 0
    s_add_u32 s35, s33, 0
    buffer_load_dwordx4 v58, s[24:27], s35 offen lds
    s_add_u32 m0, s34, 1024
    s_add_u32 s35, s33, 4096
    buffer_load_dwordx4 v58, s[24:27], s35 offen lds
    s_add_u32 m0, s34, 2048
    s_add_u32 s35, s33, 8192
    buffer_load_dwordx4 v58, s[24:27], s35 offen lds
    s_add_u32 m0, s34, 3072
    s_add_u32 s35, s33, 12288
    buffer_load_dwordx4 v58, s[24:27], s35 offen lds
    s_add_u32 m0, s34, 4096
    s_add_u32 s35, s33, 16384
    buffer_load_dwordx4 v59, s[24:27], s35 offen lds
    s_add_u32 m0, s34, 5120
    s_add_u32 s35, s33, 20480
    buffer_load_dwordx4 v59, s[24:27], s35 offen lds
    s_add_u32 m0, s34, 6144
    s_add_u32 s35, s33, 24576
    buffer_load_dwordx4 v59, s[24:27], s35 offen lds
    s_add_u32 m0, s34, 7168
    s_add_u32 s35, s33, 28672
    buffer_load_dwordx4 v59, s[24:27], s35 offen lds
    s_waitcnt vmcnt(16)
    s_barrier
    v_add_u32 v44, 98304, v72
    v_add_u32 v45, 98304, v73
    ds_read_b64_tr_b16 v[160:161], v44 offset:0
    ds_read_b64_tr_b16 v[162:163], v44 offset:512
    ds_read_b64_tr_b16 v[164:165], v44 offset:8192
    ds_read_b64_tr_b16 v[166:167], v44 offset:8704
    ds_read_b64_tr_b16 v[168:169], v44 offset:16384
    ds_read_b64_tr_b16 v[170:171], v44 offset:16896
    ds_read_b64_tr_b16 v[172:173], v44 offset:24576
    ds_read_b64_tr_b16 v[174:175], v44 offset:25088
    ds_read_b64_tr_b16 v[224:225], v45 offset:0
    ds_read_b64_tr_b16 v[226:227], v45 offset:512
    ds_read_b64_tr_b16 v[228:229], v45 offset:8192
    ds_read_b64_tr_b16 v[230:231], v45 offset:8704
    ds_read_b64_tr_b16 v[232:233], v45 offset:16384
    ds_read_b64_tr_b16 v[234:235], v45 offset:16896
    ds_read_b64_tr_b16 v[236:237], v45 offset:24576
    ds_read_b64_tr_b16 v[238:239], v45 offset:25088
    s_waitcnt lgkmcnt(0)
    s_waitcnt lgkmcnt(0)
    s_barrier
    s_waitcnt vmcnt(8)
    s_barrier
    v_add_u32 v44, 131072, v72
    v_add_u32 v45, 131072, v73
    ds_read_b64_tr_b16 v[176:177], v44 offset:0
    ds_read_b64_tr_b16 v[178:179], v44 offset:512
    ds_read_b64_tr_b16 v[180:181], v44 offset:8192
    ds_read_b64_tr_b16 v[182:183], v44 offset:8704
    ds_read_b64_tr_b16 v[184:185], v44 offset:16384
    ds_read_b64_tr_b16 v[186:187], v44 offset:16896
    ds_read_b64_tr_b16 v[188:189], v44 offset:24576
    ds_read_b64_tr_b16 v[190:191], v44 offset:25088
    ds_read_b64_tr_b16 v[240:241], v45 offset:0
    ds_read_b64_tr_b16 v[242:243], v45 offset:512
    ds_read_b64_tr_b16 v[244:245], v45 offset:8192
    ds_read_b64_tr_b16 v[246:247], v45 offset:8704
    ds_read_b64_tr_b16 v[248:249], v45 offset:16384
    ds_read_b64_tr_b16 v[250:251], v45 offset:16896
    ds_read_b64_tr_b16 v[252:253], v45 offset:24576
    ds_read_b64_tr_b16 v[254:255], v45 offset:25088
    s_waitcnt lgkmcnt(0)
    s_waitcnt lgkmcnt(0)
    s_barrier
    s_waitcnt vmcnt(0)
    s_barrier
    ds_read_b64_tr_b16 v[96:97], v54 offset:0
    ds_read_b64_tr_b16 v[98:99], v54 offset:512
    ds_read_b64_tr_b16 v[100:101], v54 offset:2048
    ds_read_b64_tr_b16 v[102:103], v54 offset:2560
    ds_read_b64_tr_b16 v[104:105], v54 offset:16384
    ds_read_b64_tr_b16 v[106:107], v54 offset:16896
    ds_read_b64_tr_b16 v[108:109], v54 offset:18432
    ds_read_b64_tr_b16 v[110:111], v54 offset:18944
    ds_read_b64_tr_b16 v[112:113], v55 offset:0
    ds_read_b64_tr_b16 v[114:115], v55 offset:512
    ds_read_b64_tr_b16 v[116:117], v55 offset:2048
    ds_read_b64_tr_b16 v[118:119], v55 offset:2560
    ds_read_b64_tr_b16 v[120:121], v55 offset:16384
    ds_read_b64_tr_b16 v[122:123], v55 offset:16896
    ds_read_b64_tr_b16 v[124:125], v55 offset:18432
    ds_read_b64_tr_b16 v[126:127], v55 offset:18944
    s_lshl_b32 s36, s6, 13
    s_add_u32 s36, s36, 65536
    v_add_u32 v47, s36, v56
    s_waitcnt lgkmcnt(0)
    ds_write_b128 v47, v[96:99] offset:0
    ds_write_b128 v47, v[100:103] offset:1024
    ds_write_b128 v47, v[104:107] offset:2048
    ds_write_b128 v47, v[108:111] offset:3072
    ds_write_b128 v47, v[112:115] offset:4096
    ds_write_b128 v47, v[116:119] offset:5120
    ds_write_b128 v47, v[120:123] offset:6144
    ds_write_b128 v47, v[124:127] offset:7168
    s_waitcnt lgkmcnt(0)
    s_barrier
    s_lshl_b32 s33, s6, 15
    s_add_u32 s33, s33, 512
    s_lshl_b32 s34, s6, 13
    s_add_u32 m0, s34, 0
    s_add_u32 s35, s33, 0
    buffer_load_dwordx4 v58, s[24:27], s35 offen lds
    s_add_u32 m0, s34, 1024
    s_add_u32 s35, s33, 4096
    buffer_load_dwordx4 v58, s[24:27], s35 offen lds
    s_add_u32 m0, s34, 2048
    s_add_u32 s35, s33, 8192
    buffer_load_dwordx4 v58, s[24:27], s35 offen lds
    s_add_u32 m0, s34, 3072
    s_add_u32 s35, s33, 12288
    buffer_load_dwordx4 v58, s[24:27], s35 offen lds
    s_add_u32 m0, s34, 4096
    s_add_u32 s35, s33, 16384
    buffer_load_dwordx4 v59, s[24:27], s35 offen lds
    s_add_u32 m0, s34, 5120
    s_add_u32 s35, s33, 20480
    buffer_load_dwordx4 v59, s[24:27], s35 offen lds
    s_add_u32 m0, s34, 6144
    s_add_u32 s35, s33, 24576
    buffer_load_dwordx4 v59, s[24:27], s35 offen lds
    s_add_u32 m0, s34, 7168
    s_add_u32 s35, s33, 28672
    buffer_load_dwordx4 v59, s[24:27], s35 offen lds
    s_waitcnt vmcnt(0)
    s_barrier
    ds_read_b64_tr_b16 v[96:97], v54 offset:0
    ds_read_b64_tr_b16 v[98:99], v54 offset:512
    ds_read_b64_tr_b16 v[100:101], v54 offset:2048
    ds_read_b64_tr_b16 v[102:103], v54 offset:2560
    ds_read_b64_tr_b16 v[104:105], v54 offset:16384
    ds_read_b64_tr_b16 v[106:107], v54 offset:16896
    ds_read_b64_tr_b16 v[108:109], v54 offset:18432
    ds_read_b64_tr_b16 v[110:111], v54 offset:18944
    ds_read_b64_tr_b16 v[112:113], v55 offset:0
    ds_read_b64_tr_b16 v[114:115], v55 offset:512
    ds_read_b64_tr_b16 v[116:117], v55 offset:2048
    ds_read_b64_tr_b16 v[118:119], v55 offset:2560
    ds_read_b64_tr_b16 v[120:121], v55 offset:16384
    ds_read_b64_tr_b16 v[122:123], v55 offset:16896
    ds_read_b64_tr_b16 v[124:125], v55 offset:18432
    ds_read_b64_tr_b16 v[126:127], v55 offset:18944
    s_lshl_b32 s36, s6, 13
    s_add_u32 s36, s36, 98304
    v_add_u32 v47, s36, v56
    s_waitcnt lgkmcnt(0)
    ds_write_b128 v47, v[96:99] offset:0
    ds_write_b128 v47, v[100:103] offset:1024
    ds_write_b128 v47, v[104:107] offset:2048
    ds_write_b128 v47, v[108:111] offset:3072
    ds_write_b128 v47, v[112:115] offset:4096
    ds_write_b128 v47, v[116:119] offset:5120
    ds_write_b128 v47, v[120:123] offset:6144
    ds_write_b128 v47, v[124:127] offset:7168
    s_waitcnt lgkmcnt(0)
    s_barrier
    s_lshl_b32 s33, s6, 15
    s_add_u32 s33, s33, 768
    s_lshl_b32 s34, s6, 13
    s_add_u32 m0, s34, 0
    s_add_u32 s35, s33, 0
    buffer_load_dwordx4 v58, s[24:27], s35 offen lds
    s_add_u32 m0, s34, 1024
    s_add_u32 s35, s33, 4096
    buffer_load_dwordx4 v58, s[24:27], s35 offen lds
    s_add_u32 m0, s34, 2048
    s_add_u32 s35, s33, 8192
    buffer_load_dwordx4 v58, s[24:27], s35 offen lds
    s_add_u32 m0, s34, 3072
    s_add_u32 s35, s33, 12288
    buffer_load_dwordx4 v58, s[24:27], s35 offen lds
    s_add_u32 m0, s34, 4096
    s_add_u32 s35, s33, 16384
    buffer_load_dwordx4 v59, s[24:27], s35 offen lds
    s_add_u32 m0, s34, 5120
    s_add_u32 s35, s33, 20480
    buffer_load_dwordx4 v59, s[24:27], s35 offen lds
    s_add_u32 m0, s34, 6144
    s_add_u32 s35, s33, 24576
    buffer_load_dwordx4 v59, s[24:27], s35 offen lds
    s_add_u32 m0, s34, 7168
    s_add_u32 s35, s33, 28672
    buffer_load_dwordx4 v59, s[24:27], s35 offen lds
    s_waitcnt vmcnt(0)
    s_barrier
    ds_read_b64_tr_b16 v[96:97], v54 offset:0
    ds_read_b64_tr_b16 v[98:99], v54 offset:512
    ds_read_b64_tr_b16 v[100:101], v54 offset:2048
    ds_read_b64_tr_b16 v[102:103], v54 offset:2560
    ds_read_b64_tr_b16 v[104:105], v54 offset:16384
    ds_read_b64_tr_b16 v[106:107], v54 offset:16896
    ds_read_b64_tr_b16 v[108:109], v54 offset:18432
    ds_read_b64_tr_b16 v[110:111], v54 offset:18944
    ds_read_b64_tr_b16 v[112:113], v55 offset:0
    ds_read_b64_tr_b16 v[114:115], v55 offset:512
    ds_read_b64_tr_b16 v[116:117], v55 offset:2048
    ds_read_b64_tr_b16 v[118:119], v55 offset:2560
    ds_read_b64_tr_b16 v[120:121], v55 offset:16384
    ds_read_b64_tr_b16 v[122:123], v55 offset:16896
    ds_read_b64_tr_b16 v[124:125], v55 offset:18432
    ds_read_b64_tr_b16 v[126:127], v55 offset:18944
    s_lshl_b32 s36, s6, 13
    s_add_u32 s36, s36, 131072
    v_add_u32 v47, s36, v56
    s_waitcnt lgkmcnt(0)
    ds_write_b128 v47, v[96:99] offset:0
    ds_write_b128 v47, v[100:103] offset:1024
    ds_write_b128 v47, v[104:107] offset:2048
    ds_write_b128 v47, v[108:111] offset:3072
    ds_write_b128 v47, v[112:115] offset:4096
    ds_write_b128 v47, v[116:119] offset:5120
    ds_write_b128 v47, v[120:123] offset:6144
    ds_write_b128 v47, v[124:127] offset:7168
    s_waitcnt lgkmcnt(0)
    s_barrier
    s_load_dwordx2 s[92:93], s[0:1], 88
    s_waitcnt lgkmcnt(0)
    s_mov_b32 s94, 256
    s_mov_b32 s95, 0x20000
    s_mov_b32 s96, 0
ch_123a_iw:
    v_mbcnt_lo_u32_b32 v9, -1, 0
    v_mbcnt_hi_u32_b32 v9, -1, v9
    v_min_u32 v9, 7, v9
    v_and_b32 v10, 1, v9
    v_lshlrev_b32 v10, 7, v10
    v_lshrrev_b32 v9, 1, v9
    v_lshl_add_u32 v9, v9, 2, v10
    buffer_load_dword v9, v9, s[92:95], 0 offen sc1
    s_waitcnt vmcnt(0)
    v_cmp_gt_u32 vcc, 32, v9
    s_cmp_eq_u64 vcc, 0
    s_cselect_b32 s97, 256, 0
    s_cmp_ge_u32 s97, 256
    s_cbranch_scc1 ch_123a_iwd
    s_add_u32 s96, s96, 1
    s_cmp_gt_u32 s96, 300000
    s_cbranch_scc1 L_fail
    s_sleep 2
    s_branch ch_123a_iw
ch_123a_iwd:
    s_cmp_lg_u32 s4, 0
    s_cbranch_scc1 ch_123_cw0
    s_load_dwordx2 s[92:93], s[0:1], 88
    s_waitcnt lgkmcnt(0)
    s_mov_b32 s94, 256
    s_mov_b32 s95, 0x20000
    s_mov_b32 s96, 0
ch_123b0_iw:
    v_mov_b32 v9, 64
    buffer_load_dword v9, v9, s[92:95], 0 offen sc1
    s_waitcnt vmcnt(0)
    v_readfirstlane_b32 s97, v9
    s_cmp_ge_u32 s97, 32
    s_cbranch_scc1 ch_123b0_iwd
    s_add_u32 s96, s96, 1
    s_cmp_gt_u32 s96, 300000
    s_cbranch_scc1 L_fail
    s_sleep 2
    s_branch ch_123b0_iw
ch_123b0_iwd:
ch_123_cw0:
    s_cmp_lg_u32 s4, 1
    s_cbranch_scc1 ch_123_cw1
    s_load_dwordx2 s[92:93], s[0:1], 88
    s_waitcnt lgkmcnt(0)
    s_mov_b32 s94, 256
    s_mov_b32 s95, 0x20000
    s_mov_b32 s96, 0
ch_123b1_iw:
    v_mov_b32 v9, 68
    buffer_load_dword v9, v9, s[92:95], 0 offen sc1
    s_waitcnt vmcnt(0)
    v_readfirstlane_b32 s97, v9
    s_cmp_ge_u32 s97, 32
    s_cbranch_scc1 ch_123b1_iwd
    s_add_u32 s96, s96, 1
    s_cmp_gt_u32 s96, 300000
    s_cbranch_scc1 L_fail
    s_sleep 2
    s_branch ch_123b1_iw
ch_123b1_iwd:
ch_123_cw1:
    v_and_b32 v60, 15, v0
    v_lshrrev_b32 v61, 4, v0
    v_lshrrev_b32 v62, 2, v60
    v_and_b32 v63, 1, v60
    v_lshl_add_u32 v62, v62, 1, v63
    v_bfe_u32 v63, v60, 1, 1
    v_mov_b32 v1, 0x4444
    v_mov_b32 v64, 0xeeee
    v_cmp_eq_u32 vcc, 1, v63
    v_lshlrev_b32 v11, 8, v61
    v_lshl_add_u32 v11, v62, 5, v11
    v_cndmask_b32 v1, v1, v64, vcc
    v_lshl_add_u32 v11, v63, 4, v11
    v_lshlrev_b32 v2, 4, v0
    v_lshl_add_u32 v66, v63, 2, v61
    v_lshlrev_b32 v13, 7, v66
    v_lshl_add_u32 v13, v62, 4, v13
    v_add_u32 v13, 14336, v13
    s_lshl_b32 s32, s6, 5
    v_add_u32 v66, s32, v60
    v_mul_u32_u24 v66, 48, v66
    v_add_u32 v66, 8192, v66
    v_lshl_add_u32 v3, v61, 2, v66
    v_lshl_add_u32 v4, v61, 3, v66
    v_add_u32 v4, 16, v4
    v_lshrrev_b32 v66, 2, v60
    v_lshrrev_b32 v67, 1, v61
    v_and_b32 v65, 1, v61
    v_lshl_add_u32 v66, v67, 4, v66
    v_lshl_add_u32 v66, v65, 2, v66
    s_lshl_b32 s32, s6, 5
    v_add_u32 v66, s32, v66
    v_mul_u32_u24 v66, 48, v66
    v_add_u32 v66, 8192, v66
    v_and_b32 v68, 1, v0
    v_lshl_add_u32 v5, v68, 3, v66
    v_and_b32 v68, 3, v0
    v_lshl_add_u32 v6, v68, 3, v66
    v_add_u32 v6, 16, v6
    v_and_b32 v68, 7, v60
    v_lshrrev_b32 v69, 3, v60
    v_lshl_add_u32 v66, v69, 4, v68
    v_lshl_add_u32 v66, v65, 5, v66
    v_lshlrev_b32 v7, 4, v66
    v_lshl_add_u32 v7, v67, 10, v7
    s_lshl_b32 s32, s6, 11
    s_add_u32 s32, s32, 16384
    v_add_u32 v7, s32, v7
    s_lshl_b32 s32, s6, 11
    s_add_u32 s33, s32, 24576
    v_lshl_add_u32 v66, v65, 5, v60
    v_lshlrev_b32 v8, 4, v66
    v_lshl_add_u32 v8, v67, 10, v8
    v_add_u32 v8, s33, v8
    v_lshlrev_b32 v9, 4, v0
    s_lshl_b32 s32, s6, 16
    s_lshl_b32 s33, s5, 8
    s_add_u32 s32, s32, s33
    v_lshlrev_b32 v10, 13, v61
    v_lshl_add_u32 v10, v60, 4, v10
    v_add_u32 v10, s32, v10
    s_lshl_b32 s32, s6, 9
    s_add_u32 s33, s32, 14336
    v_lshlrev_b32 v12, 7, v61
    v_lshl_add_u32 v12, v68, 4, v12
    v_add_u32 v12, s33, v12
    v_lshrrev_b32 v66, 2, v60
    v_and_b32 v67, 1, v60
    v_lshl_add_u32 v66, v66, 1, v67
    v_lshlrev_b32 v15, 7, v61
    v_lshl_add_u32 v15, v66, 4, v15
    s_lshl_b32 s32, s6, 9
    v_add_u32 v15, s32, v15
    s_lshl_b32 s32, s6, 15
    s_add_u32 s32, s32, 32768
    v_add_u32 v14, s32, v9
    v_mov_b32 v16, 0x3f803f80
    v_mov_b32 v17, 0x3f803f80
    v_mov_b32 v18, 0x3f803f80
    v_mov_b32 v19, 0x3f803f80
    v_mov_b32 v21, 0
    v_mov_b32 v23, 0
    v_mov_b32 v25, 0
    s_mov_b32 s40, 0x00ff00ff
    s_mov_b32 s41, 0x00ff00ff
    s_mov_b32 s60, 0x33333333
    s_mov_b32 s61, 0x33333333
    s_lshl_b32 s32, s4, 11
    s_add_u32 s32, s32, s5
    s_mul_i32 s42, s32, 24576
    s_lshl_b32 s43, s32, 12
    s_add_u32 s43, s43, 100663296
    s_lshl_b32 s44, s4, 15
    s_add_u32 s45, s44, 201326592
    s_add_u32 s46, s45, 8192
    s_add_u32 s47, s45, 16384
    s_lshl_b32 s48, s4, 20
    s_add_u32 s48, s48, 202375168
    s_mov_b32 s49, 0
    s_mov_b32 s58, 0
    s_lshl_b32 s50, s5, 13
    s_mov_b32 s51, 0
    s_mov_b32 s52, 1040356334
    s_mov_b32 s59, 0
    s_lshl_b32 s53, s32, 5
    s_add_u32 s53, s53, 205520896
    s_lshl_b32 s54, s32, 4
    s_lshl_b32 s33, s6, 2
    s_add_u32 s54, s54, s33
    s_add_u32 s54, s54, 205651968
    s_mov_b32 s38, 1040356334
    s_mov_b32 s39, 1040356334
    s_mov_b32 s55, 0
ch_123_p0_spin:
    v_and_b32 v26, 3, v0
    v_lshlrev_b32 v26, 2, v26
    buffer_load_dword v26, v26, s[8:11], s53 offen sc1
    s_waitcnt vmcnt(0)
    v_cmp_eq_u32 vcc, 0, v26
    s_cbranch_vccz ch_123_p0_ok
    s_add_u32 s55, s55, 1
    s_cmp_gt_u32 s55, 300000
    s_cbranch_scc1 ch_123_fail
    s_sleep 2
    s_branch ch_123_p0_spin
ch_123_p0_ok:
    s_lshl_b32 s34, s6, 11
    s_add_u32 m0, s34, 16384
    s_add_u32 s33, s42, s34
    s_add_u32 s33, s33, 8192
    buffer_load_dwordx4 v9, s[8:11], s33 offen sc1 lds
    buffer_load_dwordx4 v9, s[8:11], s33 offen offset:1024 sc1 lds
    v_bfe_u32 v60, v11, 5, 3
    v_lshrrev_b32 v61, 8, v11
    v_bfe_u32 v62, v11, 4, 1
    v_lshlrev_b32 v63, 10, v60
    v_lshl_add_u32 v63, v61, 5, v63
    v_lshl_add_u32 v63, v62, 4, v63
    s_lshl_b32 s32, s6, 8
    v_add_u32 v63, s32, v63
    buffer_load_dwordx4 v[20:23], v63, s[28:31], 0 offen
    buffer_load_dwordx4 v[84:87], v63, s[28:31], 0 offen offset:128
    s_waitcnt vmcnt(0)
    v_mov_b64 v[60:61], 0
    v_mov_b64 v[62:63], 0
    v_mov_b64 v[64:65], 0
    v_mov_b64 v[66:67], 0
    v_mov_b64 v[68:69], 0
    v_mov_b64 v[70:71], 0
    v_mov_b64 v[72:73], 0
    v_mov_b64 v[74:75], 0
    v_mov_b64 v[76:77], 0
    v_mov_b64 v[78:79], 0
    v_mov_b64 v[80:81], 0
    v_mov_b64 v[82:83], 0
    v_mov_b64 v[96:97], 0
    v_mov_b64 v[98:99], 0
    v_mov_b64 v[100:101], 0
    v_mov_b64 v[102:103], 0
    v_mov_b64 v[104:105], 0
    v_mov_b64 v[106:107], 0
    v_mov_b64 v[108:109], 0
    v_mov_b64 v[110:111], 0
    v_mov_b32 v27, 0
    s_mov_b32 s66, 211812352
    v_mov_b32 v88, 0
    v_mov_b32 v89, 0
    v_mov_b32 v90, 0
    v_mov_b32 v91, 0
    v_mov_b32 v92, 0
    v_mov_b32 v93, 0
    v_mov_b32 v94, 0
    v_mov_b32 v95, 0
    s_cmp_eq_u32 s6, 0
    s_cbranch_scc1 ch_123_ent0
    s_cmp_eq_u32 s6, 1
    s_cbranch_scc1 ch_123_ent1
    s_cmp_eq_u32 s6, 2
    s_cbranch_scc1 ch_123_ent2
    s_cmp_eq_u32 s6, 3
    s_cbranch_scc1 ch_123_ent3
ch_123_ent0:
    v_mov_b32 v28, v20
    v_mov_b32 v32, v84
    v_mov_b32 v29, v21
    v_mov_b32 v33, v85
    v_mov_b32 v30, v22
    v_mov_b32 v34, v86
    v_mov_b32 v31, v23
    v_mov_b32 v35, v87
    v_mov_b32 v21, 0
    v_mov_b32 v23, 0
    v_add_u32 v26, 0, v2
    ds_write_b128 v26, v[28:31]
    ds_write_b128 v26, v[32:35] offset:1024
ch_123_w0_go:
    v_smfmac_f32_16x16x64_bf16 v[60:63], v[28:31], a[0:7], v1
    s_and_b32 s57, s51, 1
    s_add_u32 s32, s53, 1024
    v_smfmac_f32_16x16x64_bf16 v[64:67], v[28:31], a[64:71], v1
    v_and_b32 v26, 3, v0
    v_smfmac_f32_16x16x64_bf16 v[68:71], v[28:31], a[128:135], v1
    v_smfmac_f32_16x16x64_bf16 v[72:75], v[28:31], a[192:199], v1
    v_smfmac_f32_16x16x64_bf16 v[60:63], v[32:35], a[8:15], v1
    v_smfmac_f32_16x16x64_bf16 v[64:67], v[32:35], a[72:79], v1
    s_waitcnt lgkmcnt(0)
    s_barrier
    ds_read_b128 v[36:39], v2 offset:2048
    ds_read_b128 v[40:43], v2 offset:3072
    v_smfmac_f32_16x16x64_bf16 v[68:71], v[32:35], a[136:143], v1
    ds_read_b128 v[44:47], v2 offset:4096
    ds_read_b128 v[48:51], v2 offset:5120
    v_smfmac_f32_16x16x64_bf16 v[72:75], v[32:35], a[200:207], v1
    ds_read_b128 v[52:55], v2 offset:6144
    ds_read_b128 v[56:59], v2 offset:7168
    v_smfmac_f32_16x16x64_bf16 v[76:79], v[28:31], v[128:135], v1
    v_lshlrev_b32 v26, 2, v26
    v_smfmac_f32_16x16x64_bf16 v[80:83], v[28:31], v[192:199], v1
    buffer_load_dword v26, v26, s[8:11], s32 offen sc1
    v_smfmac_f32_16x16x64_bf16 v[76:79], v[32:35], v[136:143], v1
    v_smfmac_f32_16x16x64_bf16 v[80:83], v[32:35], v[200:207], v1
    s_waitcnt lgkmcnt(5)
    v_smfmac_f32_16x16x64_bf16 v[60:63], v[36:39], a[16:23], v1
    s_mov_b32 m0, 24576
    s_add_u32 s33, s42, 16384
    v_smfmac_f32_16x16x64_bf16 v[64:67], v[36:39], a[80:87], v1
    s_waitcnt lgkmcnt(4)
    buffer_load_dwordx4 v9, s[8:11], s33 offen sc1 lds
    v_smfmac_f32_16x16x64_bf16 v[60:63], v[40:43], a[24:31], v1
    v_smfmac_f32_16x16x64_bf16 v[64:67], v[40:43], a[88:95], v1
    s_waitcnt lgkmcnt(3)
    v_smfmac_f32_16x16x64_bf16 v[60:63], v[44:47], a[32:39], v1
    v_smfmac_f32_16x16x64_bf16 v[64:67], v[44:47], a[96:103], v1
    s_waitcnt lgkmcnt(2)
    buffer_load_dwordx4 v9, s[8:11], s33 offen offset:1024 sc1 lds
    v_smfmac_f32_16x16x64_bf16 v[60:63], v[48:51], a[40:47], v1
    v_smfmac_f32_16x16x64_bf16 v[64:67], v[48:51], a[104:111], v1
    s_waitcnt lgkmcnt(1)
    v_smfmac_f32_16x16x64_bf16 v[60:63], v[52:55], a[48:55], v1
    v_smfmac_f32_16x16x64_bf16 v[64:67], v[52:55], a[112:119], v1
    s_waitcnt lgkmcnt(0)
    v_smfmac_f32_16x16x64_bf16 v[60:63], v[56:59], a[56:63], v1
    v_smfmac_f32_16x16x64_bf16 v[64:67], v[56:59], a[120:127], v1
    v_smfmac_f32_16x16x64_bf16 v[68:71], v[36:39], a[144:151], v1
    v_smfmac_f32_16x16x64_bf16 v[72:75], v[36:39], a[208:215], v1
    v_smfmac_f32_16x16x64_bf16 v[68:71], v[40:43], a[152:159], v1
    v_smfmac_f32_16x16x64_bf16 v[72:75], v[40:43], a[216:223], v1
    v_smfmac_f32_16x16x64_bf16 v[68:71], v[44:47], a[160:167], v1
    s_nop 1
    v_add_f32 v60, v60, v62
    v_smfmac_f32_16x16x64_bf16 v[72:75], v[44:47], a[224:231], v1
    v_add_f32 v61, v61, v63
    v_smfmac_f32_16x16x64_bf16 v[68:71], v[48:51], a[168:175], v1
    v_add_f32 v64, v64, v66
    v_smfmac_f32_16x16x64_bf16 v[72:75], v[48:51], a[232:239], v1
    v_add_f32 v65, v65, v67
    v_smfmac_f32_16x16x64_bf16 v[68:71], v[52:55], a[176:183], v1
    v_cvt_pk_bf16_f32 v60, v60, v61
    v_smfmac_f32_16x16x64_bf16 v[72:75], v[52:55], a[240:247], v1
    v_cvt_pk_bf16_f32 v61, v64, v65
    v_smfmac_f32_16x16x64_bf16 v[68:71], v[56:59], a[184:191], v1
    ds_write2_b32 v3, v60, v61 offset0:0 offset1:192
    ds_read_b64_tr_b16 v[84:85], v5
    v_smfmac_f32_16x16x64_bf16 v[72:75], v[56:59], a[248:255], v1
    ds_read_b64_tr_b16 v[86:87], v5 offset:384
    ds_read_b128 v[60:63], v7
    v_smfmac_f32_16x16x64_bf16 v[76:79], v[36:39], v[144:151], v1
    ds_read_b128 v[64:67], v7 offset:128
    v_smfmac_f32_16x16x64_bf16 v[80:83], v[36:39], v[208:215], v1
    v_smfmac_f32_16x16x64_bf16 v[76:79], v[40:43], v[152:159], v1
    s_nop 2
    v_add_f32 v68, v68, v70
    v_add_f32 v69, v69, v71
    v_add_f32 v72, v72, v74
    v_add_f32 v73, v73, v75
    v_cvt_pk_bf16_f32 v68, v68, v69
    v_cvt_pk_bf16_f32 v69, v72, v73
    ds_write2_b32 v4, v68, v69 offset0:0 offset1:192
    ds_read_b64_tr_b16 v[72:73], v6
    ds_read_b64_tr_b16 v[74:75], v6 offset:384
    s_waitcnt lgkmcnt(3)
    v_mfma_f32_16x16x32_bf16 v[88:91], v[60:63], v[84:87], 0
    v_mfma_f32_16x16x32_bf16 v[92:95], v[64:67], v[84:87], 0
    v_smfmac_f32_16x16x64_bf16 v[80:83], v[40:43], v[216:223], v1
    v_smfmac_f32_16x16x64_bf16 v[76:79], v[44:47], v[160:167], v1
    v_smfmac_f32_16x16x64_bf16 v[80:83], v[44:47], v[224:231], v1
    v_smfmac_f32_16x16x64_bf16 v[76:79], v[48:51], v[168:175], v1
    v_smfmac_f32_16x16x64_bf16 v[80:83], v[48:51], v[232:239], v1
    s_waitcnt lgkmcnt(0)
    v_mfma_f32_16x16x32_bf16 v[68:71], v[72:75], v[84:87], 0
    s_mov_b64 exec, s[60:61]
    buffer_store_dwordx4 v[72:75], v15, s[8:11], s43 offen sc1
    s_mov_b64 exec, -1
    v_smfmac_f32_16x16x64_bf16 v[76:79], v[52:55], v[176:183], v1
    s_xor_b32 s34, s49, 16384
    s_add_u32 s34, s34, 0
    v_cndmask_b32 v88, v92, v88, s[40:41]
    v_smfmac_f32_16x16x64_bf16 v[80:83], v[52:55], v[240:247], v1
    v_cndmask_b32 v89, v93, v89, s[40:41]
    v_smfmac_f32_16x16x64_bf16 v[76:79], v[56:59], v[184:191], v1
    v_cndmask_b32 v90, v94, v90, s[40:41]
    v_smfmac_f32_16x16x64_bf16 v[80:83], v[56:59], v[248:255], v1
    v_cndmask_b32 v91, v95, v91, s[40:41]
    v_add_u32 v92, s34, v9
    v_lshrrev_b32 v93, 1, v9
    v_add_u32 v93, s34, v93
    ds_write_b128 v92, v[88:91]
    ds_write_b64 v93, v[68:69] offset:1024
    v_subrev_u32 v94, 0, v92
    v_subrev_u32 v95, 0, v93
    v_add_f32 v76, v76, v78
    v_add_f32 v77, v77, v79
    v_add_f32 v80, v80, v82
    v_add_f32 v81, v81, v83
    v_cvt_pk_bf16_f32 v22, v76, v77
    v_cvt_pk_bf16_f32 v24, v80, v81
    v_mov_b32 v74, 0
    v_mov_b32 v75, 0
    v_mov_b32 v72, v22
    v_mov_b32 v73, v24
    s_add_u32 s32, s43, 2048
    v_permlane32_swap_b32 v72, v74
    v_permlane32_swap_b32 v73, v75
    s_nop 1
    v_permlane16_swap_b32 v72, v73
    v_permlane16_swap_b32 v74, v75
    s_mov_b32 exec_hi, 0
    buffer_store_dwordx4 v[72:75], v9, s[8:11], s32 offen sc1
    s_mov_b32 exec_hi, -1
    s_waitcnt vmcnt(4)
    v_cmp_eq_u32 vcc, 0, v26
    s_cmp_eq_u64 vcc, 0
    s_cselect_b32 s56, 1, 0
    s_mov_b32 s58, 1
    s_mov_b32 s35, s49
    s_add_u32 s67, s42, 786432
    s_cmp_ge_u32 s51, 63
    s_cselect_b32 s56, 0, s56
    s_cselect_b32 s58, 0, s58
    s_cmp_eq_u32 s56, 0
    s_cselect_b32 s58, s58, 2
    s_waitcnt lgkmcnt(0)
    s_barrier
    ds_read_b128 v[28:31], v94 offset:2048
    ds_read_b64 v[32:33], v95 offset:3072
    ds_read_b128 v[34:37], v94 offset:4096
    ds_read_b64 v[38:39], v95 offset:5120
    ds_read_b128 v[40:43], v94 offset:6144
    ds_read_b64 v[44:45], v95 offset:7168
    s_waitcnt vmcnt(2)
    ds_read_b128 v[52:55], v8
    ds_read_b128 v[56:59], v8 offset:256
    ds_read_b128 v[60:63], v14 offset:0
    ds_read_b128 v[64:67], v14 offset:1024
    s_waitcnt lgkmcnt(8)
    v_pk_add_f32 v[88:89], v[88:89], v[28:29]
    v_pk_add_f32 v[90:91], v[90:91], v[30:31]
    v_pk_add_f32 v[68:69], v[68:69], v[32:33]
    s_waitcnt lgkmcnt(4)
    v_pk_add_f32 v[34:35], v[34:35], v[40:41]
    v_pk_add_f32 v[36:37], v[36:37], v[42:43]
    v_pk_add_f32 v[38:39], v[38:39], v[44:45]
    v_pk_add_f32 v[88:89], v[88:89], v[34:35]
    v_pk_add_f32 v[90:91], v[90:91], v[36:37]
    v_pk_add_f32 v[68:69], v[68:69], v[38:39]
    v_max3_f32 v26, v88, v89, v90
    v_max3_f32 v26, v26, v91, v68
    v_max_f32 v26, v26, v69
    ds_read_b128 v[28:31], v14 offset:2048
    ds_read_b128 v[32:35], v14 offset:3072
    v_max_f32_dpp v26, v26, v26 row_ror:8 row_mask:0xf bank_mask:0xf
    v_mov_b32 v27, v26
    ds_read_b128 v[36:39], v14 offset:4096
    ds_read_b128 v[40:43], v14 offset:5120
    v_permlane32_swap_b32 v26, v27
    v_max_f32 v26, v26, v27
    v_mov_b32 v27, v26
    ds_read_b128 v[44:47], v14 offset:6144
    ds_read_b128 v[48:51], v14 offset:7168
    v_permlane16_swap_b32 v26, v27
    v_max_f32 v26, v26, v27
    v_mul_f32 v26, s52, v26
    v_mov_b32 v27, v26
    v_pk_fma_f32 v[88:89], v[88:89], s[38:39], v[26:27] neg_lo:[0,0,1] neg_hi:[0,0,1]
    v_pk_fma_f32 v[90:91], v[90:91], s[38:39], v[26:27] neg_lo:[0,0,1] neg_hi:[0,0,1]
    v_pk_fma_f32 v[68:69], v[68:69], s[38:39], v[26:27] neg_lo:[0,0,1] neg_hi:[0,0,1]
    v_exp_f32 v88, v88
    v_exp_f32 v89, v89
    v_exp_f32 v90, v90
    v_exp_f32 v91, v91
    v_exp_f32 v68, v68
    v_exp_f32 v69, v69
    v_cvt_pk_bf16_f32 v84, v88, v89
    v_cvt_pk_bf16_f32 v85, v90, v91
    v_cvt_pk_bf16_f32 v20, v68, v69
    v_mov_b32_dpp v86, v84 row_ror:8 row_mask:0xf bank_mask:0xf
    v_mov_b32_dpp v87, v85 row_ror:8 row_mask:0xf bank_mask:0xf
    s_waitcnt lgkmcnt(8)
    s_nop 0
    v_mfma_f32_16x16x32_bf16 v[76:79], v[16:19], v[84:87], 0
    v_mfma_f32_16x16x32_bf16 v[88:91], v[52:55], v[84:87], 0
    v_mfma_f32_16x16x32_bf16 v[92:95], v[56:59], v[84:87], 0
    v_mfma_f32_16x16x16_bf16 v[76:79], v[16:17], v[20:21], v[76:79]
    v_mfma_f32_16x16x16_bf16 v[88:91], v[22:23], v[20:21], v[88:91]
    v_mfma_f32_16x16x16_bf16 v[92:95], v[24:25], v[20:21], v[92:95]
    ds_read_b128 v[52:55], v14 offset:10240
    ds_read_b128 v[56:59], v14 offset:11264
    ds_read_b128 v[112:115], v14 offset:14336
    ds_read_b128 v[116:119], v14 offset:15360
    ds_read_b128 v[68:71], v14 offset:8192
    ds_read_b128 v[72:75], v14 offset:9216
    ds_read_b128 v[120:123], v14 offset:16384
    ds_read_b128 v[124:127], v14 offset:17408
    s_cmp_eq_u32 s58, 2
    s_cbranch_scc0 ch_123_w0_nk
    s_add_u32 m0, s35, 0
    s_add_u32 s33, s67, 8192
    buffer_load_dwordx4 v9, s[8:11], s33 offen sc1 lds
    buffer_load_dwordx4 v9, s[8:11], s33 offen offset:1024 sc1 lds
ch_123_w0_nk:
    v_rcp_f32 v26, v76
    s_nop 0
    v_mov_b32 v27, v26
    v_pk_mul_f32 v[88:89], v[88:89], v[26:27]
    v_pk_mul_f32 v[90:91], v[90:91], v[26:27]
    v_pk_mul_f32 v[92:93], v[92:93], v[26:27]
    v_pk_mul_f32 v[94:95], v[94:95], v[26:27]
    v_cvt_pk_bf16_f32 v80, v88, v89
    v_cvt_pk_bf16_f32 v81, v90, v91
    v_cvt_pk_bf16_f32 v82, v92, v93
    v_cvt_pk_bf16_f32 v83, v94, v95
    s_mov_b64 exec, s[40:41]
    ds_write_b128 v12, v[80:83]
    s_mov_b64 exec, -1
    ds_read_b128 v[84:87], v14 offset:12288
    ds_read_b128 v[88:91], v14 offset:13312
    s_waitcnt lgkmcnt(2)
    s_barrier
    ds_read_b128 v[76:79], v13
    ds_read_b128 v[80:83], v13 offset:1024
    s_waitcnt lgkmcnt(0)
    s_add_u32 s32, s48, 32768
    v_smfmac_f32_16x16x64_bf16 v[96:99], v[76:79], v[60:67], v1
    ds_read_b128 v[60:63], v14 offset:18432
    ds_read_b128 v[64:67], v14 offset:19456
    v_smfmac_f32_16x16x64_bf16 v[96:99], v[80:83], v[28:35], v1
    ds_read_b128 v[28:31], v14 offset:20480
    ds_read_b128 v[32:35], v14 offset:21504
    v_smfmac_f32_16x16x64_bf16 v[100:103], v[76:79], v[36:43], v1
    ds_read_b128 v[36:39], v14 offset:22528
    ds_read_b128 v[40:43], v14 offset:23552
    v_smfmac_f32_16x16x64_bf16 v[100:103], v[80:83], v[44:51], v1
    ds_read_b128 v[44:47], v14 offset:24576
    ds_read_b128 v[48:51], v14 offset:25600
    v_smfmac_f32_16x16x64_bf16 v[104:107], v[76:79], v[68:75], v1
    ds_read_b128 v[68:71], v14 offset:26624
    ds_read_b128 v[72:75], v14 offset:27648
    v_smfmac_f32_16x16x64_bf16 v[104:107], v[80:83], v[52:59], v1
    ds_read_b128 v[52:55], v14 offset:28672
    ds_read_b128 v[56:59], v14 offset:29696
    v_smfmac_f32_16x16x64_bf16 v[108:111], v[76:79], v[84:91], v1
    ds_read_b128 v[84:87], v14 offset:30720
    ds_read_b128 v[88:91], v14 offset:31744
    v_smfmac_f32_16x16x64_bf16 v[108:111], v[80:83], v[112:119], v1
    v_mov_b64 v[112:113], 0
    v_mov_b64 v[114:115], 0
    s_nop 1
    v_smfmac_f32_16x16x64_bf16 v[112:115], v[76:79], v[120:127], v1
    v_mov_b64 v[116:117], 0
    v_mov_b64 v[118:119], 0
    s_waitcnt lgkmcnt(12)
    v_smfmac_f32_16x16x64_bf16 v[112:115], v[80:83], v[60:67], v1
    v_mov_b64 v[120:121], 0
    v_mov_b64 v[122:123], 0
    s_waitcnt lgkmcnt(10)
    v_smfmac_f32_16x16x64_bf16 v[116:119], v[76:79], v[28:35], v1
    v_mov_b64 v[124:125], 0
    v_mov_b64 v[126:127], 0
    s_waitcnt lgkmcnt(8)
    v_smfmac_f32_16x16x64_bf16 v[116:119], v[80:83], v[36:43], v1
    v_add_f32 v96, v96, v98
    v_add_f32 v97, v97, v99
    s_waitcnt lgkmcnt(6)
    v_smfmac_f32_16x16x64_bf16 v[120:123], v[76:79], v[44:51], v1
    v_add_f32 v100, v100, v102
    v_add_f32 v101, v101, v103
    s_waitcnt lgkmcnt(4)
    v_smfmac_f32_16x16x64_bf16 v[120:123], v[80:83], v[68:75], v1
    v_add_f32 v104, v104, v106
    v_add_f32 v105, v105, v107
    s_waitcnt lgkmcnt(2)
    v_smfmac_f32_16x16x64_bf16 v[124:127], v[76:79], v[52:59], v1
    v_add_f32 v108, v108, v110
    v_add_f32 v109, v109, v111
    s_waitcnt lgkmcnt(0)
    v_smfmac_f32_16x16x64_bf16 v[124:127], v[80:83], v[84:91], v1
    v_cvt_pk_bf16_f32 v96, v96, v97
    v_cvt_pk_bf16_f32 v97, v100, v101
    v_cvt_pk_bf16_f32 v98, v104, v105
    v_cvt_pk_bf16_f32 v99, v108, v109
    s_nop 0
    v_permlane32_swap_b32 v96, v98
    v_permlane32_swap_b32 v97, v99
    s_nop 1
    v_permlane16_swap_b32 v96, v97
    v_permlane16_swap_b32 v98, v99
    v_bfi_b32 v96, 1, s57, v96
    buffer_store_dwordx4 v[96:99], v10, s[8:11], s48 offen
    v_add_f32 v112, v112, v114
    v_add_f32 v113, v113, v115
    v_add_f32 v116, v116, v118
    v_add_f32 v117, v117, v119
    v_add_f32 v120, v120, v122
    v_add_f32 v121, v121, v123
    v_add_f32 v124, v124, v126
    v_add_f32 v125, v125, v127
    v_cvt_pk_bf16_f32 v112, v112, v113
    v_cvt_pk_bf16_f32 v113, v116, v117
    v_cvt_pk_bf16_f32 v114, v120, v121
    v_cvt_pk_bf16_f32 v115, v124, v125
    s_nop 0
    v_permlane32_swap_b32 v112, v114
    v_permlane32_swap_b32 v113, v115
    s_nop 1
    v_permlane16_swap_b32 v112, v113
    v_permlane16_swap_b32 v114, v115
    v_bfi_b32 v112, 1, s57, v112
    buffer_store_dwordx4 v[112:115], v10, s[8:11], s32 offen
    s_add_u32 s51, s51, 1
    s_add_u32 s32, s48, s50
    s_add_u32 s33, s32, 4096
    s_mov_b32 s55, 0
    v_mov_b32 v100, s57
    v_and_b32 v96, 15, v0
    v_lshrrev_b32 v97, 1, v96
    v_and_b32 v103, 7, v96
    v_and_b32 v96, 1, v96
    v_lshlrev_b32 v96, 4, v96
    v_mov_b32 v98, 0x3f80
    v_lshlrev_b32 v98, v96, v98
    v_cmp_eq_u32 vcc, 0, v97
    v_cmp_eq_u32 s[56:57], 1, v97
    v_cmp_eq_u32 s[62:63], 2, v97
    v_cmp_eq_u32 s[64:65], 3, v97
    v_lshrrev_b32 v96, 4, v0
    v_lshlrev_b32 v102, 5, v103
    v_lshl_add_u32 v102, v96, 3, v102
    s_lshl_b32 s34, s5, 8
    v_add_u32 v102, s34, v102
    v_cndmask_b32 v104, 0, v98, vcc
    v_cndmask_b32 v105, 0, v98, s[56:57]
    v_cndmask_b32 v106, 0, v98, s[62:63]
    v_cndmask_b32 v107, 0, v98, s[64:65]
    v_mov_b64 v[60:61], 0
    v_mov_b64 v[62:63], 0
    v_mov_b64 v[64:65], 0
    v_mov_b64 v[66:67], 0
    v_mov_b64 v[68:69], 0
    v_mov_b64 v[70:71], 0
    v_mov_b64 v[72:73], 0
    v_mov_b64 v[74:75], 0
    v_mov_b64 v[76:77], 0
    v_mov_b64 v[78:79], 0
    v_mov_b64 v[80:81], 0
    v_mov_b64 v[82:83], 0
    v_mov_b64 v[108:109], 0
    v_mov_b64 v[110:111], 0
    s_sleep 2
ch_123_w0_rloop:
    buffer_load_dwordx4 v[28:31], v9, s[8:11], s32 offen offset:0 sc1
    buffer_load_dwordx4 v[32:35], v9, s[8:11], s32 offen offset:1024 sc1
    buffer_load_dwordx4 v[36:39], v9, s[8:11], s32 offen offset:2048 sc1
    buffer_load_dwordx4 v[40:43], v9, s[8:11], s32 offen offset:3072 sc1
    buffer_load_dwordx4 v[44:47], v9, s[8:11], s33 offen offset:0 sc1
    buffer_load_dwordx4 v[48:51], v9, s[8:11], s33 offen offset:1024 sc1
    buffer_load_dwordx4 v[52:55], v9, s[8:11], s33 offen offset:2048 sc1
    buffer_load_dwordx4 v[56:59], v9, s[8:11], s33 offen offset:3072 sc1
    s_waitcnt vmcnt(7)
    v_mfma_f32_16x16x32_bf16 v[96:99], v[28:31], v[104:107], 0
    v_xor_b32 v101, v28, v100
    s_waitcnt vmcnt(6)
    v_mfma_f32_16x16x32_bf16 v[96:99], v[32:35], v[104:107], v[96:99]
    v_bitop3_b32 v101, v32, v100, v101 bitop3:0xbe
    s_waitcnt vmcnt(5)
    v_mfma_f32_16x16x32_bf16 v[96:99], v[36:39], v[104:107], v[96:99]
    v_bitop3_b32 v101, v36, v100, v101 bitop3:0xbe
    s_waitcnt vmcnt(4)
    v_mfma_f32_16x16x32_bf16 v[96:99], v[40:43], v[104:107], v[96:99]
    v_bitop3_b32 v101, v40, v100, v101 bitop3:0xbe
    s_waitcnt vmcnt(3)
    v_mfma_f32_16x16x32_bf16 v[96:99], v[44:47], v[104:107], v[96:99]
    v_bitop3_b32 v101, v44, v100, v101 bitop3:0xbe
    s_waitcnt vmcnt(2)
    v_mfma_f32_16x16x32_bf16 v[96:99], v[48:51], v[104:107], v[96:99]
    v_bitop3_b32 v101, v48, v100, v101 bitop3:0xbe
    s_waitcnt vmcnt(1)
    v_mfma_f32_16x16x32_bf16 v[96:99], v[52:55], v[104:107], v[96:99]
    v_bitop3_b32 v101, v52, v100, v101 bitop3:0xbe
    s_waitcnt vmcnt(0)
    v_mfma_f32_16x16x32_bf16 v[96:99], v[56:59], v[104:107], v[96:99]
    v_bitop3_b32 v101, v56, v100, v101 bitop3:0xbe
    v_and_b32 v101, 1, v101
    v_cmp_ne_u32 vcc, 0, v101
    s_cbranch_vccz ch_123_w0_redok
    s_add_u32 s55, s55, 1
    s_cmp_gt_u32 s55, 300000
    s_cbranch_scc1 ch_123_fail
    s_branch ch_123_w0_rloop
ch_123_w0_redok:
    s_nop 2
    s_nop 0
    v_cvt_pk_bf16_f32 v100, v96, v97
    v_cvt_pk_bf16_f32 v101, v98, v99
    s_mov_b64 exec, s[40:41]
    v_min_u32 v100, 0xfffffffe, v100
    v_min_u32 v101, 0xfffffffe, v101
    buffer_store_dwordx2 v[100:101], v102, s[8:11], s46 offen
    s_barrier
    v_mov_b32 v100, -1
    v_mov_b32 v101, -1
    buffer_store_dwordx2 v[100:101], v102, s[8:11], s45 offen
    s_mov_b64 exec, -1
    s_cmp_ge_u32 s51, 64
    s_cbranch_scc1 ch_123_w0_done
    s_cmp_lg_u32 s58, 1
    s_cbranch_scc1 ch_123_w0_sk_n
    s_add_u32 s53, s53, 1024
    s_mov_b32 s55, 0
ch_123_w0_sk_spin:
    v_and_b32 v26, 3, v0
    v_lshlrev_b32 v26, 2, v26
    buffer_load_dword v26, v26, s[8:11], s53 offen sc1
    s_waitcnt vmcnt(0)
    v_cmp_eq_u32 vcc, 0, v26
    s_cbranch_vccz ch_123_w0_sk_ok
    s_add_u32 s55, s55, 1
    s_cmp_gt_u32 s55, 300000
    s_cbranch_scc1 ch_123_fail
    s_sleep 2
    s_branch ch_123_w0_sk_spin
ch_123_w0_sk_ok:
    s_sub_u32 s53, s53, 1024
    s_mov_b32 s35, s49
    s_add_u32 m0, s35, 0
    s_add_u32 s33, s67, 8192
    buffer_load_dwordx4 v9, s[8:11], s33 offen sc1 lds
    buffer_load_dwordx4 v9, s[8:11], s33 offen offset:1024 sc1 lds
ch_123_w0_sk_n:
    s_mov_b32 s37, s45
    s_mov_b32 s45, s46
    s_mov_b32 s46, s47
    s_mov_b32 s47, s37
    s_add_u32 s42, s42, 786432
    s_add_u32 s43, s43, 131072
    s_add_u32 s53, s53, 1024
    s_add_u32 s54, s54, 512
    s_xor_b32 s49, s49, 16384
    v_xor_b32 v2, 16384, v2
    v_xor_b32 v7, 16384, v7
    v_mov_b64 v[96:97], 0
    v_mov_b64 v[98:99], 0
    v_mov_b64 v[100:101], 0
    v_mov_b64 v[102:103], 0
    v_mov_b64 v[104:105], 0
    v_mov_b64 v[106:107], 0
    s_add_u32 s33, s45, 0
    s_add_u32 s34, s49, 0
    v_add_u32 v26, s34, v9
    s_mov_b32 s55, 0
    s_waitcnt lgkmcnt(0)
    s_sleep 1
ch_123_w0_aloop:
    buffer_load_dwordx4 v[28:31], v11, s[8:11], s33 offen offset:0 sc1
    buffer_load_dwordx4 v[32:35], v11, s[8:11], s33 offen offset:1024 sc1
    s_waitcnt vmcnt(1)
    v_max3_u32 v84, v28, v29, v30
    v_max_u32 v85, v31, v31
    s_waitcnt vmcnt(0)
    v_max3_u32 v84, v84, v32, v33
    v_max3_u32 v85, v85, v34, v35
    v_max_u32 v84, v84, v85
    v_cmp_eq_u32 vcc, -1, v84
    s_cbranch_vccz ch_123_w0_okA
    s_add_u32 s55, s55, 1
    s_cmp_gt_u32 s55, 300000
    s_cbranch_scc1 ch_123_fail
    s_branch ch_123_w0_aloop
ch_123_w0_okA:
    ds_write_b128 v26, v[28:31]
    ds_write_b128 v26, v[32:35] offset:1024
    s_branch ch_123_w0_go
ch_123_w0_done:
    s_branch ch_123_done
ch_123_ent1:
    v_mov_b32 v36, v20
    v_mov_b32 v40, v84
    v_mov_b32 v37, v21
    v_mov_b32 v41, v85
    v_mov_b32 v38, v22
    v_mov_b32 v42, v86
    v_mov_b32 v39, v23
    v_mov_b32 v43, v87
    v_mov_b32 v21, 0
    v_mov_b32 v23, 0
    v_add_u32 v26, 2048, v2
    ds_write_b128 v26, v[36:39]
    ds_write_b128 v26, v[40:43] offset:1024
ch_123_w1_go:
    v_smfmac_f32_16x16x64_bf16 v[60:63], v[36:39], a[16:23], v1
    s_and_b32 s57, s51, 1
    s_add_u32 s32, s53, 1024
    v_smfmac_f32_16x16x64_bf16 v[64:67], v[36:39], a[80:87], v1
    v_and_b32 v26, 3, v0
    v_smfmac_f32_16x16x64_bf16 v[68:71], v[36:39], a[144:151], v1
    v_smfmac_f32_16x16x64_bf16 v[72:75], v[36:39], a[208:215], v1
    v_smfmac_f32_16x16x64_bf16 v[60:63], v[40:43], a[24:31], v1
    v_smfmac_f32_16x16x64_bf16 v[64:67], v[40:43], a[88:95], v1
    s_waitcnt lgkmcnt(0)
    s_barrier
    ds_read_b128 v[28:31], v2 offset:0
    ds_read_b128 v[32:35], v2 offset:1024
    v_smfmac_f32_16x16x64_bf16 v[68:71], v[40:43], a[152:159], v1
    ds_read_b128 v[44:47], v2 offset:4096
    ds_read_b128 v[48:51], v2 offset:5120
    v_smfmac_f32_16x16x64_bf16 v[72:75], v[40:43], a[216:223], v1
    ds_read_b128 v[52:55], v2 offset:6144
    ds_read_b128 v[56:59], v2 offset:7168
    v_smfmac_f32_16x16x64_bf16 v[76:79], v[36:39], v[144:151], v1
    v_lshlrev_b32 v26, 2, v26
    v_smfmac_f32_16x16x64_bf16 v[80:83], v[36:39], v[208:215], v1
    v_smfmac_f32_16x16x64_bf16 v[76:79], v[40:43], v[152:159], v1
    buffer_load_dword v26, v26, s[8:11], s32 offen sc1
    v_smfmac_f32_16x16x64_bf16 v[80:83], v[40:43], v[216:223], v1
    s_waitcnt lgkmcnt(5)
    v_smfmac_f32_16x16x64_bf16 v[60:63], v[28:31], a[0:7], v1
    v_smfmac_f32_16x16x64_bf16 v[64:67], v[28:31], a[64:71], v1
    s_waitcnt lgkmcnt(4)
    s_mov_b32 m0, 26624
    s_add_u32 s33, s42, 18432
    v_smfmac_f32_16x16x64_bf16 v[60:63], v[32:35], a[8:15], v1
    buffer_load_dwordx4 v9, s[8:11], s33 offen sc1 lds
    v_smfmac_f32_16x16x64_bf16 v[64:67], v[32:35], a[72:79], v1
    s_waitcnt lgkmcnt(3)
    v_smfmac_f32_16x16x64_bf16 v[60:63], v[44:47], a[32:39], v1
    v_smfmac_f32_16x16x64_bf16 v[64:67], v[44:47], a[96:103], v1
    s_waitcnt lgkmcnt(2)
    v_smfmac_f32_16x16x64_bf16 v[60:63], v[48:51], a[40:47], v1
    buffer_load_dwordx4 v9, s[8:11], s33 offen offset:1024 sc1 lds
    v_smfmac_f32_16x16x64_bf16 v[64:67], v[48:51], a[104:111], v1
    s_waitcnt lgkmcnt(1)
    v_smfmac_f32_16x16x64_bf16 v[60:63], v[52:55], a[48:55], v1
    v_smfmac_f32_16x16x64_bf16 v[64:67], v[52:55], a[112:119], v1
    s_waitcnt lgkmcnt(0)
    v_smfmac_f32_16x16x64_bf16 v[60:63], v[56:59], a[56:63], v1
    v_smfmac_f32_16x16x64_bf16 v[64:67], v[56:59], a[120:127], v1
    v_smfmac_f32_16x16x64_bf16 v[68:71], v[28:31], a[128:135], v1
    v_smfmac_f32_16x16x64_bf16 v[72:75], v[28:31], a[192:199], v1
    v_smfmac_f32_16x16x64_bf16 v[68:71], v[32:35], a[136:143], v1
    v_smfmac_f32_16x16x64_bf16 v[72:75], v[32:35], a[200:207], v1
    v_smfmac_f32_16x16x64_bf16 v[68:71], v[44:47], a[160:167], v1
    s_nop 1
    v_add_f32 v60, v60, v62
    v_smfmac_f32_16x16x64_bf16 v[72:75], v[44:47], a[224:231], v1
    v_add_f32 v61, v61, v63
    v_smfmac_f32_16x16x64_bf16 v[68:71], v[48:51], a[168:175], v1
    v_add_f32 v64, v64, v66
    v_smfmac_f32_16x16x64_bf16 v[72:75], v[48:51], a[232:239], v1
    v_add_f32 v65, v65, v67
    v_smfmac_f32_16x16x64_bf16 v[68:71], v[52:55], a[176:183], v1
    v_cvt_pk_bf16_f32 v60, v60, v61
    v_smfmac_f32_16x16x64_bf16 v[72:75], v[52:55], a[240:247], v1
    v_cvt_pk_bf16_f32 v61, v64, v65
    v_smfmac_f32_16x16x64_bf16 v[68:71], v[56:59], a[184:191], v1
    ds_write2_b32 v3, v60, v61 offset0:0 offset1:192
    ds_read_b64_tr_b16 v[84:85], v5
    v_smfmac_f32_16x16x64_bf16 v[72:75], v[56:59], a[248:255], v1
    ds_read_b64_tr_b16 v[86:87], v5 offset:384
    ds_read_b128 v[60:63], v7
    v_smfmac_f32_16x16x64_bf16 v[76:79], v[28:31], v[128:135], v1
    ds_read_b128 v[64:67], v7 offset:128
    v_smfmac_f32_16x16x64_bf16 v[80:83], v[28:31], v[192:199], v1
    v_smfmac_f32_16x16x64_bf16 v[76:79], v[32:35], v[136:143], v1
    s_nop 2
    v_add_f32 v68, v68, v70
    v_add_f32 v69, v69, v71
    v_add_f32 v72, v72, v74
    v_add_f32 v73, v73, v75
    v_cvt_pk_bf16_f32 v68, v68, v69
    v_cvt_pk_bf16_f32 v69, v72, v73
    ds_write2_b32 v4, v68, v69 offset0:0 offset1:192
    ds_read_b64_tr_b16 v[72:73], v6
    ds_read_b64_tr_b16 v[74:75], v6 offset:384
    s_waitcnt lgkmcnt(3)
    v_mfma_f32_16x16x32_bf16 v[88:91], v[60:63], v[84:87], 0
    v_mfma_f32_16x16x32_bf16 v[92:95], v[64:67], v[84:87], 0
    v_smfmac_f32_16x16x64_bf16 v[80:83], v[32:35], v[200:207], v1
    v_smfmac_f32_16x16x64_bf16 v[76:79], v[44:47], v[160:167], v1
    v_smfmac_f32_16x16x64_bf16 v[80:83], v[44:47], v[224:231], v1
    v_smfmac_f32_16x16x64_bf16 v[76:79], v[48:51], v[168:175], v1
    v_smfmac_f32_16x16x64_bf16 v[80:83], v[48:51], v[232:239], v1
    s_waitcnt lgkmcnt(0)
    v_mfma_f32_16x16x32_bf16 v[68:71], v[72:75], v[84:87], 0
    s_mov_b64 exec, s[60:61]
    buffer_store_dwordx4 v[72:75], v15, s[8:11], s43 offen sc1
    s_mov_b64 exec, -1
    v_smfmac_f32_16x16x64_bf16 v[76:79], v[52:55], v[176:183], v1
    s_xor_b32 s34, s49, 16384
    s_add_u32 s34, s34, 2048
    v_cndmask_b32 v88, v92, v88, s[40:41]
    v_smfmac_f32_16x16x64_bf16 v[80:83], v[52:55], v[240:247], v1
    v_cndmask_b32 v89, v93, v89, s[40:41]
    v_smfmac_f32_16x16x64_bf16 v[76:79], v[56:59], v[184:191], v1
    v_cndmask_b32 v90, v94, v90, s[40:41]
    v_smfmac_f32_16x16x64_bf16 v[80:83], v[56:59], v[248:255], v1
    v_cndmask_b32 v91, v95, v91, s[40:41]
    v_add_u32 v92, s34, v9
    v_lshrrev_b32 v93, 1, v9
    v_add_u32 v93, s34, v93
    ds_write_b128 v92, v[88:91]
    ds_write_b64 v93, v[68:69] offset:1024
    v_subrev_u32 v94, 2048, v92
    v_subrev_u32 v95, 2048, v93
    v_add_f32 v76, v76, v78
    v_add_f32 v77, v77, v79
    v_add_f32 v80, v80, v82
    v_add_f32 v81, v81, v83
    v_cvt_pk_bf16_f32 v22, v76, v77
    v_cvt_pk_bf16_f32 v24, v80, v81
    v_mov_b32 v74, 0
    v_mov_b32 v75, 0
    v_mov_b32 v72, v22
    v_mov_b32 v73, v24
    s_add_u32 s32, s43, 2560
    v_permlane32_swap_b32 v72, v74
    v_permlane32_swap_b32 v73, v75
    s_nop 1
    v_permlane16_swap_b32 v72, v73
    v_permlane16_swap_b32 v74, v75
    s_mov_b32 exec_hi, 0
    buffer_store_dwordx4 v[72:75], v9, s[8:11], s32 offen sc1
    s_mov_b32 exec_hi, -1
    s_waitcnt vmcnt(4)
    v_cmp_eq_u32 vcc, 0, v26
    s_cmp_eq_u64 vcc, 0
    s_cselect_b32 s56, 1, 0
    s_mov_b32 s58, 1
    s_mov_b32 s35, s49
    s_add_u32 s67, s42, 786432
    s_cmp_ge_u32 s51, 63
    s_cselect_b32 s56, 0, s56
    s_cselect_b32 s58, 0, s58
    s_cmp_eq_u32 s56, 0
    s_cselect_b32 s58, s58, 2
    s_waitcnt lgkmcnt(0)
    s_barrier
    ds_read_b128 v[28:31], v94 offset:0
    ds_read_b64 v[32:33], v95 offset:1024
    ds_read_b128 v[34:37], v94 offset:4096
    ds_read_b64 v[38:39], v95 offset:5120
    ds_read_b128 v[40:43], v94 offset:6144
    ds_read_b64 v[44:45], v95 offset:7168
    s_waitcnt vmcnt(2)
    ds_read_b128 v[52:55], v8
    ds_read_b128 v[56:59], v8 offset:256
    ds_read_b128 v[60:63], v14 offset:0
    ds_read_b128 v[64:67], v14 offset:1024
    s_waitcnt lgkmcnt(8)
    v_pk_add_f32 v[88:89], v[88:89], v[28:29]
    v_pk_add_f32 v[90:91], v[90:91], v[30:31]
    v_pk_add_f32 v[68:69], v[68:69], v[32:33]
    s_waitcnt lgkmcnt(4)
    v_pk_add_f32 v[34:35], v[34:35], v[40:41]
    v_pk_add_f32 v[36:37], v[36:37], v[42:43]
    v_pk_add_f32 v[38:39], v[38:39], v[44:45]
    v_pk_add_f32 v[88:89], v[88:89], v[34:35]
    v_pk_add_f32 v[90:91], v[90:91], v[36:37]
    v_pk_add_f32 v[68:69], v[68:69], v[38:39]
    v_max3_f32 v26, v88, v89, v90
    v_max3_f32 v26, v26, v91, v68
    v_max_f32 v26, v26, v69
    ds_read_b128 v[28:31], v14 offset:2048
    ds_read_b128 v[32:35], v14 offset:3072
    v_max_f32_dpp v26, v26, v26 row_ror:8 row_mask:0xf bank_mask:0xf
    v_mov_b32 v27, v26
    ds_read_b128 v[36:39], v14 offset:4096
    ds_read_b128 v[40:43], v14 offset:5120
    v_permlane32_swap_b32 v26, v27
    v_max_f32 v26, v26, v27
    v_mov_b32 v27, v26
    ds_read_b128 v[44:47], v14 offset:6144
    ds_read_b128 v[48:51], v14 offset:7168
    v_permlane16_swap_b32 v26, v27
    v_max_f32 v26, v26, v27
    v_mul_f32 v26, s52, v26
    v_mov_b32 v27, v26
    v_pk_fma_f32 v[88:89], v[88:89], s[38:39], v[26:27] neg_lo:[0,0,1] neg_hi:[0,0,1]
    v_pk_fma_f32 v[90:91], v[90:91], s[38:39], v[26:27] neg_lo:[0,0,1] neg_hi:[0,0,1]
    v_pk_fma_f32 v[68:69], v[68:69], s[38:39], v[26:27] neg_lo:[0,0,1] neg_hi:[0,0,1]
    v_exp_f32 v88, v88
    v_exp_f32 v89, v89
    v_exp_f32 v90, v90
    v_exp_f32 v91, v91
    v_exp_f32 v68, v68
    v_exp_f32 v69, v69
    v_cvt_pk_bf16_f32 v84, v88, v89
    v_cvt_pk_bf16_f32 v85, v90, v91
    v_cvt_pk_bf16_f32 v20, v68, v69
    v_mov_b32_dpp v86, v84 row_ror:8 row_mask:0xf bank_mask:0xf
    v_mov_b32_dpp v87, v85 row_ror:8 row_mask:0xf bank_mask:0xf
    s_waitcnt lgkmcnt(8)
    s_nop 0
    v_mfma_f32_16x16x32_bf16 v[76:79], v[16:19], v[84:87], 0
    v_mfma_f32_16x16x32_bf16 v[88:91], v[52:55], v[84:87], 0
    v_mfma_f32_16x16x32_bf16 v[92:95], v[56:59], v[84:87], 0
    v_mfma_f32_16x16x16_bf16 v[76:79], v[16:17], v[20:21], v[76:79]
    v_mfma_f32_16x16x16_bf16 v[88:91], v[22:23], v[20:21], v[88:91]
    v_mfma_f32_16x16x16_bf16 v[92:95], v[24:25], v[20:21], v[92:95]
    ds_read_b128 v[52:55], v14 offset:10240
    ds_read_b128 v[56:59], v14 offset:11264
    ds_read_b128 v[112:115], v14 offset:14336
    ds_read_b128 v[116:119], v14 offset:15360
    ds_read_b128 v[68:71], v14 offset:8192
    ds_read_b128 v[72:75], v14 offset:9216
    ds_read_b128 v[120:123], v14 offset:16384
    ds_read_b128 v[124:127], v14 offset:17408
    s_cmp_eq_u32 s58, 2
    s_cbranch_scc0 ch_123_w1_nk
    s_add_u32 m0, s35, 2048
    s_add_u32 s33, s67, 10240
    buffer_load_dwordx4 v9, s[8:11], s33 offen sc1 lds
    buffer_load_dwordx4 v9, s[8:11], s33 offen offset:1024 sc1 lds
ch_123_w1_nk:
    v_rcp_f32 v26, v76
    s_nop 0
    v_mov_b32 v27, v26
    v_pk_mul_f32 v[88:89], v[88:89], v[26:27]
    v_pk_mul_f32 v[90:91], v[90:91], v[26:27]
    v_pk_mul_f32 v[92:93], v[92:93], v[26:27]
    v_pk_mul_f32 v[94:95], v[94:95], v[26:27]
    v_cvt_pk_bf16_f32 v80, v88, v89
    v_cvt_pk_bf16_f32 v81, v90, v91
    v_cvt_pk_bf16_f32 v82, v92, v93
    v_cvt_pk_bf16_f32 v83, v94, v95
    s_mov_b64 exec, s[40:41]
    ds_write_b128 v12, v[80:83]
    s_mov_b64 exec, -1
    ds_read_b128 v[84:87], v14 offset:12288
    ds_read_b128 v[88:91], v14 offset:13312
    s_waitcnt lgkmcnt(2)
    s_barrier
    ds_read_b128 v[76:79], v13
    ds_read_b128 v[80:83], v13 offset:1024
    s_waitcnt lgkmcnt(0)
    s_add_u32 s32, s48, 32768
    v_smfmac_f32_16x16x64_bf16 v[96:99], v[76:79], v[60:67], v1
    ds_read_b128 v[60:63], v14 offset:18432
    ds_read_b128 v[64:67], v14 offset:19456
    v_smfmac_f32_16x16x64_bf16 v[96:99], v[80:83], v[28:35], v1
    ds_read_b128 v[28:31], v14 offset:20480
    ds_read_b128 v[32:35], v14 offset:21504
    v_smfmac_f32_16x16x64_bf16 v[100:103], v[76:79], v[36:43], v1
    ds_read_b128 v[36:39], v14 offset:22528
    ds_read_b128 v[40:43], v14 offset:23552
    v_smfmac_f32_16x16x64_bf16 v[100:103], v[80:83], v[44:51], v1
    ds_read_b128 v[44:47], v14 offset:24576
    ds_read_b128 v[48:51], v14 offset:25600
    v_smfmac_f32_16x16x64_bf16 v[104:107], v[76:79], v[68:75], v1
    ds_read_b128 v[68:71], v14 offset:26624
    ds_read_b128 v[72:75], v14 offset:27648
    v_smfmac_f32_16x16x64_bf16 v[104:107], v[80:83], v[52:59], v1
    ds_read_b128 v[52:55], v14 offset:28672
    ds_read_b128 v[56:59], v14 offset:29696
    v_smfmac_f32_16x16x64_bf16 v[108:111], v[76:79], v[84:91], v1
    ds_read_b128 v[84:87], v14 offset:30720
    ds_read_b128 v[88:91], v14 offset:31744
    v_smfmac_f32_16x16x64_bf16 v[108:111], v[80:83], v[112:119], v1
    v_mov_b64 v[112:113], 0
    v_mov_b64 v[114:115], 0
    s_nop 1
    v_smfmac_f32_16x16x64_bf16 v[112:115], v[76:79], v[120:127], v1
    v_mov_b64 v[116:117], 0
    v_mov_b64 v[118:119], 0
    s_waitcnt lgkmcnt(12)
    v_smfmac_f32_16x16x64_bf16 v[112:115], v[80:83], v[60:67], v1
    v_mov_b64 v[120:121], 0
    v_mov_b64 v[122:123], 0
    s_waitcnt lgkmcnt(10)
    v_smfmac_f32_16x16x64_bf16 v[116:119], v[76:79], v[28:35], v1
    v_mov_b64 v[124:125], 0
    v_mov_b64 v[126:127], 0
    s_waitcnt lgkmcnt(8)
    v_smfmac_f32_16x16x64_bf16 v[116:119], v[80:83], v[36:43], v1
    v_add_f32 v96, v96, v98
    v_add_f32 v97, v97, v99
    s_waitcnt lgkmcnt(6)
    v_smfmac_f32_16x16x64_bf16 v[120:123], v[76:79], v[44:51], v1
    v_add_f32 v100, v100, v102
    v_add_f32 v101, v101, v103
    s_waitcnt lgkmcnt(4)
    v_smfmac_f32_16x16x64_bf16 v[120:123], v[80:83], v[68:75], v1
    v_add_f32 v104, v104, v106
    v_add_f32 v105, v105, v107
    s_waitcnt lgkmcnt(2)
    v_smfmac_f32_16x16x64_bf16 v[124:127], v[76:79], v[52:59], v1
    v_add_f32 v108, v108, v110
    v_add_f32 v109, v109, v111
    s_waitcnt lgkmcnt(0)
    v_smfmac_f32_16x16x64_bf16 v[124:127], v[80:83], v[84:91], v1
    v_cvt_pk_bf16_f32 v96, v96, v97
    v_cvt_pk_bf16_f32 v97, v100, v101
    v_cvt_pk_bf16_f32 v98, v104, v105
    v_cvt_pk_bf16_f32 v99, v108, v109
    s_nop 0
    v_permlane32_swap_b32 v96, v98
    v_permlane32_swap_b32 v97, v99
    s_nop 1
    v_permlane16_swap_b32 v96, v97
    v_permlane16_swap_b32 v98, v99
    v_bfi_b32 v96, 1, s57, v96
    buffer_store_dwordx4 v[96:99], v10, s[8:11], s48 offen
    v_add_f32 v112, v112, v114
    v_add_f32 v113, v113, v115
    v_add_f32 v116, v116, v118
    v_add_f32 v117, v117, v119
    v_add_f32 v120, v120, v122
    v_add_f32 v121, v121, v123
    v_add_f32 v124, v124, v126
    v_add_f32 v125, v125, v127
    v_cvt_pk_bf16_f32 v112, v112, v113
    v_cvt_pk_bf16_f32 v113, v116, v117
    v_cvt_pk_bf16_f32 v114, v120, v121
    v_cvt_pk_bf16_f32 v115, v124, v125
    s_nop 0
    v_permlane32_swap_b32 v112, v114
    v_permlane32_swap_b32 v113, v115
    s_nop 1
    v_permlane16_swap_b32 v112, v113
    v_permlane16_swap_b32 v114, v115
    v_bfi_b32 v112, 1, s57, v112
    buffer_store_dwordx4 v[112:115], v10, s[8:11], s32 offen
    s_add_u32 s51, s51, 1
    s_cmp_ge_u32 s51, 64
    s_cbranch_scc1 ch_123_w1_last
    s_cmp_lg_u32 s58, 1
    s_cbranch_scc1 ch_123_w1_sk_n
    s_add_u32 s53, s53, 1024
    s_mov_b32 s55, 0
ch_123_w1_sk_spin:
    v_and_b32 v26, 3, v0
    v_lshlrev_b32 v26, 2, v26
    buffer_load_dword v26, v26, s[8:11], s53 offen sc1
    s_waitcnt vmcnt(0)
    v_cmp_eq_u32 vcc, 0, v26
    s_cbranch_vccz ch_123_w1_sk_ok
    s_add_u32 s55, s55, 1
    s_cmp_gt_u32 s55, 300000
    s_cbranch_scc1 ch_123_fail
    s_sleep 2
    s_branch ch_123_w1_sk_spin
ch_123_w1_sk_ok:
    s_sub_u32 s53, s53, 1024
    s_mov_b32 s35, s49
    s_add_u32 m0, s35, 2048
    s_add_u32 s33, s67, 10240
    buffer_load_dwordx4 v9, s[8:11], s33 offen sc1 lds
    buffer_load_dwordx4 v9, s[8:11], s33 offen offset:1024 sc1 lds
ch_123_w1_sk_n:
    s_mov_b32 s37, s45
    s_mov_b32 s45, s46
    s_mov_b32 s46, s47
    s_mov_b32 s47, s37
    s_add_u32 s42, s42, 786432
    s_add_u32 s43, s43, 131072
    s_add_u32 s53, s53, 1024
    s_add_u32 s54, s54, 512
    s_xor_b32 s49, s49, 16384
    v_xor_b32 v2, 16384, v2
    v_xor_b32 v7, 16384, v7
    v_mov_b64 v[60:61], 0
    v_mov_b64 v[62:63], 0
    v_mov_b64 v[64:65], 0
    v_mov_b64 v[66:67], 0
    v_mov_b64 v[68:69], 0
    v_mov_b64 v[70:71], 0
    v_mov_b64 v[72:73], 0
    v_mov_b64 v[74:75], 0
    v_mov_b64 v[76:77], 0
    v_mov_b64 v[78:79], 0
    v_mov_b64 v[80:81], 0
    v_mov_b64 v[82:83], 0
    v_mov_b64 v[96:97], 0
    v_mov_b64 v[98:99], 0
    v_mov_b64 v[100:101], 0
    v_mov_b64 v[102:103], 0
    v_mov_b64 v[104:105], 0
    v_mov_b64 v[106:107], 0
    v_mov_b64 v[108:109], 0
    v_mov_b64 v[110:111], 0
    s_add_u32 s33, s45, 2048
    s_add_u32 s34, s49, 2048
    v_add_u32 v26, s34, v9
    s_mov_b32 s55, 0
    s_waitcnt lgkmcnt(0)
    s_waitcnt vmcnt(2)
    s_barrier
    s_sleep 3
ch_123_w1_aloop:
    buffer_load_dwordx4 v[36:39], v11, s[8:11], s33 offen offset:0 sc1
    buffer_load_dwordx4 v[40:43], v11, s[8:11], s33 offen offset:1024 sc1
    s_waitcnt vmcnt(1)
    v_max3_u32 v84, v36, v37, v38
    v_max_u32 v85, v39, v39
    s_waitcnt vmcnt(0)
    v_max3_u32 v84, v84, v40, v41
    v_max3_u32 v85, v85, v42, v43
    v_max_u32 v84, v84, v85
    v_cmp_eq_u32 vcc, -1, v84
    s_cbranch_vccz ch_123_w1_okA
    s_add_u32 s55, s55, 1
    s_cmp_gt_u32 s55, 300000
    s_cbranch_scc1 ch_123_fail
    s_branch ch_123_w1_aloop
ch_123_w1_okA:
    ds_write_b128 v26, v[36:39]
    ds_write_b128 v26, v[40:43] offset:1024
    s_branch ch_123_w1_go
ch_123_w1_last:
    s_waitcnt vmcnt(2)
    s_barrier
ch_123_w1_done:
    s_branch ch_123_done
ch_123_ent2:
    v_mov_b32 v44, v20
    v_mov_b32 v48, v84
    v_mov_b32 v45, v21
    v_mov_b32 v49, v85
    v_mov_b32 v46, v22
    v_mov_b32 v50, v86
    v_mov_b32 v47, v23
    v_mov_b32 v51, v87
    v_mov_b32 v21, 0
    v_mov_b32 v23, 0
    v_add_u32 v26, 4096, v2
    ds_write_b128 v26, v[44:47]
    ds_write_b128 v26, v[48:51] offset:1024
ch_123_w2_go:
    v_smfmac_f32_16x16x64_bf16 v[60:63], v[44:47], a[32:39], v1
    s_and_b32 s57, s51, 1
    s_add_u32 s32, s53, 1024
    v_smfmac_f32_16x16x64_bf16 v[64:67], v[44:47], a[96:103], v1
    v_and_b32 v26, 3, v0
    v_smfmac_f32_16x16x64_bf16 v[68:71], v[44:47], a[160:167], v1
    v_smfmac_f32_16x16x64_bf16 v[72:75], v[44:47], a[224:231], v1
    v_smfmac_f32_16x16x64_bf16 v[60:63], v[48:51], a[40:47], v1
    v_smfmac_f32_16x16x64_bf16 v[64:67], v[48:51], a[104:111], v1
    s_waitcnt lgkmcnt(0)
    s_barrier
    ds_read_b128 v[28:31], v2 offset:0
    ds_read_b128 v[32:35], v2 offset:1024
    v_smfmac_f32_16x16x64_bf16 v[68:71], v[48:51], a[168:175], v1
    ds_read_b128 v[36:39], v2 offset:2048
    ds_read_b128 v[40:43], v2 offset:3072
    v_smfmac_f32_16x16x64_bf16 v[72:75], v[48:51], a[232:239], v1
    ds_read_b128 v[52:55], v2 offset:6144
    ds_read_b128 v[56:59], v2 offset:7168
    v_smfmac_f32_16x16x64_bf16 v[76:79], v[44:47], v[160:167], v1
    v_lshlrev_b32 v26, 2, v26
    v_smfmac_f32_16x16x64_bf16 v[80:83], v[44:47], v[224:231], v1
    buffer_load_dword v26, v26, s[8:11], s32 offen sc1
    v_smfmac_f32_16x16x64_bf16 v[76:79], v[48:51], v[168:175], v1
    v_smfmac_f32_16x16x64_bf16 v[80:83], v[48:51], v[232:239], v1
    s_waitcnt lgkmcnt(5)
    v_smfmac_f32_16x16x64_bf16 v[60:63], v[28:31], a[0:7], v1
    v_smfmac_f32_16x16x64_bf16 v[64:67], v[28:31], a[64:71], v1
    s_waitcnt lgkmcnt(4)
    v_smfmac_f32_16x16x64_bf16 v[60:63], v[32:35], a[8:15], v1
    s_mov_b32 m0, 28672
    s_add_u32 s33, s42, 20480
    v_smfmac_f32_16x16x64_bf16 v[64:67], v[32:35], a[72:79], v1
    s_waitcnt lgkmcnt(3)
    buffer_load_dwordx4 v9, s[8:11], s33 offen sc1 lds
    v_smfmac_f32_16x16x64_bf16 v[60:63], v[36:39], a[16:23], v1
    v_smfmac_f32_16x16x64_bf16 v[64:67], v[36:39], a[80:87], v1
    s_waitcnt lgkmcnt(2)
    v_smfmac_f32_16x16x64_bf16 v[60:63], v[40:43], a[24:31], v1
    v_smfmac_f32_16x16x64_bf16 v[64:67], v[40:43], a[88:95], v1
    s_waitcnt lgkmcnt(1)
    buffer_load_dwordx4 v9, s[8:11], s33 offen offset:1024 sc1 lds
    v_smfmac_f32_16x16x64_bf16 v[60:63], v[52:55], a[48:55], v1
    v_smfmac_f32_16x16x64_bf16 v[64:67], v[52:55], a[112:119], v1
    s_waitcnt lgkmcnt(0)
    v_smfmac_f32_16x16x64_bf16 v[60:63], v[56:59], a[56:63], v1
    v_smfmac_f32_16x16x64_bf16 v[64:67], v[56:59], a[120:127], v1
    v_smfmac_f32_16x16x64_bf16 v[68:71], v[28:31], a[128:135], v1
    v_smfmac_f32_16x16x64_bf16 v[72:75], v[28:31], a[192:199], v1
    v_smfmac_f32_16x16x64_bf16 v[68:71], v[32:35], a[136:143], v1
    v_smfmac_f32_16x16x64_bf16 v[72:75], v[32:35], a[200:207], v1
    v_smfmac_f32_16x16x64_bf16 v[68:71], v[36:39], a[144:151], v1
    s_nop 1
    v_add_f32 v60, v60, v62
    v_smfmac_f32_16x16x64_bf16 v[72:75], v[36:39], a[208:215], v1
    v_add_f32 v61, v61, v63
    v_smfmac_f32_16x16x64_bf16 v[68:71], v[40:43], a[152:159], v1
    v_add_f32 v64, v64, v66
    v_smfmac_f32_16x16x64_bf16 v[72:75], v[40:43], a[216:223], v1
    v_add_f32 v65, v65, v67
    v_smfmac_f32_16x16x64_bf16 v[68:71], v[52:55], a[176:183], v1
    v_cvt_pk_bf16_f32 v60, v60, v61
    v_smfmac_f32_16x16x64_bf16 v[72:75], v[52:55], a[240:247], v1
    v_cvt_pk_bf16_f32 v61, v64, v65
    v_smfmac_f32_16x16x64_bf16 v[68:71], v[56:59], a[184:191], v1
    ds_write2_b32 v3, v60, v61 offset0:0 offset1:192
    ds_read_b64_tr_b16 v[84:85], v5
    v_smfmac_f32_16x16x64_bf16 v[72:75], v[56:59], a[248:255], v1
    ds_read_b64_tr_b16 v[86:87], v5 offset:384
    ds_read_b128 v[60:63], v7
    v_smfmac_f32_16x16x64_bf16 v[76:79], v[28:31], v[128:135], v1
    ds_read_b128 v[64:67], v7 offset:128
    v_smfmac_f32_16x16x64_bf16 v[80:83], v[28:31], v[192:199], v1
    v_smfmac_f32_16x16x64_bf16 v[76:79], v[32:35], v[136:143], v1
    s_nop 2
    v_add_f32 v68, v68, v70
    v_add_f32 v69, v69, v71
    v_add_f32 v72, v72, v74
    v_add_f32 v73, v73, v75
    v_cvt_pk_bf16_f32 v68, v68, v69
    v_cvt_pk_bf16_f32 v69, v72, v73
    ds_write2_b32 v4, v68, v69 offset0:0 offset1:192
    ds_read_b64_tr_b16 v[72:73], v6
    ds_read_b64_tr_b16 v[74:75], v6 offset:384
    s_waitcnt lgkmcnt(3)
    v_mfma_f32_16x16x32_bf16 v[88:91], v[60:63], v[84:87], 0
    v_mfma_f32_16x16x32_bf16 v[92:95], v[64:67], v[84:87], 0
    v_smfmac_f32_16x16x64_bf16 v[80:83], v[32:35], v[200:207], v1
    v_smfmac_f32_16x16x64_bf16 v[76:79], v[36:39], v[144:151], v1
    v_smfmac_f32_16x16x64_bf16 v[80:83], v[36:39], v[208:215], v1
    v_smfmac_f32_16x16x64_bf16 v[76:79], v[40:43], v[152:159], v1
    v_smfmac_f32_16x16x64_bf16 v[80:83], v[40:43], v[216:223], v1
    s_waitcnt lgkmcnt(0)
    v_mfma_f32_16x16x32_bf16 v[68:71], v[72:75], v[84:87], 0
    s_mov_b64 exec, s[60:61]
    buffer_store_dwordx4 v[72:75], v15, s[8:11], s43 offen sc1
    s_mov_b64 exec, -1
    v_smfmac_f32_16x16x64_bf16 v[76:79], v[52:55], v[176:183], v1
    s_xor_b32 s34, s49, 16384
    s_add_u32 s34, s34, 4096
    v_cndmask_b32 v88, v92, v88, s[40:41]
    v_smfmac_f32_16x16x64_bf16 v[80:83], v[52:55], v[240:247], v1
    v_cndmask_b32 v89, v93, v89, s[40:41]
    v_smfmac_f32_16x16x64_bf16 v[76:79], v[56:59], v[184:191], v1
    v_cndmask_b32 v90, v94, v90, s[40:41]
    v_smfmac_f32_16x16x64_bf16 v[80:83], v[56:59], v[248:255], v1
    v_cndmask_b32 v91, v95, v91, s[40:41]
    v_add_u32 v92, s34, v9
    v_lshrrev_b32 v93, 1, v9
    v_add_u32 v93, s34, v93
    ds_write_b128 v92, v[88:91]
    ds_write_b64 v93, v[68:69] offset:1024
    v_subrev_u32 v94, 4096, v92
    v_subrev_u32 v95, 4096, v93
    v_add_f32 v76, v76, v78
    v_add_f32 v77, v77, v79
    v_add_f32 v80, v80, v82
    v_add_f32 v81, v81, v83
    v_cvt_pk_bf16_f32 v22, v76, v77
    v_cvt_pk_bf16_f32 v24, v80, v81
    v_mov_b32 v74, 0
    v_mov_b32 v75, 0
    v_mov_b32 v72, v22
    v_mov_b32 v73, v24
    s_add_u32 s32, s43, 3072
    v_permlane32_swap_b32 v72, v74
    v_permlane32_swap_b32 v73, v75
    s_nop 1
    v_permlane16_swap_b32 v72, v73
    v_permlane16_swap_b32 v74, v75
    s_mov_b32 exec_hi, 0
    buffer_store_dwordx4 v[72:75], v9, s[8:11], s32 offen sc1
    s_mov_b32 exec_hi, -1
    s_waitcnt vmcnt(4)
    v_cmp_eq_u32 vcc, 0, v26
    s_cmp_eq_u64 vcc, 0
    s_cselect_b32 s56, 1, 0
    s_mov_b32 s58, 1
    s_mov_b32 s35, s49
    s_add_u32 s67, s42, 786432
    s_cmp_ge_u32 s51, 63
    s_cselect_b32 s56, 0, s56
    s_cselect_b32 s58, 0, s58
    s_cmp_eq_u32 s56, 0
    s_cselect_b32 s58, s58, 2
    s_waitcnt lgkmcnt(0)
    s_barrier
    ds_read_b128 v[28:31], v94 offset:0
    ds_read_b64 v[32:33], v95 offset:1024
    ds_read_b128 v[34:37], v94 offset:2048
    ds_read_b64 v[38:39], v95 offset:3072
    ds_read_b128 v[40:43], v94 offset:6144
    ds_read_b64 v[44:45], v95 offset:7168
    s_waitcnt vmcnt(2)
    ds_read_b128 v[52:55], v8
    ds_read_b128 v[56:59], v8 offset:256
    ds_read_b128 v[60:63], v14 offset:0
    ds_read_b128 v[64:67], v14 offset:1024
    s_waitcnt lgkmcnt(8)
    v_pk_add_f32 v[88:89], v[88:89], v[28:29]
    v_pk_add_f32 v[90:91], v[90:91], v[30:31]
    v_pk_add_f32 v[68:69], v[68:69], v[32:33]
    s_waitcnt lgkmcnt(4)
    v_pk_add_f32 v[34:35], v[34:35], v[40:41]
    v_pk_add_f32 v[36:37], v[36:37], v[42:43]
    v_pk_add_f32 v[38:39], v[38:39], v[44:45]
    v_pk_add_f32 v[88:89], v[88:89], v[34:35]
    v_pk_add_f32 v[90:91], v[90:91], v[36:37]
    v_pk_add_f32 v[68:69], v[68:69], v[38:39]
    v_max3_f32 v26, v88, v89, v90
    v_max3_f32 v26, v26, v91, v68
    v_max_f32 v26, v26, v69
    ds_read_b128 v[28:31], v14 offset:2048
    ds_read_b128 v[32:35], v14 offset:3072
    v_max_f32_dpp v26, v26, v26 row_ror:8 row_mask:0xf bank_mask:0xf
    v_mov_b32 v27, v26
    ds_read_b128 v[36:39], v14 offset:4096
    ds_read_b128 v[40:43], v14 offset:5120
    v_permlane32_swap_b32 v26, v27
    v_max_f32 v26, v26, v27
    v_mov_b32 v27, v26
    ds_read_b128 v[44:47], v14 offset:6144
    ds_read_b128 v[48:51], v14 offset:7168
    v_permlane16_swap_b32 v26, v27
    v_max_f32 v26, v26, v27
    v_mul_f32 v26, s52, v26
    v_mov_b32 v27, v26
    v_pk_fma_f32 v[88:89], v[88:89], s[38:39], v[26:27] neg_lo:[0,0,1] neg_hi:[0,0,1]
    v_pk_fma_f32 v[90:91], v[90:91], s[38:39], v[26:27] neg_lo:[0,0,1] neg_hi:[0,0,1]
    v_pk_fma_f32 v[68:69], v[68:69], s[38:39], v[26:27] neg_lo:[0,0,1] neg_hi:[0,0,1]
    v_exp_f32 v88, v88
    v_exp_f32 v89, v89
    v_exp_f32 v90, v90
    v_exp_f32 v91, v91
    v_exp_f32 v68, v68
    v_exp_f32 v69, v69
    v_cvt_pk_bf16_f32 v84, v88, v89
    v_cvt_pk_bf16_f32 v85, v90, v91
    v_cvt_pk_bf16_f32 v20, v68, v69
    v_mov_b32_dpp v86, v84 row_ror:8 row_mask:0xf bank_mask:0xf
    v_mov_b32_dpp v87, v85 row_ror:8 row_mask:0xf bank_mask:0xf
    s_waitcnt lgkmcnt(8)
    s_nop 0
    v_mfma_f32_16x16x32_bf16 v[76:79], v[16:19], v[84:87], 0
    v_mfma_f32_16x16x32_bf16 v[88:91], v[52:55], v[84:87], 0
    v_mfma_f32_16x16x32_bf16 v[92:95], v[56:59], v[84:87], 0
    v_mfma_f32_16x16x16_bf16 v[76:79], v[16:17], v[20:21], v[76:79]
    v_mfma_f32_16x16x16_bf16 v[88:91], v[22:23], v[20:21], v[88:91]
    v_mfma_f32_16x16x16_bf16 v[92:95], v[24:25], v[20:21], v[92:95]
    ds_read_b128 v[52:55], v14 offset:10240
    ds_read_b128 v[56:59], v14 offset:11264
    ds_read_b128 v[112:115], v14 offset:14336
    ds_read_b128 v[116:119], v14 offset:15360
    ds_read_b128 v[68:71], v14 offset:8192
    ds_read_b128 v[72:75], v14 offset:9216
    ds_read_b128 v[120:123], v14 offset:16384
    ds_read_b128 v[124:127], v14 offset:17408
    s_cmp_eq_u32 s58, 2
    s_cbranch_scc0 ch_123_w2_nk
    s_add_u32 m0, s35, 4096
    s_add_u32 s33, s67, 12288
    buffer_load_dwordx4 v9, s[8:11], s33 offen sc1 lds
    buffer_load_dwordx4 v9, s[8:11], s33 offen offset:1024 sc1 lds
ch_123_w2_nk:
    v_rcp_f32 v26, v76
    s_nop 0
    v_mov_b32 v27, v26
    v_pk_mul_f32 v[88:89], v[88:89], v[26:27]
    v_pk_mul_f32 v[90:91], v[90:91], v[26:27]
    v_pk_mul_f32 v[92:93], v[92:93], v[26:27]
    v_pk_mul_f32 v[94:95], v[94:95], v[26:27]
    v_cvt_pk_bf16_f32 v80, v88, v89
    v_cvt_pk_bf16_f32 v81, v90, v91
    v_cvt_pk_bf16_f32 v82, v92, v93
    v_cvt_pk_bf16_f32 v83, v94, v95
    s_mov_b64 exec, s[40:41]
    ds_write_b128 v12, v[80:83]
    s_mov_b64 exec, -1
    ds_read_b128 v[84:87], v14 offset:12288
    ds_read_b128 v[88:91], v14 offset:13312
    s_waitcnt lgkmcnt(2)
    s_barrier
    ds_read_b128 v[76:79], v13
    ds_read_b128 v[80:83], v13 offset:1024
    s_waitcnt lgkmcnt(0)
    s_add_u32 s32, s48, 32768
    v_smfmac_f32_16x16x64_bf16 v[96:99], v[76:79], v[60:67], v1
    ds_read_b128 v[60:63], v14 offset:18432
    ds_read_b128 v[64:67], v14 offset:19456
    v_smfmac_f32_16x16x64_bf16 v[96:99], v[80:83], v[28:35], v1
    ds_read_b128 v[28:31], v14 offset:20480
    ds_read_b128 v[32:35], v14 offset:21504
    v_smfmac_f32_16x16x64_bf16 v[100:103], v[76:79], v[36:43], v1
    ds_read_b128 v[36:39], v14 offset:22528
    ds_read_b128 v[40:43], v14 offset:23552
    v_smfmac_f32_16x16x64_bf16 v[100:103], v[80:83], v[44:51], v1
    ds_read_b128 v[44:47], v14 offset:24576
    ds_read_b128 v[48:51], v14 offset:25600
    v_smfmac_f32_16x16x64_bf16 v[104:107], v[76:79], v[68:75], v1
    ds_read_b128 v[68:71], v14 offset:26624
    ds_read_b128 v[72:75], v14 offset:27648
    v_smfmac_f32_16x16x64_bf16 v[104:107], v[80:83], v[52:59], v1
    ds_read_b128 v[52:55], v14 offset:28672
    ds_read_b128 v[56:59], v14 offset:29696
    v_smfmac_f32_16x16x64_bf16 v[108:111], v[76:79], v[84:91], v1
    ds_read_b128 v[84:87], v14 offset:30720
    ds_read_b128 v[88:91], v14 offset:31744
    v_smfmac_f32_16x16x64_bf16 v[108:111], v[80:83], v[112:119], v1
    v_mov_b64 v[112:113], 0
    v_mov_b64 v[114:115], 0
    s_nop 1
    v_smfmac_f32_16x16x64_bf16 v[112:115], v[76:79], v[120:127], v1
    v_mov_b64 v[116:117], 0
    v_mov_b64 v[118:119], 0
    s_waitcnt lgkmcnt(12)
    v_smfmac_f32_16x16x64_bf16 v[112:115], v[80:83], v[60:67], v1
    v_mov_b64 v[120:121], 0
    v_mov_b64 v[122:123], 0
    s_waitcnt lgkmcnt(10)
    v_smfmac_f32_16x16x64_bf16 v[116:119], v[76:79], v[28:35], v1
    v_mov_b64 v[124:125], 0
    v_mov_b64 v[126:127], 0
    s_waitcnt lgkmcnt(8)
    v_smfmac_f32_16x16x64_bf16 v[116:119], v[80:83], v[36:43], v1
    v_add_f32 v96, v96, v98
    v_add_f32 v97, v97, v99
    s_waitcnt lgkmcnt(6)
    v_smfmac_f32_16x16x64_bf16 v[120:123], v[76:79], v[44:51], v1
    v_add_f32 v100, v100, v102
    v_add_f32 v101, v101, v103
    s_waitcnt lgkmcnt(4)
    v_smfmac_f32_16x16x64_bf16 v[120:123], v[80:83], v[68:75], v1
    v_add_f32 v104, v104, v106
    v_add_f32 v105, v105, v107
    s_waitcnt lgkmcnt(2)
    v_smfmac_f32_16x16x64_bf16 v[124:127], v[76:79], v[52:59], v1
    v_add_f32 v108, v108, v110
    v_add_f32 v109, v109, v111
    s_waitcnt lgkmcnt(0)
    v_smfmac_f32_16x16x64_bf16 v[124:127], v[80:83], v[84:91], v1
    v_cvt_pk_bf16_f32 v96, v96, v97
    v_cvt_pk_bf16_f32 v97, v100, v101
    v_cvt_pk_bf16_f32 v98, v104, v105
    v_cvt_pk_bf16_f32 v99, v108, v109
    s_nop 0
    v_permlane32_swap_b32 v96, v98
    v_permlane32_swap_b32 v97, v99
    s_nop 1
    v_permlane16_swap_b32 v96, v97
    v_permlane16_swap_b32 v98, v99
    v_bfi_b32 v96, 1, s57, v96
    buffer_store_dwordx4 v[96:99], v10, s[8:11], s48 offen
    v_add_f32 v112, v112, v114
    v_add_f32 v113, v113, v115
    v_add_f32 v116, v116, v118
    v_add_f32 v117, v117, v119
    v_add_f32 v120, v120, v122
    v_add_f32 v121, v121, v123
    v_add_f32 v124, v124, v126
    v_add_f32 v125, v125, v127
    v_cvt_pk_bf16_f32 v112, v112, v113
    v_cvt_pk_bf16_f32 v113, v116, v117
    v_cvt_pk_bf16_f32 v114, v120, v121
    v_cvt_pk_bf16_f32 v115, v124, v125
    s_nop 0
    v_permlane32_swap_b32 v112, v114
    v_permlane32_swap_b32 v113, v115
    s_nop 1
    v_permlane16_swap_b32 v112, v113
    v_permlane16_swap_b32 v114, v115
    v_bfi_b32 v112, 1, s57, v112
    buffer_store_dwordx4 v[112:115], v10, s[8:11], s32 offen
    s_add_u32 s51, s51, 1
    s_cmp_ge_u32 s51, 64
    s_cbranch_scc1 ch_123_w2_last
    s_cmp_lg_u32 s58, 1
    s_cbranch_scc1 ch_123_w2_sk_n
    s_add_u32 s53, s53, 1024
    s_mov_b32 s55, 0
ch_123_w2_sk_spin:
    v_and_b32 v26, 3, v0
    v_lshlrev_b32 v26, 2, v26
    buffer_load_dword v26, v26, s[8:11], s53 offen sc1
    s_waitcnt vmcnt(0)
    v_cmp_eq_u32 vcc, 0, v26
    s_cbranch_vccz ch_123_w2_sk_ok
    s_add_u32 s55, s55, 1
    s_cmp_gt_u32 s55, 300000
    s_cbranch_scc1 ch_123_fail
    s_sleep 2
    s_branch ch_123_w2_sk_spin
ch_123_w2_sk_ok:
    s_sub_u32 s53, s53, 1024
    s_mov_b32 s35, s49
    s_add_u32 m0, s35, 4096
    s_add_u32 s33, s67, 12288
    buffer_load_dwordx4 v9, s[8:11], s33 offen sc1 lds
    buffer_load_dwordx4 v9, s[8:11], s33 offen offset:1024 sc1 lds
ch_123_w2_sk_n:
    s_mov_b32 s37, s45
    s_mov_b32 s45, s46
    s_mov_b32 s46, s47
    s_mov_b32 s47, s37
    s_add_u32 s42, s42, 786432
    s_add_u32 s43, s43, 131072
    s_add_u32 s53, s53, 1024
    s_add_u32 s54, s54, 512
    s_xor_b32 s49, s49, 16384
    v_xor_b32 v2, 16384, v2
    v_xor_b32 v7, 16384, v7
    v_mov_b64 v[60:61], 0
    v_mov_b64 v[62:63], 0
    v_mov_b64 v[64:65], 0
    v_mov_b64 v[66:67], 0
    v_mov_b64 v[68:69], 0
    v_mov_b64 v[70:71], 0
    v_mov_b64 v[72:73], 0
    v_mov_b64 v[74:75], 0
    v_mov_b64 v[76:77], 0
    v_mov_b64 v[78:79], 0
    v_mov_b64 v[80:81], 0
    v_mov_b64 v[82:83], 0
    v_mov_b64 v[96:97], 0
    v_mov_b64 v[98:99], 0
    v_mov_b64 v[100:101], 0
    v_mov_b64 v[102:103], 0
    v_mov_b64 v[104:105], 0
    v_mov_b64 v[106:107], 0
    v_mov_b64 v[108:109], 0
    v_mov_b64 v[110:111], 0
    s_add_u32 s33, s45, 4096
    s_add_u32 s34, s49, 4096
    v_add_u32 v26, s34, v9
    s_mov_b32 s55, 0
    s_waitcnt lgkmcnt(0)
    s_waitcnt vmcnt(2)
    s_barrier
    s_sleep 3
ch_123_w2_aloop:
    buffer_load_dwordx4 v[44:47], v11, s[8:11], s33 offen offset:0 sc1
    buffer_load_dwordx4 v[48:51], v11, s[8:11], s33 offen offset:1024 sc1
    s_waitcnt vmcnt(1)
    v_max3_u32 v84, v44, v45, v46
    v_max_u32 v85, v47, v47
    s_waitcnt vmcnt(0)
    v_max3_u32 v84, v84, v48, v49
    v_max3_u32 v85, v85, v50, v51
    v_max_u32 v84, v84, v85
    v_cmp_eq_u32 vcc, -1, v84
    s_cbranch_vccz ch_123_w2_okA
    s_add_u32 s55, s55, 1
    s_cmp_gt_u32 s55, 300000
    s_cbranch_scc1 ch_123_fail
    s_branch ch_123_w2_aloop
ch_123_w2_okA:
    ds_write_b128 v26, v[44:47]
    ds_write_b128 v26, v[48:51] offset:1024
    s_branch ch_123_w2_go
ch_123_w2_last:
    s_waitcnt vmcnt(2)
    s_barrier
ch_123_w2_done:
    s_branch ch_123_done
ch_123_ent3:
    v_mov_b32 v52, v20
    v_mov_b32 v56, v84
    v_mov_b32 v53, v21
    v_mov_b32 v57, v85
    v_mov_b32 v54, v22
    v_mov_b32 v58, v86
    v_mov_b32 v55, v23
    v_mov_b32 v59, v87
    v_mov_b32 v21, 0
    v_mov_b32 v23, 0
    v_add_u32 v26, 6144, v2
    ds_write_b128 v26, v[52:55]
    ds_write_b128 v26, v[56:59] offset:1024
ch_123_w3_go:
    v_smfmac_f32_16x16x64_bf16 v[60:63], v[52:55], a[48:55], v1
    s_and_b32 s57, s51, 1
    s_add_u32 s32, s53, 1024
    v_smfmac_f32_16x16x64_bf16 v[64:67], v[52:55], a[112:119], v1
    v_and_b32 v26, 3, v0
    v_smfmac_f32_16x16x64_bf16 v[68:71], v[52:55], a[176:183], v1
    v_smfmac_f32_16x16x64_bf16 v[72:75], v[52:55], a[240:247], v1
    v_smfmac_f32_16x16x64_bf16 v[60:63], v[56:59], a[56:63], v1
    v_smfmac_f32_16x16x64_bf16 v[64:67], v[56:59], a[120:127], v1
    s_waitcnt lgkmcnt(0)
    s_barrier
    ds_read_b128 v[28:31], v2 offset:0
    ds_read_b128 v[32:35], v2 offset:1024
    v_smfmac_f32_16x16x64_bf16 v[68:71], v[56:59], a[184:191], v1
    ds_read_b128 v[36:39], v2 offset:2048
    ds_read_b128 v[40:43], v2 offset:3072
    v_smfmac_f32_16x16x64_bf16 v[72:75], v[56:59], a[248:255], v1
    ds_read_b128 v[44:47], v2 offset:4096
    ds_read_b128 v[48:51], v2 offset:5120
    v_smfmac_f32_16x16x64_bf16 v[76:79], v[52:55], v[176:183], v1
    v_lshlrev_b32 v26, 2, v26
    v_smfmac_f32_16x16x64_bf16 v[80:83], v[52:55], v[240:247], v1
    v_smfmac_f32_16x16x64_bf16 v[76:79], v[56:59], v[184:191], v1
    buffer_load_dword v26, v26, s[8:11], s32 offen sc1
    v_smfmac_f32_16x16x64_bf16 v[80:83], v[56:59], v[248:255], v1
    s_waitcnt lgkmcnt(5)
    v_smfmac_f32_16x16x64_bf16 v[60:63], v[28:31], a[0:7], v1
    v_smfmac_f32_16x16x64_bf16 v[64:67], v[28:31], a[64:71], v1
    s_waitcnt lgkmcnt(4)
    v_smfmac_f32_16x16x64_bf16 v[60:63], v[32:35], a[8:15], v1
    v_smfmac_f32_16x16x64_bf16 v[64:67], v[32:35], a[72:79], v1
    s_waitcnt lgkmcnt(3)
    s_mov_b32 m0, 30720
    s_add_u32 s33, s42, 22528
    v_smfmac_f32_16x16x64_bf16 v[60:63], v[36:39], a[16:23], v1
    buffer_load_dwordx4 v9, s[8:11], s33 offen sc1 lds
    v_smfmac_f32_16x16x64_bf16 v[64:67], v[36:39], a[80:87], v1
    s_waitcnt lgkmcnt(2)
    v_smfmac_f32_16x16x64_bf16 v[60:63], v[40:43], a[24:31], v1
    v_smfmac_f32_16x16x64_bf16 v[64:67], v[40:43], a[88:95], v1
    s_waitcnt lgkmcnt(1)
    v_smfmac_f32_16x16x64_bf16 v[60:63], v[44:47], a[32:39], v1
    buffer_load_dwordx4 v9, s[8:11], s33 offen offset:1024 sc1 lds
    v_smfmac_f32_16x16x64_bf16 v[64:67], v[44:47], a[96:103], v1
    s_waitcnt lgkmcnt(0)
    v_smfmac_f32_16x16x64_bf16 v[60:63], v[48:51], a[40:47], v1
    v_smfmac_f32_16x16x64_bf16 v[64:67], v[48:51], a[104:111], v1
    v_smfmac_f32_16x16x64_bf16 v[68:71], v[28:31], a[128:135], v1
    v_smfmac_f32_16x16x64_bf16 v[72:75], v[28:31], a[192:199], v1
    v_smfmac_f32_16x16x64_bf16 v[68:71], v[32:35], a[136:143], v1
    v_smfmac_f32_16x16x64_bf16 v[72:75], v[32:35], a[200:207], v1
    v_smfmac_f32_16x16x64_bf16 v[68:71], v[36:39], a[144:151], v1
    s_nop 1
    v_add_f32 v60, v60, v62
    v_smfmac_f32_16x16x64_bf16 v[72:75], v[36:39], a[208:215], v1
    v_add_f32 v61, v61, v63
    v_smfmac_f32_16x16x64_bf16 v[68:71], v[40:43], a[152:159], v1
    v_add_f32 v64, v64, v66
    v_smfmac_f32_16x16x64_bf16 v[72:75], v[40:43], a[216:223], v1
    v_add_f32 v65, v65, v67
    v_smfmac_f32_16x16x64_bf16 v[68:71], v[44:47], a[160:167], v1
    v_cvt_pk_bf16_f32 v60, v60, v61
    v_smfmac_f32_16x16x64_bf16 v[72:75], v[44:47], a[224:231], v1
    v_cvt_pk_bf16_f32 v61, v64, v65
    v_smfmac_f32_16x16x64_bf16 v[68:71], v[48:51], a[168:175], v1
    ds_write2_b32 v3, v60, v61 offset0:0 offset1:192
    ds_read_b64_tr_b16 v[84:85], v5
    v_smfmac_f32_16x16x64_bf16 v[72:75], v[48:51], a[232:239], v1
    ds_read_b64_tr_b16 v[86:87], v5 offset:384
    ds_read_b128 v[60:63], v7
    v_smfmac_f32_16x16x64_bf16 v[76:79], v[28:31], v[128:135], v1
    ds_read_b128 v[64:67], v7 offset:128
    v_smfmac_f32_16x16x64_bf16 v[80:83], v[28:31], v[192:199], v1
    v_smfmac_f32_16x16x64_bf16 v[76:79], v[32:35], v[136:143], v1
    s_nop 2
    v_add_f32 v68, v68, v70
    v_add_f32 v69, v69, v71
    v_add_f32 v72, v72, v74
    v_add_f32 v73, v73, v75
    v_cvt_pk_bf16_f32 v68, v68, v69
    v_cvt_pk_bf16_f32 v69, v72, v73
    ds_write2_b32 v4, v68, v69 offset0:0 offset1:192
    ds_read_b64_tr_b16 v[72:73], v6
    ds_read_b64_tr_b16 v[74:75], v6 offset:384
    s_waitcnt lgkmcnt(3)
    v_mfma_f32_16x16x32_bf16 v[88:91], v[60:63], v[84:87], 0
    v_mfma_f32_16x16x32_bf16 v[92:95], v[64:67], v[84:87], 0
    v_smfmac_f32_16x16x64_bf16 v[80:83], v[32:35], v[200:207], v1
    v_smfmac_f32_16x16x64_bf16 v[76:79], v[36:39], v[144:151], v1
    v_smfmac_f32_16x16x64_bf16 v[80:83], v[36:39], v[208:215], v1
    v_smfmac_f32_16x16x64_bf16 v[76:79], v[40:43], v[152:159], v1
    v_smfmac_f32_16x16x64_bf16 v[80:83], v[40:43], v[216:223], v1
    s_waitcnt lgkmcnt(0)
    v_mfma_f32_16x16x32_bf16 v[68:71], v[72:75], v[84:87], 0
    s_mov_b64 exec, s[60:61]
    buffer_store_dwordx4 v[72:75], v15, s[8:11], s43 offen sc1
    s_mov_b64 exec, -1
    v_smfmac_f32_16x16x64_bf16 v[76:79], v[44:47], v[160:167], v1
    s_xor_b32 s34, s49, 16384
    s_add_u32 s34, s34, 6144
    v_cndmask_b32 v88, v92, v88, s[40:41]
    v_smfmac_f32_16x16x64_bf16 v[80:83], v[44:47], v[224:231], v1
    v_cndmask_b32 v89, v93, v89, s[40:41]
    v_smfmac_f32_16x16x64_bf16 v[76:79], v[48:51], v[168:175], v1
    v_cndmask_b32 v90, v94, v90, s[40:41]
    v_smfmac_f32_16x16x64_bf16 v[80:83], v[48:51], v[232:239], v1
    v_cndmask_b32 v91, v95, v91, s[40:41]
    v_add_u32 v92, s34, v9
    v_lshrrev_b32 v93, 1, v9
    v_add_u32 v93, s34, v93
    ds_write_b128 v92, v[88:91]
    ds_write_b64 v93, v[68:69] offset:1024
    v_subrev_u32 v94, 6144, v92
    v_subrev_u32 v95, 6144, v93
    v_add_f32 v76, v76, v78
    v_add_f32 v77, v77, v79
    v_add_f32 v80, v80, v82
    v_add_f32 v81, v81, v83
    v_cvt_pk_bf16_f32 v22, v76, v77
    v_cvt_pk_bf16_f32 v24, v80, v81
    v_mov_b32 v74, 0
    v_mov_b32 v75, 0
    v_mov_b32 v72, v22
    v_mov_b32 v73, v24
    s_add_u32 s32, s43, 3584
    v_permlane32_swap_b32 v72, v74
    v_permlane32_swap_b32 v73, v75
    s_nop 1
    v_permlane16_swap_b32 v72, v73
    v_permlane16_swap_b32 v74, v75
    s_mov_b32 exec_hi, 0
    buffer_store_dwordx4 v[72:75], v9, s[8:11], s32 offen sc1
    s_mov_b32 exec_hi, -1
    s_waitcnt vmcnt(4)
    v_cmp_eq_u32 vcc, 0, v26
    s_cmp_eq_u64 vcc, 0
    s_cselect_b32 s56, 1, 0
    s_mov_b32 s58, 1
    s_mov_b32 s35, s49
    s_add_u32 s67, s42, 786432
    s_cmp_ge_u32 s51, 63
    s_cselect_b32 s56, 0, s56
    s_cselect_b32 s58, 0, s58
    s_cmp_eq_u32 s56, 0
    s_cselect_b32 s58, s58, 2
    s_waitcnt lgkmcnt(0)
    s_barrier
    ds_read_b128 v[28:31], v94 offset:0
    ds_read_b64 v[32:33], v95 offset:1024
    ds_read_b128 v[34:37], v94 offset:2048
    ds_read_b64 v[38:39], v95 offset:3072
    ds_read_b128 v[40:43], v94 offset:4096
    ds_read_b64 v[44:45], v95 offset:5120
    s_waitcnt vmcnt(2)
    ds_read_b128 v[52:55], v8
    ds_read_b128 v[56:59], v8 offset:256
    ds_read_b128 v[60:63], v14 offset:0
    ds_read_b128 v[64:67], v14 offset:1024
    s_waitcnt lgkmcnt(8)
    v_pk_add_f32 v[88:89], v[88:89], v[28:29]
    v_pk_add_f32 v[90:91], v[90:91], v[30:31]
    v_pk_add_f32 v[68:69], v[68:69], v[32:33]
    s_waitcnt lgkmcnt(4)
    v_pk_add_f32 v[34:35], v[34:35], v[40:41]
    v_pk_add_f32 v[36:37], v[36:37], v[42:43]
    v_pk_add_f32 v[38:39], v[38:39], v[44:45]
    v_pk_add_f32 v[88:89], v[88:89], v[34:35]
    v_pk_add_f32 v[90:91], v[90:91], v[36:37]
    v_pk_add_f32 v[68:69], v[68:69], v[38:39]
    v_max3_f32 v26, v88, v89, v90
    v_max3_f32 v26, v26, v91, v68
    v_max_f32 v26, v26, v69
    ds_read_b128 v[28:31], v14 offset:2048
    ds_read_b128 v[32:35], v14 offset:3072
    v_max_f32_dpp v26, v26, v26 row_ror:8 row_mask:0xf bank_mask:0xf
    v_mov_b32 v27, v26
    ds_read_b128 v[36:39], v14 offset:4096
    ds_read_b128 v[40:43], v14 offset:5120
    v_permlane32_swap_b32 v26, v27
    v_max_f32 v26, v26, v27
    v_mov_b32 v27, v26
    ds_read_b128 v[44:47], v14 offset:6144
    ds_read_b128 v[48:51], v14 offset:7168
    v_permlane16_swap_b32 v26, v27
    v_max_f32 v26, v26, v27
    v_mul_f32 v26, s52, v26
    v_mov_b32 v27, v26
    v_pk_fma_f32 v[88:89], v[88:89], s[38:39], v[26:27] neg_lo:[0,0,1] neg_hi:[0,0,1]
    v_pk_fma_f32 v[90:91], v[90:91], s[38:39], v[26:27] neg_lo:[0,0,1] neg_hi:[0,0,1]
    v_pk_fma_f32 v[68:69], v[68:69], s[38:39], v[26:27] neg_lo:[0,0,1] neg_hi:[0,0,1]
    v_exp_f32 v88, v88
    v_exp_f32 v89, v89
    v_exp_f32 v90, v90
    v_exp_f32 v91, v91
    v_exp_f32 v68, v68
    v_exp_f32 v69, v69
    v_cvt_pk_bf16_f32 v84, v88, v89
    v_cvt_pk_bf16_f32 v85, v90, v91
    v_cvt_pk_bf16_f32 v20, v68, v69
    v_mov_b32_dpp v86, v84 row_ror:8 row_mask:0xf bank_mask:0xf
    v_mov_b32_dpp v87, v85 row_ror:8 row_mask:0xf bank_mask:0xf
    s_waitcnt lgkmcnt(8)
    s_nop 0
    v_mfma_f32_16x16x32_bf16 v[76:79], v[16:19], v[84:87], 0
    v_mfma_f32_16x16x32_bf16 v[88:91], v[52:55], v[84:87], 0
    v_mfma_f32_16x16x32_bf16 v[92:95], v[56:59], v[84:87], 0
    v_mfma_f32_16x16x16_bf16 v[76:79], v[16:17], v[20:21], v[76:79]
    v_mfma_f32_16x16x16_bf16 v[88:91], v[22:23], v[20:21], v[88:91]
    v_mfma_f32_16x16x16_bf16 v[92:95], v[24:25], v[20:21], v[92:95]
    ds_read_b128 v[52:55], v14 offset:10240
    ds_read_b128 v[56:59], v14 offset:11264
    ds_read_b128 v[112:115], v14 offset:14336
    ds_read_b128 v[116:119], v14 offset:15360
    ds_read_b128 v[68:71], v14 offset:8192
    ds_read_b128 v[72:75], v14 offset:9216
    ds_read_b128 v[120:123], v14 offset:16384
    ds_read_b128 v[124:127], v14 offset:17408
    s_cmp_eq_u32 s58, 2
    s_cbranch_scc0 ch_123_w3_nk
    s_add_u32 m0, s35, 6144
    s_add_u32 s33, s67, 14336
    buffer_load_dwordx4 v9, s[8:11], s33 offen sc1 lds
    buffer_load_dwordx4 v9, s[8:11], s33 offen offset:1024 sc1 lds
ch_123_w3_nk:
    v_rcp_f32 v26, v76
    s_nop 0
    v_mov_b32 v27, v26
    v_pk_mul_f32 v[88:89], v[88:89], v[26:27]
    v_pk_mul_f32 v[90:91], v[90:91], v[26:27]
    v_pk_mul_f32 v[92:93], v[92:93], v[26:27]
    v_pk_mul_f32 v[94:95], v[94:95], v[26:27]
    v_cvt_pk_bf16_f32 v80, v88, v89
    v_cvt_pk_bf16_f32 v81, v90, v91
    v_cvt_pk_bf16_f32 v82, v92, v93
    v_cvt_pk_bf16_f32 v83, v94, v95
    s_mov_b64 exec, s[40:41]
    ds_write_b128 v12, v[80:83]
    s_mov_b64 exec, -1
    ds_read_b128 v[84:87], v14 offset:12288
    ds_read_b128 v[88:91], v14 offset:13312
    s_waitcnt lgkmcnt(2)
    s_barrier
    ds_read_b128 v[76:79], v13
    ds_read_b128 v[80:83], v13 offset:1024
    s_waitcnt lgkmcnt(0)
    s_add_u32 s32, s48, 32768
    v_smfmac_f32_16x16x64_bf16 v[96:99], v[76:79], v[60:67], v1
    ds_read_b128 v[60:63], v14 offset:18432
    ds_read_b128 v[64:67], v14 offset:19456
    v_smfmac_f32_16x16x64_bf16 v[96:99], v[80:83], v[28:35], v1
    ds_read_b128 v[28:31], v14 offset:20480
    ds_read_b128 v[32:35], v14 offset:21504
    v_smfmac_f32_16x16x64_bf16 v[100:103], v[76:79], v[36:43], v1
    ds_read_b128 v[36:39], v14 offset:22528
    ds_read_b128 v[40:43], v14 offset:23552
    v_smfmac_f32_16x16x64_bf16 v[100:103], v[80:83], v[44:51], v1
    ds_read_b128 v[44:47], v14 offset:24576
    ds_read_b128 v[48:51], v14 offset:25600
    v_smfmac_f32_16x16x64_bf16 v[104:107], v[76:79], v[68:75], v1
    ds_read_b128 v[68:71], v14 offset:26624
    ds_read_b128 v[72:75], v14 offset:27648
    v_smfmac_f32_16x16x64_bf16 v[104:107], v[80:83], v[52:59], v1
    ds_read_b128 v[52:55], v14 offset:28672
    ds_read_b128 v[56:59], v14 offset:29696
    v_smfmac_f32_16x16x64_bf16 v[108:111], v[76:79], v[84:91], v1
    ds_read_b128 v[84:87], v14 offset:30720
    ds_read_b128 v[88:91], v14 offset:31744
    v_smfmac_f32_16x16x64_bf16 v[108:111], v[80:83], v[112:119], v1
    v_mov_b64 v[112:113], 0
    v_mov_b64 v[114:115], 0
    s_nop 1
    v_smfmac_f32_16x16x64_bf16 v[112:115], v[76:79], v[120:127], v1
    v_mov_b64 v[116:117], 0
    v_mov_b64 v[118:119], 0
    s_waitcnt lgkmcnt(12)
    v_smfmac_f32_16x16x64_bf16 v[112:115], v[80:83], v[60:67], v1
    v_mov_b64 v[120:121], 0
    v_mov_b64 v[122:123], 0
    s_waitcnt lgkmcnt(10)
    v_smfmac_f32_16x16x64_bf16 v[116:119], v[76:79], v[28:35], v1
    v_mov_b64 v[124:125], 0
    v_mov_b64 v[126:127], 0
    s_waitcnt lgkmcnt(8)
    v_smfmac_f32_16x16x64_bf16 v[116:119], v[80:83], v[36:43], v1
    v_add_f32 v96, v96, v98
    v_add_f32 v97, v97, v99
    s_waitcnt lgkmcnt(6)
    v_smfmac_f32_16x16x64_bf16 v[120:123], v[76:79], v[44:51], v1
    v_add_f32 v100, v100, v102
    v_add_f32 v101, v101, v103
    s_waitcnt lgkmcnt(4)
    v_smfmac_f32_16x16x64_bf16 v[120:123], v[80:83], v[68:75], v1
    v_add_f32 v104, v104, v106
    v_add_f32 v105, v105, v107
    s_waitcnt lgkmcnt(2)
    v_smfmac_f32_16x16x64_bf16 v[124:127], v[76:79], v[52:59], v1
    v_add_f32 v108, v108, v110
    v_add_f32 v109, v109, v111
    s_waitcnt lgkmcnt(0)
    v_smfmac_f32_16x16x64_bf16 v[124:127], v[80:83], v[84:91], v1
    v_cvt_pk_bf16_f32 v96, v96, v97
    v_cvt_pk_bf16_f32 v97, v100, v101
    v_cvt_pk_bf16_f32 v98, v104, v105
    v_cvt_pk_bf16_f32 v99, v108, v109
    s_nop 0
    v_permlane32_swap_b32 v96, v98
    v_permlane32_swap_b32 v97, v99
    s_nop 1
    v_permlane16_swap_b32 v96, v97
    v_permlane16_swap_b32 v98, v99
    v_bfi_b32 v96, 1, s57, v96
    buffer_store_dwordx4 v[96:99], v10, s[8:11], s48 offen
    v_add_f32 v112, v112, v114
    v_add_f32 v113, v113, v115
    v_add_f32 v116, v116, v118
    v_add_f32 v117, v117, v119
    v_add_f32 v120, v120, v122
    v_add_f32 v121, v121, v123
    v_add_f32 v124, v124, v126
    v_add_f32 v125, v125, v127
    v_cvt_pk_bf16_f32 v112, v112, v113
    v_cvt_pk_bf16_f32 v113, v116, v117
    v_cvt_pk_bf16_f32 v114, v120, v121
    v_cvt_pk_bf16_f32 v115, v124, v125
    s_nop 0
    v_permlane32_swap_b32 v112, v114
    v_permlane32_swap_b32 v113, v115
    s_nop 1
    v_permlane16_swap_b32 v112, v113
    v_permlane16_swap_b32 v114, v115
    v_bfi_b32 v112, 1, s57, v112
    buffer_store_dwordx4 v[112:115], v10, s[8:11], s32 offen
    s_add_u32 s51, s51, 1
    s_cmp_ge_u32 s51, 64
    s_cbranch_scc1 ch_123_w3_last
    s_cmp_lg_u32 s58, 1
    s_cbranch_scc1 ch_123_w3_sk_n
    s_add_u32 s53, s53, 1024
    s_mov_b32 s55, 0
ch_123_w3_sk_spin:
    v_and_b32 v26, 3, v0
    v_lshlrev_b32 v26, 2, v26
    buffer_load_dword v26, v26, s[8:11], s53 offen sc1
    s_waitcnt vmcnt(0)
    v_cmp_eq_u32 vcc, 0, v26
    s_cbranch_vccz ch_123_w3_sk_ok
    s_add_u32 s55, s55, 1
    s_cmp_gt_u32 s55, 300000
    s_cbranch_scc1 ch_123_fail
    s_sleep 2
    s_branch ch_123_w3_sk_spin
ch_123_w3_sk_ok:
    s_sub_u32 s53, s53, 1024
    s_mov_b32 s35, s49
    s_add_u32 m0, s35, 6144
    s_add_u32 s33, s67, 14336
    buffer_load_dwordx4 v9, s[8:11], s33 offen sc1 lds
    buffer_load_dwordx4 v9, s[8:11], s33 offen offset:1024 sc1 lds
ch_123_w3_sk_n:
    s_mov_b32 s37, s45
    s_mov_b32 s45, s46
    s_mov_b32 s46, s47
    s_mov_b32 s47, s37
    s_add_u32 s42, s42, 786432
    s_add_u32 s43, s43, 131072
    s_add_u32 s53, s53, 1024
    s_add_u32 s54, s54, 512
    s_xor_b32 s49, s49, 16384
    v_xor_b32 v2, 16384, v2
    v_xor_b32 v7, 16384, v7
    v_mov_b64 v[60:61], 0
    v_mov_b64 v[62:63], 0
    v_mov_b64 v[64:65], 0
    v_mov_b64 v[66:67], 0
    v_mov_b64 v[68:69], 0
    v_mov_b64 v[70:71], 0
    v_mov_b64 v[72:73], 0
    v_mov_b64 v[74:75], 0
    v_mov_b64 v[76:77], 0
    v_mov_b64 v[78:79], 0
    v_mov_b64 v[80:81], 0
    v_mov_b64 v[82:83], 0
    v_mov_b64 v[96:97], 0
    v_mov_b64 v[98:99], 0
    v_mov_b64 v[100:101], 0
    v_mov_b64 v[102:103], 0
    v_mov_b64 v[104:105], 0
    v_mov_b64 v[106:107], 0
    v_mov_b64 v[108:109], 0
    v_mov_b64 v[110:111], 0
    s_add_u32 s33, s45, 6144
    s_add_u32 s34, s49, 6144
    v_add_u32 v26, s34, v9
    s_mov_b32 s55, 0
    s_waitcnt lgkmcnt(0)
    s_waitcnt vmcnt(2)
    s_barrier
    s_sleep 3
ch_123_w3_aloop:
    buffer_load_dwordx4 v[52:55], v11, s[8:11], s33 offen offset:0 sc1
    buffer_load_dwordx4 v[56:59], v11, s[8:11], s33 offen offset:1024 sc1
    s_waitcnt vmcnt(1)
    v_max3_u32 v84, v52, v53, v54
    v_max_u32 v85, v55, v55
    s_waitcnt vmcnt(0)
    v_max3_u32 v84, v84, v56, v57
    v_max3_u32 v85, v85, v58, v59
    v_max_u32 v84, v84, v85
    v_cmp_eq_u32 vcc, -1, v84
    s_cbranch_vccz ch_123_w3_okA
    s_add_u32 s55, s55, 1
    s_cmp_gt_u32 s55, 300000
    s_cbranch_scc1 ch_123_fail
    s_branch ch_123_w3_aloop
ch_123_w3_okA:
    ds_write_b128 v26, v[52:55]
    ds_write_b128 v26, v[56:59] offset:1024
    v_mov_b32 v85, 1
    v_lshlrev_b32 v84, 2, v0
    s_sub_u32 s32, s54, 512+12
    s_mov_b64 exec, 15
    buffer_store_dword v85, v84, s[8:11], s32 offen sc1
    s_mov_b64 exec, -1
    s_branch ch_123_w3_go
ch_123_w3_last:
    s_waitcnt vmcnt(2)
    s_barrier
    v_mov_b32 v85, 1
    v_lshlrev_b32 v84, 2, v0
    s_sub_u32 s32, s54, 12
    s_mov_b64 exec, 15
    buffer_store_dword v85, v84, s[8:11], s32 offen sc1
    s_mov_b64 exec, -1
ch_123_w3_done:
    s_branch ch_123_done
ch_123_fail:
    s_waitcnt vmcnt(0)
    s_mov_b32 s59, 1
ch_123_done:
    s_waitcnt vmcnt(0)
LE_CH:
    s_cmp_eq_u32 s59, 0
    s_cbranch_scc1 L_CHend
    s_branch L_fail
L_CHend:
    s_endpgm
.section .rodata,"a"
.p2align 6

.amdhsa_kernel interleave_layers__sliding_block__memory_aug_recurrent_mem_tr__prompt_kernel
  .amdhsa_next_free_vgpr 512
  .amdhsa_next_free_sgpr 102
  .amdhsa_accum_offset 256
  .amdhsa_group_segment_fixed_size 0
  .amdhsa_kernarg_size 104
  .amdhsa_user_sgpr_count 2
  .amdhsa_user_sgpr_kernarg_segment_ptr 1
  .amdhsa_system_sgpr_workgroup_id_x 1
.end_amdhsa_kernel
```
